```python
import torch

def _softmax(x, axis=-1):
    return torch.softmax(x, dim=axis)
def _gelu(x):
    return torch.nn.functional.gelu(x, approximate="tanh")
def _silu(x):
    return torch.nn.functional.silu(x)
def _sigmoid(x):
    return torch.sigmoid(x)
def _layernorm(x, axis=-1, eps=1e-5):
    m = x.mean(dim=axis, keepdim=True)
    v = x.var(dim=axis, keepdim=True, unbiased=False)
    return (x - m) / torch.sqrt(v + eps)
def _scatter_add(tgt, idx, src, axis=0):
    return tgt.clone().index_add_(axis, idx, src)
def _segment_sum(src, seg, n):
    out = torch.zeros((n,) + src.shape[1:], dtype=src.dtype)
    return out.index_add_(0, seg, src)
def _pad(x, pw):
    flat = tuple(v for pair in reversed(pw) for v in pair)
    return torch.nn.functional.pad(x, flat)

kernel_name = 'interleave_layers__linear_attn_block__dense_activation_squared_relu__prompt'

def setup_inputs():

    _w = (lambda a: (lambda t: t.to(torch.bfloat16) if t.is_floating_point() else t)(torch.as_tensor(a)))
    def _A_setup():
        B, S, D = 1, 2048, 640
        return {
            "x": _w((lambda *s: torch.randn(*s, dtype=torch.bfloat16) * 0.05)(B, S, D)),
            "wqkv": _w((lambda *s: torch.randn(*s, dtype=torch.bfloat16) * 0.1)(D, 3 * D)),
            "wo": _w((lambda *s: torch.randn(*s, dtype=torch.bfloat16) * 0.05)(D, D)),
        }
    _A_in = _A_setup()

    def _B_setup():
        B, S, D, F = 1, 2048, 640, 1728
        return {
            "x": _w((lambda *s: torch.randn(*s, dtype=torch.bfloat16) * 0.05)(B, S, D)),
            "w1": _w((lambda *s: torch.randn(*s, dtype=torch.bfloat16) * 0.05)(D, F)),
            "b1": _w((lambda *s: torch.randn(*s, dtype=torch.bfloat16) * 0.2)(F)),
            "w2": _w((lambda *s: torch.randn(*s, dtype=torch.bfloat16) * 0.05)(F, D)),
            "b2": _w((lambda *s: torch.randn(*s, dtype=torch.bfloat16) * 0.8)(D)),
        }
    _B_in = _B_setup()

    return {
        "A_x": _A_in["x"],
        "A_wqkv": _A_in["wqkv"],
        "A_wo": _A_in["wo"],
        "B_x": _B_in["x"],
        "B_w1": _B_in["w1"],
        "B_b1": _B_in["b1"],
        "B_w2": _B_in["w2"],
        "B_b2": _B_in["b2"],
    }

def reference(A_x, A_wqkv, A_wo, B_x, B_w1, B_b1, B_w2, B_b2):
    def _A_ref(x, wqkv, wo):
        B, S, D = x.shape
        H = 32; Dh = D // H
        qkv = (lambda x, *d: x.permute(*d))((x @ wqkv).reshape(B, S, 3, H, Dh), 2, 0, 3, 1, 4)
        q, k, v = qkv[0], qkv[1], qkv[2]
        phi = lambda t: torch.where(t > 0, t + 1, torch.exp(t)) + 1e-6
        pq, pk = phi(q), phi(k)
        kv = torch.einsum("bhsd,bhse->bhde", pk, v)
        z = torch.einsum("bhsd->bhd", pk)
        num = torch.einsum("bhqd,bhde->bhqe", pq, kv)
        den = torch.einsum("bhqd,bhd->bhq", pq, z)[..., None] + 1e-6
        o = num / den
        return (lambda x, *d: x.permute(*d))(o, 0, 2, 1, 3).reshape(B, S, D) @ wo

    def _B_ref(x, w1, b1, w2, b2):
        h = torch.einsum("bsd,df->bsf", x, w1) + b1
        zero = torch.zeros_like(h)
        r = torch.where(h > zero, h, zero)
        h = r * r
        out = torch.einsum("bsf,fd->bsd", h, w2) + b2
        return out

    x = A_x
    x = x + _A_ref(_layernorm(x, axis=-1), A_wqkv, A_wo)
    x = x + _B_ref(_layernorm(x, axis=-1), B_w1, B_b1, B_w2, B_b2)
    x = x + _A_ref(_layernorm(x, axis=-1), A_wqkv, A_wo)
    x = x + _B_ref(_layernorm(x, axis=-1), B_w1, B_b1, B_w2, B_b2)
    return x
```

```asm
; @launch grid=(256,1,1) block=(256,1,1) lds=163840
.amdgcn_target "amdgcn-amd-amdhsa--gfx950"
.text
.globl interleave_layers__linear_attn_block__dense_activation_squared_relu__prompt_kernel
.p2align 8
.type interleave_layers__linear_attn_block__dense_activation_squared_relu__prompt_kernel,@function
interleave_layers__linear_attn_block__dense_activation_squared_relu__prompt_kernel:
    s_cmp_ge_u32 s2, 256
    s_cbranch_scc1 L_exit
    s_load_dwordx4 s[64:67], s[0:1], 0
    s_load_dwordx2 s[76:77], s[0:1], 16
    s_load_dwordx4 s[80:83], s[0:1], 32
    s_load_dwordx4 s[84:87], s[0:1], 48
    s_load_dwordx2 s[54:55], s[0:1], 64
    s_load_dwordx2 s[52:53], s[0:1], 80
    s_getpc_b64 s[40:41]
S_pc:
    s_lshr_b32 s36, s2, 3
    s_and_b32 s36, s36, 7
    s_lshl_b32 s36, s36, 10
    v_lshrrev_b32 v36, 5, v0
    v_lshlrev_b32 v36, 7, v36
    v_add_u32 v36, s36, v36
    global_load_dword v239, v36, s[40:41]
    s_lshr_b32 s36, s2, 3
    s_lshl_b32 s36, s36, 11
    s_add_u32 s36, s36, 8192
    v_lshrrev_b32 v37, 4, v0
    v_lshlrev_b32 v37, 7, v37
    v_add_u32_e64 v37, s36, v37
    v_min_u32 v37, L_exit-S_pc, v37
    global_load_dword v229, v37, s[40:41]
    v_lshrrev_b32 v230, 6, v0
    v_and_b32 v231, 63, v0
    v_readfirstlane_b32 s16, v230
    v_and_b32 v232, 15, v231
    v_lshrrev_b32 v233, 4, v231
    v_lshlrev_b32 v1, 4, v231
    v_lshlrev_b32 v2, 2, v231
    v_lshrrev_b32 v236, 2, v232
    v_and_b32 v237, 3, v232
    v_mov_b32 v238, v0
    s_and_b32 s17, s2, 7
    s_lshl_b32 s17, s17, 1
    s_lshr_b32 s18, s2, 7
    s_add_u32 s17, s17, s18
    s_lshr_b32 s18, s2, 3
    s_and_b32 s18, s18, 15
    s_lshl_b32 s20, s17, 3
    s_add_u32 s20, s20, s18
    s_sub_u32 s21, s20, 8
    s_add_u32 s47, s20, 128
    s_cmp_ge_u32 s18, 8
    s_cselect_b32 s47, s21, s47
    s_mov_b32 s6, 268435456
    s_mov_b32 s7, 0x20000
    s_mov_b32 s15, 0x20000
    s_mov_b32 s71, 0x20000
    s_mov_b32 s3, 20910080
    s_waitcnt lgkmcnt(0)
    s_mov_b32 s4, s52
    s_mov_b32 s5, s53
    s_load_dword s39, s[52:53], s3
    s_mov_b32 s12, s64
    s_mov_b32 s13, s65
    s_mov_b32 s14, 2621440
    s_lshl_b32 s36, s18, 2
    s_add_u32 s36, s36, s16
    s_mul_i32 s37, s17, 163840
    s_mul_i32 s36, s36, 2560
    s_add_u32 s37, s37, s36
    v_min_u32 v36, 19, v231
    v_lshlrev_b32 v36, 7, v36
    buffer_load_dword v225, v36, s[12:15], s37 offen
    s_cmp_lt_u32 s18, 8
    s_cselect_b32 s21, 120, s21
    s_mov_b32 s12, s66
    s_mov_b32 s13, s67
    s_mov_b32 s14, 2457600
    s_cmp_ge_u32 s21, 120
    s_cbranch_scc1 S_a_done
    s_sub_u32 s23, s21, 80
    s_lshr_b32 s22, s21, 2
    s_and_b32 s24, s21, 3
    s_mul_i32 s26, s24, 320
    s_add_u32 s26, s26, 1280
    s_lshr_b32 s27, s23, 1
    s_and_b32 s23, s23, 1
    s_mul_i32 s28, s23, 640
    s_cmp_ge_u32 s21, 80
    s_cselect_b32 s22, s27, s22
    s_cselect_b32 s24, s23, s24
    s_cselect_b32 s26, s28, s26
    s_cselect_b32 s27, 0, 960
    s_lshl_b32 s28, s22, 2
    s_add_u32 s28, s28, s16
    s_mul_i32 s28, s28, 30720
    s_add_u32 s26, s26, s28
    s_mul_i32 s42, s16, 5120
    s_add_u32 s42, s42, 0
    v_add_u32_e64 v36, 0, v231
    v_mul_u32_u24 v37, 1639, v36
    v_lshrrev_b32 v37, 16, v37
    v_mul_u32_u24 v38, 40, v37
    v_sub_u32_e64 v36, v36, v38
    v_mul_u32_u24 v37, 3840, v37
    v_cmp_le_u32 vcc, 20, v36
    v_lshl_add_u32 v40, v36, 4, v37
    v_add_u32 v38, s27, v40
    v_cndmask_b32 v40, v40, v38, vcc
    s_mov_b32 m0, s42
    s_add_u32 s42, s42, 1024
    buffer_load_dwordx4 v40, s[12:15], s26 offen lds
    v_add_u32_e64 v36, 64, v231
    v_mul_u32_u24 v37, 1639, v36
    v_lshrrev_b32 v37, 16, v37
    v_mul_u32_u24 v38, 40, v37
    v_sub_u32_e64 v36, v36, v38
    v_mul_u32_u24 v37, 3840, v37
    v_cmp_le_u32 vcc, 20, v36
    v_lshl_add_u32 v41, v36, 4, v37
    v_add_u32 v38, s27, v41
    v_cndmask_b32 v41, v41, v38, vcc
    s_mov_b32 m0, s42
    s_add_u32 s42, s42, 1024
    buffer_load_dwordx4 v41, s[12:15], s26 offen lds
    v_add_u32 v36, 128, v231
    v_mul_u32_u24 v37, 1639, v36
    v_lshrrev_b32 v37, 16, v37
    v_mul_u32_u24 v38, 40, v37
    v_sub_u32_e64 v36, v36, v38
    v_mul_u32_u24 v37, 3840, v37
    v_cmp_le_u32 vcc, 20, v36
    v_lshl_add_u32 v42, v36, 4, v37
    v_add_u32 v38, s27, v42
    v_cndmask_b32 v42, v42, v38, vcc
    s_mov_b32 m0, s42
    s_add_u32 s42, s42, 1024
    buffer_load_dwordx4 v42, s[12:15], s26 offen lds
    v_add_u32 v36, 192, v231
    v_mul_u32_u24 v37, 1639, v36
    v_lshrrev_b32 v37, 16, v37
    v_mul_u32_u24 v38, 40, v37
    v_sub_u32_e64 v36, v36, v38
    v_mul_u32_u24 v37, 3840, v37
    v_cmp_le_u32 vcc, 20, v36
    v_lshl_add_u32 v43, v36, 4, v37
    v_add_u32 v38, s27, v43
    v_cndmask_b32 v43, v43, v38, vcc
    s_mov_b32 m0, s42
    s_add_u32 s42, s42, 1024
    buffer_load_dwordx4 v43, s[12:15], s26 offen lds
    v_add_u32 v36, 256, v231
    v_mul_u32_u24 v37, 1639, v36
    v_lshrrev_b32 v37, 16, v37
    v_mul_u32_u24 v38, 40, v37
    v_sub_u32_e64 v36, v36, v38
    v_mul_u32_u24 v37, 3840, v37
    v_cmp_le_u32 vcc, 20, v36
    v_lshl_add_u32 v44, v36, 4, v37
    v_add_u32 v38, s27, v44
    v_cndmask_b32 v44, v44, v38, vcc
    s_mov_b32 m0, s42
    s_nop 0
    buffer_load_dwordx4 v44, s[12:15], s26 offen lds
S_a_done:
    s_cmp_ge_u32 s47, 248
    s_cbranch_scc1 S_b_bias
    s_cmp_ge_u32 s47, 148
    s_cbranch_scc1 S_b_w1
    s_and_b32 s29, s47, 1
    s_cmp_ge_u32 s47, 108
    s_cbranch_scc1 S_b_wo
    s_mov_b32 s68, s84
    s_mov_b32 s69, s85
    s_mov_b32 s70, 2211840
    s_lshr_b32 s30, s47, 1
    s_mul_hi_u32 s31, s30, 1431655766
    s_mul_i32 s33, s31, 3
    s_sub_u32 s32, s30, s33
    s_lshl_b32 s33, s30, 2
    s_add_u32 s33, s33, s16
    s_mul_i32 s33, s33, 10240
    s_mov_b32 s34, 1280
    s_mov_b32 s35, 5120
    s_and_b32 s36, s31, 3
    s_lshr_b32 s31, s31, 2
    s_lshl_b32 s37, s36, 1
    s_add_u32 s37, s37, s32
    s_add_u32 s36, s36, 8
    s_cmp_eq_u32 s32, 2
    s_cselect_b32 s37, s36, s37
    s_sub_u32 s36, s30, 48
    s_cmp_ge_u32 s30, 48
    s_cselect_b32 s31, s36, s31
    s_cselect_b32 s37, 12, s37
    s_sub_u32 s36, s30, 52
    s_lshl_b32 s36, s36, 1
    s_cmp_ge_u32 s30, 52
    s_cselect_b32 s31, s36, s31
    s_cselect_b32 s37, 13, s37
    s_cselect_b32 s38, 1, 0
    s_mul_i32 s31, s31, 14
    s_add_u32 s31, s31, s37
    s_mul_i32 s31, s31, 5120
    s_add_u32 s31, s31, 5570560
    s_mov_b32 s30, 286720
    s_branch S_b_o2
S_b_wo:
    s_mov_b32 s68, s76
    s_mov_b32 s69, s77
    s_mov_b32 s70, 819200
    s_sub_u32 s30, s47, 108
    s_lshr_b32 s30, s30, 1
    s_mul_hi_u32 s31, s30, 858993460
    s_mul_i32 s33, s31, 5
    s_sub_u32 s32, s30, s33
    s_mul_i32 s33, s31, 160
    s_mul_i32 s36, s32, 40
    s_lshl_b32 s37, s16, 2
    s_add_u32 s36, s36, s37
    s_add_u32 s37, s16, 16
    s_mov_b32 s34, 1280
    s_mov_b32 s35, 25600
    s_cmp_eq_u32 s32, 4
    s_cselect_b32 s36, s37, s36
    s_cselect_b32 s34, s35, s34
    s_cselect_b32 s35, 102400, s35
    s_add_u32 s33, s33, s36
    s_mul_i32 s33, s33, 1280
    s_mov_b32 s38, 0
    s_mul_i32 s31, s30, 5120
    s_add_u32 s31, s31, 4751360
    s_mov_b32 s30, 102400
S_b_o2:
    s_mul_i32 s36, s29, 640
    s_add_u32 s33, s33, s36
    s_mul_i32 s42, s16, 5120
    s_add_u32 s42, s42, 25600
    v_add_u32 v36, 0, v231
    v_mul_u32_u24 v37, 1639, v36
    v_lshrrev_b32 v37, 16, v37
    v_mul_u32_u24 v38, 40, v37
    v_sub_u32 v36, v36, v38
    v_and_b32 v38, 3, v37
    v_mul_lo_u32 v38, v38, s34
    v_lshrrev_b32_e64 v37, 2, v37
    v_mul_lo_u32 v37, v37, s35
    v_lshl_add_u32 v36, v36, 4, v38
    v_add_u32 v40, v36, v37
    s_mov_b32 m0, s42
    s_add_u32 s42, s42, 1024
    buffer_load_dwordx4 v40, s[68:71], s33 offen lds
    v_add_u32_e64 v36, 64, v231
    v_mul_u32_u24 v37, 1639, v36
    v_lshrrev_b32 v37, 16, v37
    v_mul_u32_u24 v38, 40, v37
    v_sub_u32 v36, v36, v38
    v_and_b32 v38, 3, v37
    v_mul_lo_u32 v38, v38, s34
    v_lshrrev_b32_e64 v37, 2, v37
    v_mul_lo_u32 v37, v37, s35
    v_lshl_add_u32 v36, v36, 4, v38
    v_add_u32 v41, v36, v37
    s_mov_b32 m0, s42
    s_add_u32 s42, s42, 1024
    buffer_load_dwordx4 v41, s[68:71], s33 offen lds
    v_add_u32 v36, 128, v231
    v_mul_u32_u24 v37, 1639, v36
    v_lshrrev_b32 v37, 16, v37
    v_mul_u32_u24 v38, 40, v37
    v_sub_u32 v36, v36, v38
    v_and_b32 v38, 3, v37
    v_mul_lo_u32 v38, v38, s34
    v_lshrrev_b32_e64 v37, 2, v37
    v_mul_lo_u32 v37, v37, s35
    v_lshl_add_u32 v36, v36, 4, v38
    v_add_u32 v42, v36, v37
    s_mov_b32 m0, s42
    s_add_u32 s42, s42, 1024
    buffer_load_dwordx4 v42, s[68:71], s33 offen lds
    v_add_u32 v36, 192, v231
    v_mul_u32_u24 v37, 1639, v36
    v_lshrrev_b32 v37, 16, v37
    v_mul_u32_u24 v38, 40, v37
    v_sub_u32 v36, v36, v38
    v_and_b32 v38, 3, v37
    v_mul_lo_u32 v38, v38, s34
    v_lshrrev_b32_e64 v37, 2, v37
    v_mul_lo_u32 v37, v37, s35
    v_lshl_add_u32 v36, v36, 4, v38
    v_add_u32 v43, v36, v37
    s_mov_b32 m0, s42
    s_add_u32 s42, s42, 1024
    buffer_load_dwordx4 v43, s[68:71], s33 offen lds
    v_add_u32 v36, 256, v231
    v_mul_u32_u24 v37, 1639, v36
    v_lshrrev_b32 v37, 16, v37
    v_mul_u32_u24 v38, 40, v37
    v_sub_u32 v36, v36, v38
    v_and_b32 v38, 3, v37
    v_mul_lo_u32 v38, v38, s34
    v_lshrrev_b32_e64 v37, 2, v37
    v_mul_lo_u32 v37, v37, s35
    v_lshl_add_u32 v36, v36, 4, v38
    v_add_u32 v44, v36, v37
    s_mov_b32 m0, s42
    s_nop 0
    buffer_load_dwordx4 v44, s[68:71], s33 offen lds
    buffer_load_dwordx4 v44, s[68:71], s33 offen lds
    s_waitcnt lgkmcnt(0)
    s_branch S_b_done
S_b_w1:
    s_mov_b32 s68, s80
    s_mov_b32 s69, s81
    s_mov_b32 s70, 2211840
    s_sub_u32 s30, s47, 148
    s_mul_hi_u32 s31, s30, 858993460
    s_mul_i32 s33, s31, 5
    s_sub_u32 s32, s30, s33
    s_lshl_b32 s33, s31, 2
    s_add_u32 s33, s33, s16
    s_mul_i32 s33, s33, 27648
    s_mul_i32 s36, s32, 704
    s_add_u32 s33, s33, s36
    s_mul_i32 s42, s16, 5632
    s_add_u32 s42, s42, 25600
    v_add_u32_e64 v36, 0, v231
    v_mul_u32_u24 v37, 1490, v36
    v_lshrrev_b32 v37, 16, v37
    v_mul_u32_u24 v38, 44, v37
    v_sub_u32_e64 v36, v36, v38
    v_mul_u32_u24 v37, 3456, v37
    v_lshl_add_u32 v40, v36, 4, v37
    s_mov_b32 m0, s42
    s_add_u32 s42, s42, 1024
    buffer_load_dwordx4 v40, s[68:71], s33 offen lds
    v_add_u32 v36, 64, v231
    v_mul_u32_u24 v37, 1490, v36
    v_lshrrev_b32 v37, 16, v37
    v_mul_u32_u24 v38, 44, v37
    v_sub_u32_e64 v36, v36, v38
    v_mul_u32_u24 v37, 3456, v37
    v_lshl_add_u32 v41, v36, 4, v37
    s_mov_b32 m0, s42
    s_add_u32 s42, s42, 1024
    buffer_load_dwordx4 v41, s[68:71], s33 offen lds
    v_add_u32 v36, 128, v231
    v_mul_u32_u24 v37, 1490, v36
    v_lshrrev_b32 v37, 16, v37
    v_mul_u32_u24 v38, 44, v37
    v_sub_u32 v36, v36, v38
    v_mul_u32_u24 v37, 3456, v37
    v_lshl_add_u32 v42, v36, 4, v37
    s_mov_b32 m0, s42
    s_add_u32 s42, s42, 1024
    buffer_load_dwordx4 v42, s[68:71], s33 offen lds
    v_add_u32 v36, 192, v231
    v_mul_u32_u24 v37, 1490, v36
    v_lshrrev_b32 v37, 16, v37
    v_mul_u32_u24 v38, 44, v37
    v_sub_u32 v36, v36, v38
    v_mul_u32_u24 v37, 3456, v37
    v_lshl_add_u32 v43, v36, 4, v37
    s_mov_b32 m0, s42
    s_add_u32 s42, s42, 1024
    buffer_load_dwordx4 v43, s[68:71], s33 offen lds
    v_add_u32 v36, 256, v231
    v_mul_u32_u24 v37, 1490, v36
    v_lshrrev_b32 v37, 16, v37
    v_mul_u32_u24 v38, 44, v37
    v_sub_u32 v36, v36, v38
    v_mul_u32_u24 v37, 3456, v37
    v_lshl_add_u32 v44, v36, 4, v37
    s_mov_b32 m0, s42
    s_add_u32 s42, s42, 1024
    buffer_load_dwordx4 v44, s[68:71], s33 offen lds
    v_add_u32 v36, 320, v231
    v_mul_u32_u24 v37, 1490, v36
    v_lshrrev_b32 v37, 16, v37
    v_mul_u32_u24 v38, 44, v37
    v_sub_u32 v36, v36, v38
    v_mul_u32_u24 v37, 3456, v37
    v_lshl_add_u32 v45, v36, 4, v37
    s_mov_b32 m0, s42
    s_nop 0
    buffer_load_dwordx4 v45, s[68:71], s33 offen lds
    s_waitcnt lgkmcnt(0)
    s_branch S_b_done
S_b_bias:
    v_and_b32 v36, 127, v238
    v_lshrrev_b32_e64 v36, 4, v36
    v_lshl_add_u32 v37, v236, 3, v237
    v_lshrrev_b32 v38, 1, v36
    v_and_b32 v39, 1, v36
    v_lshlrev_b32_e64 v38, 5, v38
    v_lshl_add_u32 v38, v39, 2, v38
    s_mov_b32 s70, 3456
    s_mov_b32 s37, 6
    s_cmp_ge_u32 s16, 2
    s_cselect_b32 s68, s86, s82
    s_cselect_b32 s69, s87, s83
    s_cselect_b32 s70, 1280, s70
    s_cselect_b32 s37, 4, s37
    s_sub_u32 s30, s47, 248
    s_lshl_b32 s30, s30, 1
    s_add_u32 s30, s30, 0
    s_mul_i32 s31, s30, 96
    s_lshr_b32 s32, s30, 1
    s_min_u32 s32, s32, 5
    s_add_u32 s32, s32, 48
    s_lshl_b32 s32, s32, 5
    s_add_u32 s32, s32, 0
    s_bfe_u32 s33, s30, 0x20001
    s_mul_i32 s33, s33, 5
    s_add_u32 s34, s33, 0
    s_lshl_b32 s34, s34, 5
    s_add_u32 s33, s33, 2
    s_lshl_b32 s33, s33, 5
    s_add_u32 s33, s33, 0
    s_cmp_ge_u32 s16, 2
    s_cselect_b32 s31, s34, s31
    s_cselect_b32 s32, s33, s32
    v_add_u32 v40, s31, v38
    v_mov_b32 v41, s32
    v_cmp_le_u32 vcc, s37, v36
    s_nop 1
    v_cndmask_b32 v40, v40, v41, vcc
    v_add_lshl_u32 v40, v40, v37, 1
    buffer_load_ushort v240, v40, s[68:71], 0 offen
    buffer_load_ushort v241, v40, s[68:71], 0 offen
    buffer_load_ushort v242, v40, s[68:71], 0 offen
    s_sub_u32 s30, s47, 248
    s_lshl_b32 s30, s30, 1
    s_add_u32 s30, s30, 1
    s_mul_i32 s31, s30, 96
    s_lshr_b32 s32, s30, 1
    s_min_u32 s32, s32, 5
    s_add_u32 s32, s32, 48
    s_lshl_b32 s32, s32, 5
    s_add_u32 s32, s32, 4
    s_bfe_u32 s33, s30, 0x20001
    s_mul_i32 s33, s33, 5
    s_add_u32 s34, s33, 3
    s_lshl_b32 s34, s34, 5
    s_add_u32 s33, s33, 2
    s_lshl_b32 s33, s33, 5
    s_add_u32 s33, s33, 4
    s_cmp_ge_u32 s16, 2
    s_cselect_b32 s31, s34, s31
    s_cselect_b32 s32, s33, s32
    v_add_u32 v40, s31, v38
    v_mov_b32 v41, s32
    v_cmp_le_u32 vcc, s37, v36
    s_nop 1
    v_cndmask_b32 v40, v40, v41, vcc
    v_add_lshl_u32 v40, v40, v37, 1
    buffer_load_ushort v243, v40, s[68:71], 0 offen
    buffer_load_ushort v244, v40, s[68:71], 0 offen
    buffer_load_ushort v245, v40, s[68:71], 0 offen
S_b_done:
    s_mov_b32 s12, s64
    s_mov_b32 s13, s65
    s_mov_b32 s14, 2621440
    s_lshl_b32 s101, s17, 3
    s_lshl_b32 s3, s16, 1
    s_add_u32 s101, s101, s3
    s_mul_i32 s100, s101, 20480
    v_mul_u32_u24 v226, 1280, v232
    v_lshl_add_u32 v226, v233, 4, v226
    v_mov_b32 v60, 0
    v_mov_b32 v61, 0
    v_mov_b32 v62, 0
    v_mov_b32 v63, 0
    s_lshl_b32 s94, s16, 10
    s_lshl_b32 s95, s16, 11
    s_mul_i32 s96, s16, 3072
    s_lshl_b32 s97, s16, 12
    s_mul_i32 s25, s18, 153600
    s_add_u32 s3, s100, 8388608
    v_add_u32 v6, s3, v1
    s_add_u32 s3, s3, 20480
    v_add_u32 v7, s3, v1
    s_getreg_b32 s90, hwreg(HW_REG_XCC_ID, 0, 4)
    s_cmp_eq_u32 s16, 0
    s_cselect_b64 s[92:93], 1, 0
    v_mov_b32 v56, 0x3f803f80
    v_mov_b32 v57, 0x3f803f80
    v_mov_b32 v58, 0x3f803f80
    v_mov_b32 v59, 0x3f803f80
    v_and_b32 v55, 127, v2
    v_cmp_eq_u32 vcc, 0, v236
    s_nop 1
    v_cndmask_b32 v128, 0, v56, vcc
    v_mov_b32 v129, v128
    v_mov_b32 v130, v128
    v_mov_b32 v131, v128
    v_cmp_eq_u32 vcc, 1, v236
    s_nop 1
    v_cndmask_b32 v132, 0, v56, vcc
    v_mov_b32 v133, v132
    v_mov_b32 v134, v132
    v_mov_b32 v135, v132
    v_cmp_eq_u32 vcc, 2, v236
    s_nop 1
    v_cndmask_b32 v136, 0, v56, vcc
    v_mov_b32 v137, v136
    v_mov_b32 v138, v136
    v_mov_b32 v139, v136
    v_cmp_eq_u32 vcc, 3, v236
    s_nop 1
    v_cndmask_b32 v140, 0, v56, vcc
    v_mov_b32 v141, v140
    v_mov_b32 v142, v140
    v_mov_b32 v143, v140
    s_waitcnt vmcnt(6) lgkmcnt(0)
    s_mul_i32 s39, s39, 0x41c64e6d
    s_add_u32 s39, s39, 0x3039cafd
    s_barrier
    s_cmp_ge_u32 s21, 120
    s_cbranch_scc1 S_c_none
    v_lshl_add_u32 v50, v233, 3, v236
    v_mul_u32_u24 v50, 640, v50
    v_add_u32 v50, 0, v50
    v_lshl_add_u32 v51, v237, 4, v50
    v_lshl_add_u32 v52, v237, 3, v50
    s_mul_hi_u32 s44, s22, 858993460
    s_mul_i32 s43, s44, 5
    s_sub_u32 s45, s22, s43
    s_mul_i32 s45, s45, 5
    s_lshr_b32 s43, 13698432, s45
    s_and_b32 s43, s43, 31
    s_cmp_lt_u32 s43, 12
    s_cselect_b32 s45, 3, 2
    s_mul_i32 s44, s44, s45
    s_add_u32 s43, s43, s44
    s_sub_u32 s44, 19, s43
    v_mul_u32_u24 v53, 5120, v233
    v_lshl_add_u32 v53, v236, 1, v53
    v_and_b32 v54, 1, v232
    v_mad_u32_u24 v53, v54, 40, v53
    s_cmp_ge_u32 s21, 80
    s_nop 0
    s_cbranch_scc1 S_c_q
    s_mul_i32 s23, s16, 80
    v_add_u32 v52, s23, v52
    v_and_b32 v54, 2, v232
    v_mul_u32_u24 v54, 160, v54
    v_add3_u32 v53, v53, v54, s23
    s_lshl_b32 s24, s24, 2
    s_add_u32 s24, s24, s16
    s_mul_i32 s26, s43, 5120
    s_mul_i32 s27, s24, 153600
    s_add_u32 s26, s26, s27
    s_add_u32 s26, s26, 51200
    s_add_u32 s27, s26, 4096
    s_mul_i32 s28, s24, 12800
    s_mul_i32 s22, s22, 640
    s_add_u32 s28, s28, s22
    s_add_u32 s28, s28, 21495808
    ds_read_b64_tr_b16 v[64:65], v52 offset:0
    ds_read_b64_tr_b16 v[66:67], v52 offset:2560
    ds_read_b64_tr_b16 v[68:69], v52 offset:40
    ds_read_b64_tr_b16 v[70:71], v52 offset:2600
    ds_read_b64_tr_b16 v[72:73], v52 offset:320
    ds_read_b64_tr_b16 v[74:75], v52 offset:2880
    ds_read_b64_tr_b16 v[76:77], v52 offset:360
    ds_read_b64_tr_b16 v[78:79], v52 offset:2920
    ds_read_u16 v120, v53 offset:32
    ds_read_u16 v121, v53 offset:672
    ds_read_u16 v122, v53 offset:1312
    ds_read_u16 v123, v53 offset:1952
    ds_read_u16 v124, v53 offset:2592
    ds_read_u16 v125, v53 offset:3232
    ds_read_u16 v126, v53 offset:3872
    ds_read_u16 v127, v53 offset:4512
    s_waitcnt lgkmcnt(6)
    v_lshl_or_b32 v80, v121, 16, v120
    s_waitcnt lgkmcnt(4)
    v_lshl_or_b32 v81, v123, 16, v122
    s_waitcnt lgkmcnt(2)
    v_lshl_or_b32 v82, v125, 16, v124
    s_waitcnt lgkmcnt(0)
    v_lshl_or_b32 v83, v127, 16, v126
    v_mfma_f32_16x16x32_bf16 v[92:95], v[128:131], v[64:67], 0
    buffer_store_dwordx4 v[64:67], v1, s[4:7], s26 offen offset:0 sc1
    v_mfma_f32_16x16x32_bf16 v[92:95], v[132:135], v[68:71], v[92:95]
    buffer_store_dwordx4 v[68:71], v1, s[4:7], s26 offen offset:1024 sc1
    v_mfma_f32_16x16x32_bf16 v[92:95], v[136:139], v[72:75], v[92:95]
    buffer_store_dwordx4 v[72:75], v1, s[4:7], s26 offen offset:2048 sc1
    v_mfma_f32_16x16x32_bf16 v[92:95], v[140:143], v[76:79], v[92:95]
    buffer_store_dwordx4 v[76:79], v1, s[4:7], s26 offen offset:3072 sc1
    v_mfma_f32_16x16x32_bf16 v[96:99], v[56:59], v[80:83], 0
    buffer_store_dwordx4 v[80:83], v1, s[4:7], s27 offen offset:0 sc1
    s_nop 4
    buffer_store_dword v92, v2, s[4:7], s28 offen offset:0 sc1
    s_mov_b32 exec_hi, 0
    buffer_store_dword v96, v2, s[4:7], s28 offen offset:256 sc1
    s_mov_b32 exec_hi, -1
    s_waitcnt lgkmcnt(0)
    s_branch S_c_done
S_c_q:
    s_mul_i32 s23, s16, 160
    v_add_u32 v52, s23, v52
    v_add_u32_e64 v53, s23, v53
    v_lshl_add_u32 v54, v236, 1, v54
    v_lshl_add_u32 v54, v233, 3, v54
    v_lshlrev_b32 v54, 4, v54
    s_lshl_b32 s23, s24, 3
    s_lshl_b32 s26, s16, 1
    s_add_u32 s27, s23, s26
    s_mul_i32 s26, s27, 153600
    s_mul_i32 s28, s44, 2560
    s_add_u32 s26, s26, s28
    s_mul_i32 s28, s27, 12800
    s_mul_i32 s27, s22, 640
    s_add_u32 s28, s28, s27
    s_add_u32 s28, s28, 21496192
    s_add_u32 s23, s23, s22
    s_mul_i32 s23, s23, 5120
    s_add_u32 s23, s23, s94
    s_add_u32 s23, s23, 8192000
    s_cmp_ge_u32 s22, 8
    s_cselect_b32 s23, 268435456, s23
    s_add_u32 s24, s23, 81920
    s_sub_u32 s27, s23, s94
    s_and_b32 s22, s16, 1
    s_mul_i32 s22, s22, 81920
    s_add_u32 s27, s27, s22
    s_add_u32 s27, s27, 4096
    buffer_store_dwordx4 v[60:63], v1, s[4:7], s23 offen sc1
    buffer_store_dwordx4 v[60:63], v1, s[4:7], s24 offen sc1
    buffer_store_dwordx4 v[60:63], v1, s[4:7], s27 offen sc1
    ds_read_b64_tr_b16 v[64:65], v52 offset:0
    ds_read_b64_tr_b16 v[66:67], v52 offset:2560
    ds_read_b64_tr_b16 v[68:69], v52 offset:40
    ds_read_b64_tr_b16 v[70:71], v52 offset:2600
    ds_read_u16 v120, v53 offset:32
    ds_read_u16 v121, v53 offset:672
    ds_read_u16 v122, v53 offset:1312
    ds_read_u16 v123, v53 offset:1952
    ds_read_u16 v124, v53 offset:2592
    ds_read_u16 v125, v53 offset:3232
    ds_read_u16 v126, v53 offset:3872
    ds_read_u16 v127, v53 offset:4512
    s_waitcnt lgkmcnt(6)
    v_lshl_or_b32 v72, v121, 16, v120
    s_waitcnt lgkmcnt(4)
    v_lshl_or_b32 v73, v123, 16, v122
    s_waitcnt lgkmcnt(2)
    v_lshl_or_b32 v74, v125, 16, v124
    s_waitcnt lgkmcnt(0)
    v_lshl_or_b32 v75, v127, 16, v126
    v_mfma_f32_16x16x32_bf16 v[92:95], v[128:131], v[64:67], 0
    v_mfma_f32_16x16x32_bf16 v[92:95], v[132:135], v[68:71], v[92:95]
    v_mfma_f32_16x16x32_bf16 v[92:95], v[136:139], v[72:75], v[92:95]
    buffer_store_dwordx4 v[64:67], v1, s[4:7], s26 offen offset:0 sc1
    buffer_store_dwordx4 v[68:71], v1, s[4:7], s26 offen offset:1024 sc1
    s_mov_b32 exec_lo, 0x33333333
    s_mov_b32 exec_hi, 0x33333333
    buffer_store_dwordx4 v[72:75], v54, s[4:7], s26 offen offset:2048 sc1
    s_mov_b64 exec, -1
    s_nop 1
    buffer_store_dword v92, v2, s[4:7], s28 offen offset:0 sc1
    s_add_u32 s26, s26, 153600
    s_add_u32 s28, s28, 12800
    ds_read_b64_tr_b16 v[76:77], v52 offset:80
    ds_read_b64_tr_b16 v[78:79], v52 offset:2640
    ds_read_b64_tr_b16 v[80:81], v52 offset:120
    ds_read_b64_tr_b16 v[82:83], v52 offset:2680
    ds_read_u16 v120, v53 offset:112
    ds_read_u16 v121, v53 offset:752
    ds_read_u16 v122, v53 offset:1392
    ds_read_u16 v123, v53 offset:2032
    ds_read_u16 v124, v53 offset:2672
    ds_read_u16 v125, v53 offset:3312
    ds_read_u16 v126, v53 offset:3952
    ds_read_u16 v127, v53 offset:4592
    s_waitcnt lgkmcnt(6)
    v_lshl_or_b32 v84, v121, 16, v120
    s_waitcnt lgkmcnt(4)
    v_lshl_or_b32 v85, v123, 16, v122
    s_waitcnt lgkmcnt(2)
    v_lshl_or_b32 v86, v125, 16, v124
    s_waitcnt lgkmcnt(0)
    v_lshl_or_b32 v87, v127, 16, v126
    v_mfma_f32_16x16x32_bf16 v[96:99], v[128:131], v[76:79], 0
    v_mfma_f32_16x16x32_bf16 v[96:99], v[132:135], v[80:83], v[96:99]
    v_mfma_f32_16x16x32_bf16 v[96:99], v[136:139], v[84:87], v[96:99]
    buffer_store_dwordx4 v[76:79], v1, s[4:7], s26 offen offset:0 sc1
    buffer_store_dwordx4 v[80:83], v1, s[4:7], s26 offen offset:1024 sc1
    s_mov_b32 exec_lo, 0x33333333
    s_mov_b32 exec_hi, 0x33333333
    buffer_store_dwordx4 v[84:87], v54, s[4:7], s26 offen offset:2048 sc1
    s_mov_b64 exec, -1
    s_nop 1
    buffer_store_dword v96, v2, s[4:7], s28 offen offset:0 sc1
    s_add_u32 s26, s26, 153600
    s_add_u32 s28, s28, 12800
    s_waitcnt lgkmcnt(0)
    s_branch S_c_done
S_c_none:
S_c_done:
    s_mul_i32 s98, s16, 20480
    s_add_u32 s98, s98, 51200
    s_mov_b32 s42, s98
    s_add_u32 s99, s100, 0
    v_add_u32_e64 v36, 0, v231
    v_mul_u32_u24 v37, 52429, v36
    v_lshrrev_b32_e64 v37, 22, v37
    v_mul_u32_u24 v38, 80, v37
    v_sub_u32 v36, v36, v38
    v_lshlrev_b32 v39, 1, v37
    v_and_b32 v39, 15, v39
    v_xor_b32 v36, v36, v39
    v_add_lshl_u32 v168, v36, v38, 4
    s_mov_b32 m0, s42
    s_add_u32 s42, s42, 1024
    buffer_load_dwordx4 v168, s[12:15], s99 offen lds
    v_add_u32 v36, 64, v231
    v_mul_u32_u24 v37, 52429, v36
    v_lshrrev_b32_e64 v37, 22, v37
    v_mul_u32_u24 v38, 80, v37
    v_sub_u32 v36, v36, v38
    v_lshlrev_b32 v39, 1, v37
    v_and_b32 v39, 15, v39
    v_xor_b32 v36, v36, v39
    v_add_lshl_u32 v169, v36, v38, 4
    s_mov_b32 m0, s42
    s_add_u32 s42, s42, 1024
    buffer_load_dwordx4 v169, s[12:15], s99 offen lds
    v_add_u32 v36, 128, v231
    v_mul_u32_u24 v37, 52429, v36
    v_lshrrev_b32 v37, 22, v37
    v_mul_u32_u24 v38, 80, v37
    v_sub_u32 v36, v36, v38
    v_lshlrev_b32 v39, 1, v37
    v_and_b32 v39, 15, v39
    v_xor_b32 v36, v36, v39
    v_add_lshl_u32 v170, v36, v38, 4
    s_mov_b32 m0, s42
    s_add_u32 s42, s42, 1024
    buffer_load_dwordx4 v170, s[12:15], s99 offen lds
    v_add_u32 v36, 192, v231
    v_mul_u32_u24 v37, 52429, v36
    v_lshrrev_b32 v37, 22, v37
    v_mul_u32_u24 v38, 80, v37
    v_sub_u32 v36, v36, v38
    v_lshlrev_b32 v39, 1, v37
    v_and_b32 v39, 15, v39
    v_xor_b32 v36, v36, v39
    v_add_lshl_u32 v171, v36, v38, 4
    s_mov_b32 m0, s42
    s_add_u32 s42, s42, 1024
    buffer_load_dwordx4 v171, s[12:15], s99 offen lds
    v_add_u32 v36, 256, v231
    v_mul_u32_u24 v37, 52429, v36
    v_lshrrev_b32 v37, 22, v37
    v_mul_u32_u24 v38, 80, v37
    v_sub_u32 v36, v36, v38
    v_lshlrev_b32 v39, 1, v37
    v_and_b32 v39, 15, v39
    v_xor_b32 v36, v36, v39
    v_add_lshl_u32 v172, v36, v38, 4
    s_mov_b32 m0, s42
    s_add_u32 s42, s42, 1024
    buffer_load_dwordx4 v172, s[12:15], s99 offen lds
    v_add_u32 v36, 320, v231
    v_mul_u32_u24 v37, 52429, v36
    v_lshrrev_b32 v37, 22, v37
    v_mul_u32_u24 v38, 80, v37
    v_sub_u32 v36, v36, v38
    v_lshlrev_b32 v39, 1, v37
    v_and_b32 v39, 15, v39
    v_xor_b32 v36, v36, v39
    v_add_lshl_u32 v173, v36, v38, 4
    s_mov_b32 m0, s42
    s_add_u32 s42, s42, 1024
    buffer_load_dwordx4 v173, s[12:15], s99 offen lds
    v_add_u32 v36, 384, v231
    v_mul_u32_u24 v37, 52429, v36
    v_lshrrev_b32 v37, 22, v37
    v_mul_u32_u24 v38, 80, v37
    v_sub_u32 v36, v36, v38
    v_lshlrev_b32 v39, 1, v37
    v_and_b32 v39, 15, v39
    v_xor_b32 v36, v36, v39
    v_add_lshl_u32 v174, v36, v38, 4
    s_mov_b32 m0, s42
    s_add_u32 s42, s42, 1024
    buffer_load_dwordx4 v174, s[12:15], s99 offen lds
    v_add_u32 v36, 448, v231
    v_mul_u32_u24 v37, 52429, v36
    v_lshrrev_b32 v37, 22, v37
    v_mul_u32_u24 v38, 80, v37
    v_sub_u32 v36, v36, v38
    v_lshlrev_b32 v39, 1, v37
    v_and_b32 v39, 15, v39
    v_xor_b32 v36, v36, v39
    v_add_lshl_u32 v175, v36, v38, 4
    s_mov_b32 m0, s42
    s_add_u32 s42, s42, 1024
    buffer_load_dwordx4 v175, s[12:15], s99 offen lds
    v_add_u32 v36, 512, v231
    v_mul_u32_u24 v37, 52429, v36
    v_lshrrev_b32 v37, 22, v37
    v_mul_u32_u24 v38, 80, v37
    v_sub_u32 v36, v36, v38
    v_lshlrev_b32 v39, 1, v37
    v_and_b32 v39, 15, v39
    v_xor_b32 v36, v36, v39
    v_add_lshl_u32 v176, v36, v38, 4
    s_mov_b32 m0, s42
    s_add_u32 s42, s42, 1024
    buffer_load_dwordx4 v176, s[12:15], s99 offen lds
    v_add_u32 v36, 576, v231
    v_mul_u32_u24 v37, 52429, v36
    v_lshrrev_b32 v37, 22, v37
    v_mul_u32_u24 v38, 80, v37
    v_sub_u32 v36, v36, v38
    v_lshlrev_b32 v39, 1, v37
    v_and_b32 v39, 15, v39
    v_xor_b32 v36, v36, v39
    v_add_lshl_u32 v177, v36, v38, 4
    s_mov_b32 m0, s42
    s_add_u32 s42, s42, 1024
    buffer_load_dwordx4 v177, s[12:15], s99 offen lds
    v_add_u32 v36, 640, v231
    v_mul_u32_u24 v37, 52429, v36
    v_lshrrev_b32 v37, 22, v37
    v_mul_u32_u24 v38, 80, v37
    v_sub_u32 v36, v36, v38
    v_lshlrev_b32 v39, 1, v37
    v_and_b32 v39, 15, v39
    v_xor_b32 v36, v36, v39
    v_add_lshl_u32 v178, v36, v38, 4
    s_mov_b32 m0, s42
    s_add_u32 s42, s42, 1024
    buffer_load_dwordx4 v178, s[12:15], s99 offen lds
    v_add_u32 v36, 704, v231
    v_mul_u32_u24 v37, 52429, v36
    v_lshrrev_b32 v37, 22, v37
    v_mul_u32_u24 v38, 80, v37
    v_sub_u32 v36, v36, v38
    v_lshlrev_b32 v39, 1, v37
    v_and_b32 v39, 15, v39
    v_xor_b32 v36, v36, v39
    v_add_lshl_u32 v179, v36, v38, 4
    s_mov_b32 m0, s42
    s_add_u32 s42, s42, 1024
    buffer_load_dwordx4 v179, s[12:15], s99 offen lds
    v_add_u32 v36, 768, v231
    v_mul_u32_u24 v37, 52429, v36
    v_lshrrev_b32 v37, 22, v37
    v_mul_u32_u24 v38, 80, v37
    v_sub_u32 v36, v36, v38
    v_lshlrev_b32 v39, 1, v37
    v_and_b32 v39, 15, v39
    v_xor_b32 v36, v36, v39
    v_add_lshl_u32 v180, v36, v38, 4
    s_mov_b32 m0, s42
    s_add_u32 s42, s42, 1024
    buffer_load_dwordx4 v180, s[12:15], s99 offen lds
    v_add_u32 v36, 832, v231
    v_mul_u32_u24 v37, 52429, v36
    v_lshrrev_b32 v37, 22, v37
    v_mul_u32_u24 v38, 80, v37
    v_sub_u32 v36, v36, v38
    v_lshlrev_b32 v39, 1, v37
    v_and_b32 v39, 15, v39
    v_xor_b32 v36, v36, v39
    v_add_lshl_u32 v181, v36, v38, 4
    s_mov_b32 m0, s42
    s_add_u32 s42, s42, 1024
    buffer_load_dwordx4 v181, s[12:15], s99 offen lds
    v_add_u32 v36, 896, v231
    v_mul_u32_u24 v37, 52429, v36
    v_lshrrev_b32 v37, 22, v37
    v_mul_u32_u24 v38, 80, v37
    v_sub_u32 v36, v36, v38
    v_lshlrev_b32 v39, 1, v37
    v_and_b32 v39, 15, v39
    v_xor_b32 v36, v36, v39
    v_add_lshl_u32 v182, v36, v38, 4
    s_mov_b32 m0, s42
    s_add_u32 s42, s42, 1024
    buffer_load_dwordx4 v182, s[12:15], s99 offen lds
    v_add_u32 v36, 960, v231
    v_mul_u32_u24 v37, 52429, v36
    v_lshrrev_b32 v37, 22, v37
    v_mul_u32_u24 v38, 80, v37
    v_sub_u32 v36, v36, v38
    v_lshlrev_b32 v39, 1, v37
    v_and_b32 v39, 15, v39
    v_xor_b32 v36, v36, v39
    v_add_lshl_u32 v183, v36, v38, 4
    s_mov_b32 m0, s42
    s_add_u32 s42, s42, 1024
    buffer_load_dwordx4 v183, s[12:15], s99 offen lds
    v_add_u32 v36, 1024, v231
    v_mul_u32_u24 v37, 52429, v36
    v_lshrrev_b32 v37, 22, v37
    v_mul_u32_u24 v38, 80, v37
    v_sub_u32 v36, v36, v38
    v_lshlrev_b32 v39, 1, v37
    v_and_b32 v39, 15, v39
    v_xor_b32 v36, v36, v39
    v_add_lshl_u32 v184, v36, v38, 4
    s_mov_b32 m0, s42
    s_add_u32 s42, s42, 1024
    buffer_load_dwordx4 v184, s[12:15], s99 offen lds
    v_add_u32 v36, 1088, v231
    v_mul_u32_u24 v37, 52429, v36
    v_lshrrev_b32 v37, 22, v37
    v_mul_u32_u24 v38, 80, v37
    v_sub_u32 v36, v36, v38
    v_lshlrev_b32 v39, 1, v37
    v_and_b32 v39, 15, v39
    v_xor_b32 v36, v36, v39
    v_add_lshl_u32 v185, v36, v38, 4
    s_mov_b32 m0, s42
    s_add_u32 s42, s42, 1024
    buffer_load_dwordx4 v185, s[12:15], s99 offen lds
    v_add_u32 v36, 1152, v231
    v_mul_u32_u24 v37, 52429, v36
    v_lshrrev_b32 v37, 22, v37
    v_mul_u32_u24 v38, 80, v37
    v_sub_u32 v36, v36, v38
    v_lshlrev_b32 v39, 1, v37
    v_and_b32 v39, 15, v39
    v_xor_b32 v36, v36, v39
    v_add_lshl_u32 v186, v36, v38, 4
    s_mov_b32 m0, s42
    s_add_u32 s42, s42, 1024
    buffer_load_dwordx4 v186, s[12:15], s99 offen lds
    v_add_u32 v36, 1216, v231
    v_mul_u32_u24 v37, 52429, v36
    v_lshrrev_b32 v37, 22, v37
    v_mul_u32_u24 v38, 80, v37
    v_sub_u32 v36, v36, v38
    v_lshlrev_b32 v39, 1, v37
    v_and_b32 v39, 15, v39
    v_xor_b32 v36, v36, v39
    v_add_lshl_u32 v187, v36, v38, 4
    s_mov_b32 m0, s42
    s_add_u32 s42, s42, 1024
    buffer_load_dwordx4 v187, s[12:15], s99 offen lds
    v_lshlrev_b32 v39, 1, v232
    v_and_b32_e64 v39, 15, v39
    v_mul_u32_u24 v38, 1280, v232
    v_add_u32 v38, s98, v38
    v_add_u32 v36, 0, v233
    v_xor_b32_e64 v36, v36, v39
    v_lshl_add_u32 v188, v36, 4, v38
    v_add_u32 v36, 4, v233
    v_xor_b32 v36, v36, v39
    v_lshl_add_u32 v189, v36, 4, v38
    v_add_u32 v36, 8, v233
    v_xor_b32 v36, v36, v39
    v_lshl_add_u32 v190, v36, 4, v38
    v_add_u32 v36, 12, v233
    v_xor_b32 v36, v36, v39
    v_lshl_add_u32 v191, v36, 4, v38
    s_add_u32 s91, s39, 16
    s_add_u32 s90, s90, s91
    v_mov_b32 v15, s90
    s_lshl_b32 s3, s17, 4
    s_add_u32 s3, s3, s18
    s_lshl_b32 s3, s3, 7
    s_add_u32 s3, s3, 20873216
    s_waitcnt vmcnt(20)
    s_barrier
    s_sub_u32 exec_lo, 0, s92
    s_mov_b32 exec_hi, 0
    buffer_store_dword v15, v2, s[4:7], s3 offen sc1
    s_mov_b64 exec, -1
    s_lshl_b32 s36, s18, 2
    s_add_u32 s36, s36, s16
    s_mul_i32 s37, s17, 163840
    s_mul_i32 s3, s36, 2560
    s_add_u32 s37, s37, s3
    s_add_u32 s37, s37, 8388608
    v_lshl_add_u32 v36, v231, 7, s37
    s_lshl_b32 s37, s17, 1
    s_lshr_b32 s3, s36, 5
    s_add_u32 s37, s37, s3
    s_mul_i32 s37, s37, 221184
    s_and_b32 s3, s36, 31
    s_mul_i32 s3, s3, 2816
    s_add_u32 s37, s37, s3
    s_add_u32 s37, s37, 13760000
    v_lshl_add_u32 v37, v231, 7, s37
    v_cmp_gt_u32 vcc, 20, v231
    s_nop 1
    v_cndmask_b32 v36, v37, v36, vcc
    s_lshl_b32 s37, s17, 6
    s_add_u32 s37, s37, s36
    s_lshl_b32 s37, s37, 7
    s_add_u32 s37, s37, 13631488
    v_mov_b32 v37, s37
    v_cmp_gt_u32 vcc, 42, v231
    s_nop 1
    v_cndmask_b32 v36, v37, v36, vcc
    s_and_b32 s3, s36, 3
    s_lshl_b32 s37, s17, 2
    s_add_u32 s37, s37, s3
    s_lshl_b32 s37, s37, 7
    s_bfe_u32 s3, s36, 0x10002
    s_mul_i32 s3, s3, 20480
    s_add_u32 s37, s37, s3
    s_and_b32 s3, s36, 1
    s_lshl1_add_u32 s3, s17, s3
    s_lshl_b32 s3, s3, 7
    s_bfe_u32 s40, s36, 0x20001
    s_lshl_b32 s40, s40, 12
    s_add_u32 s3, s3, s40
    s_add_u32 s3, s3, 0x2000
    s_bitcmp1_b32 s36, 3
    s_cselect_b32 s37, s3, s37
    s_add_u32 s37, s37, 8355840
    v_mov_b32 v37, s37
    v_cmp_gt_u32 vcc, 43, v231
    s_nop 1
    v_cndmask_b32 v36, v37, v36, vcc
    v_mov_b32 v35, v36
    buffer_load_dword v228, v35, s[4:7], 0 offen sc1
    s_waitcnt vmcnt(2)
    ds_read_b128 a[0:3], v188 offset:0
    ds_read_b128 a[96:99], v189 offset:0
    ds_read_b128 a[8:11], v190 offset:0
    ds_read_b128 a[16:19], v191 offset:0
    ds_read_b128 a[104:107], v188 offset:256
    ds_read_b128 a[24:27], v189 offset:256
    ds_read_b128 a[112:115], v190 offset:256
    ds_read_b128 a[32:35], v191 offset:256
    ds_read_b128 a[40:43], v188 offset:512
    ds_read_b128 a[120:123], v189 offset:512
    ds_read_b128 a[48:51], v190 offset:512
    ds_read_b128 a[128:131], v191 offset:512
    ds_read_b128 a[56:59], v188 offset:768
    ds_read_b128 a[64:67], v189 offset:768
    ds_read_b128 a[136:139], v190 offset:768
    ds_read_b128 a[72:75], v191 offset:768
    ds_read_b128 a[144:147], v188 offset:1024
    ds_read_b128 a[80:83], v189 offset:1024
    ds_read_b128 a[88:91], v190 offset:1024
    ds_read_b128 a[152:155], v191 offset:1024
    s_waitcnt lgkmcnt(0)
    s_cmp_ge_u32 s47, 248
    s_cbranch_scc1 S_d_bias
    s_cmp_ge_u32 s47, 148
    s_cbranch_scc1 S_d_w1
    v_lshl_add_u32 v50, v233, 3, v236
    v_mul_u32_u24 v50, 640, v50
    v_add_u32 v50, 25600, v50
    v_lshl_add_u32 v51, v237, 4, v50
    v_lshl_add_u32 v52, v237, 3, v50
    s_lshr_b32 s22, s16, 1
    s_mul_i32 s22, s22, 320
    s_and_b32 s23, s16, 1
    s_mul_i32 s24, s23, 192
    s_add_u32 s24, s24, s22
    v_add_u32 v52, s24, v51
    s_lshl_b32 s23, s23, 3
    s_add_u32 s23, s23, s22
    v_add_u32 v53, s23, v51
    s_lshl_b32 s29, s29, 2
    s_add_u32 s29, s29, s16
    s_mul_i32 s29, s29, s30
    s_add_u32 s31, s31, s29
    ds_read_b64_tr_b16 v[64:65], v52 offset:0
    ds_read_b64_tr_b16 v[66:67], v52 offset:2560
    ds_read_b64_tr_b16 v[68:69], v52 offset:8
    ds_read_b64_tr_b16 v[70:71], v52 offset:2568
    ds_read_b64_tr_b16 v[72:73], v52 offset:64
    ds_read_b64_tr_b16 v[74:75], v52 offset:2624
    ds_read_b64_tr_b16 v[76:77], v52 offset:72
    ds_read_b64_tr_b16 v[78:79], v52 offset:2632
    ds_read_b64_tr_b16 v[80:81], v53 offset:128
    ds_read_b64_tr_b16 v[82:83], v53 offset:2688
    s_cmp_eq_u32 s38, 0
    s_cselect_b32 s46, 5, 10
S_d_store:
    s_add_u32 s32, s31, 4096
    s_waitcnt lgkmcnt(8)
    buffer_store_dwordx4 v[64:67], v1, s[4:7], s31 offen offset:0 sc1
    s_waitcnt lgkmcnt(6)
    buffer_store_dwordx4 v[68:71], v1, s[4:7], s31 offen offset:1024 sc1
    s_waitcnt lgkmcnt(4)
    buffer_store_dwordx4 v[72:75], v1, s[4:7], s31 offen offset:2048 sc1
    s_waitcnt lgkmcnt(2)
    buffer_store_dwordx4 v[76:79], v1, s[4:7], s31 offen offset:3072 sc1
    s_waitcnt lgkmcnt(0)
    buffer_store_dwordx4 v[80:83], v1, s[4:7], s32 offen offset:0 sc1
    s_cmp_eq_u32 s38, 0
    s_nop 0
    s_cbranch_scc1 S_d_done
    s_mov_b32 s38, 0
    s_add_u32 s31, s31, 71680
    s_branch S_d_store
S_d_w1:
    v_lshl_add_u32 v50, v233, 3, v236
    v_mul_u32_u24 v50, 704, v50
    v_add_u32 v50, 25600, v50
    v_lshl_add_u32 v51, v237, 4, v50
    v_lshl_add_u32 v52, v237, 3, v50
    s_mul_hi_u32 s44, s31, 858993460
    s_mul_i32 s43, s44, 5
    s_sub_u32 s45, s31, s43
    s_mul_i32 s45, s45, 5
    s_lshr_b32 s43, 13698432, s45
    s_and_b32 s43, s43, 31
    s_cmp_lt_u32 s43, 12
    s_cselect_b32 s45, 3, 2
    s_mul_i32 s44, s44, s45
    s_add_u32 s43, s43, s44
    s_sub_u32 s44, 19, s43
    s_lshl_b32 s22, s16, 6
    v_add_u32 v51, s22, v51
    ds_read_b64_tr_b16 v[64:65], v51 offset:0
    ds_read_b64_tr_b16 v[66:67], v51 offset:2816
    ds_read_b64_tr_b16 v[68:69], v51 offset:8
    ds_read_b64_tr_b16 v[70:71], v51 offset:2824
    ds_read_b64_tr_b16 v[72:73], v51 offset:256
    ds_read_b64_tr_b16 v[74:75], v51 offset:3072
    ds_read_b64_tr_b16 v[76:77], v51 offset:264
    ds_read_b64_tr_b16 v[78:79], v51 offset:3080
    ds_read_b64_tr_b16 v[80:81], v51 offset:512
    ds_read_b64_tr_b16 v[82:83], v51 offset:3328
    ds_read_b64_tr_b16 v[84:85], v51 offset:520
    ds_read_b64_tr_b16 v[86:87], v51 offset:3336
    s_mul_i32 s22, s32, 11
    s_add_u32 s22, s22, s16
    s_add_u32 s22, s22, 0
    s_mul_hi_u32 s23, s22, 1431655766
    s_mul_i32 s26, s23, 3
    s_sub_u32 s24, s22, s26
    s_lshl_b32 s26, s43, 12
    s_lshl_b32 s27, s24, 11
    s_add_u32 s26, s26, s27
    s_mul_i32 s27, s44, 3072
    s_add_u32 s27, s27, 81920
    s_cmp_eq_u32 s24, 2
    s_cselect_b32 s26, s27, s26
    s_add_u32 s27, s27, 2048
    s_lshl_b32 s28, s24, 7
    s_sub_u32 s29, s22, 48
    s_lshl_b32 s29, s29, 1
    s_mov_b32 s30, 1024
    s_mov_b32 s33, 268435456
    s_cmp_ge_u32 s22, 48
    s_cselect_b32 s23, s29, s23
    s_cselect_b32 s26, s27, s26
    s_cselect_b32 s28, 384, s28
    s_cselect_b32 s30, 143360, s30
    s_cselect_b32 s33, 10240, s33
    s_mul_i32 s27, s23, 143360
    s_add_u32 s27, s27, s26
    s_add_u32 s76, s27, 2457600
    s_add_u32 s77, s76, s30
    s_mul_i32 s27, s23, 10240
    s_lshl_b32 s29, s31, 9
    s_add_u32 s27, s27, s29
    s_add_u32 s27, s27, s28
    s_add_u32 s78, s27, 8028160
    s_add_u32 s79, s78, s33
    s_waitcnt lgkmcnt(10)
    v_mfma_f32_16x16x32_bf16 v[92:95], v[128:131], v[64:67], 0
    buffer_store_dwordx4 v[64:67], v1, s[4:7], s76 offen sc1
    s_waitcnt lgkmcnt(8)
    v_mfma_f32_16x16x32_bf16 v[92:95], v[132:135], v[68:71], v[92:95]
    v_mfma_f32_16x16x32_bf16 v[96:99], v[56:59], v[68:71], 0
    buffer_store_dwordx4 v[68:71], v1, s[4:7], s77 offen sc1
    s_mul_i32 s22, s32, 11
    s_add_u32 s22, s22, s16
    s_add_u32 s22, s22, 4
    s_mul_hi_u32 s23, s22, 1431655766
    s_mul_i32 s26, s23, 3
    s_sub_u32 s24, s22, s26
    s_lshl_b32 s26, s43, 12
    s_lshl_b32 s27, s24, 11
    s_add_u32 s26, s26, s27
    s_mul_i32 s27, s44, 3072
    s_add_u32 s27, s27, 81920
    s_cmp_eq_u32 s24, 2
    s_cselect_b32 s26, s27, s26
    s_add_u32 s27, s27, 2048
    s_lshl_b32 s28, s24, 7
    s_sub_u32 s29, s22, 48
    s_lshl_b32 s29, s29, 1
    s_mov_b32 s30, 1024
    s_mov_b32 s33, 268435456
    s_cmp_ge_u32 s22, 48
    s_cselect_b32 s23, s29, s23
    s_cselect_b32 s26, s27, s26
    s_cselect_b32 s28, 384, s28
    s_cselect_b32 s30, 143360, s30
    s_cselect_b32 s33, 10240, s33
    s_mul_i32 s27, s23, 143360
    s_add_u32 s27, s27, s26
    s_add_u32 s80, s27, 2457600
    s_add_u32 s81, s80, s30
    s_mul_i32 s27, s23, 10240
    s_lshl_b32 s29, s31, 9
    s_add_u32 s27, s27, s29
    s_add_u32 s27, s27, s28
    s_add_u32 s82, s27, 8028160
    s_add_u32 s83, s82, s33
    s_waitcnt lgkmcnt(6)
    v_mfma_f32_16x16x32_bf16 v[100:103], v[128:131], v[72:75], 0
    buffer_store_dwordx4 v[72:75], v1, s[4:7], s80 offen sc1
    s_waitcnt lgkmcnt(4)
    v_mfma_f32_16x16x32_bf16 v[100:103], v[132:135], v[76:79], v[100:103]
    v_mfma_f32_16x16x32_bf16 v[104:107], v[56:59], v[76:79], 0
    buffer_store_dwordx4 v[76:79], v1, s[4:7], s81 offen sc1
    s_mul_i32 s22, s32, 11
    s_add_u32 s22, s22, s16
    s_add_u32 s22, s22, 8
    s_mul_hi_u32 s23, s22, 1431655766
    s_mul_i32 s26, s23, 3
    s_sub_u32 s24, s22, s26
    s_lshl_b32 s26, s43, 12
    s_lshl_b32 s27, s24, 11
    s_add_u32 s26, s26, s27
    s_mul_i32 s27, s44, 3072
    s_add_u32 s27, s27, 81920
    s_cmp_eq_u32 s24, 2
    s_cselect_b32 s26, s27, s26
    s_add_u32 s27, s27, 2048
    s_lshl_b32 s28, s24, 7
    s_sub_u32 s29, s22, 48
    s_lshl_b32 s29, s29, 1
    s_mov_b32 s30, 1024
    s_mov_b32 s33, 268435456
    s_cmp_ge_u32 s22, 48
    s_cselect_b32 s23, s29, s23
    s_cselect_b32 s26, s27, s26
    s_cselect_b32 s28, 384, s28
    s_cselect_b32 s30, 143360, s30
    s_cselect_b32 s33, 10240, s33
    s_mul_i32 s27, s23, 143360
    s_add_u32 s27, s27, s26
    s_add_u32 s84, s27, 2457600
    s_add_u32 s85, s84, s30
    s_mul_i32 s27, s23, 10240
    s_lshl_b32 s29, s31, 9
    s_add_u32 s27, s27, s29
    s_add_u32 s27, s27, s28
    s_add_u32 s86, s27, 8028160
    s_add_u32 s87, s86, s33
    s_cmp_eq_u32 s16, 3
    s_cselect_b32 s22, 54, s22
    s_cmp_ge_u32 s22, 54
    s_cselect_b32 s84, 268435456, s84
    s_cselect_b32 s85, 268435456, s85
    s_cselect_b32 s86, 268435456, s86
    s_cselect_b32 s87, 268435456, s87
    s_waitcnt lgkmcnt(2)
    v_mfma_f32_16x16x32_bf16 v[108:111], v[128:131], v[80:83], 0
    buffer_store_dwordx4 v[80:83], v1, s[4:7], s84 offen sc1
    s_waitcnt lgkmcnt(0)
    v_mfma_f32_16x16x32_bf16 v[108:111], v[132:135], v[84:87], v[108:111]
    v_mfma_f32_16x16x32_bf16 v[112:115], v[56:59], v[84:87], 0
    buffer_store_dwordx4 v[84:87], v1, s[4:7], s85 offen sc1
    s_mov_b32 exec_hi, 0
    buffer_store_dword v92, v2, s[4:7], s78 offen offset:0 sc1
    s_mov_b32 exec_hi, -1
    s_mov_b32 exec_hi, 0
    buffer_store_dword v96, v2, s[4:7], s79 offen offset:0 sc1
    s_mov_b32 exec_hi, -1
    s_mov_b32 exec_hi, 0
    buffer_store_dword v100, v2, s[4:7], s82 offen offset:0 sc1
    s_mov_b32 exec_hi, -1
    s_mov_b32 exec_hi, 0
    buffer_store_dword v104, v2, s[4:7], s83 offen offset:0 sc1
    s_mov_b32 exec_hi, -1
    s_mov_b32 exec_hi, 0
    buffer_store_dword v108, v2, s[4:7], s86 offen offset:0 sc1
    s_mov_b32 exec_hi, -1
    s_mov_b32 exec_hi, 0
    buffer_store_dword v112, v2, s[4:7], s87 offen offset:0 sc1
    s_mov_b32 exec_hi, -1
    s_add_u32 s23, s16, 12
    s_mul_i32 s24, s23, 143360
    s_mul_i32 s26, s44, 3072
    s_add_u32 s24, s24, s26
    s_add_u32 s24, s24, 2541568
    s_mul_i32 s23, s23, 10240
    s_lshl_b32 s26, s31, 9
    s_add_u32 s23, s23, s26
    s_add_u32 s23, s23, 8028544
    s_cmp_lg_u32 s32, 4
    s_cselect_b32 s46, 12, 14
    s_cbranch_scc1 S_d_done
    buffer_store_dwordx4 v[60:63], v1, s[4:7], s24 offen sc1
    buffer_store_dword v60, v55, s[4:7], s23 offen sc1
    s_waitcnt lgkmcnt(0)
    s_branch S_d_done
S_d_bias:
    s_mov_b32 s46, 2
    s_sub_u32 s30, s47, 248
    s_lshl_b32 s30, s30, 11
    s_add_u32 s30, s30, 20840448
    v_lshlrev_b32 v36, 2, v238
    v_lshlrev_b32 v240, 16, v240
    v_lshlrev_b32 v243, 16, v243
    buffer_store_dword v240, v36, s[4:7], s30 offen sc1
    buffer_store_dword v243, v36, s[4:7], s30 offen offset:1024 sc1
S_d_done:
    s_mul_i32 s98, s16, 20480
    s_add_u32 s98, s98, 51200
    s_mov_b32 s42, s98
    s_add_u32 s99, s100, 20480
    s_mov_b32 m0, s42
    s_add_u32 s42, s42, 1024
    buffer_load_dwordx4 v168, s[12:15], s99 offen lds
    v_mfma_f32_16x16x32_bf16 v[144:147], v[56:59], a[0:3], 0
    v_mfma_f32_16x16x32_bf16 v[148:151], a[0:3], a[0:3], 0
    s_mov_b32 m0, s42
    s_add_u32 s42, s42, 1024
    buffer_load_dwordx4 v169, s[12:15], s99 offen lds
    v_mfma_f32_16x16x32_bf16 v[144:147], v[56:59], a[8:11], v[144:147]
    v_mfma_f32_16x16x32_bf16 v[148:151], a[8:11], a[8:11], v[148:151]
    s_mov_b32 m0, s42
    s_add_u32 s42, s42, 1024
    buffer_load_dwordx4 v170, s[12:15], s99 offen lds
    v_mfma_f32_16x16x32_bf16 v[144:147], v[56:59], a[16:19], v[144:147]
    v_mfma_f32_16x16x32_bf16 v[148:151], a[16:19], a[16:19], v[148:151]
    s_mov_b32 m0, s42
    s_add_u32 s42, s42, 1024
    buffer_load_dwordx4 v171, s[12:15], s99 offen lds
    v_mfma_f32_16x16x32_bf16 v[144:147], v[56:59], a[24:27], v[144:147]
    v_mfma_f32_16x16x32_bf16 v[148:151], a[24:27], a[24:27], v[148:151]
    s_mov_b32 m0, s42
    s_add_u32 s42, s42, 1024
    buffer_load_dwordx4 v172, s[12:15], s99 offen lds
    v_mfma_f32_16x16x32_bf16 v[144:147], v[56:59], a[32:35], v[144:147]
    v_mfma_f32_16x16x32_bf16 v[148:151], a[32:35], a[32:35], v[148:151]
    s_mov_b32 m0, s42
    s_add_u32 s42, s42, 1024
    buffer_load_dwordx4 v173, s[12:15], s99 offen lds
    v_mfma_f32_16x16x32_bf16 v[144:147], v[56:59], a[40:43], v[144:147]
    v_mfma_f32_16x16x32_bf16 v[148:151], a[40:43], a[40:43], v[148:151]
    s_mov_b32 m0, s42
    s_add_u32 s42, s42, 1024
    buffer_load_dwordx4 v174, s[12:15], s99 offen lds
    v_mfma_f32_16x16x32_bf16 v[144:147], v[56:59], a[48:51], v[144:147]
    v_mfma_f32_16x16x32_bf16 v[148:151], a[48:51], a[48:51], v[148:151]
    s_mov_b32 m0, s42
    s_add_u32 s42, s42, 1024
    buffer_load_dwordx4 v175, s[12:15], s99 offen lds
    v_mfma_f32_16x16x32_bf16 v[144:147], v[56:59], a[56:59], v[144:147]
    v_mfma_f32_16x16x32_bf16 v[148:151], a[56:59], a[56:59], v[148:151]
    s_mov_b32 m0, s42
    s_add_u32 s42, s42, 1024
    buffer_load_dwordx4 v176, s[12:15], s99 offen lds
    v_mfma_f32_16x16x32_bf16 v[144:147], v[56:59], a[64:67], v[144:147]
    v_mfma_f32_16x16x32_bf16 v[148:151], a[64:67], a[64:67], v[148:151]
    s_mov_b32 m0, s42
    s_add_u32 s42, s42, 1024
    buffer_load_dwordx4 v177, s[12:15], s99 offen lds
    v_mfma_f32_16x16x32_bf16 v[144:147], v[56:59], a[72:75], v[144:147]
    v_mfma_f32_16x16x32_bf16 v[148:151], a[72:75], a[72:75], v[148:151]
    s_mov_b32 m0, s42
    s_add_u32 s42, s42, 1024
    buffer_load_dwordx4 v178, s[12:15], s99 offen lds
    v_mfma_f32_16x16x32_bf16 v[144:147], v[56:59], a[80:83], v[144:147]
    v_mfma_f32_16x16x32_bf16 v[148:151], a[80:83], a[80:83], v[148:151]
    s_mov_b32 m0, s42
    s_add_u32 s42, s42, 1024
    buffer_load_dwordx4 v179, s[12:15], s99 offen lds
    v_mfma_f32_16x16x32_bf16 v[144:147], v[56:59], a[88:91], v[144:147]
    v_mfma_f32_16x16x32_bf16 v[148:151], a[88:91], a[88:91], v[148:151]
    s_mov_b32 m0, s42
    s_add_u32 s42, s42, 1024
    buffer_load_dwordx4 v180, s[12:15], s99 offen lds
    v_mfma_f32_16x16x32_bf16 v[144:147], v[56:59], a[96:99], v[144:147]
    v_mfma_f32_16x16x32_bf16 v[148:151], a[96:99], a[96:99], v[148:151]
    s_mov_b32 m0, s42
    s_add_u32 s42, s42, 1024
    buffer_load_dwordx4 v181, s[12:15], s99 offen lds
    v_mfma_f32_16x16x32_bf16 v[144:147], v[56:59], a[104:107], v[144:147]
    v_mfma_f32_16x16x32_bf16 v[148:151], a[104:107], a[104:107], v[148:151]
    s_mov_b32 m0, s42
    s_add_u32 s42, s42, 1024
    buffer_load_dwordx4 v182, s[12:15], s99 offen lds
    v_mfma_f32_16x16x32_bf16 v[144:147], v[56:59], a[112:115], v[144:147]
    v_mfma_f32_16x16x32_bf16 v[148:151], a[112:115], a[112:115], v[148:151]
    s_mov_b32 m0, s42
    s_add_u32 s42, s42, 1024
    buffer_load_dwordx4 v183, s[12:15], s99 offen lds
    v_mfma_f32_16x16x32_bf16 v[144:147], v[56:59], a[120:123], v[144:147]
    v_mfma_f32_16x16x32_bf16 v[148:151], a[120:123], a[120:123], v[148:151]
    s_mov_b32 m0, s42
    s_add_u32 s42, s42, 1024
    buffer_load_dwordx4 v184, s[12:15], s99 offen lds
    v_mfma_f32_16x16x32_bf16 v[144:147], v[56:59], a[128:131], v[144:147]
    v_mfma_f32_16x16x32_bf16 v[148:151], a[128:131], a[128:131], v[148:151]
    s_mov_b32 m0, s42
    s_add_u32 s42, s42, 1024
    buffer_load_dwordx4 v185, s[12:15], s99 offen lds
    v_mfma_f32_16x16x32_bf16 v[144:147], v[56:59], a[136:139], v[144:147]
    v_mfma_f32_16x16x32_bf16 v[148:151], a[136:139], a[136:139], v[148:151]
    s_mov_b32 m0, s42
    s_add_u32 s42, s42, 1024
    buffer_load_dwordx4 v186, s[12:15], s99 offen lds
    v_mfma_f32_16x16x32_bf16 v[144:147], v[56:59], a[144:147], v[144:147]
    v_mfma_f32_16x16x32_bf16 v[148:151], a[144:147], a[144:147], v[148:151]
    s_mov_b32 m0, s42
    s_add_u32 s42, s42, 1024
    buffer_load_dwordx4 v187, s[12:15], s99 offen lds
    v_mfma_f32_16x16x32_bf16 v[144:147], v[56:59], a[152:155], v[144:147]
    v_mfma_f32_16x16x32_bf16 v[148:151], a[152:155], a[152:155], v[148:151]
    s_mov_b32 s21, 4096
    s_mov_b32 s22, 8192
    s_mov_b32 s23, 12288
    s_mov_b32 s24, 16384
    s_cmp_lg_u32 s16, 0
    s_nop 2
    s_cbranch_scc1 S_wait
    s_lshr_b32 s26, s18, 2
    s_lshr_b32 s27, s18, 3
    s_add_u32 s27, s27, 40
    s_lshl_b32 s28, s17, 4
    v_lshl_add_u32 v36, v231, 2, s26
    v_lshl_add_u32 v37, v231, 1, s27
    v_cmp_gt_u32 vcc, 20, v231
    s_nop 1
    v_cndmask_b32 v36, v37, v36, vcc
    v_lshrrev_b32 v37, 3, v36
    v_and_b32 v36, 7, v36
    v_lshl_add_u32 v36, v37, 4, v36
    v_add_u32 v36, 8, v36
    v_add_u32 v37, s28, v232
    v_cmp_gt_u32 s[26:27], 40, v231
    s_nop 1
    v_cndmask_b32 v36, v37, v36, s[26:27]
    v_lshlrev_b32 v36, 7, v36
    s_mov_b32 s3, 20873216
    s_mov_b32 s60, 0
S_poll:
    buffer_load_dword v14, v36, s[4:7], s3 offen sc1
    s_add_u32 s60, s60, 1
    s_cmp_gt_u32 s60, 0x40000
    s_cbranch_scc1 L_abort
    s_waitcnt vmcnt(0)
    v_subrev_u32 v37, s91, v14
    v_cmp_le_u32 vcc, 16, v37
    s_nop 1
    s_cbranch_vccnz S_poll
    v_cmp_ne_u32 vcc, s90, v14
    s_nop 0
    s_andn2_b64 vcc, vcc, s[26:27]
    s_cselect_b32 s3, 0, 1
    v_mov_b32_e64 v36, s3
    v_mov_b32 v37, 156928
    ds_write_b32 v37, v36
    s_nop 0
S_wait:
    s_waitcnt vmcnt(0) lgkmcnt(0)
    ds_read_b128 a[4:7], v188 offset:0
    ds_read_b128 a[100:103], v189 offset:0
    ds_read_b128 a[12:15], v190 offset:0
    ds_read_b128 a[20:23], v191 offset:0
    ds_read_b128 a[108:111], v188 offset:256
    ds_read_b128 a[28:31], v189 offset:256
    ds_read_b128 a[116:119], v190 offset:256
    ds_read_b128 a[36:39], v191 offset:256
    ds_read_b128 a[44:47], v188 offset:512
    ds_read_b128 a[124:127], v189 offset:512
    ds_read_b128 a[52:55], v190 offset:512
    ds_read_b128 a[132:135], v191 offset:512
    ds_read_b128 a[60:63], v188 offset:768
    ds_read_b128 a[68:71], v189 offset:768
    ds_read_b128 a[140:143], v190 offset:768
    ds_read_b128 a[76:79], v191 offset:768
    ds_read_b128 a[148:151], v188 offset:1024
    ds_read_b128 a[84:87], v189 offset:1024
    ds_read_b128 a[92:95], v190 offset:1024
    ds_read_b128 a[156:159], v191 offset:1024
    s_waitcnt lgkmcnt(0)
    s_barrier
    v_mov_b32 v37, 156928
    ds_read_b32 v239, v37
    s_lshl_b32 s91, s2, 2
    s_add_u32 s91, s91, 20905984
    s_add_u32 s83, s97, s25
    s_add_u32 s82, s97, 71680
    s_add_u32 s83, s83, 51200
    s_mov_b32 m0, s82
    s_nop 0
    buffer_load_dwordx4 v1, s[4:7], s83 offen offset:0 lds
    buffer_load_dwordx4 v1, s[4:7], s83 offen offset:1024 lds
    buffer_load_dwordx4 v1, s[4:7], s83 offen offset:2048 lds
    buffer_load_dwordx4 v1, s[4:7], s83 offen offset:3072 lds
    s_add_u32 s83, s97, s25
    s_add_u32 s82, s97, 88064
    s_add_u32 s83, s83, 67584
    s_mov_b32 m0, s82
    s_nop 0
    buffer_load_dwordx4 v1, s[4:7], s83 offen offset:0 lds
    buffer_load_dwordx4 v1, s[4:7], s83 offen offset:1024 lds
    buffer_load_dwordx4 v1, s[4:7], s83 offen offset:2048 lds
    buffer_load_dwordx4 v1, s[4:7], s83 offen offset:3072 lds
    v_mfma_f32_16x16x32_bf16 v[152:155], v[56:59], a[4:7], 0
    v_mfma_f32_16x16x32_bf16 v[156:159], a[4:7], a[4:7], 0
    v_mfma_f32_16x16x32_bf16 v[152:155], v[56:59], a[12:15], v[152:155]
    v_mfma_f32_16x16x32_bf16 v[156:159], a[12:15], a[12:15], v[156:159]
    v_mfma_f32_16x16x32_bf16 v[152:155], v[56:59], a[20:23], v[152:155]
    v_mfma_f32_16x16x32_bf16 v[156:159], a[20:23], a[20:23], v[156:159]
    v_mfma_f32_16x16x32_bf16 v[152:155], v[56:59], a[28:31], v[152:155]
    v_mfma_f32_16x16x32_bf16 v[156:159], a[28:31], a[28:31], v[156:159]
    v_mfma_f32_16x16x32_bf16 v[152:155], v[56:59], a[36:39], v[152:155]
    v_mfma_f32_16x16x32_bf16 v[156:159], a[36:39], a[36:39], v[156:159]
    v_mfma_f32_16x16x32_bf16 v[152:155], v[56:59], a[44:47], v[152:155]
    v_mfma_f32_16x16x32_bf16 v[156:159], a[44:47], a[44:47], v[156:159]
    v_mfma_f32_16x16x32_bf16 v[152:155], v[56:59], a[52:55], v[152:155]
    v_mfma_f32_16x16x32_bf16 v[156:159], a[52:55], a[52:55], v[156:159]
    v_mfma_f32_16x16x32_bf16 v[152:155], v[56:59], a[60:63], v[152:155]
    v_mfma_f32_16x16x32_bf16 v[156:159], a[60:63], a[60:63], v[156:159]
    v_mfma_f32_16x16x32_bf16 v[152:155], v[56:59], a[68:71], v[152:155]
    v_mfma_f32_16x16x32_bf16 v[156:159], a[68:71], a[68:71], v[156:159]
    v_mfma_f32_16x16x32_bf16 v[152:155], v[56:59], a[76:79], v[152:155]
    v_mfma_f32_16x16x32_bf16 v[156:159], a[76:79], a[76:79], v[156:159]
    v_mfma_f32_16x16x32_bf16 v[152:155], v[56:59], a[84:87], v[152:155]
    v_mfma_f32_16x16x32_bf16 v[156:159], a[84:87], a[84:87], v[156:159]
    v_mfma_f32_16x16x32_bf16 v[152:155], v[56:59], a[92:95], v[152:155]
    v_mfma_f32_16x16x32_bf16 v[156:159], a[92:95], a[92:95], v[156:159]
    v_mfma_f32_16x16x32_bf16 v[152:155], v[56:59], a[100:103], v[152:155]
    v_mfma_f32_16x16x32_bf16 v[156:159], a[100:103], a[100:103], v[156:159]
    v_mfma_f32_16x16x32_bf16 v[152:155], v[56:59], a[108:111], v[152:155]
    v_mfma_f32_16x16x32_bf16 v[156:159], a[108:111], a[108:111], v[156:159]
    v_mfma_f32_16x16x32_bf16 v[152:155], v[56:59], a[116:119], v[152:155]
    v_mfma_f32_16x16x32_bf16 v[156:159], a[116:119], a[116:119], v[156:159]
    v_mfma_f32_16x16x32_bf16 v[152:155], v[56:59], a[124:127], v[152:155]
    v_mfma_f32_16x16x32_bf16 v[156:159], a[124:127], a[124:127], v[156:159]
    v_mfma_f32_16x16x32_bf16 v[152:155], v[56:59], a[132:135], v[152:155]
    v_mfma_f32_16x16x32_bf16 v[156:159], a[132:135], a[132:135], v[156:159]
    v_mfma_f32_16x16x32_bf16 v[152:155], v[56:59], a[140:143], v[152:155]
    v_mfma_f32_16x16x32_bf16 v[156:159], a[140:143], a[140:143], v[156:159]
    v_mfma_f32_16x16x32_bf16 v[152:155], v[56:59], a[148:151], v[152:155]
    v_mfma_f32_16x16x32_bf16 v[156:159], a[148:151], a[148:151], v[156:159]
    v_mfma_f32_16x16x32_bf16 v[152:155], v[56:59], a[156:159], v[152:155]
    v_mfma_f32_16x16x32_bf16 v[156:159], a[156:159], a[156:159], v[156:159]
    s_waitcnt lgkmcnt(0)
    v_readfirstlane_b32 s90, v239
    v_cmp_eq_u32 s[26:27], v236, v233
    s_mov_b32 s28, 0xaaaaaaaa
    s_mov_b32 s29, 0xaaaaaaaa
    s_mov_b32 s30, 0xcccccccc
    s_mov_b32 s31, 0xcccccccc
    v_cndmask_b32 v148, v148, v149, s[28:29]
    v_cndmask_b32 v150, v150, v151, s[28:29]
    v_cndmask_b32 v148, v148, v150, s[30:31]
    v_cndmask_b32 v148, 0, v148, s[26:27]
    v_cndmask_b32 v156, v156, v157, s[28:29]
    v_cndmask_b32 v158, v158, v159, s[28:29]
    v_cndmask_b32 v156, v156, v158, s[30:31]
    v_cndmask_b32 v156, 0, v156, s[26:27]
    v_mov_b32 v149, v148
    v_mov_b32 v157, v156
    s_nop 0
    v_permlane16_swap_b32 v148, v149
    v_permlane16_swap_b32 v156, v157
    v_add_f32 v148, v148, v149
    v_add_f32 v156, v156, v157
    v_mov_b32 v149, v148
    v_mov_b32 v157, v156
    s_nop 0
    v_permlane32_swap_b32 v148, v149
    v_permlane32_swap_b32 v156, v157
    v_add_f32 v148, v148, v149
    v_add_f32 v156, v156, v157
    v_mov_b32 v145, v148
    v_mov_b32_e64 v153, v156
    v_add_u32 v3, 0x10000, v1
    v_add_u32 v4, 0x20000, v1
    s_waitcnt vmcnt(4)
    s_barrier
    v_mov_b32 v15, s39
    s_mov_b64 exec, s[92:93]
    buffer_store_dword v15, off, s[4:7], s91 sc1
    s_mov_b64 exec, -1
    ds_read_b128 v[76:79], v3 offset:6144
    ds_read_b128 v[80:83], v3 offset:7168
    ds_read_b128 v[84:87], v3 offset:8192
    ds_read_b128 v[88:91], v3 offset:9216
    ds_read_b128 v[92:95], v3 offset:10240
    s_waitcnt lgkmcnt(4)
    v_mfma_f32_16x16x32_bf16 v[36:39], a[0:3], v[76:79], 0
    ds_read_b128 v[96:99], v3 offset:11264
    s_mov_b32 s8, s54
    s_mov_b32 s9, s55
    s_mov_b32 s10, 2621440
    v_mfma_f32_16x16x32_bf16 v[40:43], a[4:7], v[76:79], 0
    s_mov_b32 s11, 0x20000
    s_mov_b32 s52, s101
    s_lshl_b32 s19, s17, 1
    s_add_u32 s83, s97, s25
    s_add_u32 s82, s97, 104448
    s_add_u32 s83, s83, 83968
    s_mov_b32 m0, s82
    s_nop 0
    buffer_load_dwordx4 v1, s[4:7], s83 offen offset:0 lds
    s_waitcnt lgkmcnt(4)
    v_mfma_f32_16x16x32_bf16 v[44:47], a[0:3], v[80:83], 0
    ds_read_b128 v[100:103], v3 offset:12288
    s_lshr_b32 s3, s18, 3
    s_add_u32 s19, s19, s3
    s_and_b32 s20, s18, 7
    v_mfma_f32_16x16x32_bf16 v[48:51], a[4:7], v[80:83], 0
    s_mul_i32 s26, s18, 143360
    s_add_u32 s26, s26, 2457600
    s_mul_i32 s27, s20, 102400
    s_waitcnt lgkmcnt(4)
    v_mfma_f32_16x16x32_bf16 v[52:55], a[0:3], v[84:87], 0
    ds_read_b128 v[104:107], v3 offset:13312
    s_mul_i32 s3, s16, 25600
    s_add_u32 s27, s27, s3
    s_add_u32 s27, s27, 4751360
    buffer_load_dwordx4 v1, s[4:7], s83 offen offset:1024 lds
    v_mfma_f32_16x16x32_bf16 v[56:59], a[4:7], v[84:87], 0
    s_mul_i32 s28, s20, 286720
    s_mul_i32 s3, s16, 71680
    s_add_u32 s28, s28, s3
    s_waitcnt lgkmcnt(4)
    v_mfma_f32_16x16x32_bf16 v[60:63], a[0:3], v[88:91], 0
    ds_read_b128 v[108:111], v3 offset:14336
    s_add_u32 s28, s28, 5570560
    v_add_u32 v26, 4096, v1
    v_lshrrev_b32 v234, 2, v232
    v_mfma_f32_16x16x32_bf16 v[64:67], a[4:7], v[88:91], 0
    v_and_b32_e64 v235, 1, v232
    v_lshl_add_u32 v234, v234, 1, v235
    v_lshl_add_u32 v234, v233, 3, v234
    buffer_load_dwordx4 v1, s[4:7], s83 offen offset:2048 lds
    s_waitcnt lgkmcnt(4)
    v_mfma_f32_16x16x32_bf16 v[68:71], a[0:3], v[92:95], 0
    ds_read_b128 v[112:115], v3 offset:15360
    v_lshlrev_b32 v5, 4, v234
    s_lshl_b32 s53, s19, 2
    s_add_u32 s53, s53, s16
    v_mfma_f32_16x16x32_bf16 v[72:75], a[4:7], v[92:95], 0
    s_lshr_b32 s54, s52, 2
    s_and_b32 s55, s16, 1
    v_lshlrev_b32 v234, 6, v232
    s_waitcnt lgkmcnt(4)
    v_mfma_f32_16x16x32_bf16 v[36:39], a[8:11], v[96:99], v[36:39]
    ds_read_b128 v[76:79], v3 offset:16384
    v_lshl_add_u32 v235, v233, 4, v234
    s_lshl_b32 s3, s52, 10
    s_add_u32 s3, s3, 13631488
    v_mfma_f32_16x16x32_bf16 v[40:43], a[12:15], v[96:99], v[40:43]
    v_add_u32 v8, s3, v235
    v_lshrrev_b32_e64 v235, 1, v233
    v_lshl_add_u32 v235, v235, 5, v234
    s_waitcnt lgkmcnt(4)
    v_mfma_f32_16x16x32_bf16 v[44:47], a[8:11], v[100:103], v[44:47]
    ds_read_b128 v[80:83], v3 offset:17408
    s_lshl_b32 s3, s53, 10
    s_lshl_b32 s56, s20, 2
    s_add_u32 s3, s3, s56
    buffer_load_dwordx4 v1, s[4:7], s83 offen offset:3072 lds
    v_mfma_f32_16x16x32_bf16 v[48:51], a[12:15], v[100:103], v[48:51]
    s_add_u32 s3, s3, 13631488
    v_add_u32 v9, s3, v235
    s_lshr_b32 s56, s20, 1
    s_waitcnt lgkmcnt(4)
    v_mfma_f32_16x16x32_bf16 v[52:55], a[8:11], v[104:107], v[52:55]
    ds_read_b128 v[84:87], v3 offset:18432
    s_mul_i32 s56, s56, 5
    s_and_b32 s57, s20, 1
    s_mul_i32 s3, s57, 3
    v_mfma_f32_16x16x32_bf16 v[56:59], a[12:15], v[104:107], v[56:59]
    s_add_u32 s3, s3, s56
    s_lshl_b32 s61, s3, 6
    s_mul_i32 s62, s53, 20
    s_waitcnt lgkmcnt(4)
    v_mfma_f32_16x16x32_bf16 v[60:63], a[8:11], v[108:111], v[60:63]
    ds_read_b128 v[88:91], v3 offset:19456
    s_add_u32 s3, s3, s62
    s_lshl_b32 s3, s3, 10
    s_add_u32 s3, s3, 8388608
    v_mfma_f32_16x16x32_bf16 v[64:67], a[12:15], v[108:111], v[64:67]
    v_add_u32 v10, s3, v1
    s_add_u32 s3, s56, 2
    s_add_u32 s3, s3, s62
    s_add_u32 s83, s97, s25
    s_add_u32 s82, s97, 120832
    s_add_u32 s83, s83, 100352
    s_mov_b32 m0, s82
    s_nop 0
    buffer_load_dwordx4 v1, s[4:7], s83 offen offset:0 lds
    s_waitcnt lgkmcnt(4)
    v_mfma_f32_16x16x32_bf16 v[68:71], a[8:11], v[112:115], v[68:71]
    ds_read_b128 v[92:95], v3 offset:20480
    s_lshl_b32 s3, s3, 10
    s_lshl_b32 s63, s57, 3
    s_add_u32 s3, s3, s63
    v_mfma_f32_16x16x32_bf16 v[72:75], a[12:15], v[112:115], v[72:75]
    s_add_u32 s3, s3, 8388608
    v_add_u32 v11, s3, v1
    s_mul_i32 s3, s53, 20480
    s_waitcnt lgkmcnt(4)
    v_mfma_f32_16x16x32_bf16 v[36:39], a[16:19], v[76:79], v[36:39]
    s_waitcnt vmcnt(6)
    s_barrier
    v_mfma_f32_16x16x32_bf16 v[40:43], a[20:23], v[76:79], v[40:43]
    ds_read_b128 v[96:99], v3 offset:21504
    s_add_u32 s61, s61, s3
    v_lshlrev_b32 v12, 4, v233
    v_add_u32 v12, 153600, v12
    v_lshlrev_b32 v13, 2, v232
    s_waitcnt lgkmcnt(4)
    v_mfma_f32_16x16x32_bf16 v[44:47], a[16:19], v[80:83], v[44:47]
    ds_read_b128 v[100:103], v3 offset:22528
    v_add_u32 v13, 153600, v13
    s_mul_i32 s3, s54, 221184
    s_mul_i32 s62, s55, 40960
    buffer_load_dwordx4 v1, s[4:7], s83 offen offset:1024 lds
    v_mfma_f32_16x16x32_bf16 v[48:51], a[20:23], v[80:83], v[48:51]
    ds_read_b128 v[104:107], v3 offset:23552
    s_add_u32 s3, s3, s62
    s_lshr_b32 s62, s18, 2
    s_mul_i32 s62, s62, 5120
    s_waitcnt lgkmcnt(5)
    v_mfma_f32_16x16x32_bf16 v[52:55], a[16:19], v[84:87], v[52:55]
    ds_read_b128 v[108:111], v3 offset:24576
    s_add_u32 s3, s3, s62
    s_and_b32 s62, s18, 3
    s_lshl_b32 s63, s62, 10
    s_add_u32 s3, s3, s63
    v_mfma_f32_16x16x32_bf16 v[56:59], a[20:23], v[84:87], v[56:59]
    ds_read_b128 v[112:115], v3 offset:25600
    s_add_u32 s29, s3, 13762560
    s_add_u32 s30, s29, 20480
    s_mul_i32 s62, s62, 1020
    buffer_load_dwordx4 v1, s[4:7], s83 offen offset:2048 lds
    s_waitcnt lgkmcnt(6)
    v_mfma_f32_16x16x32_bf16 v[60:63], a[16:19], v[88:91], v[60:63]
    s_sub_u32 s62, 4096, s62
    v_add_u32 v27, s62, v1
    s_and_b32 s62, s18, 1
    v_mfma_f32_16x16x32_bf16 v[64:67], a[20:23], v[88:91], v[64:67]
    s_lshl_b32 s62, s62, 3
    v_add_u32 v28, s62, v1
    s_add_u32 s3, s16, 1
    s_and_b32 s3, s3, 3
    s_waitcnt lgkmcnt(5)
    v_mfma_f32_16x16x32_bf16 v[68:71], a[16:19], v[92:95], v[68:71]
    s_mul_i32 s63, s3, 15360
    s_add_u32 s63, s63, 0
    v_add_u32 v29, s63, v1
    buffer_load_dwordx4 v1, s[4:7], s83 offen offset:3072 lds
    v_mfma_f32_16x16x32_bf16 v[72:75], a[20:23], v[92:95], v[72:75]
    s_lshl_b32 s3, s3, 2
    s_add_u32 s3, s3, s16
    s_mul_i32 s3, s3, 5120
    s_waitcnt lgkmcnt(4)
    v_mfma_f32_16x16x32_bf16 v[36:39], a[24:27], v[96:99], v[36:39]
    ds_read_b128 v[76:79], v3 offset:26624
    s_mul_i32 s62, s19, 221184
    s_add_u32 s3, s3, s62
    s_add_u32 s31, s3, 13762560
    v_mfma_f32_16x16x32_bf16 v[40:43], a[28:31], v[96:99], v[40:43]
    s_add_u32 s3, s16, 2
    s_and_b32 s3, s3, 3
    s_mul_i32 s63, s3, 15360
    s_waitcnt lgkmcnt(4)
    v_mfma_f32_16x16x32_bf16 v[44:47], a[24:27], v[100:103], v[44:47]
    ds_read_b128 v[80:83], v3 offset:27648
    s_add_u32 s63, s63, 5120
    v_add_u32 v30, s63, v1
    s_lshl_b32 s3, s3, 2
    s_add_u32 s83, s97, s25
    s_add_u32 s82, s97, 137216
    s_add_u32 s83, s83, 116736
    s_mov_b32 m0, s82
    s_nop 0
    buffer_load_dwordx4 v1, s[4:7], s83 offen offset:0 lds
    v_mfma_f32_16x16x32_bf16 v[48:51], a[28:31], v[100:103], v[48:51]
    s_add_u32 s3, s3, s16
    s_mul_i32 s3, s3, 5120
    s_mul_i32 s62, s19, 221184
    s_waitcnt lgkmcnt(4)
    v_mfma_f32_16x16x32_bf16 v[52:55], a[24:27], v[104:107], v[52:55]
    ds_read_b128 v[84:87], v3 offset:28672
    s_add_u32 s3, s3, s62
    s_add_u32 s32, s3, 13762560
    s_add_u32 s3, s16, 3
    v_mfma_f32_16x16x32_bf16 v[56:59], a[28:31], v[104:107], v[56:59]
    s_and_b32 s3, s3, 3
    s_mul_i32 s63, s3, 15360
    s_add_u32 s63, s63, 10240
    s_waitcnt lgkmcnt(4)
    v_mfma_f32_16x16x32_bf16 v[60:63], a[24:27], v[108:111], v[60:63]
    ds_read_b128 v[88:91], v3 offset:29696
    v_add_u32 v31, s63, v1
    s_lshl_b32 s3, s3, 2
    s_add_u32 s3, s3, s16
    v_mfma_f32_16x16x32_bf16 v[64:67], a[28:31], v[108:111], v[64:67]
    s_mul_i32 s3, s3, 5120
    s_mul_i32 s62, s19, 221184
    s_add_u32 s3, s3, s62
    buffer_load_dwordx4 v1, s[4:7], s83 offen offset:1024 lds
    s_waitcnt lgkmcnt(4)
    v_mfma_f32_16x16x32_bf16 v[68:71], a[24:27], v[112:115], v[68:71]
    ds_read_b128 v[92:95], v3 offset:30720
    s_add_u32 s33, s3, 13762560
    s_add_u32 s3, s16, 4
    s_and_b32 s3, s3, 3
    v_mfma_f32_16x16x32_bf16 v[72:75], a[28:31], v[112:115], v[72:75]
    s_mul_i32 s63, s3, 15360
    s_add_u32 s63, s63, 0
    v_add_u32 v32, s63, v1
    s_waitcnt lgkmcnt(4)
    v_mfma_f32_16x16x32_bf16 v[36:39], a[32:35], v[76:79], v[36:39]
    ds_read_b128 v[96:99], v3 offset:31744
    s_lshl_b32 s3, s3, 2
    s_add_u32 s3, s3, s16
    s_mul_i32 s3, s3, 5120
    v_mfma_f32_16x16x32_bf16 v[40:43], a[36:39], v[76:79], v[40:43]
    s_mul_i32 s62, s19, 221184
    s_add_u32 s3, s3, s62
    s_add_u32 s34, s3, 13762560
    s_waitcnt lgkmcnt(4)
    v_mfma_f32_16x16x32_bf16 v[44:47], a[32:35], v[80:83], v[44:47]
    ds_read_b128 v[100:103], v3 offset:32768
    s_mul_i32 s3, s16, 5120
    s_add_u32 s3, s3, 71680
    v_add_u32 v33, s3, v1
    buffer_load_dwordx4 v1, s[4:7], s83 offen offset:2048 lds
    v_mfma_f32_16x16x32_bf16 v[48:51], a[36:39], v[80:83], v[48:51]
    s_mul_i32 s3, s16, 1280
    s_add_u32 s3, s3, 71680
    v_add_u32 v34, s3, v2
    s_waitcnt lgkmcnt(4)
    v_mfma_f32_16x16x32_bf16 v[52:55], a[32:35], v[84:87], v[52:55]
    ds_read_b128 v[104:107], v3 offset:33792
    s_mul_i32 s3, s54, 221184
    s_lshl_b32 s62, s55, 11
    s_add_u32 s3, s3, s62
    v_mfma_f32_16x16x32_bf16 v[56:59], a[36:39], v[84:87], v[56:59]
    s_add_u32 s3, s3, 13762560
    s_lshl_b32 s62, s18, 12
    s_add_u32 s38, s3, s62
    s_waitcnt lgkmcnt(4)
    v_mfma_f32_16x16x32_bf16 v[60:63], a[32:35], v[88:91], v[60:63]
    ds_read_b128 v[108:111], v3 offset:34816
    s_add_u32 s35, s38, s62
    s_add_u32 s35, s35, 90112
    s_lshr_b32 s62, s18, 1
    v_mfma_f32_16x16x32_bf16 v[64:67], a[36:39], v[88:91], v[64:67]
    s_add_u32 s62, s62, 16
    s_lshl_b32 s62, s62, 12
    s_add_u32 s3, s3, s62
    buffer_load_dwordx4 v1, s[4:7], s83 offen offset:3072 lds
    s_waitcnt lgkmcnt(4)
    v_mfma_f32_16x16x32_bf16 v[68:71], a[32:35], v[92:95], v[68:71]
    ds_read_b128 v[112:115], v3 offset:35840
    s_cmp_lt_u32 s18, 12
    s_cselect_b32 s36, s3, 268435456
    s_mul_i32 s3, s19, 221184
    s_add_u32 s37, s3, 13762560
    v_mfma_f32_16x16x32_bf16 v[72:75], a[36:39], v[92:95], v[72:75]
    s_lshr_b32 s3, s53, 1
    s_lshl_b32 s3, s3, 7
    s_and_b32 s62, s53, 1
    s_waitcnt lgkmcnt(4)
    v_mfma_f32_16x16x32_bf16 v[36:39], a[40:43], v[96:99], v[36:39]
    s_waitcnt vmcnt(8)
    s_barrier
    v_mfma_f32_16x16x32_bf16 v[40:43], a[44:47], v[96:99], v[40:43]
    ds_read_b128 v[76:79], v3 offset:36864
    s_lshl_b32 s62, s62, 3
    s_add_u32 s62, s62, s20
    s_lshl_b32 s62, s62, 2
    s_add_u32 s3, s3, s62
    s_waitcnt lgkmcnt(4)
    v_mfma_f32_16x16x32_bf16 v[44:47], a[40:43], v[100:103], v[44:47]
    ds_read_b128 v[80:83], v3 offset:37888
    s_add_u32 s40, s3, 8355840
    s_lshr_b32 s3, s52, 1
    s_lshl_b32 s3, s3, 7
    v_mfma_f32_16x16x32_bf16 v[48:51], a[44:47], v[100:103], v[48:51]
    ds_read_b128 v[84:87], v3 offset:38912
    s_add_u32 s41, s3, 8355840
    s_lshl_b32 s3, s54, 7
    s_lshl_b32 s62, s18, 1
    s_waitcnt lgkmcnt(5)
    v_mfma_f32_16x16x32_bf16 v[52:55], a[40:43], v[104:107], v[52:55]
    ds_read_b128 v[88:91], v3 offset:39936
    s_add_u32 s62, s62, s55
    s_lshl_b32 s62, s62, 2
    s_add_u32 s3, s3, s62
    s_add_u32 s42, s3, 8364032
    v_mfma_f32_16x16x32_bf16 v[56:59], a[44:47], v[104:107], v[56:59]
    ds_read_b128 v[92:95], v3 offset:40960
    s_add_u32 s44, s3, 8368128
    s_lshl_b32 s3, s19, 7
    s_add_u32 s45, s3, 8368128
    s_waitcnt lgkmcnt(6)
    v_mfma_f32_16x16x32_bf16 v[60:63], a[40:43], v[108:111], v[60:63]
    s_lshl_b32 s62, s16, 5
    s_add_u32 s3, s3, s62
    s_add_u32 s43, s3, 8364032
    v_mfma_f32_16x16x32_bf16 v[64:67], a[44:47], v[108:111], v[64:67]
    s_mul_i32 s46, s18, 5120
    s_add_u32 s46, s46, 8192000
    s_mul_i32 s3, s16, 1280
    s_add_u32 s47, s46, s3
    s_waitcnt lgkmcnt(5)
    v_mfma_f32_16x16x32_bf16 v[68:71], a[40:43], v[112:115], v[68:71]
    s_mov_b32 s48, 0xaaaaaaaa
    s_mov_b32 s49, 0xaaaaaaaa
    s_mov_b32 s50, 0x33333333
    v_mfma_f32_16x16x32_bf16 v[72:75], a[44:47], v[112:115], v[72:75]
    s_mov_b32 s51, 0x33333333
    s_mov_b32 s76, 897988541
    s_mov_b32 s77, 897988541
    s_waitcnt lgkmcnt(4)
    v_mfma_f32_16x16x32_bf16 v[36:39], a[48:51], v[76:79], v[36:39]
    ds_read_b128 v[96:99], v3 offset:41984
    s_mov_b32 s78, 1069066811
    s_mov_b32 s79, 1069066811
    s_mov_b32 s80, 3049365963
    v_mfma_f32_16x16x32_bf16 v[40:43], a[52:55], v[76:79], v[40:43]
    s_mov_b32 s81, 3049365963
    s_mov_b32 s62, 640
    s_mov_b32 s72, 21495808
    s_waitcnt lgkmcnt(4)
    v_mfma_f32_16x16x32_bf16 v[44:47], a[48:51], v[80:83], v[44:47]
    ds_read_b128 v[100:103], v3 offset:43008
    s_lshl_b32 s63, s55, 6
    s_cmp_ge_u32 s16, 2
    s_cselect_b32 s62, 512, s62
    s_cselect_b32 s72, 8028160, s72
    s_cselect_b32 s63, 0, s63
    s_mul_i32 s3, s18, 20
    v_mfma_f32_16x16x32_bf16 v[48:51], a[52:55], v[80:83], v[48:51]
    s_mul_i32 s3, s3, s62
    s_add_u32 s72, s72, s3
    s_lshl_b32 s3, s55, 8
    s_waitcnt lgkmcnt(4)
    v_mfma_f32_16x16x32_bf16 v[52:55], a[48:51], v[84:87], v[52:55]
    ds_read_b128 v[104:107], v3 offset:44032
    s_add_u32 s72, s72, s3
    s_lshl_b32 s73, s62, 2
    v_mul_lo_u32 v141, v233, s62
    v_mfma_f32_16x16x32_bf16 v[56:59], a[52:55], v[84:87], v[56:59]
    v_lshl_add_u32 v141, v232, 4, v141
    v_add_u32 v234, s63, v141
    v_cmp_le_u32 vcc, 4, v232
    s_nop 1
    v_cndmask_b32 v141, v141, v234, vcc
    s_waitcnt lgkmcnt(4)
    v_mfma_f32_16x16x32_bf16 v[60:63], a[48:51], v[88:91], v[60:63]
    ds_read_b128 v[108:111], v3 offset:45056
    v_lshrrev_b32 v234, 1, v233
    v_and_b32 v235, 1, v233
    v_lshl_add_u32 v234, v235, 1, v234
    v_mfma_f32_16x16x32_bf16 v[64:67], a[52:55], v[88:91], v[64:67]
    v_lshl_add_u32 v234, v232, 2, v234
    s_lshl_b32 s62, s16, 8
    s_add_u32 s3, s62, 153600
    s_waitcnt lgkmcnt(4)
    v_mfma_f32_16x16x32_bf16 v[68:71], a[48:51], v[92:95], v[68:71]
    ds_read_b128 v[112:115], v3 offset:46080
    v_lshl_add_u32 v142, v234, 2, s3
    s_add_u32 s63, s62, 154624
    s_lshl_b32 s3, s18, 10
    v_mfma_f32_16x16x32_bf16 v[72:75], a[52:55], v[92:95], v[72:75]
    s_add_u32 s62, s62, s3
    s_add_u32 s62, s62, 20840448
    s_waitcnt lgkmcnt(4)
    v_mfma_f32_16x16x32_bf16 v[36:39], a[56:59], v[96:99], v[36:39]
    ds_read_b128 v[76:79], v3 offset:47104
    v_mul_f32 v144, 986500301, v144
    v_mfma_f32_16x16x32_bf16 v[40:43], a[60:63], v[96:99], v[40:43]
    v_mul_f32 v152, 986500301, v152
    s_waitcnt lgkmcnt(4)
    v_mfma_f32_16x16x32_bf16 v[44:47], a[56:59], v[100:103], v[44:47]
    ds_read_b128 v[80:83], v3 offset:48128
    s_add_u32 s85, s97, s25
    s_add_u32 s84, s97, 51200
    s_add_u32 s85, s85, 133120
    s_mov_b32 m0, s84
    s_nop 0
    buffer_load_dwordx4 v1, s[4:7], s85 offen offset:0 lds
    v_mul_f32 v145, 986500301, v145
    v_mfma_f32_16x16x32_bf16 v[48:51], a[60:63], v[100:103], v[48:51]
    s_waitcnt lgkmcnt(4)
    v_mfma_f32_16x16x32_bf16 v[52:55], a[56:59], v[104:107], v[52:55]
    ds_read_b128 v[84:87], v3 offset:49152
    v_mul_f32 v153, 986500301, v153
    v_mfma_f32_16x16x32_bf16 v[56:59], a[60:63], v[104:107], v[56:59]
    v_fma_f32 v145, -v144, v144, v145
    s_waitcnt lgkmcnt(4)
    v_mfma_f32_16x16x32_bf16 v[60:63], a[56:59], v[108:111], v[60:63]
    ds_read_b128 v[88:91], v3 offset:50176
    v_mfma_f32_16x16x32_bf16 v[64:67], a[60:63], v[108:111], v[64:67]
    buffer_load_dwordx4 v1, s[4:7], s85 offen offset:1024 lds
    v_fma_f32 v153, -v152, v152, v153
    s_waitcnt lgkmcnt(4)
    v_mfma_f32_16x16x32_bf16 v[68:71], a[56:59], v[112:115], v[68:71]
    ds_read_b128 v[92:95], v3 offset:51200
    v_max_f32 v145, 0, v145
    v_mfma_f32_16x16x32_bf16 v[72:75], a[60:63], v[112:115], v[72:75]
    s_waitcnt lgkmcnt(4)
    v_mfma_f32_16x16x32_bf16 v[36:39], a[64:67], v[76:79], v[36:39]
    s_waitcnt vmcnt(6)
    s_barrier
    v_mfma_f32_16x16x32_bf16 v[40:43], a[68:71], v[76:79], v[40:43]
    ds_read_b128 v[96:99], v3 offset:52224
    buffer_load_dwordx4 v1, s[4:7], s85 offen offset:2048 lds
    v_max_f32 v153, 0, v153
    s_waitcnt lgkmcnt(4)
    v_mfma_f32_16x16x32_bf16 v[44:47], a[64:67], v[80:83], v[44:47]
    ds_read_b128 v[100:103], v3 offset:53248
    v_add_f32 v145, 925353388, v145
    v_mfma_f32_16x16x32_bf16 v[48:51], a[68:71], v[80:83], v[48:51]
    ds_read_b128 v[104:107], v3 offset:54272
    s_add_u32 s74, s72, 0
    buffer_load_dwordx4 v[204:207], v141, s[4:7], s74 offen sc1
    v_add_f32 v153, 925353388, v153
    s_waitcnt lgkmcnt(5)
    v_mfma_f32_16x16x32_bf16 v[52:55], a[64:67], v[84:87], v[52:55]
    ds_read_b128 v[108:111], v3 offset:55296
    v_rsq_f32 v132, v145
    v_mfma_f32_16x16x32_bf16 v[56:59], a[68:71], v[84:87], v[56:59]
    ds_read_b128 v[112:115], v3 offset:56320
    s_waitcnt lgkmcnt(6)
    v_mfma_f32_16x16x32_bf16 v[60:63], a[64:67], v[88:91], v[60:63]
    s_add_u32 s74, s74, s73
    buffer_load_dwordx4 v[208:211], v141, s[4:7], s74 offen sc1
    v_rsq_f32 v133, v153
    v_mfma_f32_16x16x32_bf16 v[64:67], a[68:71], v[88:91], v[64:67]
    v_mul_f32_e64 v134, -v144, v132
    s_waitcnt lgkmcnt(5)
    v_mfma_f32_16x16x32_bf16 v[68:71], a[64:67], v[92:95], v[68:71]
    s_add_u32 s74, s74, s73
    buffer_load_dwordx4 v[212:215], v141, s[4:7], s74 offen sc1
    v_mul_f32_e64 v135, -v152, v133
    v_mfma_f32_16x16x32_bf16 v[72:75], a[68:71], v[92:95], v[72:75]
    s_waitcnt lgkmcnt(4)
    v_mfma_f32_16x16x32_bf16 v[36:39], a[72:75], v[96:99], v[36:39]
    ds_read_b128 v[76:79], v3 offset:57344
    v_mfma_f32_16x16x32_bf16 v[40:43], a[76:79], v[96:99], v[40:43]
    buffer_load_dwordx4 v1, s[4:7], s85 offen offset:3072 lds
    s_waitcnt lgkmcnt(4)
    v_mfma_f32_16x16x32_bf16 v[44:47], a[72:75], v[100:103], v[44:47]
    ds_read_b128 v[80:83], v3 offset:58368
    v_mfma_f32_16x16x32_bf16 v[48:51], a[76:79], v[100:103], v[48:51]
    s_waitcnt lgkmcnt(4)
    v_mfma_f32_16x16x32_bf16 v[52:55], a[72:75], v[104:107], v[52:55]
    ds_read_b128 v[84:87], v3 offset:59392
    s_add_u32 s74, s74, s73
    buffer_load_dwordx4 v[216:219], v141, s[4:7], s74 offen sc1
    v_mfma_f32_16x16x32_bf16 v[56:59], a[76:79], v[104:107], v[56:59]
    s_waitcnt lgkmcnt(4)
    v_mfma_f32_16x16x32_bf16 v[60:63], a[72:75], v[108:111], v[60:63]
    ds_read_b128 v[88:91], v3 offset:60416
    v_mfma_f32_16x16x32_bf16 v[64:67], a[76:79], v[108:111], v[64:67]
    s_add_u32 s74, s74, s73
    buffer_load_dwordx4 v[220:223], v141, s[4:7], s74 offen sc1
    s_waitcnt lgkmcnt(4)
    v_mfma_f32_16x16x32_bf16 v[68:71], a[72:75], v[112:115], v[68:71]
    ds_read_b128 v[92:95], v3 offset:61440
    v_mfma_f32_16x16x32_bf16 v[72:75], a[76:79], v[112:115], v[72:75]
    s_waitcnt lgkmcnt(4)
    v_mfma_f32_16x16x32_bf16 v[36:39], a[80:83], v[76:79], v[36:39]
    ds_read_b128 v[96:99], v3 offset:62464
    v_mfma_f32_16x16x32_bf16 v[40:43], a[84:87], v[76:79], v[40:43]
    s_waitcnt lgkmcnt(4)
    v_mfma_f32_16x16x32_bf16 v[44:47], a[80:83], v[80:83], v[44:47]
    ds_read_b128 v[100:103], v3 offset:63488
    v_mfma_f32_16x16x32_bf16 v[48:51], a[84:87], v[80:83], v[48:51]
    s_waitcnt lgkmcnt(4)
    v_mfma_f32_16x16x32_bf16 v[52:55], a[80:83], v[84:87], v[52:55]
    ds_read_b128 v[104:107], v3 offset:64512
    s_add_u32 s85, s94, s25
    s_add_u32 s84, s94, 67584
    s_add_u32 s85, s85, 149504
    s_mov_b32 m0, s84
    s_nop 0
    buffer_load_dwordx4 v1, s[4:7], s85 offen offset:0 lds
    v_mfma_f32_16x16x32_bf16 v[56:59], a[84:87], v[84:87], v[56:59]
    s_waitcnt lgkmcnt(4)
    v_mfma_f32_16x16x32_bf16 v[60:63], a[80:83], v[88:91], v[60:63]
    ds_read_b128 v[108:111], v4 offset:0
    v_mfma_f32_16x16x32_bf16 v[64:67], a[84:87], v[88:91], v[64:67]
    s_waitcnt lgkmcnt(4)
    v_mfma_f32_16x16x32_bf16 v[68:71], a[80:83], v[92:95], v[68:71]
    ds_read_b128 v[112:115], v4 offset:1024
    v_mfma_f32_16x16x32_bf16 v[72:75], a[84:87], v[92:95], v[72:75]
    s_waitcnt lgkmcnt(4)
    v_mfma_f32_16x16x32_bf16 v[36:39], a[88:91], v[96:99], v[36:39]
    s_waitcnt vmcnt(10)
    s_barrier
    v_mfma_f32_16x16x32_bf16 v[40:43], a[92:95], v[96:99], v[40:43]
    ds_read_b128 v[76:79], v4 offset:2048
    s_waitcnt lgkmcnt(4)
    v_mfma_f32_16x16x32_bf16 v[44:47], a[88:91], v[100:103], v[44:47]
    ds_read_b128 v[80:83], v4 offset:3072
    s_add_u32 s87, s97, s25
    s_add_u32 s86, s97, 0
    s_mov_b32 m0, s86
    s_nop 0
    buffer_load_dwordx4 v1, s[4:7], s87 offen offset:0 lds
    v_mfma_f32_16x16x32_bf16 v[48:51], a[92:95], v[100:103], v[48:51]
    ds_read_b128 v[84:87], v4 offset:4096
    s_waitcnt lgkmcnt(5)
    v_mfma_f32_16x16x32_bf16 v[52:55], a[88:91], v[104:107], v[52:55]
    ds_read_b128 v[88:91], v4 offset:5120
    v_mfma_f32_16x16x32_bf16 v[56:59], a[92:95], v[104:107], v[56:59]
    ds_read_b128 v[92:95], v4 offset:6144
    s_waitcnt lgkmcnt(6)
    v_mfma_f32_16x16x32_bf16 v[60:63], a[88:91], v[108:111], v[60:63]
    v_mfma_f32_16x16x32_bf16 v[64:67], a[92:95], v[108:111], v[64:67]
    buffer_load_dwordx4 v1, s[4:7], s87 offen offset:1024 lds
    s_waitcnt lgkmcnt(5)
    v_mfma_f32_16x16x32_bf16 v[68:71], a[88:91], v[112:115], v[68:71]
    v_mfma_f32_16x16x32_bf16 v[72:75], a[92:95], v[112:115], v[72:75]
    s_waitcnt lgkmcnt(4)
    v_mfma_f32_16x16x32_bf16 v[36:39], a[96:99], v[76:79], v[36:39]
    ds_read_b128 v[96:99], v4 offset:7168
    v_mfma_f32_16x16x32_bf16 v[40:43], a[100:103], v[76:79], v[40:43]
    s_waitcnt lgkmcnt(4)
    v_mfma_f32_16x16x32_bf16 v[44:47], a[96:99], v[80:83], v[44:47]
    ds_read_b128 v[100:103], v4 offset:8192
    v_mfma_f32_16x16x32_bf16 v[48:51], a[100:103], v[80:83], v[48:51]
    s_waitcnt lgkmcnt(4)
    v_mfma_f32_16x16x32_bf16 v[52:55], a[96:99], v[84:87], v[52:55]
    ds_read_b128 v[104:107], v4 offset:9216
    buffer_load_dwordx4 v1, s[4:7], s87 offen offset:2048 lds
    v_mfma_f32_16x16x32_bf16 v[56:59], a[100:103], v[84:87], v[56:59]
    s_waitcnt lgkmcnt(4)
    v_mfma_f32_16x16x32_bf16 v[60:63], a[96:99], v[88:91], v[60:63]
    ds_read_b128 v[108:111], v4 offset:10240
    v_mfma_f32_16x16x32_bf16 v[64:67], a[100:103], v[88:91], v[64:67]
    s_waitcnt lgkmcnt(4)
    v_mfma_f32_16x16x32_bf16 v[68:71], a[96:99], v[92:95], v[68:71]
    ds_read_b128 v[112:115], v4 offset:11264
    v_mfma_f32_16x16x32_bf16 v[72:75], a[100:103], v[92:95], v[72:75]
    s_waitcnt lgkmcnt(4)
    v_mfma_f32_16x16x32_bf16 v[36:39], a[104:107], v[96:99], v[36:39]
    ds_read_b128 v[76:79], v4 offset:12288
    s_waitcnt vmcnt(8)
    v_add_f32 v204, v204, v208
    s_waitcnt vmcnt(5)
    v_add_f32 v212, v212, v216
    v_mfma_f32_16x16x32_bf16 v[40:43], a[108:111], v[96:99], v[40:43]
    v_add_f32 v205, v205, v209
    s_waitcnt lgkmcnt(4)
    v_mfma_f32_16x16x32_bf16 v[44:47], a[104:107], v[100:103], v[44:47]
    ds_read_b128 v[80:83], v4 offset:13312
    buffer_load_dwordx4 v1, s[4:7], s87 offen offset:3072 lds
    v_add_f32 v213, v213, v217
    v_mfma_f32_16x16x32_bf16 v[48:51], a[108:111], v[100:103], v[48:51]
    v_add_f32 v206, v206, v210
    s_waitcnt lgkmcnt(4)
    v_mfma_f32_16x16x32_bf16 v[52:55], a[104:107], v[104:107], v[52:55]
    ds_read_b128 v[84:87], v4 offset:14336
    v_add_f32 v214, v214, v218
    v_mfma_f32_16x16x32_bf16 v[56:59], a[108:111], v[104:107], v[56:59]
    v_add_f32 v207, v207, v211
    v_add_f32 v215, v215, v219
    s_waitcnt lgkmcnt(4)
    v_mfma_f32_16x16x32_bf16 v[60:63], a[104:107], v[108:111], v[60:63]
    ds_read_b128 v[88:91], v4 offset:15360
    s_waitcnt vmcnt(5)
    v_add_f32 v204, v204, v220
    v_mfma_f32_16x16x32_bf16 v[64:67], a[108:111], v[108:111], v[64:67]
    s_add_u32 s87, s97, s25
    s_add_u32 s86, s97, 16384
    s_add_u32 s87, s87, 16384
    s_mov_b32 m0, s86
    s_nop 0
    buffer_load_dwordx4 v1, s[4:7], s87 offen offset:0 lds
    v_add_f32 v205, v205, v221
    s_waitcnt lgkmcnt(4)
    v_mfma_f32_16x16x32_bf16 v[68:71], a[104:107], v[112:115], v[68:71]
    ds_read_b128 v[92:95], v4 offset:16384
    v_add_f32 v206, v206, v222
    v_mfma_f32_16x16x32_bf16 v[72:75], a[108:111], v[112:115], v[72:75]
    v_add_f32 v207, v207, v223
    s_waitcnt lgkmcnt(4)
    v_mfma_f32_16x16x32_bf16 v[36:39], a[112:115], v[76:79], v[36:39]
    ds_read_b128 v[96:99], v4 offset:17408
    v_add_f32 v204, v204, v212
    v_add_f32 v205, v205, v213
    v_mfma_f32_16x16x32_bf16 v[40:43], a[116:119], v[76:79], v[40:43]
    v_add_f32 v206, v206, v214
    v_add_f32 v207, v207, v215
    s_waitcnt lgkmcnt(4)
    v_mfma_f32_16x16x32_bf16 v[44:47], a[112:115], v[80:83], v[44:47]
    ds_read_b128 v[100:103], v4 offset:18432
    v_permlane32_swap_b32 v204, v205
    v_permlane32_swap_b32 v206, v207
    v_mfma_f32_16x16x32_bf16 v[48:51], a[116:119], v[80:83], v[48:51]
    v_add_f32 v204, v204, v205
    v_add_f32 v206, v206, v207
    s_waitcnt lgkmcnt(4)
    v_mfma_f32_16x16x32_bf16 v[52:55], a[112:115], v[84:87], v[52:55]
    ds_read_b128 v[104:107], v4 offset:19456
    buffer_load_dwordx4 v1, s[4:7], s87 offen offset:1024 lds
    s_nop 0
    v_permlane16_swap_b32 v204, v206
    v_mfma_f32_16x16x32_bf16 v[56:59], a[116:119], v[84:87], v[56:59]
    v_add_f32 v204, v204, v206
    ds_write_b32 v142, v204
    s_waitcnt lgkmcnt(5)
    v_mfma_f32_16x16x32_bf16 v[60:63], a[112:115], v[88:91], v[60:63]
    ds_read_b128 v[108:111], v4 offset:20480
    s_lshl_b32 s3, s16, 8
    v_add_u32 v154, s3, v13
    v_mfma_f32_16x16x32_bf16 v[64:67], a[116:119], v[88:91], v[64:67]
    v_add_u32 v155, s3, v12
    ds_write_b32 v154, v132 offset:2048
    s_waitcnt lgkmcnt(6)
    v_mfma_f32_16x16x32_bf16 v[68:71], a[112:115], v[92:95], v[68:71]
    ds_read_b128 v[112:115], v4 offset:21504
    ds_write_b32 v154, v134 offset:2176
    ds_write_b32 v154, v133 offset:2112
    v_mfma_f32_16x16x32_bf16 v[72:75], a[116:119], v[92:95], v[72:75]
    ds_write_b32 v154, v135 offset:2240
    s_waitcnt lgkmcnt(9)
    v_mfma_f32_16x16x32_bf16 v[36:39], a[120:123], v[96:99], v[36:39]
    s_waitcnt vmcnt(6)
    s_waitcnt lgkmcnt(6)
    s_barrier
    v_mfma_f32_16x16x32_bf16 v[40:43], a[124:127], v[96:99], v[40:43]
    ds_read_b128 v[76:79], v1 offset:51200
    ds_read_b128 v[116:119], v155 offset:2048
    v_mfma_f32_16x16x32_bf16 v[44:47], a[120:123], v[100:103], v[44:47]
    ds_read_b128 v[80:83], v1 offset:52224
    buffer_load_dwordx4 v1, s[4:7], s87 offen offset:2048 lds
    v_mfma_f32_16x16x32_bf16 v[48:51], a[124:127], v[100:103], v[48:51]
    ds_read_b128 v[84:87], v1 offset:53248
    v_mfma_f32_16x16x32_bf16 v[52:55], a[120:123], v[104:107], v[52:55]
    ds_read_b128 v[88:91], v1 offset:54272
    v_mfma_f32_16x16x32_bf16 v[56:59], a[124:127], v[104:107], v[56:59]
    ds_read_b128 v[92:95], v1 offset:55296
    ds_read_b128 v[120:123], v155 offset:2112
    s_waitcnt lgkmcnt(12)
    v_mfma_f32_16x16x32_bf16 v[60:63], a[120:123], v[108:111], v[60:63]
    v_mfma_f32_16x16x32_bf16 v[64:67], a[124:127], v[108:111], v[64:67]
    buffer_load_dwordx4 v1, s[4:7], s87 offen offset:3072 lds
    s_waitcnt lgkmcnt(10)
    v_mfma_f32_16x16x32_bf16 v[68:71], a[120:123], v[112:115], v[68:71]
    v_mfma_f32_16x16x32_bf16 v[72:75], a[124:127], v[112:115], v[72:75]
    s_waitcnt lgkmcnt(6)
    v_mfma_f32_16x16x32_bf16 v[36:39], a[128:131], v[76:79], v[36:39]
    ds_read_b128 v[96:99], v1 offset:56320
    ds_read_b128 v[124:127], v155 offset:2176
    v_mfma_f32_16x16x32_bf16 v[40:43], a[132:135], v[76:79], v[40:43]
    ds_read_b128 v[128:131], v155 offset:2240
    s_waitcnt lgkmcnt(7)
    v_mfma_f32_16x16x32_bf16 v[44:47], a[128:131], v[80:83], v[44:47]
    ds_read_b128 v[100:103], v1 offset:57344
    v_mov_b32 v156, 897988541
    v_mfma_f32_16x16x32_bf16 v[48:51], a[132:135], v[80:83], v[48:51]
    s_waitcnt lgkmcnt(7)
    v_mfma_f32_16x16x32_bf16 v[52:55], a[128:131], v[84:87], v[52:55]
    ds_read_b128 v[104:107], v1 offset:58368
    s_add_u32 s87, s97, s25
    s_add_u32 s86, s97, 32768
    s_add_u32 s87, s87, 32768
    s_mov_b32 m0, s86
    s_nop 0
    buffer_load_dwordx4 v1, s[4:7], s87 offen offset:0 lds
    v_mov_b32 v157, 1069066811
    v_mfma_f32_16x16x32_bf16 v[56:59], a[132:135], v[84:87], v[56:59]
    v_mov_b32 v160, 3049365963
    s_waitcnt lgkmcnt(7)
    v_mfma_f32_16x16x32_bf16 v[60:63], a[128:131], v[88:91], v[60:63]
    ds_read_b128 v[108:111], v1 offset:59392
    v_mfma_f32_16x16x32_bf16 v[64:67], a[132:135], v[88:91], v[64:67]
    v_mov_b32 v158, 0xc47a0000
    s_waitcnt lgkmcnt(7)
    v_mfma_f32_16x16x32_bf16 v[68:71], a[128:131], v[92:95], v[68:71]
    ds_read_b128 v[112:115], v1 offset:60416
    v_mov_b32 v159, 0xff800000
    v_mfma_f32_16x16x32_bf16 v[72:75], a[132:135], v[92:95], v[72:75]
    s_waitcnt lgkmcnt(6)
    v_mfma_f32_16x16x32_bf16 v[36:39], a[136:139], v[96:99], v[36:39]
    ds_read_b128 v[76:79], v1 offset:61440
    ds_read_b32 v136, v13 offset:0
    v_mfma_f32_16x16x32_bf16 v[40:43], a[140:143], v[96:99], v[40:43]
    buffer_load_dwordx4 v1, s[4:7], s87 offen offset:1024 lds
    s_waitcnt lgkmcnt(5)
    v_mfma_f32_16x16x32_bf16 v[44:47], a[136:139], v[100:103], v[44:47]
    ds_read_b128 v[80:83], v1 offset:62464
    v_mfma_f32_16x16x32_bf16 v[48:51], a[140:143], v[100:103], v[48:51]
    ds_read_b32 v137, v13 offset:64
    s_waitcnt lgkmcnt(6)
    v_mfma_f32_16x16x32_bf16 v[52:55], a[136:139], v[104:107], v[52:55]
    ds_read_b128 v[84:87], v1 offset:63488
    buffer_load_dwordx4 v1, s[4:7], s87 offen offset:2048 lds
    v_mfma_f32_16x16x32_bf16 v[56:59], a[140:143], v[104:107], v[56:59]
    s_waitcnt lgkmcnt(6)
    v_mfma_f32_16x16x32_bf16 v[60:63], a[136:139], v[108:111], v[60:63]
    ds_read_b128 v[88:91], v1 offset:64512
    ds_read_b32 v138, v13 offset:128
    v_mfma_f32_16x16x32_bf16 v[64:67], a[140:143], v[108:111], v[64:67]
    s_mov_b32 s75, 20905984
    buffer_load_dwordx4 v[220:223], v1, s[4:7], s75 offen sc1
    s_waitcnt lgkmcnt(7)
    v_mfma_f32_16x16x32_bf16 v[68:71], a[136:139], v[112:115], v[68:71]
    ds_read_b128 v[92:95], v3 offset:0
    v_mfma_f32_16x16x32_bf16 v[72:75], a[140:143], v[112:115], v[72:75]
    s_waitcnt lgkmcnt(7)
    v_mfma_f32_16x16x32_bf16 v[36:39], a[144:147], v[76:79], v[36:39]
    ds_read_b128 v[96:99], v3 offset:1024
    ds_read_b32 v139, v13 offset:192
    v_mfma_f32_16x16x32_bf16 v[40:43], a[148:151], v[76:79], v[40:43]
    ds_read_b32 v140, v13 offset:256
    s_waitcnt lgkmcnt(8)
    v_mfma_f32_16x16x32_bf16 v[44:47], a[144:147], v[80:83], v[44:47]
    ds_read_b128 v[100:103], v3 offset:2048
    v_mfma_f32_16x16x32_bf16 v[48:51], a[148:151], v[80:83], v[48:51]
    v_cndmask_b32 v159, v159, v156, s[50:51]
    s_waitcnt lgkmcnt(7)
    v_mfma_f32_16x16x32_bf16 v[52:55], a[144:147], v[84:87], v[52:55]
    ds_read_b128 v[104:107], v3 offset:3072
    buffer_load_dwordx4 v1, s[4:7], s87 offen offset:3072 lds
    v_mfma_f32_16x16x32_bf16 v[56:59], a[148:151], v[84:87], v[56:59]
    v_cndmask_b32 v156, 0, v156, s[50:51]
    s_waitcnt lgkmcnt(7)
    v_mfma_f32_16x16x32_bf16 v[60:63], a[144:147], v[88:91], v[60:63]
    ds_read_b128 v[108:111], v3 offset:4096
    v_cndmask_b32 v157, 0, v157, s[50:51]
    v_mfma_f32_16x16x32_bf16 v[64:67], a[148:151], v[88:91], v[64:67]
    s_waitcnt lgkmcnt(6)
    v_mfma_f32_16x16x32_bf16 v[68:71], a[144:147], v[92:95], v[68:71]
    ds_read_b128 v[112:115], v3 offset:5120
    v_cndmask_b32 v158, v158, v160, s[50:51]
    v_mfma_f32_16x16x32_bf16 v[72:75], a[148:151], v[92:95], v[72:75]
    s_waitcnt lgkmcnt(6)
    v_mfma_f32_16x16x32_bf16 v[36:39], a[152:155], v[96:99], v[36:39]
    s_and_b32 s3, s20, 1
    s_mul_i32 s3, s3, 4294967112
    s_add_u32 s3, s3, 128
    s_add_u32 s3, s3, s61
    buffer_load_dwordx2 v[24:25], v226, s[12:15], s3 offen
    v_mov_b32 v161, 3049365963
    v_mfma_f32_16x16x32_bf16 v[40:43], a[156:159], v[96:99], v[40:43]
    s_waitcnt lgkmcnt(3)
    v_mfma_f32_16x16x32_bf16 v[44:47], a[152:155], v[100:103], v[44:47]
    v_mfma_f32_16x16x32_bf16 v[48:51], a[156:159], v[100:103], v[48:51]
    buffer_load_dwordx4 v[16:19], v226, s[12:15], s61 offen
    s_waitcnt lgkmcnt(2)
    v_mfma_f32_16x16x32_bf16 v[52:55], a[152:155], v[104:107], v[52:55]
    v_mfma_f32_16x16x32_bf16 v[56:59], a[156:159], v[104:107], v[56:59]
    buffer_load_dwordx4 v[20:23], v226, s[12:15], s61 offen offset:64
    v_mov_b32 v160, 0x3f803f80
    s_waitcnt lgkmcnt(1)
    v_mfma_f32_16x16x32_bf16 v[60:63], a[152:155], v[108:111], v[60:63]
    v_mfma_f32_16x16x32_bf16 v[64:67], a[156:159], v[108:111], v[64:67]
    s_waitcnt lgkmcnt(0)
    v_mfma_f32_16x16x32_bf16 v[68:71], a[152:155], v[112:115], v[68:71]
    s_add_u32 s87, s94, s25
    s_add_u32 s86, s94, 47104
    s_add_u32 s87, s87, 47104
    s_mov_b32 m0, s86
    s_nop 0
    buffer_load_dwordx4 v1, s[4:7], s87 offen offset:0 lds
    v_mfma_f32_16x16x32_bf16 v[72:75], a[156:159], v[112:115], v[72:75]
    s_waitcnt vmcnt(5)
    v_xor_b32 v220, s39, v220
    v_xor_b32 v221, s39, v221
    v_xor_b32 v222, s39, v222
    v_xor_b32 v223, s39, v223
    v_or3_b32 v220, v220, v221, v222
    v_or_b32 v220, v220, v223
    v_cmp_ne_u32 vcc, 0, v220
    s_nop 1
    s_cbranch_vccz L_ok_3
    s_mov_b32 s60, 0
L_lp_2:
    buffer_load_dwordx4 v[220:223], v1, s[4:7], s75 offen sc1
    s_add_u32 s60, s60, 1
    s_cmp_gt_u32 s60, 0x40000
    s_cbranch_scc1 L_abort
    s_waitcnt vmcnt(0)
    v_xor_b32 v220, s39, v220
    v_xor_b32 v221, s39, v221
    v_xor_b32 v222, s39, v222
    v_xor_b32 v223, s39, v223
    v_or3_b32 v220, v220, v221, v222
    v_or_b32 v220, v220, v223
    v_cmp_ne_u32 vcc, 0, v220
    s_nop 1
    s_cbranch_vccnz L_lp_2
L_ok_3:
    s_add_u32 s3, s2, s16
    s_cmp_eq_u32 s3, 0
    s_cselect_b64 exec, 1, 0
    v_mov_b32 v15, s39
    s_mov_b32 s3, 20910080
    buffer_store_dword v15, off, s[4:7], s3
    s_mov_b64 exec, -1
    v_pk_fma_f32 v[144:145], v[124:125], v[136:137], s[76:77] op_sel:[0,0,0] op_sel_hi:[1,0,1]
    v_pk_fma_f32 v[148:149], v[128:129], v[136:137], s[76:77] op_sel:[0,0,0] op_sel_hi:[1,0,1]
    s_add_u32 s69, s28, 0
    buffer_load_dwordx4 v[168:171], v1, s[4:7], s69 offen offset:0
    v_pk_fma_f32 v[146:147], v[126:127], v[136:137], s[76:77] op_sel:[0,0,0] op_sel_hi:[1,0,1]
    v_pk_fma_f32 v[150:151], v[130:131], v[136:137], s[76:77] op_sel:[0,0,0] op_sel_hi:[1,0,1]
    v_pk_fma_f32 v[36:37], v[36:37], v[116:117], v[144:145] op_sel:[0,0,0] op_sel_hi:[1,1,1]
    v_pk_fma_f32 v[40:41], v[40:41], v[120:121], v[148:149] op_sel:[0,0,0] op_sel_hi:[1,1,1]
    v_pk_fma_f32 v[38:39], v[38:39], v[118:119], v[146:147] op_sel:[0,0,0] op_sel_hi:[1,1,1]
    v_pk_fma_f32 v[42:43], v[42:43], v[122:123], v[150:151] op_sel:[0,0,0] op_sel_hi:[1,1,1]
    v_pk_fma_f32 v[144:145], v[36:37], s[78:79], v[160:161] op_sel:[0,0,1] op_sel_hi:[1,1,1]
    v_pk_fma_f32 v[148:149], v[40:41], s[78:79], v[160:161] op_sel:[0,0,1] op_sel_hi:[1,1,1]
    v_pk_fma_f32 v[146:147], v[38:39], s[78:79], v[160:161] op_sel:[0,0,1] op_sel_hi:[1,1,1]
    v_pk_fma_f32 v[150:151], v[42:43], s[78:79], v[160:161] op_sel:[0,0,1] op_sel_hi:[1,1,1]
    v_exp_f32_e64 v144, v144 clamp
    v_exp_f32_e64 v148, v148 clamp
    v_exp_f32_e64 v145, v145 clamp
    v_exp_f32_e64 v149, v149 clamp
    v_exp_f32_e64 v146, v146 clamp
    v_exp_f32_e64 v150, v150 clamp
    v_exp_f32_e64 v147, v147 clamp
    v_exp_f32_e64 v151, v151 clamp
    buffer_load_dwordx4 v[172:175], v1, s[4:7], s69 offen offset:1024
    v_max_f32 v36, s76, v36
    v_max_f32 v40, s76, v40
    v_max_f32 v37, s76, v37
    v_max_f32 v41, s76, v41
    v_max_f32 v38, s76, v38
    v_max_f32 v42, s76, v42
    v_max_f32 v39, s76, v39
    v_max_f32 v43, s76, v43
    v_pk_add_f32 v[36:37], v[36:37], v[144:145] op_sel:[0,0] op_sel_hi:[1,1]
    v_pk_add_f32 v[40:41], v[40:41], v[148:149] op_sel:[0,0] op_sel_hi:[1,1]
    v_pk_add_f32 v[38:39], v[38:39], v[146:147] op_sel:[0,0] op_sel_hi:[1,1]
    v_pk_add_f32 v[42:43], v[42:43], v[150:151] op_sel:[0,0] op_sel_hi:[1,1]
    v_cvt_pk_bf16_f32 v76, v36, v37
    v_cvt_pk_bf16_f32 v78, v40, v41
    v_cvt_pk_bf16_f32 v77, v38, v39
    v_cvt_pk_bf16_f32 v79, v42, v43
    v_pk_fma_f32 v[144:145], v[124:125], v[136:137], s[76:77] op_sel:[0,1,0] op_sel_hi:[1,1,1]
    v_pk_fma_f32 v[148:149], v[128:129], v[136:137], s[76:77] op_sel:[0,1,0] op_sel_hi:[1,1,1]
    buffer_load_dwordx4 v[176:179], v1, s[4:7], s69 offen offset:2048
    v_pk_fma_f32 v[146:147], v[126:127], v[136:137], s[76:77] op_sel:[0,1,0] op_sel_hi:[1,1,1]
    v_pk_fma_f32 v[150:151], v[130:131], v[136:137], s[76:77] op_sel:[0,1,0] op_sel_hi:[1,1,1]
    v_pk_fma_f32 v[44:45], v[44:45], v[116:117], v[144:145] op_sel:[0,0,0] op_sel_hi:[1,1,1]
    v_pk_fma_f32 v[48:49], v[48:49], v[120:121], v[148:149] op_sel:[0,0,0] op_sel_hi:[1,1,1]
    v_pk_fma_f32 v[46:47], v[46:47], v[118:119], v[146:147] op_sel:[0,0,0] op_sel_hi:[1,1,1]
    v_pk_fma_f32 v[50:51], v[50:51], v[122:123], v[150:151] op_sel:[0,0,0] op_sel_hi:[1,1,1]
    v_pk_fma_f32 v[144:145], v[44:45], s[78:79], v[160:161] op_sel:[0,0,1] op_sel_hi:[1,1,1]
    v_pk_fma_f32 v[148:149], v[48:49], s[78:79], v[160:161] op_sel:[0,0,1] op_sel_hi:[1,1,1]
    v_pk_fma_f32 v[146:147], v[46:47], s[78:79], v[160:161] op_sel:[0,0,1] op_sel_hi:[1,1,1]
    v_pk_fma_f32 v[150:151], v[50:51], s[78:79], v[160:161] op_sel:[0,0,1] op_sel_hi:[1,1,1]
    v_exp_f32_e64 v144, v144 clamp
    v_exp_f32_e64 v148, v148 clamp
    v_exp_f32_e64 v145, v145 clamp
    v_exp_f32_e64 v149, v149 clamp
    v_exp_f32_e64 v146, v146 clamp
    v_exp_f32_e64 v150, v150 clamp
    v_exp_f32_e64 v147, v147 clamp
    v_exp_f32_e64 v151, v151 clamp
    buffer_load_dwordx4 v[180:183], v1, s[4:7], s69 offen offset:3072
    v_max_f32 v44, s76, v44
    v_max_f32 v48, s76, v48
    v_max_f32 v45, s76, v45
    v_max_f32 v49, s76, v49
    v_max_f32 v46, s76, v46
    v_max_f32 v50, s76, v50
    v_max_f32 v47, s76, v47
    v_max_f32 v51, s76, v51
    v_pk_add_f32 v[44:45], v[44:45], v[144:145] op_sel:[0,0] op_sel_hi:[1,1]
    v_pk_add_f32 v[48:49], v[48:49], v[148:149] op_sel:[0,0] op_sel_hi:[1,1]
    v_pk_add_f32 v[46:47], v[46:47], v[146:147] op_sel:[0,0] op_sel_hi:[1,1]
    v_pk_add_f32 v[50:51], v[50:51], v[150:151] op_sel:[0,0] op_sel_hi:[1,1]
    v_cvt_pk_bf16_f32 v80, v44, v45
    v_cvt_pk_bf16_f32 v82, v48, v49
    v_cvt_pk_bf16_f32 v81, v46, v47
    v_cvt_pk_bf16_f32 v83, v50, v51
    v_pk_fma_f32 v[144:145], v[124:125], v[140:141], v[156:157] op_sel:[0,0,0] op_sel_hi:[1,0,0]
    v_pk_fma_f32 v[148:149], v[128:129], v[140:141], v[156:157] op_sel:[0,0,0] op_sel_hi:[1,0,0]
    s_add_u32 s69, s28, 4096
    buffer_load_dwordx4 v[184:187], v1, s[4:7], s69 offen offset:0
    v_pk_fma_f32 v[146:147], v[126:127], v[140:141], v[156:157] op_sel:[0,0,0] op_sel_hi:[1,0,0]
    v_pk_fma_f32 v[150:151], v[130:131], v[140:141], v[156:157] op_sel:[0,0,0] op_sel_hi:[1,0,0]
    v_pk_fma_f32 v[68:69], v[68:69], v[116:117], v[144:145] op_sel:[0,0,0] op_sel_hi:[1,1,1]
    v_pk_fma_f32 v[72:73], v[72:73], v[120:121], v[148:149] op_sel:[0,0,0] op_sel_hi:[1,1,1]
    v_pk_fma_f32 v[70:71], v[70:71], v[118:119], v[146:147] op_sel:[0,0,0] op_sel_hi:[1,1,1]
    v_pk_fma_f32 v[74:75], v[74:75], v[122:123], v[150:151] op_sel:[0,0,0] op_sel_hi:[1,1,1]
    v_pk_fma_f32 v[144:145], v[68:69], v[156:157], v[158:159] op_sel:[0,1,0] op_sel_hi:[1,1,0]
    v_pk_fma_f32 v[148:149], v[72:73], v[156:157], v[158:159] op_sel:[0,1,0] op_sel_hi:[1,1,0]
    v_pk_fma_f32 v[146:147], v[70:71], v[156:157], v[158:159] op_sel:[0,1,0] op_sel_hi:[1,1,0]
    v_pk_fma_f32 v[150:151], v[74:75], v[156:157], v[158:159] op_sel:[0,1,0] op_sel_hi:[1,1,0]
    v_exp_f32_e64 v144, v144 clamp
    v_exp_f32_e64 v148, v148 clamp
    v_exp_f32_e64 v145, v145 clamp
    v_exp_f32_e64 v149, v149 clamp
    v_exp_f32_e64 v146, v146 clamp
    v_exp_f32_e64 v150, v150 clamp
    v_exp_f32_e64 v147, v147 clamp
    v_exp_f32_e64 v151, v151 clamp
    buffer_load_dwordx4 v[188:191], v1, s[4:7], s69 offen offset:1024
    v_max_f32 v68, v159, v68
    v_max_f32 v72, v159, v72
    v_max_f32 v69, v159, v69
    v_max_f32 v73, v159, v73
    v_max_f32 v70, v159, v70
    v_max_f32 v74, v159, v74
    v_max_f32 v71, v159, v71
    v_max_f32 v75, v159, v75
    v_pk_add_f32 v[68:69], v[68:69], v[144:145] op_sel:[0,0] op_sel_hi:[1,1]
    v_pk_add_f32 v[72:73], v[72:73], v[148:149] op_sel:[0,0] op_sel_hi:[1,1]
    v_pk_add_f32 v[70:71], v[70:71], v[146:147] op_sel:[0,0] op_sel_hi:[1,1]
    v_pk_add_f32 v[74:75], v[74:75], v[150:151] op_sel:[0,0] op_sel_hi:[1,1]
    v_cvt_pk_bf16_f32 v92, v68, v69
    v_cvt_pk_bf16_f32 v94, v72, v73
    v_cvt_pk_bf16_f32 v93, v70, v71
    v_cvt_pk_bf16_f32 v95, v74, v75
    v_cndmask_b32 v96, v92, v160, s[50:51]
    v_cndmask_b32 v97, v93, v160, s[50:51]
    buffer_load_dwordx4 v[192:195], v1, s[4:7], s69 offen offset:2048
    v_cndmask_b32 v98, v94, v160, s[50:51]
    v_cndmask_b32 v99, v95, v160, s[50:51]
    s_nop 1
    v_mfma_f32_16x16x32_bf16 v[100:103], v[76:79], v[96:99], 0
    v_mfma_f32_16x16x32_bf16 v[104:107], v[80:83], v[96:99], 0
    v_mfma_f32_16x16x32_bf16 v[108:111], v[92:95], v[96:99], 0
    v_pk_mul_f32 v[144:145], v[124:125], v[138:139] op_sel:[0,0] op_sel_hi:[1,0]
    v_pk_mul_f32 v[148:149], v[128:129], v[138:139] op_sel:[0,0] op_sel_hi:[1,0]
    v_pk_mul_f32 v[146:147], v[126:127], v[138:139] op_sel:[0,0] op_sel_hi:[1,0]
    v_pk_mul_f32 v[150:151], v[130:131], v[138:139] op_sel:[0,0] op_sel_hi:[1,0]
    v_pk_fma_f32 v[52:53], v[52:53], v[116:117], v[144:145] op_sel:[0,0,0] op_sel_hi:[1,1,1]
    v_pk_fma_f32 v[56:57], v[56:57], v[120:121], v[148:149] op_sel:[0,0,0] op_sel_hi:[1,1,1]
    v_pk_fma_f32 v[54:55], v[54:55], v[118:119], v[146:147] op_sel:[0,0,0] op_sel_hi:[1,1,1]
    v_pk_fma_f32 v[58:59], v[58:59], v[122:123], v[150:151] op_sel:[0,0,0] op_sel_hi:[1,1,1]
    v_cvt_pk_bf16_f32 v84, v52, v53
    v_cvt_pk_bf16_f32 v86, v56, v57
    v_cvt_pk_bf16_f32 v85, v54, v55
    v_cvt_pk_bf16_f32 v87, v58, v59
    s_nop 1
    v_mfma_f32_16x16x32_bf16 v[36:39], v[76:79], v[84:87], 0
    buffer_load_dwordx4 v[196:199], v1, s[4:7], s69 offen offset:3072
    v_mfma_f32_16x16x32_bf16 v[40:43], v[92:95], v[84:87], 0
    v_pk_mul_f32 v[144:145], v[124:125], v[138:139] op_sel:[0,1] op_sel_hi:[1,1]
    v_pk_mul_f32 v[148:149], v[128:129], v[138:139] op_sel:[0,1] op_sel_hi:[1,1]
    v_pk_mul_f32 v[146:147], v[126:127], v[138:139] op_sel:[0,1] op_sel_hi:[1,1]
    v_pk_mul_f32 v[150:151], v[130:131], v[138:139] op_sel:[0,1] op_sel_hi:[1,1]
    v_pk_fma_f32 v[60:61], v[60:61], v[116:117], v[144:145] op_sel:[0,0,0] op_sel_hi:[1,1,1]
    v_pk_fma_f32 v[64:65], v[64:65], v[120:121], v[148:149] op_sel:[0,0,0] op_sel_hi:[1,1,1]
    v_pk_fma_f32 v[62:63], v[62:63], v[118:119], v[146:147] op_sel:[0,0,0] op_sel_hi:[1,1,1]
    v_pk_fma_f32 v[66:67], v[66:67], v[122:123], v[150:151] op_sel:[0,0,0] op_sel_hi:[1,1,1]
    v_cvt_pk_bf16_f32 v88, v60, v61
    v_cvt_pk_bf16_f32 v90, v64, v65
    v_cvt_pk_bf16_f32 v89, v62, v63
    v_cvt_pk_bf16_f32 v91, v66, v67
    s_nop 1
    v_mfma_f32_16x16x32_bf16 v[44:47], v[80:83], v[88:91], 0
    v_mfma_f32_16x16x32_bf16 v[48:51], v[92:95], v[88:91], 0
    v_cndmask_b32 v161, v100, v104, s[48:49]
    v_cndmask_b32 v162, v101, v105, s[48:49]
    v_cndmask_b32 v164, v102, v106, s[48:49]
    v_cndmask_b32 v165, v103, v107, s[48:49]
    v_cndmask_b32 v166, v108, v109, s[48:49]
    v_mov_b32 v167, 0x3e800000
    ds_write_b128 v33, v[164:167] offset:4096
    v_mov_b32 v151, 0x3e800000
    v_mov_b32 v155, 0x3e800000
    v_mov_b32 v159, 0x3e800000
    v_mov_b32 v163, 0x3e800000
    v_mov_b32 v148, v36
    v_mov_b32 v149, v37
    v_mov_b32 v150, v38
    ds_write_b128 v33, v[148:151]
    v_mov_b32 v152, v39
    v_mov_b32 v153, v40
    v_mov_b32 v154, v44
    ds_write_b128 v33, v[152:155] offset:1024
    v_mov_b32 v156, v45
    v_mov_b32 v157, v46
    v_mov_b32 v158, v47
    ds_write_b128 v33, v[156:159] offset:2048
    v_mov_b32 v160, v49
    ds_write_b128 v33, v[160:163] offset:3072
    s_waitcnt lgkmcnt(0)
    s_waitcnt vmcnt(9)
    s_barrier
    ds_read_b32 v100, v34 offset:0
    ds_read_b32 v101, v34 offset:5120
    ds_read_b32 v102, v34 offset:10240
    ds_read_b32 v103, v34 offset:15360
    ds_read_b32 v104, v34 offset:256
    ds_read_b32 v105, v34 offset:5376
    ds_read_b32 v106, v34 offset:10496
    ds_read_b32 v107, v34 offset:15616
    ds_read_b32 v108, v34 offset:512
    ds_read_b32 v109, v34 offset:5632
    ds_read_b32 v110, v34 offset:10752
    ds_read_b32 v111, v34 offset:15872
    ds_read_b32 v112, v34 offset:768
    ds_read_b32 v113, v34 offset:5888
    ds_read_b32 v114, v34 offset:11008
    ds_read_b32 v115, v34 offset:16128
    ds_read_b32 v116, v34 offset:1024
    ds_read_b32 v117, v34 offset:6144
    ds_read_b32 v118, v34 offset:11264
    ds_read_b32 v119, v34 offset:16384
    v_pk_add_f32 v[100:101], v[100:101], v[102:103] op_sel:[0,0] op_sel_hi:[1,1]
    v_add_f32 v100, v100, v101
    buffer_atomic_add_f32 v100, v2, s[4:7], s47 offen offset:0
    s_waitcnt lgkmcnt(12)
    v_pk_add_f32 v[104:105], v[104:105], v[106:107] op_sel:[0,0] op_sel_hi:[1,1]
    v_add_f32 v104, v104, v105
    buffer_atomic_add_f32 v104, v2, s[4:7], s47 offen offset:256
    s_waitcnt lgkmcnt(8)
    v_pk_add_f32 v[108:109], v[108:109], v[110:111] op_sel:[0,0] op_sel_hi:[1,1]
    v_add_f32 v108, v108, v109
    buffer_atomic_add_f32 v108, v2, s[4:7], s47 offen offset:512
    s_waitcnt lgkmcnt(4)
    v_pk_add_f32 v[112:113], v[112:113], v[114:115] op_sel:[0,0] op_sel_hi:[1,1]
    v_add_f32 v112, v112, v113
    buffer_atomic_add_f32 v112, v2, s[4:7], s47 offen offset:768
    s_waitcnt lgkmcnt(0)
    v_pk_add_f32 v[116:117], v[116:117], v[118:119] op_sel:[0,0] op_sel_hi:[1,1]
    v_add_f32 v116, v116, v117
    buffer_atomic_add_f32 v116, v2, s[4:7], s47 offen offset:1024
    ds_read_b128 v[76:79], v1 offset:0
    ds_read_b128 v[80:83], v1 offset:1024
    ds_read_b128 v[84:87], v5 offset:2048
    s_waitcnt lgkmcnt(2)
    v_mfma_f32_16x16x32_bf16 v[36:39], v[76:79], a[152:155], 0
    ds_read_b128 v[88:91], v1 offset:2560
    s_add_u32 s74, s72, 0
    buffer_load_dwordx4 v[144:147], v141, s[4:7], s74 offen sc1
    v_mfma_f32_16x16x32_bf16 v[40:43], v[76:79], a[156:159], 0
    s_waitcnt lgkmcnt(2)
    v_mfma_f32_16x16x32_bf16 v[44:47], v[80:83], a[152:155], 0
    ds_read_b128 v[92:95], v1 offset:3584
    s_add_u32 s74, s74, s73
    buffer_load_dwordx4 v[148:151], v141, s[4:7], s74 offen sc1
    v_mfma_f32_16x16x32_bf16 v[48:51], v[80:83], a[156:159], 0
    s_waitcnt lgkmcnt(2)
    v_mfma_f32_16x16x32_bf16 v[52:55], v[84:87], a[152:155], 0
    ds_read_b128 v[96:99], v5 offset:4608
    s_add_u32 s74, s74, s73
    buffer_load_dwordx4 v[152:155], v141, s[4:7], s74 offen sc1
    v_mfma_f32_16x16x32_bf16 v[56:59], v[84:87], a[156:159], 0
    s_waitcnt lgkmcnt(2)
    v_mfma_f32_16x16x32_bf16 v[36:39], v[88:91], a[144:147], v[36:39]
    ds_read_b128 v[76:79], v1 offset:5120
    s_add_u32 s68, s27, 0
    buffer_load_dwordx4 a[156:159], v1, s[4:7], s68 offen offset:0
    v_mfma_f32_16x16x32_bf16 v[40:43], v[88:91], a[148:151], v[40:43]
    buffer_load_dwordx4 a[152:155], v1, s[4:7], s68 offen offset:1024
    s_waitcnt lgkmcnt(2)
    v_mfma_f32_16x16x32_bf16 v[44:47], v[92:95], a[144:147], v[44:47]
    ds_read_b128 v[80:83], v1 offset:6144
    s_add_u32 s74, s74, s73
    buffer_load_dwordx4 v[156:159], v141, s[4:7], s74 offen sc1
    v_mfma_f32_16x16x32_bf16 v[48:51], v[92:95], a[148:151], v[48:51]
    s_add_u32 s74, s74, s73
    buffer_load_dwordx4 v[160:163], v141, s[4:7], s74 offen sc1
    s_waitcnt lgkmcnt(2)
    v_mfma_f32_16x16x32_bf16 v[52:55], v[96:99], a[144:147], v[52:55]
    ds_read_b128 v[84:87], v5 offset:7168
    s_mov_b32 m0, s63
    s_nop 0
    buffer_load_dword v2, s[4:7], s62 offen lds
    v_mfma_f32_16x16x32_bf16 v[56:59], v[96:99], a[148:151], v[56:59]
    s_waitcnt lgkmcnt(2)
    v_mfma_f32_16x16x32_bf16 v[36:39], v[76:79], a[136:139], v[36:39]
    ds_read_b128 v[88:91], v1 offset:7680
    v_mfma_f32_16x16x32_bf16 v[40:43], v[76:79], a[140:143], v[40:43]
    buffer_load_dwordx4 a[148:151], v1, s[4:7], s68 offen offset:2048
    s_waitcnt lgkmcnt(2)
    v_mfma_f32_16x16x32_bf16 v[44:47], v[80:83], a[136:139], v[44:47]
    ds_read_b128 v[92:95], v1 offset:8704
    v_mfma_f32_16x16x32_bf16 v[48:51], v[80:83], a[140:143], v[48:51]
    s_waitcnt lgkmcnt(2)
    v_mfma_f32_16x16x32_bf16 v[52:55], v[84:87], a[136:139], v[52:55]
    ds_read_b128 v[96:99], v5 offset:9728
    buffer_load_dwordx4 a[144:147], v1, s[4:7], s68 offen offset:3072
    v_mfma_f32_16x16x32_bf16 v[56:59], v[84:87], a[140:143], v[56:59]
    s_waitcnt lgkmcnt(2)
    v_mfma_f32_16x16x32_bf16 v[36:39], v[88:91], a[128:131], v[36:39]
    ds_read_b128 v[76:79], v1 offset:10240
    v_mfma_f32_16x16x32_bf16 v[40:43], v[88:91], a[132:135], v[40:43]
    s_waitcnt lgkmcnt(2)
    v_mfma_f32_16x16x32_bf16 v[44:47], v[92:95], a[128:131], v[44:47]
    ds_read_b128 v[80:83], v1 offset:11264
    s_add_u32 s68, s27, 4096
    buffer_load_dwordx4 a[140:143], v1, s[4:7], s68 offen offset:0
    v_mfma_f32_16x16x32_bf16 v[48:51], v[92:95], a[132:135], v[48:51]
    s_waitcnt lgkmcnt(2)
    v_mfma_f32_16x16x32_bf16 v[52:55], v[96:99], a[128:131], v[52:55]
    ds_read_b128 v[84:87], v5 offset:12288
    v_mfma_f32_16x16x32_bf16 v[56:59], v[96:99], a[132:135], v[56:59]
    s_waitcnt lgkmcnt(2)
    v_mfma_f32_16x16x32_bf16 v[36:39], v[76:79], a[120:123], v[36:39]
    s_barrier
    v_mfma_f32_16x16x32_bf16 v[40:43], v[76:79], a[124:127], v[40:43]
    ds_read_b128 v[88:91], v1 offset:12800
    buffer_load_dwordx4 a[136:139], v1, s[4:7], s68 offen offset:1024
    s_waitcnt lgkmcnt(2)
    v_mfma_f32_16x16x32_bf16 v[44:47], v[80:83], a[120:123], v[44:47]
    ds_read_b128 v[92:95], v1 offset:13824
    v_mfma_f32_16x16x32_bf16 v[48:51], v[80:83], a[124:127], v[48:51]
    ds_read_b128 v[96:99], v5 offset:14848
    s_waitcnt lgkmcnt(3)
    v_mfma_f32_16x16x32_bf16 v[52:55], v[84:87], a[120:123], v[52:55]
    buffer_load_dwordx4 a[132:135], v1, s[4:7], s68 offen offset:2048
    v_mfma_f32_16x16x32_bf16 v[56:59], v[84:87], a[124:127], v[56:59]
    s_waitcnt lgkmcnt(2)
    v_mfma_f32_16x16x32_bf16 v[36:39], v[88:91], a[112:115], v[36:39]
    ds_read_b128 v[76:79], v1 offset:15360
    v_mfma_f32_16x16x32_bf16 v[40:43], v[88:91], a[116:119], v[40:43]
    buffer_load_dwordx4 a[128:131], v1, s[4:7], s68 offen offset:3072
    s_waitcnt lgkmcnt(2)
    v_mfma_f32_16x16x32_bf16 v[44:47], v[92:95], a[112:115], v[44:47]
    ds_read_b128 v[80:83], v1 offset:16384
    v_mfma_f32_16x16x32_bf16 v[48:51], v[92:95], a[116:119], v[48:51]
    s_waitcnt lgkmcnt(2)
    v_mfma_f32_16x16x32_bf16 v[52:55], v[96:99], a[112:115], v[52:55]
    ds_read_b128 v[84:87], v5 offset:17408
    s_add_u32 s68, s27, 8192
    buffer_load_dwordx4 a[124:127], v1, s[4:7], s68 offen offset:0
    v_mfma_f32_16x16x32_bf16 v[56:59], v[96:99], a[116:119], v[56:59]
    s_waitcnt lgkmcnt(2)
    v_mfma_f32_16x16x32_bf16 v[36:39], v[76:79], a[104:107], v[36:39]
    ds_read_b128 v[88:91], v1 offset:17920
    v_mfma_f32_16x16x32_bf16 v[40:43], v[76:79], a[108:111], v[40:43]
    s_waitcnt lgkmcnt(2)
    v_mfma_f32_16x16x32_bf16 v[44:47], v[80:83], a[104:107], v[44:47]
    ds_read_b128 v[92:95], v1 offset:18944
    buffer_load_dwordx4 a[120:123], v1, s[4:7], s68 offen offset:1024
    v_mfma_f32_16x16x32_bf16 v[48:51], v[80:83], a[108:111], v[48:51]
    s_waitcnt lgkmcnt(2)
    v_mfma_f32_16x16x32_bf16 v[52:55], v[84:87], a[104:107], v[52:55]
    ds_read_b128 v[96:99], v5 offset:19968
    v_mfma_f32_16x16x32_bf16 v[56:59], v[84:87], a[108:111], v[56:59]
    s_waitcnt lgkmcnt(2)
    v_mfma_f32_16x16x32_bf16 v[36:39], v[88:91], a[96:99], v[36:39]
    ds_read_b128 v[76:79], v1 offset:20480
    v_mfma_f32_16x16x32_bf16 v[40:43], v[88:91], a[100:103], v[40:43]
    buffer_load_dwordx4 a[116:119], v1, s[4:7], s68 offen offset:2048
    s_waitcnt lgkmcnt(2)
    v_mfma_f32_16x16x32_bf16 v[44:47], v[92:95], a[96:99], v[44:47]
    ds_read_b128 v[80:83], v1 offset:21504
    v_mfma_f32_16x16x32_bf16 v[48:51], v[92:95], a[100:103], v[48:51]
    s_waitcnt lgkmcnt(2)
    v_mfma_f32_16x16x32_bf16 v[52:55], v[96:99], a[96:99], v[52:55]
    ds_read_b128 v[84:87], v5 offset:22528
    buffer_load_dwordx4 a[112:115], v1, s[4:7], s68 offen offset:3072
    v_mfma_f32_16x16x32_bf16 v[56:59], v[96:99], a[100:103], v[56:59]
    s_waitcnt lgkmcnt(2)
    v_mfma_f32_16x16x32_bf16 v[36:39], v[76:79], a[88:91], v[36:39]
    ds_read_b128 v[88:91], v1 offset:23040
    v_mfma_f32_16x16x32_bf16 v[40:43], v[76:79], a[92:95], v[40:43]
    s_add_u32 s68, s27, 12288
    buffer_load_dwordx4 a[108:111], v1, s[4:7], s68 offen offset:0
    s_waitcnt lgkmcnt(2)
    v_mfma_f32_16x16x32_bf16 v[44:47], v[80:83], a[88:91], v[44:47]
    ds_read_b128 v[92:95], v1 offset:24064
    v_mfma_f32_16x16x32_bf16 v[48:51], v[80:83], a[92:95], v[48:51]
    s_waitcnt lgkmcnt(2)
    v_mfma_f32_16x16x32_bf16 v[52:55], v[84:87], a[88:91], v[52:55]
    ds_read_b128 v[96:99], v5 offset:25088
    buffer_load_dwordx4 a[104:107], v1, s[4:7], s68 offen offset:1024
    v_mfma_f32_16x16x32_bf16 v[56:59], v[84:87], a[92:95], v[56:59]
    s_waitcnt lgkmcnt(2)
    v_mfma_f32_16x16x32_bf16 v[36:39], v[88:91], a[80:83], v[36:39]
    ds_read_b128 v[76:79], v1 offset:25600
    v_mfma_f32_16x16x32_bf16 v[40:43], v[88:91], a[84:87], v[40:43]
    s_waitcnt lgkmcnt(2)
    v_mfma_f32_16x16x32_bf16 v[44:47], v[92:95], a[80:83], v[44:47]
    ds_read_b128 v[80:83], v1 offset:26624
    buffer_load_dwordx4 a[100:103], v1, s[4:7], s68 offen offset:2048
    v_mfma_f32_16x16x32_bf16 v[48:51], v[92:95], a[84:87], v[48:51]
    s_waitcnt lgkmcnt(2)
    v_mfma_f32_16x16x32_bf16 v[52:55], v[96:99], a[80:83], v[52:55]
    ds_read_b128 v[84:87], v5 offset:27648
    v_mfma_f32_16x16x32_bf16 v[56:59], v[96:99], a[84:87], v[56:59]
    s_waitcnt lgkmcnt(2)
    v_mfma_f32_16x16x32_bf16 v[36:39], v[76:79], a[72:75], v[36:39]
    ds_read_b128 v[88:91], v1 offset:28160
    v_mfma_f32_16x16x32_bf16 v[40:43], v[76:79], a[76:79], v[40:43]
    buffer_load_dwordx4 a[96:99], v1, s[4:7], s68 offen offset:3072
    s_waitcnt lgkmcnt(2)
    v_mfma_f32_16x16x32_bf16 v[44:47], v[80:83], a[72:75], v[44:47]
    ds_read_b128 v[92:95], v1 offset:29184
    v_mfma_f32_16x16x32_bf16 v[48:51], v[80:83], a[76:79], v[48:51]
    s_waitcnt lgkmcnt(2)
    v_mfma_f32_16x16x32_bf16 v[52:55], v[84:87], a[72:75], v[52:55]
    ds_read_b128 v[96:99], v5 offset:30208
    s_add_u32 s68, s27, 16384
    buffer_load_dwordx4 a[92:95], v1, s[4:7], s68 offen offset:0
    v_mfma_f32_16x16x32_bf16 v[56:59], v[84:87], a[76:79], v[56:59]
    s_waitcnt lgkmcnt(2)
    v_mfma_f32_16x16x32_bf16 v[36:39], v[88:91], a[64:67], v[36:39]
    ds_read_b128 v[76:79], v1 offset:30720
    v_mfma_f32_16x16x32_bf16 v[40:43], v[88:91], a[68:71], v[40:43]
    buffer_load_dwordx4 a[88:91], v1, s[4:7], s68 offen offset:1024
    s_waitcnt lgkmcnt(2)
    v_mfma_f32_16x16x32_bf16 v[44:47], v[92:95], a[64:67], v[44:47]
    ds_read_b128 v[80:83], v1 offset:31744
    v_mfma_f32_16x16x32_bf16 v[48:51], v[92:95], a[68:71], v[48:51]
    s_waitcnt lgkmcnt(2)
    v_mfma_f32_16x16x32_bf16 v[52:55], v[96:99], a[64:67], v[52:55]
    ds_read_b128 v[84:87], v5 offset:32768
    buffer_load_dwordx4 a[84:87], v1, s[4:7], s68 offen offset:2048
    v_mfma_f32_16x16x32_bf16 v[56:59], v[96:99], a[68:71], v[56:59]
    s_waitcnt lgkmcnt(2)
    v_mfma_f32_16x16x32_bf16 v[36:39], v[76:79], a[56:59], v[36:39]
    ds_read_b128 v[88:91], v1 offset:33280
    s_waitcnt vmcnt(23)
    v_add_f32 v144, v144, v148
    v_mfma_f32_16x16x32_bf16 v[40:43], v[76:79], a[60:63], v[40:43]
    buffer_load_dwordx4 a[80:83], v1, s[4:7], s68 offen offset:3072
    s_waitcnt vmcnt(20)
    v_add_f32 v152, v152, v156
    s_waitcnt lgkmcnt(2)
    v_mfma_f32_16x16x32_bf16 v[44:47], v[80:83], a[56:59], v[44:47]
    ds_read_b128 v[92:95], v1 offset:34304
    v_add_f32 v145, v145, v149
    v_mfma_f32_16x16x32_bf16 v[48:51], v[80:83], a[60:63], v[48:51]
    v_add_f32 v153, v153, v157
    s_waitcnt lgkmcnt(2)
    v_mfma_f32_16x16x32_bf16 v[52:55], v[84:87], a[56:59], v[52:55]
    ds_read_b128 v[96:99], v5 offset:35328
    s_add_u32 s89, s97, s26
    s_add_u32 s88, s97, 92160
    s_add_u32 s89, s89, 20480
    s_mov_b32 m0, s88
    s_nop 0
    buffer_load_dwordx4 v1, s[4:7], s89 offen offset:0 lds
    v_add_f32 v146, v146, v150
    v_mfma_f32_16x16x32_bf16 v[56:59], v[84:87], a[60:63], v[56:59]
    v_add_f32 v154, v154, v158
    s_waitcnt lgkmcnt(2)
    v_mfma_f32_16x16x32_bf16 v[36:39], v[88:91], a[48:51], v[36:39]
    ds_read_b128 v[76:79], v1 offset:35840
    s_add_u32 s68, s27, 20480
    buffer_load_dwordx4 v[116:119], v1, s[4:7], s68 offen offset:0
    v_add_f32 v147, v147, v151
    v_mfma_f32_16x16x32_bf16 v[40:43], v[88:91], a[52:55], v[40:43]
    v_add_f32 v155, v155, v159
    s_waitcnt lgkmcnt(2)
    v_mfma_f32_16x16x32_bf16 v[44:47], v[92:95], a[48:51], v[44:47]
    ds_read_b128 v[80:83], v1 offset:36864
    buffer_load_dwordx4 v[120:123], v1, s[4:7], s68 offen offset:1024
    s_waitcnt vmcnt(22)
    v_add_f32 v144, v144, v160
    v_mfma_f32_16x16x32_bf16 v[48:51], v[92:95], a[52:55], v[48:51]
    v_add_f32 v145, v145, v161
    s_waitcnt lgkmcnt(2)
    v_mfma_f32_16x16x32_bf16 v[52:55], v[96:99], a[48:51], v[52:55]
    ds_read_b128 v[84:87], v5 offset:37888
    buffer_load_dwordx4 v1, s[4:7], s89 offen offset:1024 lds
    v_add_f32 v146, v146, v162
    v_mfma_f32_16x16x32_bf16 v[56:59], v[96:99], a[52:55], v[56:59]
    v_add_f32 v147, v147, v163
    s_waitcnt lgkmcnt(2)
    v_mfma_f32_16x16x32_bf16 v[36:39], v[76:79], a[40:43], v[36:39]
    ds_read_b128 v[88:91], v1 offset:38400
    v_add_f32 v144, v144, v152
    v_mfma_f32_16x16x32_bf16 v[40:43], v[76:79], a[44:47], v[40:43]
    buffer_load_dwordx4 v[124:127], v1, s[4:7], s68 offen offset:2048
    v_add_f32 v145, v145, v153
    s_waitcnt lgkmcnt(2)
    v_mfma_f32_16x16x32_bf16 v[44:47], v[80:83], a[40:43], v[44:47]
    ds_read_b128 v[92:95], v1 offset:39424
    v_add_f32 v146, v146, v154
    v_mfma_f32_16x16x32_bf16 v[48:51], v[80:83], a[44:47], v[48:51]
    v_add_f32 v147, v147, v155
    s_waitcnt lgkmcnt(2)
    v_mfma_f32_16x16x32_bf16 v[52:55], v[84:87], a[40:43], v[52:55]
    ds_read_b128 v[96:99], v5 offset:40448
    buffer_load_dwordx4 v[128:131], v1, s[4:7], s68 offen offset:3072
    v_permlane32_swap_b32 v144, v145
    v_mfma_f32_16x16x32_bf16 v[56:59], v[84:87], a[44:47], v[56:59]
    v_permlane32_swap_b32 v146, v147
    s_waitcnt lgkmcnt(2)
    v_mfma_f32_16x16x32_bf16 v[36:39], v[88:91], a[32:35], v[36:39]
    ds_read_b128 v[76:79], v1 offset:40960
    v_add_f32 v144, v144, v145
    v_mfma_f32_16x16x32_bf16 v[40:43], v[88:91], a[36:39], v[40:43]
    s_add_u32 s68, s27, 24576
    buffer_load_dwordx4 v[164:167], v1, s[4:7], s68 offen offset:0
    v_add_f32 v146, v146, v147
    s_waitcnt lgkmcnt(2)
    v_mfma_f32_16x16x32_bf16 v[44:47], v[92:95], a[32:35], v[44:47]
    ds_read_b128 v[80:83], v1 offset:41984
    s_nop 0
    v_mfma_f32_16x16x32_bf16 v[48:51], v[92:95], a[36:39], v[48:51]
    v_permlane16_swap_b32 v144, v146
    s_waitcnt lgkmcnt(2)
    v_mfma_f32_16x16x32_bf16 v[52:55], v[96:99], a[32:35], v[52:55]
    ds_read_b128 v[84:87], v5 offset:43008
    buffer_load_dwordx4 v1, s[4:7], s89 offen offset:2048 lds
    v_add_f32 v144, v144, v146
    v_mfma_f32_16x16x32_bf16 v[56:59], v[96:99], a[36:39], v[56:59]
    ds_write_b32 v142, v144
    s_waitcnt lgkmcnt(3)
    v_mfma_f32_16x16x32_bf16 v[36:39], v[76:79], a[24:27], v[36:39]
    ds_read_b128 v[88:91], v1 offset:43520
    v_mfma_f32_16x16x32_bf16 v[40:43], v[76:79], a[28:31], v[40:43]
    s_waitcnt lgkmcnt(3)
    v_mfma_f32_16x16x32_bf16 v[44:47], v[80:83], a[24:27], v[44:47]
    ds_read_b128 v[92:95], v1 offset:44544
    buffer_load_dwordx4 v1, s[4:7], s89 offen offset:3072 lds
    v_mfma_f32_16x16x32_bf16 v[48:51], v[80:83], a[28:31], v[48:51]
    s_waitcnt lgkmcnt(3)
    v_mfma_f32_16x16x32_bf16 v[52:55], v[84:87], a[24:27], v[52:55]
    ds_read_b128 v[96:99], v5 offset:45568
    v_mfma_f32_16x16x32_bf16 v[56:59], v[84:87], a[28:31], v[56:59]
    s_waitcnt lgkmcnt(2)
    v_mfma_f32_16x16x32_bf16 v[36:39], v[88:91], a[16:19], v[36:39]
    ds_read_b128 v[76:79], v1 offset:46080
    v_mfma_f32_16x16x32_bf16 v[40:43], v[88:91], a[20:23], v[40:43]
    s_waitcnt lgkmcnt(2)
    v_mfma_f32_16x16x32_bf16 v[44:47], v[92:95], a[16:19], v[44:47]
    ds_read_b128 v[80:83], v1 offset:47104
    v_mfma_f32_16x16x32_bf16 v[48:51], v[92:95], a[20:23], v[48:51]
    s_waitcnt lgkmcnt(2)
    v_mfma_f32_16x16x32_bf16 v[52:55], v[96:99], a[16:19], v[52:55]
    ds_read_b128 v[84:87], v5 offset:48128
    v_mfma_f32_16x16x32_bf16 v[56:59], v[96:99], a[20:23], v[56:59]
    s_waitcnt lgkmcnt(2)
    v_mfma_f32_16x16x32_bf16 v[36:39], v[76:79], a[8:11], v[36:39]
    ds_read_b128 v[88:91], v1 offset:48640
    v_mfma_f32_16x16x32_bf16 v[40:43], v[76:79], a[12:15], v[40:43]
    s_waitcnt lgkmcnt(2)
    v_mfma_f32_16x16x32_bf16 v[44:47], v[80:83], a[8:11], v[44:47]
    ds_read_b128 v[92:95], v1 offset:49664
    s_add_u32 s89, s97, s26
    s_add_u32 s88, s97, 108544
    s_add_u32 s89, s89, 36864
    s_mov_b32 m0, s88
    s_nop 0
    buffer_load_dwordx4 v1, s[4:7], s89 offen offset:0 lds
    v_mfma_f32_16x16x32_bf16 v[48:51], v[80:83], a[12:15], v[48:51]
    s_waitcnt lgkmcnt(2)
    v_mfma_f32_16x16x32_bf16 v[52:55], v[84:87], a[8:11], v[52:55]
    ds_read_b128 v[96:99], v5 offset:50688
    v_mfma_f32_16x16x32_bf16 v[56:59], v[84:87], a[12:15], v[56:59]
    s_waitcnt lgkmcnt(2)
    v_mfma_f32_16x16x32_bf16 v[36:39], v[88:91], a[0:3], v[36:39]
    ds_read_b128 v[76:79], v12 offset:320
    ds_read_b128 v[80:83], v12 offset:384
    v_mfma_f32_16x16x32_bf16 v[40:43], v[88:91], a[4:7], v[40:43]
    ds_read_b128 v[84:87], v12 offset:448
    s_waitcnt lgkmcnt(4)
    v_mfma_f32_16x16x32_bf16 v[44:47], v[92:95], a[0:3], v[44:47]
    v_mov_b32 v103, 0
    v_mov_b32 v107, 0
    v_mfma_f32_16x16x32_bf16 v[48:51], v[92:95], a[4:7], v[48:51]
    v_mov_b32 v111, 0
    s_waitcnt lgkmcnt(3)
    v_mfma_f32_16x16x32_bf16 v[52:55], v[96:99], a[0:3], v[52:55]
    v_mov_b32 v115, 0
    v_mov_b32 v65, 0
    v_mfma_f32_16x16x32_bf16 v[56:59], v[96:99], a[4:7], v[56:59]
    v_mov_b32 v71, 0
    s_waitcnt vmcnt(28)
    s_barrier
    buffer_load_dwordx4 v[144:147], v1, s[4:7], s46 offen offset:0 sc1
    buffer_load_dwordx4 v[148:151], v1, s[4:7], s46 offen offset:1024 sc1
    buffer_load_dwordx4 v[152:155], v1, s[4:7], s46 offen offset:2048 sc1
    buffer_load_dwordx4 v[156:159], v1, s[4:7], s46 offen offset:3072 sc1
    buffer_load_dwordx4 v[160:163], v26, s[4:7], s46 offen offset:0 sc1
    buffer_load_dwordx4 v1, s[4:7], s89 offen offset:1024 lds
    buffer_load_dwordx4 v1, s[4:7], s89 offen offset:2048 lds
    buffer_load_dwordx4 v1, s[4:7], s89 offen offset:3072 lds
    s_add_u32 s89, s97, s26
    s_add_u32 s88, s97, 124928
    s_add_u32 s89, s89, 53248
    s_mov_b32 m0, s88
    s_nop 0
    buffer_load_dwordx4 v1, s[4:7], s89 offen offset:0 lds
    buffer_load_dwordx4 v1, s[4:7], s89 offen offset:1024 lds
    buffer_load_dwordx4 v1, s[4:7], s89 offen offset:2048 lds
    v_mov_b32 v143, 3049365963
    s_waitcnt lgkmcnt(2)
    v_pk_fma_f32 v[136:137], v[76:77], v[134:135], s[76:77] op_sel:[0,0,0] op_sel_hi:[1,0,1]
    v_pk_fma_f32 v[72:73], v[76:77], v[134:135], s[76:77] op_sel:[0,1,0] op_sel_hi:[1,1,1]
    v_pk_fma_f32 v[138:139], v[78:79], v[134:135], s[76:77] op_sel:[0,0,0] op_sel_hi:[1,0,1]
    v_pk_fma_f32 v[74:75], v[78:79], v[134:135], s[76:77] op_sel:[0,1,0] op_sel_hi:[1,1,1]
    v_pk_fma_f32 v[36:37], v[36:37], v[132:133], v[136:137] op_sel:[0,0,0] op_sel_hi:[1,0,1]
    v_pk_fma_f32 v[40:41], v[40:41], v[132:133], v[72:73] op_sel:[0,1,0] op_sel_hi:[1,1,1]
    v_pk_fma_f32 v[38:39], v[38:39], v[132:133], v[138:139] op_sel:[0,0,0] op_sel_hi:[1,0,1]
    v_pk_fma_f32 v[42:43], v[42:43], v[132:133], v[74:75] op_sel:[0,1,0] op_sel_hi:[1,1,1]
    v_pk_fma_f32 v[136:137], v[36:37], s[78:79], v[142:143] op_sel:[0,0,1] op_sel_hi:[1,1,1]
    v_pk_fma_f32 v[72:73], v[40:41], s[78:79], v[142:143] op_sel:[0,0,1] op_sel_hi:[1,1,1]
    v_pk_fma_f32 v[138:139], v[38:39], s[78:79], v[142:143] op_sel:[0,0,1] op_sel_hi:[1,1,1]
    v_pk_fma_f32 v[74:75], v[42:43], s[78:79], v[142:143] op_sel:[0,0,1] op_sel_hi:[1,1,1]
    v_exp_f32_e64 v136, v136 clamp
    v_exp_f32_e64 v72, v72 clamp
    v_exp_f32_e64 v137, v137 clamp
    v_exp_f32_e64 v73, v73 clamp
    v_exp_f32_e64 v138, v138 clamp
    v_exp_f32_e64 v74, v74 clamp
    v_exp_f32_e64 v139, v139 clamp
    v_exp_f32_e64 v75, v75 clamp
    v_max_f32 v36, s76, v36
    v_max_f32 v40, s76, v40
    v_max_f32 v37, s76, v37
    v_max_f32 v41, s76, v41
    v_max_f32 v38, s76, v38
    v_max_f32 v42, s76, v42
    v_max_f32 v39, s76, v39
    v_max_f32 v43, s76, v43
    v_pk_add_f32 v[36:37], v[36:37], v[136:137] op_sel:[0,0] op_sel_hi:[1,1]
    v_pk_add_f32 v[40:41], v[40:41], v[72:73] op_sel:[0,0] op_sel_hi:[1,1]
    v_pk_add_f32 v[38:39], v[38:39], v[138:139] op_sel:[0,0] op_sel_hi:[1,1]
    v_pk_add_f32 v[42:43], v[42:43], v[74:75] op_sel:[0,0] op_sel_hi:[1,1]
    v_cvt_pk_bf16_f32 v60, v36, v37
    v_cvt_pk_bf16_f32 v66, v40, v41
    v_cvt_pk_bf16_f32 v61, v38, v39
    v_cvt_pk_bf16_f32 v67, v42, v43
    s_waitcnt lgkmcnt(1)
    v_pk_fma_f32 v[136:137], v[80:81], v[134:135], s[76:77] op_sel:[0,0,0] op_sel_hi:[1,0,1]
    v_pk_fma_f32 v[72:73], v[80:81], v[134:135], s[76:77] op_sel:[0,1,0] op_sel_hi:[1,1,1]
    v_pk_fma_f32 v[138:139], v[82:83], v[134:135], s[76:77] op_sel:[0,0,0] op_sel_hi:[1,0,1]
    v_pk_fma_f32 v[74:75], v[82:83], v[134:135], s[76:77] op_sel:[0,1,0] op_sel_hi:[1,1,1]
    v_pk_fma_f32 v[44:45], v[44:45], v[132:133], v[136:137] op_sel:[0,0,0] op_sel_hi:[1,0,1]
    v_pk_fma_f32 v[48:49], v[48:49], v[132:133], v[72:73] op_sel:[0,1,0] op_sel_hi:[1,1,1]
    v_pk_fma_f32 v[46:47], v[46:47], v[132:133], v[138:139] op_sel:[0,0,0] op_sel_hi:[1,0,1]
    v_pk_fma_f32 v[50:51], v[50:51], v[132:133], v[74:75] op_sel:[0,1,0] op_sel_hi:[1,1,1]
    v_pk_fma_f32 v[136:137], v[44:45], s[78:79], v[142:143] op_sel:[0,0,1] op_sel_hi:[1,1,1]
    v_pk_fma_f32 v[72:73], v[48:49], s[78:79], v[142:143] op_sel:[0,0,1] op_sel_hi:[1,1,1]
    v_pk_fma_f32 v[138:139], v[46:47], s[78:79], v[142:143] op_sel:[0,0,1] op_sel_hi:[1,1,1]
    v_pk_fma_f32 v[74:75], v[50:51], s[78:79], v[142:143] op_sel:[0,0,1] op_sel_hi:[1,1,1]
    v_exp_f32_e64 v136, v136 clamp
    v_exp_f32_e64 v72, v72 clamp
    v_exp_f32_e64 v137, v137 clamp
    v_exp_f32_e64 v73, v73 clamp
    v_exp_f32_e64 v138, v138 clamp
    v_exp_f32_e64 v74, v74 clamp
    v_exp_f32_e64 v139, v139 clamp
    v_exp_f32_e64 v75, v75 clamp
    v_max_f32 v44, s76, v44
    v_max_f32 v48, s76, v48
    v_max_f32 v45, s76, v45
    v_max_f32 v49, s76, v49
    v_max_f32 v46, s76, v46
    v_max_f32 v50, s76, v50
    v_max_f32 v47, s76, v47
    v_max_f32_e64 v51, s76, v51
    v_pk_add_f32 v[44:45], v[44:45], v[136:137] op_sel:[0,0] op_sel_hi:[1,1]
    v_pk_add_f32 v[48:49], v[48:49], v[72:73] op_sel:[0,0] op_sel_hi:[1,1]
    v_pk_add_f32 v[46:47], v[46:47], v[138:139] op_sel:[0,0] op_sel_hi:[1,1]
    v_pk_add_f32 v[50:51], v[50:51], v[74:75] op_sel:[0,0] op_sel_hi:[1,1]
    v_cvt_pk_bf16_f32 v63, v44, v45
    v_cvt_pk_bf16_f32 v69, v48, v49
    v_cvt_pk_bf16_f32 v64, v46, v47
    v_cvt_pk_bf16_f32 v70, v50, v51
    s_waitcnt lgkmcnt(0)
    v_pk_fma_f32 v[136:137], v[84:85], v[134:135], s[76:77] op_sel:[0,0,0] op_sel_hi:[1,0,1]
    v_pk_fma_f32 v[72:73], v[84:85], v[134:135], s[76:77] op_sel:[0,1,0] op_sel_hi:[1,1,1]
    v_pk_fma_f32 v[52:53], v[52:53], v[132:133], v[136:137] op_sel:[0,0,0] op_sel_hi:[1,0,1]
    v_pk_fma_f32 v[56:57], v[56:57], v[132:133], v[72:73] op_sel:[0,1,0] op_sel_hi:[1,1,1]
    v_pk_fma_f32 v[136:137], v[52:53], s[78:79], v[142:143] op_sel:[0,0,1] op_sel_hi:[1,1,1]
    v_pk_fma_f32 v[72:73], v[56:57], s[78:79], v[142:143] op_sel:[0,0,1] op_sel_hi:[1,1,1]
    v_exp_f32_e64 v136, v136 clamp
    v_exp_f32_e64 v72, v72 clamp
    v_exp_f32_e64 v137, v137 clamp
    v_exp_f32_e64 v73, v73 clamp
    v_max_f32 v52, s76, v52
    v_max_f32 v56, s76, v56
    v_max_f32 v53, s76, v53
    v_max_f32_e64 v57, s76, v57
    v_pk_add_f32 v[52:53], v[52:53], v[136:137] op_sel:[0,0] op_sel_hi:[1,1]
    v_pk_add_f32 v[56:57], v[56:57], v[72:73] op_sel:[0,0] op_sel_hi:[1,1]
    v_cvt_pk_bf16_f32 v62, v52, v53
    v_cvt_pk_bf16_f32 v68, v56, v57
    s_mov_b32 s52, 0x41800000
    s_waitcnt vmcnt(9)
    v_min_f32 v136, v147, v151
    s_waitcnt vmcnt(7)
    v_min3_f32 v136, v136, v155, v159
    s_waitcnt vmcnt(6)
    v_min_f32 v136, v136, v163
    v_cmp_gt_f32 vcc, s52, v136
    s_nop 1
    s_cbranch_vccz L_ok_6
    s_mov_b32 s60, 0
L_lp_5:
    s_sleep 4
    buffer_load_dwordx4 v[144:147], v1, s[4:7], s46 offen offset:0 sc1
    buffer_load_dwordx4 v[148:151], v1, s[4:7], s46 offen offset:1024 sc1
    buffer_load_dwordx4 v[152:155], v1, s[4:7], s46 offen offset:2048 sc1
    buffer_load_dwordx4 v[156:159], v1, s[4:7], s46 offen offset:3072 sc1
    buffer_load_dwordx4 v[160:163], v26, s[4:7], s46 offen offset:0 sc1
    s_add_u32 s60, s60, 1
    s_cmp_gt_u32 s60, 0x40000
    s_cbranch_scc1 L_abort
    s_waitcnt vmcnt(0)
    v_min_f32 v136, v147, v151
    v_min3_f32 v136, v136, v155, v159
    v_min_f32 v136, v136, v163
    v_cmp_gt_f32 vcc, s52, v136
    s_nop 1
    s_cbranch_vccnz L_lp_5
L_ok_6:
    s_cmp_eq_u32 s90, 0
    s_cbranch_scc1 L_slow
    v_cvt_pk_bf16_f32 v72, v157, v158
    v_cvt_pk_bf16_f32 v73, v160, v161
    v_cvt_pk_bf16_f32 v74, v162, 0
    v_cvt_pk_bf16_f32 v75, 0, v162
    v_cndmask_b32 v108, v72, 0, s[48:49]
    v_cndmask_b32 v109, v73, 0, s[48:49]
    v_cndmask_b32 v110, v74, 0, s[48:49]
    v_cndmask_b32 v112, 0, v75, s[48:49]
    v_cndmask_b32 v113, 0, v72, s[48:49]
    v_cndmask_b32 v114, 0, v73, s[48:49]
    v_cvt_pk_bf16_f32 v100, v144, v145
    v_mfma_f32_16x16x32_bf16 v[84:87], v[108:111], v[60:63], 0
    v_cvt_pk_bf16_f32 v101, v146, v148
    v_cvt_pk_bf16_f32 v102, v149, 0
    v_mfma_f32_16x16x32_bf16 v[96:99], v[108:111], v[66:69], 0
    v_cvt_pk_bf16_f32 v104, 0, v156
    v_cvt_pk_bf16_f32 v105, v150, v152
    v_mfma_f32_16x16x32_bf16 v[84:87], v[112:115], v[62:65], v[84:87]
    v_cvt_pk_bf16_f32 v106, v153, v154
    v_mfma_f32_16x16x32_bf16 v[96:99], v[112:115], v[68:71], v[96:99]
    v_mfma_f32_16x16x32_bf16 v[76:79], v[100:103], v[60:63], 0
    v_mfma_f32_16x16x32_bf16 v[80:83], v[104:107], v[62:65], 0
    v_mfma_f32_16x16x32_bf16 v[88:91], v[100:103], v[66:69], 0
    v_mfma_f32_16x16x32_bf16 v[92:95], v[104:107], v[68:71], 0
    s_nop 1
    v_pk_add_f32 v[84:85], v[84:85], s[76:77] op_sel:[0,0] op_sel_hi:[1,1]
    v_rcp_f32 v84, v84
    v_rcp_f32_e64 v85, v85
    v_pk_add_f32 v[96:97], v[96:97], s[76:77] op_sel:[0,0] op_sel_hi:[1,1]
    v_rcp_f32 v96, v96
    v_rcp_f32 v97, v97
    v_pk_mul_f32 v[86:87], v[86:87], v[84:85] op_sel:[0,0] op_sel_hi:[1,1]
    v_pk_mul_f32 v[76:77], v[76:77], v[84:85] op_sel:[0,0] op_sel_hi:[1,0]
    v_pk_mul_f32 v[78:79], v[78:79], v[84:85] op_sel:[0,0] op_sel_hi:[1,0]
    v_pk_mul_f32 v[80:81], v[80:81], v[84:85] op_sel:[0,1] op_sel_hi:[1,1]
    v_pk_mul_f32 v[82:83], v[82:83], v[84:85] op_sel:[0,1] op_sel_hi:[1,1]
    v_cvt_pk_bf16_f32 v40, v86, v87
    v_cvt_pk_bf16_f32 v36, v76, v77
    v_cvt_pk_bf16_f32 v37, v78, v79
    v_cvt_pk_bf16_f32 v38, v80, v81
    v_cvt_pk_bf16_f32 v39, v82, v83
    buffer_store_dwordx4 v[36:39], v1, s[4:7], s29 offen
    buffer_store_dword v40, v27, s[4:7], s29 offen
    v_pk_mul_f32 v[98:99], v[98:99], v[96:97] op_sel:[0,0] op_sel_hi:[1,1]
    v_pk_mul_f32 v[88:89], v[88:89], v[96:97] op_sel:[0,0] op_sel_hi:[1,0]
    v_pk_mul_f32 v[90:91], v[90:91], v[96:97] op_sel:[0,0] op_sel_hi:[1,0]
    v_pk_mul_f32 v[92:93], v[92:93], v[96:97] op_sel:[0,1] op_sel_hi:[1,1]
    v_pk_mul_f32 v[94:95], v[94:95], v[96:97] op_sel:[0,1] op_sel_hi:[1,1]
    v_cvt_pk_bf16_f32 v46, v98, v99
    v_cvt_pk_bf16_f32 v42, v88, v89
    v_cvt_pk_bf16_f32 v43, v90, v91
    v_cvt_pk_bf16_f32 v44, v92, v93
    v_cvt_pk_bf16_f32 v45, v94, v95
    buffer_store_dwordx4 v[42:45], v1, s[4:7], s30 offen
    buffer_store_dword v46, v27, s[4:7], s30 offen
    s_add_u32 s46, s46, 81920
    s_add_u32 s47, s47, 81920
    s_add_u32 s52, s39, 1
    v_mov_b32 v15, s52
    s_mov_b32 m0, s88
    s_nop 0
    buffer_load_dwordx4 v1, s[4:7], s89 offen offset:3072 lds
    s_add_u32 s89, s96, s26
    s_add_u32 s88, s96, 141312
    s_add_u32 s89, s89, 69632
    s_mov_b32 m0, s88
    s_nop 0
    buffer_load_dwordx4 v1, s[4:7], s89 offen offset:0 lds
    buffer_load_dwordx4 v1, s[4:7], s89 offen offset:1024 lds
    buffer_load_dwordx4 v1, s[4:7], s89 offen offset:2048 lds
    s_waitcnt vmcnt(4)
    s_mov_b64 exec, 1
    buffer_store_dword v15, off, s[4:7], s42
    s_mov_b64 exec, -1
    v_lshlrev_b32_e64 v96, 16, v16
    v_and_b32 v97, 0xffff0000, v16
    v_lshlrev_b32_e64 v98, 16, v17
    v_and_b32 v99, 0xffff0000, v17
    v_lshlrev_b32_e64 v100, 16, v18
    v_and_b32 v101, 0xffff0000, v18
    v_lshlrev_b32_e64 v102, 16, v19
    v_and_b32 v103, 0xffff0000, v19
    v_lshlrev_b32_e64 v104, 16, v20
    v_and_b32 v105, 0xffff0000, v20
    v_lshlrev_b32_e64 v106, 16, v21
    v_and_b32 v107, 0xffff0000, v21
    v_lshlrev_b32_e64 v108, 16, v22
    v_and_b32 v109, 0xffff0000, v22
    v_lshlrev_b32_e64 v110, 16, v23
    v_and_b32 v111, 0xffff0000, v23
    v_lshlrev_b32_e64 v112, 16, v24
    v_and_b32 v113, 0xffff0000, v24
    v_lshlrev_b32_e64 v114, 16, v25
    v_and_b32 v115, 0xffff0000, v25
    v_and_b32 v15, 31, v2
    s_mov_b32 s60, 0
    s_add_u32 s52, s39, 1
L_poll_7:
    buffer_load_dword v14, v15, s[4:7], s43 offen sc1
    s_add_u32 s60, s60, 1
    s_cmp_gt_u32 s60, 0x40000
    s_cbranch_scc1 L_abort
    s_waitcnt vmcnt(0)
    v_cmp_ne_u32 vcc, s52, v14
    s_nop 1
    s_cbranch_vccnz L_poll_7
    buffer_load_dwordx4 a[0:3], v1, s[4:7], s31 offen offset:0 sc1
    buffer_load_dwordx4 a[4:7], v1, s[4:7], s31 offen offset:1024 sc1
    buffer_load_dwordx4 a[8:11], v1, s[4:7], s31 offen offset:2048 sc1
    buffer_load_dwordx4 a[12:15], v1, s[4:7], s31 offen offset:3072 sc1
    buffer_load_dwordx4 a[16:19], v26, s[4:7], s31 offen offset:0 sc1
    buffer_load_dwordx4 a[20:23], v1, s[4:7], s32 offen offset:0 sc1
    s_waitcnt vmcnt(5)
    v_mfma_f32_16x16x32_bf16 v[36:39], a[156:159], a[0:3], 0
    buffer_load_dwordx4 a[24:27], v1, s[4:7], s32 offen offset:1024 sc1
    v_mfma_f32_16x16x32_bf16 v[40:43], a[152:155], a[0:3], 0
    v_mfma_f32_16x16x32_bf16 v[52:55], a[140:143], a[0:3], 0
    buffer_load_dwordx4 a[28:31], v1, s[4:7], s32 offen offset:2048 sc1
    s_waitcnt vmcnt(6)
    v_mfma_f32_16x16x32_bf16 v[36:39], a[136:139], a[4:7], v[36:39]
    v_mfma_f32_16x16x32_bf16 v[40:43], a[132:135], a[4:7], v[40:43]
    buffer_load_dwordx4 a[32:35], v1, s[4:7], s32 offen offset:3072 sc1
    v_mfma_f32_16x16x32_bf16 v[52:55], a[120:123], a[4:7], v[52:55]
    s_waitcnt vmcnt(6)
    v_mfma_f32_16x16x32_bf16 v[36:39], a[116:119], a[8:11], v[36:39]
    v_mfma_f32_16x16x32_bf16 v[40:43], a[112:115], a[8:11], v[40:43]
    buffer_load_dwordx4 a[36:39], v26, s[4:7], s32 offen offset:0 sc1
    v_mfma_f32_16x16x32_bf16 v[52:55], a[100:103], a[8:11], v[52:55]
    s_waitcnt vmcnt(6)
    v_mfma_f32_16x16x32_bf16 v[36:39], a[96:99], a[12:15], v[36:39]
    buffer_load_dwordx4 a[40:43], v1, s[4:7], s33 offen offset:0 sc1
    v_mfma_f32_16x16x32_bf16 v[40:43], a[92:95], a[12:15], v[40:43]
    v_mfma_f32_16x16x32_bf16 v[52:55], a[80:83], a[12:15], v[52:55]
    buffer_load_dwordx4 a[44:47], v1, s[4:7], s33 offen offset:1024 sc1
    s_waitcnt vmcnt(7)
    v_mfma_f32_16x16x32_bf16 v[36:39], v[116:119], a[16:19], v[36:39]
    v_mfma_f32_16x16x32_bf16 v[40:43], v[120:123], a[16:19], v[40:43]
    buffer_load_dwordx4 a[48:51], v1, s[4:7], s33 offen offset:2048 sc1
    v_mfma_f32_16x16x32_bf16 v[52:55], v[164:167], a[16:19], v[52:55]
    s_waitcnt vmcnt(7)
    v_mfma_f32_16x16x32_bf16 v[56:59], a[156:159], a[20:23], 0
    buffer_load_dwordx4 a[52:55], v1, s[4:7], s33 offen offset:3072 sc1
    v_mfma_f32_16x16x32_bf16 v[60:63], a[152:155], a[20:23], 0
    v_mfma_f32_16x16x32_bf16 v[72:75], a[140:143], a[20:23], 0
    buffer_load_dwordx4 a[56:59], v26, s[4:7], s33 offen offset:0 sc1
    s_waitcnt vmcnt(8)
    v_mfma_f32_16x16x32_bf16 v[56:59], a[136:139], a[24:27], v[56:59]
    ds_write_b128 v29, v[36:39] offset:0
    v_mfma_f32_16x16x32_bf16 v[60:63], a[132:135], a[24:27], v[60:63]
    buffer_load_dwordx4 a[60:63], v1, s[4:7], s34 offen offset:0 sc1
    v_mfma_f32_16x16x32_bf16 v[72:75], a[120:123], a[24:27], v[72:75]
    s_waitcnt vmcnt(8)
    v_mfma_f32_16x16x32_bf16 v[56:59], a[116:119], a[28:31], v[56:59]
    v_mfma_f32_16x16x32_bf16 v[60:63], a[112:115], a[28:31], v[60:63]
    buffer_load_dwordx4 a[64:67], v1, s[4:7], s34 offen offset:1024 sc1
    ds_write_b128 v29, v[40:43] offset:1024
    v_mfma_f32_16x16x32_bf16 v[72:75], a[100:103], a[28:31], v[72:75]
    s_waitcnt vmcnt(8)
    v_mfma_f32_16x16x32_bf16 v[56:59], a[96:99], a[32:35], v[56:59]
    buffer_load_dwordx4 a[68:71], v1, s[4:7], s34 offen offset:2048 sc1
    v_mfma_f32_16x16x32_bf16 v[60:63], a[92:95], a[32:35], v[60:63]
    v_mfma_f32_16x16x32_bf16 v[72:75], a[80:83], a[32:35], v[72:75]
    buffer_load_dwordx4 a[72:75], v1, s[4:7], s34 offen offset:3072 sc1
    ds_write_b128 v29, v[52:55] offset:4096
    s_waitcnt vmcnt(9)
    v_mfma_f32_16x16x32_bf16 v[56:59], v[116:119], a[36:39], v[56:59]
    v_mfma_f32_16x16x32_bf16 v[60:63], v[120:123], a[36:39], v[60:63]
    buffer_load_dwordx4 a[76:79], v26, s[4:7], s34 offen offset:0 sc1
    v_mfma_f32_16x16x32_bf16 v[72:75], v[164:167], a[36:39], v[72:75]
    s_waitcnt vmcnt(9)
    v_mfma_f32_16x16x32_bf16 v[76:79], a[156:159], a[40:43], 0
    v_mfma_f32_16x16x32_bf16 v[80:83], a[152:155], a[40:43], 0
    v_mfma_f32_16x16x32_bf16 v[92:95], a[140:143], a[40:43], 0
    s_waitcnt vmcnt(8)
    v_mfma_f32_16x16x32_bf16 v[76:79], a[136:139], a[44:47], v[76:79]
    ds_write_b128 v30, v[56:59] offset:0
    v_mfma_f32_16x16x32_bf16 v[80:83], a[132:135], a[44:47], v[80:83]
    v_mfma_f32_16x16x32_bf16 v[92:95], a[120:123], a[44:47], v[92:95]
    s_waitcnt vmcnt(7)
    v_mfma_f32_16x16x32_bf16 v[76:79], a[116:119], a[48:51], v[76:79]
    v_mfma_f32_16x16x32_bf16 v[80:83], a[112:115], a[48:51], v[80:83]
    ds_write_b128 v30, v[60:63] offset:1024
    v_mfma_f32_16x16x32_bf16 v[92:95], a[100:103], a[48:51], v[92:95]
    s_waitcnt vmcnt(6)
    v_mfma_f32_16x16x32_bf16 v[76:79], a[96:99], a[52:55], v[76:79]
    v_mfma_f32_16x16x32_bf16 v[80:83], a[92:95], a[52:55], v[80:83]
    v_mfma_f32_16x16x32_bf16 v[92:95], a[80:83], a[52:55], v[92:95]
    ds_write_b128 v30, v[72:75] offset:4096
    s_waitcnt vmcnt(5)
    v_mfma_f32_16x16x32_bf16 v[76:79], v[116:119], a[56:59], v[76:79]
    v_mfma_f32_16x16x32_bf16 v[80:83], v[120:123], a[56:59], v[80:83]
    v_mfma_f32_16x16x32_bf16 v[92:95], v[164:167], a[56:59], v[92:95]
    s_waitcnt vmcnt(4)
    v_mfma_f32_16x16x32_bf16 v[96:99], a[156:159], a[60:63], v[96:99]
    v_mfma_f32_16x16x32_bf16 v[100:103], a[152:155], a[60:63], v[100:103]
    v_mfma_f32_16x16x32_bf16 v[112:115], a[140:143], a[60:63], v[112:115]
    s_waitcnt vmcnt(3)
    v_mfma_f32_16x16x32_bf16 v[96:99], a[136:139], a[64:67], v[96:99]
    ds_write_b128 v31, v[76:79] offset:0
    v_mfma_f32_16x16x32_bf16 v[100:103], a[132:135], a[64:67], v[100:103]
    v_mfma_f32_16x16x32_bf16 v[112:115], a[120:123], a[64:67], v[112:115]
    s_waitcnt vmcnt(2)
    v_mfma_f32_16x16x32_bf16 v[96:99], a[116:119], a[68:71], v[96:99]
    v_mfma_f32_16x16x32_bf16 v[100:103], a[112:115], a[68:71], v[100:103]
    ds_write_b128 v31, v[80:83] offset:1024
    v_mfma_f32_16x16x32_bf16 v[112:115], a[100:103], a[68:71], v[112:115]
    s_waitcnt vmcnt(1)
    v_mfma_f32_16x16x32_bf16 v[96:99], a[96:99], a[72:75], v[96:99]
    v_mfma_f32_16x16x32_bf16 v[100:103], a[92:95], a[72:75], v[100:103]
    v_mfma_f32_16x16x32_bf16 v[112:115], a[80:83], a[72:75], v[112:115]
    ds_write_b128 v31, v[92:95] offset:4096
    s_waitcnt vmcnt(0)
    v_mfma_f32_16x16x32_bf16 v[96:99], v[116:119], a[76:79], v[96:99]
    v_mfma_f32_16x16x32_bf16 v[100:103], v[120:123], a[76:79], v[100:103]
    v_mfma_f32_16x16x32_bf16 v[112:115], v[164:167], a[76:79], v[112:115]
    v_mfma_f32_16x16x32_bf16 v[44:47], a[148:151], a[0:3], 0
    v_mfma_f32_16x16x32_bf16 v[48:51], a[144:147], a[0:3], 0
    s_add_u32 s13, s97, s26
    s_add_u32 s12, s97, 71680
    s_mov_b32 m0, s12
    s_nop 0
    buffer_load_dwordx4 v1, s[4:7], s13 offen offset:0 lds
    v_mfma_f32_16x16x32_bf16 v[44:47], a[128:131], a[4:7], v[44:47]
    s_waitcnt lgkmcnt(0)
    s_barrier
    ds_read_b128 v[36:39], v32 offset:0
    v_mfma_f32_16x16x32_bf16 v[48:51], a[124:127], a[4:7], v[48:51]
    ds_read_b128 v[56:59], v32 offset:5120
    ds_read_b128 v[76:79], v32 offset:10240
    v_mfma_f32_16x16x32_bf16 v[44:47], a[108:111], a[8:11], v[44:47]
    buffer_load_dwordx4 v1, s[4:7], s13 offen offset:1024 lds
    ds_read_b128 v[40:43], v32 offset:1024
    ds_read_b128 v[60:63], v32 offset:6144
    v_mfma_f32_16x16x32_bf16 v[48:51], a[104:107], a[8:11], v[48:51]
    ds_read_b128 v[80:83], v32 offset:11264
    ds_read_b128 v[52:55], v32 offset:4096
    v_mfma_f32_16x16x32_bf16 v[44:47], a[88:91], a[12:15], v[44:47]
    ds_read_b128 v[72:75], v32 offset:9216
    ds_read_b128 v[92:95], v32 offset:14336
    v_mfma_f32_16x16x32_bf16 v[48:51], a[84:87], a[12:15], v[48:51]
    buffer_load_dwordx4 v1, s[4:7], s13 offen offset:2048 lds
    v_mov_b32 v140, 0
    v_mov_b32 v141, 0
    v_mfma_f32_16x16x32_bf16 v[44:47], v[124:127], a[16:19], v[44:47]
    v_mov_b32 v142, 0
    v_mov_b32 v143, 0
    v_mfma_f32_16x16x32_bf16 v[48:51], v[128:131], a[16:19], v[48:51]
    v_mov_b32 v139, 0x3f803f80
    s_waitcnt lgkmcnt(8)
    v_add_f32 v96, v96, v36
    v_mfma_f32_16x16x32_bf16 v[64:67], a[148:151], a[20:23], 0
    v_add_f32 v97, v97, v37
    v_add_f32 v98, v98, v38
    v_mfma_f32_16x16x32_bf16 v[68:71], a[144:147], a[20:23], 0
    buffer_load_dwordx4 v1, s[4:7], s13 offen offset:3072 lds
    v_add_f32 v99, v99, v39
    s_waitcnt lgkmcnt(6)
    v_add_f32 v56, v56, v76
    v_mfma_f32_16x16x32_bf16 v[64:67], a[128:131], a[24:27], v[64:67]
    v_add_f32 v57, v57, v77
    v_add_f32 v58, v58, v78
    v_mfma_f32_16x16x32_bf16 v[68:71], a[124:127], a[24:27], v[68:71]
    ds_write_b128 v29, v[44:47] offset:2048
    v_add_f32 v59, v59, v79
    v_add_f32 v96, v96, v56
    v_mfma_f32_16x16x32_bf16 v[64:67], a[108:111], a[28:31], v[64:67]
    s_add_u32 s13, s94, s26
    s_add_u32 s12, s94, 88064
    s_add_u32 s13, s13, 16384
    s_mov_b32 m0, s12
    s_nop 0
    buffer_load_dwordx4 v1, s[4:7], s13 offen offset:0 lds
    v_add_f32 v97, v97, v57
    v_add_f32 v98, v98, v58
    v_mfma_f32_16x16x32_bf16 v[68:71], a[104:107], a[28:31], v[68:71]
    ds_write_b128 v29, v[48:51] offset:3072
    v_add_f32_e64 v99, v99, v59
    v_cvt_pk_bf16_f32 v16, v96, v97
    v_mfma_f32_16x16x32_bf16 v[64:67], a[88:91], a[32:35], v[64:67]
    v_cvt_pk_bf16_f32 v17, v98, v99
    s_waitcnt lgkmcnt(7)
    v_add_f32 v100, v100, v40
    v_mfma_f32_16x16x32_bf16 v[68:71], a[84:87], a[32:35], v[68:71]
    s_add_u32 s69, s28, 8192
    buffer_load_dwordx4 v[200:203], v1, s[4:7], s69 offen offset:0
    v_add_f32 v101, v101, v41
    v_add_f32 v102, v102, v42
    v_mfma_f32_16x16x32_bf16 v[64:67], v[124:127], a[36:39], v[64:67]
    v_add_f32 v103, v103, v43
    s_waitcnt lgkmcnt(5)
    v_add_f32 v60, v60, v80
    v_mfma_f32_16x16x32_bf16 v[68:71], v[128:131], a[36:39], v[68:71]
    v_add_f32 v61, v61, v81
    v_add_f32 v62, v62, v82
    v_mfma_f32_16x16x32_bf16 v[84:87], a[148:151], a[40:43], 0
    v_add_f32 v63, v63, v83
    v_add_f32 v100, v100, v60
    v_mfma_f32_16x16x32_bf16 v[88:91], a[144:147], a[40:43], 0
    buffer_load_dwordx4 v[204:207], v1, s[4:7], s69 offen offset:1024
    v_add_f32 v101, v101, v61
    v_add_f32 v102, v102, v62
    v_mfma_f32_16x16x32_bf16 v[84:87], a[128:131], a[44:47], v[84:87]
    v_add_f32 v103, v103, v63
    v_cvt_pk_bf16_f32 v18, v100, v101
    v_mfma_f32_16x16x32_bf16 v[88:91], a[124:127], a[44:47], v[88:91]
    ds_write_b128 v30, v[64:67] offset:2048
    v_cvt_pk_bf16_f32 v19, v102, v103
    buffer_store_dwordx4 v[16:19], v10, s[4:7], 0 offen offset:0
    v_mfma_f32_16x16x32_bf16 v[84:87], a[108:111], a[48:51], v[84:87]
    buffer_load_dwordx4 v[208:211], v1, s[4:7], s69 offen offset:2048
    s_waitcnt lgkmcnt(5)
    v_add_f32 v112, v112, v52
    v_add_f32 v113, v113, v53
    v_mfma_f32_16x16x32_bf16 v[88:91], a[104:107], a[48:51], v[88:91]
    ds_write_b128 v30, v[68:71] offset:3072
    v_add_f32 v114, v114, v54
    v_add_f32 v115, v115, v55
    v_mfma_f32_16x16x32_bf16 v[84:87], a[88:91], a[52:55], v[84:87]
    s_waitcnt lgkmcnt(4)
    v_add_f32 v72, v72, v92
    v_add_f32 v73, v73, v93
    v_mfma_f32_16x16x32_bf16 v[88:91], a[84:87], a[52:55], v[88:91]
    buffer_load_dwordx4 v[212:215], v1, s[4:7], s69 offen offset:3072
    v_add_f32 v74, v74, v94
    v_add_f32 v75, v75, v95
    v_mfma_f32_16x16x32_bf16 v[84:87], v[124:127], a[56:59], v[84:87]
    v_add_f32 v112, v112, v72
    v_add_f32 v113, v113, v73
    v_mfma_f32_16x16x32_bf16 v[88:91], v[128:131], a[56:59], v[88:91]
    v_add_f32 v114, v114, v74
    v_add_f32 v115, v115, v75
    v_mfma_f32_16x16x32_bf16 v[104:107], a[148:151], a[60:63], v[104:107]
    v_cvt_pk_bf16_f32 v24, v112, v113
    v_cvt_pk_bf16_f32 v25, v114, v115
    v_mfma_f32_16x16x32_bf16 v[108:111], a[144:147], a[60:63], v[108:111]
    buffer_store_dwordx2 v[24:25], v11, s[4:7], 0 offen
    v_mfma_f32_16x16x32_bf16 v[104:107], a[128:131], a[64:67], v[104:107]
    s_add_u32 s69, s28, 12288
    buffer_load_dwordx4 v[216:219], v1, s[4:7], s69 offen offset:0
    v_mfma_f32_16x16x32_bf16 v[108:111], a[124:127], a[64:67], v[108:111]
    ds_write_b128 v31, v[84:87] offset:2048
    v_mfma_f32_16x16x32_bf16 v[104:107], a[108:111], a[68:71], v[104:107]
    v_mfma_f32_16x16x32_bf16 v[108:111], a[104:107], a[68:71], v[108:111]
    ds_write_b128 v31, v[88:91] offset:3072
    v_mfma_f32_16x16x32_bf16 v[104:107], a[88:91], a[72:75], v[104:107]
    v_mfma_f32_16x16x32_bf16 v[108:111], a[84:87], a[72:75], v[108:111]
    buffer_load_dwordx4 v[220:223], v1, s[4:7], s69 offen offset:1024
    v_mfma_f32_16x16x32_bf16 v[104:107], v[124:127], a[76:79], v[104:107]
    v_mfma_f32_16x16x32_bf16 v[108:111], v[128:131], a[76:79], v[108:111]
    buffer_load_dwordx4 v[224:227], v1, s[4:7], s69 offen offset:2048
    buffer_load_dwordx4 v[228:231], v1, s[4:7], s69 offen offset:3072
    s_add_u32 s69, s28, 16384
    buffer_load_dwordx4 v[232:235], v1, s[4:7], s69 offen offset:0
    buffer_load_dwordx4 v[236:239], v1, s[4:7], s69 offen offset:1024
    buffer_load_dwordx4 v[240:243], v1, s[4:7], s69 offen offset:2048
    buffer_load_dwordx4 v[244:247], v1, s[4:7], s69 offen offset:3072
    s_add_u32 s69, s28, 20480
    buffer_load_dwordx4 v[248:251], v1, s[4:7], s69 offen offset:0
    buffer_load_dwordx4 v[252:255], v1, s[4:7], s69 offen offset:1024
    v_dot2_f32_bf16 v140, v16, v139, v140
    v_dot2_f32_bf16 v141, v16, v16, v141
    v_dot2_f32_bf16 v142, v17, v139, v142
    v_dot2_f32_bf16 v143, v17, v17, v143
    v_dot2_f32_bf16 v140, v18, v139, v140
    v_dot2_f32_bf16 v141, v18, v18, v141
    v_dot2_f32_bf16 v142, v19, v139, v142
    v_dot2_f32_bf16 v143, v19, v19, v143
    v_dot2_f32_bf16 v140, v24, v139, v140
    v_dot2_f32_bf16 v141, v24, v24, v141
    v_dot2_f32_bf16 v142, v25, v139, v142
    v_dot2_f32_bf16 v143, v25, v25, v143
    s_add_u32 s3, s39, 1
    v_mov_b32 v15, s3
    s_add_u32 s3, s40, 20480
    s_waitcnt vmcnt(10)
    s_mov_b64 exec, 1
    buffer_store_dword v15, off, s[4:7], s3
    s_mov_b64 exec, -1
    s_waitcnt lgkmcnt(0)
    s_barrier
    ds_read_b128 v[44:47], v32 offset:2048
    ds_read_b128 v[64:67], v32 offset:7168
    ds_read_b128 v[84:87], v32 offset:12288
    ds_read_b128 v[48:51], v32 offset:3072
    ds_read_b128 v[68:71], v32 offset:8192
    ds_read_b128 v[88:91], v32 offset:13312
    s_waitcnt lgkmcnt(5)
    v_pk_add_f32 v[104:105], v[104:105], v[44:45] op_sel:[0,0] op_sel_hi:[1,1]
    v_pk_add_f32 v[106:107], v[106:107], v[46:47] op_sel:[0,0] op_sel_hi:[1,1]
    s_waitcnt lgkmcnt(3)
    v_pk_add_f32 v[64:65], v[64:65], v[84:85] op_sel:[0,0] op_sel_hi:[1,1]
    v_pk_add_f32 v[66:67], v[66:67], v[86:87] op_sel:[0,0] op_sel_hi:[1,1]
    v_pk_add_f32 v[104:105], v[104:105], v[64:65] op_sel:[0,0] op_sel_hi:[1,1]
    v_pk_add_f32 v[106:107], v[106:107], v[66:67] op_sel:[0,0] op_sel_hi:[1,1]
    v_cvt_pk_bf16_f32 v20, v104, v105
    v_cvt_pk_bf16_f32 v21, v106, v107
    v_dot2_f32_bf16 v140, v20, v139, v140
    v_dot2_f32_bf16 v141, v20, v20, v141
    v_dot2_f32_bf16 v142, v21, v139, v142
    v_dot2_f32_bf16 v143, v21, v21, v143
    s_waitcnt lgkmcnt(2)
    v_pk_add_f32 v[108:109], v[108:109], v[48:49] op_sel:[0,0] op_sel_hi:[1,1]
    v_pk_add_f32 v[110:111], v[110:111], v[50:51] op_sel:[0,0] op_sel_hi:[1,1]
    s_waitcnt lgkmcnt(0)
    v_pk_add_f32 v[68:69], v[68:69], v[88:89] op_sel:[0,0] op_sel_hi:[1,1]
    v_pk_add_f32 v[70:71], v[70:71], v[90:91] op_sel:[0,0] op_sel_hi:[1,1]
    v_pk_add_f32 v[108:109], v[108:109], v[68:69] op_sel:[0,0] op_sel_hi:[1,1]
    v_pk_add_f32 v[110:111], v[110:111], v[70:71] op_sel:[0,0] op_sel_hi:[1,1]
    v_cvt_pk_bf16_f32 v22, v108, v109
    v_cvt_pk_bf16_f32 v23, v110, v111
    buffer_store_dwordx4 v[20:23], v10, s[4:7], 0 offen offset:1024
    v_dot2_f32_bf16 v140, v22, v139, v140
    v_dot2_f32_bf16 v141, v22, v22, v141
    v_dot2_f32_bf16 v142, v23, v139, v142
    v_dot2_f32_bf16 v143, v23, v23, v143
    s_nop 2
    v_pk_add_f32 v[140:141], v[140:141], v[142:143] op_sel:[0,0] op_sel_hi:[1,1]
    s_nop 1
    v_permlane32_swap_b32 v140, v141
    v_add_f32 v140, v140, v141
    v_mov_b32 v141, v140
    s_nop 1
    v_permlane16_swap_b32 v140, v141
    v_add_f32 v140, v140, v141
    v_and_b32 v15, 63, v2
    v_add_u32 v15, 20480, v15
    buffer_load_dword v14, v15, s[4:7], s41 offen sc1
    buffer_store_dword v140, v9, s[4:7], 0 offen
    s_barrier
    ds_read_b128 v[92:95], v3 offset:6144
    ds_read_b128 v[96:99], v3 offset:7168
    ds_read_b128 v[100:103], v3 offset:8192
    ds_read_b128 v[104:107], v3 offset:9216
    s_add_u32 s70, s28, 22528
    buffer_load_dwordx4 a[160:163], v1, s[4:7], s70 offen offset:0
    buffer_load_dwordx4 a[164:167], v1, s[4:7], s70 offen offset:1024
    buffer_load_dwordx4 a[168:171], v1, s[4:7], s70 offen offset:2048
    buffer_load_dwordx4 a[172:175], v1, s[4:7], s70 offen offset:3072
    s_add_u32 s52, s39, 1
    s_waitcnt vmcnt(5)
    v_cmp_ne_u32 vcc, s52, v14
    s_nop 1
    s_cbranch_vccz L_ok_10
    s_mov_b32 s60, 0
L_lp_9:
    v_and_b32 v15, 63, v2
    v_add_u32 v15, 20480, v15
    buffer_load_dword v14, v15, s[4:7], s41 offen sc1
    s_add_u32 s60, s60, 1
    s_cmp_gt_u32 s60, 0x40000
    s_cbranch_scc1 L_abort
    s_waitcnt vmcnt(0)
    v_cmp_ne_u32 vcc, s52, v14
    s_nop 1
    s_cbranch_vccnz L_lp_9
L_ok_10:
    buffer_load_dwordx4 a[0:3], v6, s[4:7], 0 offen offset:0 sc1
    buffer_load_dwordx4 a[4:7], v7, s[4:7], 0 offen offset:0 sc1
    buffer_load_dwordx4 a[8:11], v6, s[4:7], 0 offen offset:2048 sc1
    buffer_load_dwordx4 a[12:15], v7, s[4:7], 0 offen offset:2048 sc1
    buffer_load_dwordx4 a[16:19], v6, s[4:7], 0 offen offset:3072 sc1
    buffer_load_dwordx4 a[20:23], v7, s[4:7], 0 offen offset:3072 sc1
    buffer_load_dwordx4 a[24:27], v6, s[4:7], s21 offen offset:1024 sc1
    buffer_load_dwordx4 a[28:31], v7, s[4:7], s21 offen offset:1024 sc1
    s_waitcnt vmcnt(7) lgkmcnt(3)
    v_mfma_f32_16x16x32_bf16 v[36:39], v[92:95], a[0:3], 0
    ds_read_b128 v[108:111], v3 offset:10240
    s_add_u32 s3, s39, 1
    v_mov_b32 v15, s3
    s_mov_b64 exec, 1
    buffer_store_dword v15, off, s[4:7], s40
    s_mov_b64 exec, -1
    s_waitcnt vmcnt(7)
    v_mfma_f32_16x16x32_bf16 v[40:43], v[92:95], a[4:7], 0
    s_waitcnt lgkmcnt(3)
    v_mfma_f32_16x16x32_bf16 v[44:47], v[96:99], a[0:3], 0
    ds_read_b128 v[112:115], v3 offset:11264
    v_mfma_f32_16x16x32_bf16 v[48:51], v[96:99], a[4:7], 0
    buffer_load_dwordx4 a[32:35], v6, s[4:7], s21 offen offset:3072 sc1
    s_waitcnt lgkmcnt(3)
    v_mfma_f32_16x16x32_bf16 v[52:55], v[100:103], a[0:3], 0
    ds_read_b128 v[116:119], v3 offset:12288
    v_mfma_f32_16x16x32_bf16 v[56:59], v[100:103], a[4:7], 0
    s_waitcnt lgkmcnt(3)
    v_mfma_f32_16x16x32_bf16 v[60:63], v[104:107], a[0:3], 0
    ds_read_b128 v[120:123], v3 offset:13312
    buffer_load_dwordx4 a[36:39], v7, s[4:7], s21 offen offset:3072 sc1
    v_mfma_f32_16x16x32_bf16 v[64:67], v[104:107], a[4:7], 0
    s_waitcnt vmcnt(8) lgkmcnt(3)
    v_mfma_f32_16x16x32_bf16 v[36:39], v[108:111], a[8:11], v[36:39]
    ds_read_b128 v[92:95], v3 offset:14336
    s_waitcnt vmcnt(7)
    v_mfma_f32_16x16x32_bf16 v[40:43], v[108:111], a[12:15], v[40:43]
    buffer_load_dwordx4 a[40:43], v6, s[4:7], s22 offen offset:0 sc1
    s_waitcnt lgkmcnt(3)
    v_mfma_f32_16x16x32_bf16 v[44:47], v[112:115], a[8:11], v[44:47]
    ds_read_b128 v[96:99], v3 offset:15360
    v_mfma_f32_16x16x32_bf16 v[48:51], v[112:115], a[12:15], v[48:51]
    s_waitcnt lgkmcnt(3)
    v_mfma_f32_16x16x32_bf16 v[52:55], v[116:119], a[8:11], v[52:55]
    ds_read_b128 v[100:103], v3 offset:16384
    v_mfma_f32_16x16x32_bf16 v[56:59], v[116:119], a[12:15], v[56:59]
    buffer_load_dwordx4 a[44:47], v7, s[4:7], s22 offen offset:0 sc1
    s_waitcnt lgkmcnt(3)
    v_mfma_f32_16x16x32_bf16 v[60:63], v[120:123], a[8:11], v[60:63]
    ds_read_b128 v[104:107], v3 offset:17408
    v_mfma_f32_16x16x32_bf16 v[64:67], v[120:123], a[12:15], v[64:67]
    s_waitcnt vmcnt(8) lgkmcnt(3)
    v_mfma_f32_16x16x32_bf16 v[36:39], v[92:95], a[16:19], v[36:39]
    ds_read_b128 v[108:111], v3 offset:18432
    s_waitcnt vmcnt(7)
    v_mfma_f32_16x16x32_bf16 v[40:43], v[92:95], a[20:23], v[40:43]
    buffer_load_dwordx4 a[48:51], v6, s[4:7], s22 offen offset:2048 sc1
    s_waitcnt lgkmcnt(3)
    v_mfma_f32_16x16x32_bf16 v[44:47], v[96:99], a[16:19], v[44:47]
    ds_read_b128 v[112:115], v3 offset:19456
    v_mfma_f32_16x16x32_bf16 v[48:51], v[96:99], a[20:23], v[48:51]
    s_waitcnt lgkmcnt(3)
    v_mfma_f32_16x16x32_bf16 v[52:55], v[100:103], a[16:19], v[52:55]
    ds_read_b128 v[116:119], v3 offset:20480
    v_mfma_f32_16x16x32_bf16 v[56:59], v[100:103], a[20:23], v[56:59]
    buffer_load_dwordx4 a[52:55], v7, s[4:7], s22 offen offset:2048 sc1
    s_waitcnt lgkmcnt(3)
    v_mfma_f32_16x16x32_bf16 v[60:63], v[104:107], a[16:19], v[60:63]
    ds_read_b128 v[120:123], v3 offset:21504
    v_mfma_f32_16x16x32_bf16 v[64:67], v[104:107], a[20:23], v[64:67]
    s_waitcnt vmcnt(8) lgkmcnt(3)
    v_mfma_f32_16x16x32_bf16 v[36:39], v[108:111], a[24:27], v[36:39]
    ds_read_b128 v[92:95], v3 offset:22528
    buffer_load_dwordx4 a[56:59], v6, s[4:7], s23 offen offset:0 sc1
    s_waitcnt vmcnt(8)
    v_mfma_f32_16x16x32_bf16 v[40:43], v[108:111], a[28:31], v[40:43]
    s_waitcnt lgkmcnt(3)
    v_mfma_f32_16x16x32_bf16 v[44:47], v[112:115], a[24:27], v[44:47]
    ds_read_b128 v[96:99], v3 offset:23552
    v_mfma_f32_16x16x32_bf16 v[48:51], v[112:115], a[28:31], v[48:51]
    buffer_load_dwordx4 a[60:63], v7, s[4:7], s23 offen offset:0 sc1
    s_waitcnt lgkmcnt(3)
    v_mfma_f32_16x16x32_bf16 v[52:55], v[116:119], a[24:27], v[52:55]
    ds_read_b128 v[100:103], v3 offset:24576
    v_mfma_f32_16x16x32_bf16 v[56:59], v[116:119], a[28:31], v[56:59]
    s_waitcnt lgkmcnt(3)
    v_mfma_f32_16x16x32_bf16 v[60:63], v[120:123], a[24:27], v[60:63]
    ds_read_b128 v[104:107], v3 offset:25600
    v_and_b32 v15, 63, v2
    buffer_load_dword v14, v15, s[4:7], s41 offen sc1
    v_mfma_f32_16x16x32_bf16 v[64:67], v[120:123], a[28:31], v[64:67]
    s_waitcnt vmcnt(8) lgkmcnt(3)
    v_mfma_f32_16x16x32_bf16 v[36:39], v[92:95], a[32:35], v[36:39]
    ds_read_b128 v[108:111], v3 offset:26624
    s_waitcnt vmcnt(7)
    v_mfma_f32_16x16x32_bf16 v[40:43], v[92:95], a[36:39], v[40:43]
    buffer_load_dwordx4 a[64:67], v6, s[4:7], s23 offen offset:1024 sc1
    s_waitcnt lgkmcnt(3)
    v_mfma_f32_16x16x32_bf16 v[44:47], v[96:99], a[32:35], v[44:47]
    ds_read_b128 v[112:115], v3 offset:27648
    v_mfma_f32_16x16x32_bf16 v[48:51], v[96:99], a[36:39], v[48:51]
    s_waitcnt lgkmcnt(3)
    v_mfma_f32_16x16x32_bf16 v[52:55], v[100:103], a[32:35], v[52:55]
    ds_read_b128 v[116:119], v3 offset:28672
    v_mfma_f32_16x16x32_bf16 v[56:59], v[100:103], a[36:39], v[56:59]
    buffer_load_dwordx4 a[68:71], v7, s[4:7], s23 offen offset:1024 sc1
    s_waitcnt lgkmcnt(3)
    v_mfma_f32_16x16x32_bf16 v[60:63], v[104:107], a[32:35], v[60:63]
    ds_read_b128 v[120:123], v3 offset:29696
    v_mfma_f32_16x16x32_bf16 v[64:67], v[104:107], a[36:39], v[64:67]
    s_waitcnt vmcnt(8) lgkmcnt(3)
    v_mfma_f32_16x16x32_bf16 v[36:39], v[108:111], a[40:43], v[36:39]
    ds_read_b128 v[92:95], v3 offset:30720
    s_waitcnt vmcnt(7)
    v_mfma_f32_16x16x32_bf16 v[40:43], v[108:111], a[44:47], v[40:43]
    buffer_load_dwordx4 a[72:75], v6, s[4:7], s23 offen offset:3072 sc1
    s_waitcnt lgkmcnt(3)
    v_mfma_f32_16x16x32_bf16 v[44:47], v[112:115], a[40:43], v[44:47]
    ds_read_b128 v[96:99], v3 offset:31744
    v_mfma_f32_16x16x32_bf16 v[48:51], v[112:115], a[44:47], v[48:51]
    s_waitcnt lgkmcnt(3)
    v_mfma_f32_16x16x32_bf16 v[52:55], v[116:119], a[40:43], v[52:55]
    ds_read_b128 v[100:103], v3 offset:32768
    v_mfma_f32_16x16x32_bf16 v[56:59], v[116:119], a[44:47], v[56:59]
    buffer_load_dwordx4 a[76:79], v7, s[4:7], s23 offen offset:3072 sc1
    s_waitcnt lgkmcnt(3)
    v_mfma_f32_16x16x32_bf16 v[60:63], v[120:123], a[40:43], v[60:63]
    ds_read_b128 v[104:107], v3 offset:33792
    v_mfma_f32_16x16x32_bf16 v[64:67], v[120:123], a[44:47], v[64:67]
    s_waitcnt vmcnt(8) lgkmcnt(3)
    v_mfma_f32_16x16x32_bf16 v[36:39], v[92:95], a[48:51], v[36:39]
    ds_read_b128 v[108:111], v3 offset:34816
    s_waitcnt vmcnt(7)
    v_mfma_f32_16x16x32_bf16 v[40:43], v[92:95], a[52:55], v[40:43]
    buffer_load_dwordx4 a[80:83], v6, s[4:7], s24 offen offset:1024 sc1
    s_waitcnt lgkmcnt(3)
    v_mfma_f32_16x16x32_bf16 v[44:47], v[96:99], a[48:51], v[44:47]
    ds_read_b128 v[112:115], v3 offset:35840
    v_mfma_f32_16x16x32_bf16 v[48:51], v[96:99], a[52:55], v[48:51]
    s_waitcnt lgkmcnt(3)
    v_mfma_f32_16x16x32_bf16 v[52:55], v[100:103], a[48:51], v[52:55]
    ds_read_b128 v[116:119], v3 offset:36864
    v_mfma_f32_16x16x32_bf16 v[56:59], v[100:103], a[52:55], v[56:59]
    buffer_load_dwordx4 a[84:87], v7, s[4:7], s24 offen offset:1024 sc1
    s_waitcnt lgkmcnt(3)
    v_mfma_f32_16x16x32_bf16 v[60:63], v[104:107], a[48:51], v[60:63]
    ds_read_b128 v[120:123], v3 offset:37888
    v_mfma_f32_16x16x32_bf16 v[64:67], v[104:107], a[52:55], v[64:67]
    s_waitcnt vmcnt(8) lgkmcnt(3)
    v_mfma_f32_16x16x32_bf16 v[36:39], v[108:111], a[56:59], v[36:39]
    s_add_u32 s52, s39, 1
    s_waitcnt vmcnt(6)
    v_cmp_ne_u32 vcc, s52, v14
    s_nop 4
    s_cbranch_vccz L_ok_13
    s_mov_b32 s60, 0
L_lp_12:
    v_and_b32 v15, 63, v2
    buffer_load_dword v14, v15, s[4:7], s41 offen sc1
    s_add_u32 s60, s60, 1
    s_cmp_gt_u32 s60, 0x40000
    s_cbranch_scc1 L_abort
    s_waitcnt vmcnt(0)
    v_cmp_ne_u32 vcc, s52, v14
    s_nop 1
    s_cbranch_vccnz L_lp_12
L_ok_13:
    v_mfma_f32_16x16x32_bf16 v[40:43], v[108:111], a[60:63], v[40:43]
    ds_read_b128 v[92:95], v3 offset:38912
    s_waitcnt lgkmcnt(3)
    v_mfma_f32_16x16x32_bf16 v[44:47], v[112:115], a[56:59], v[44:47]
    ds_read_b128 v[96:99], v3 offset:39936
    buffer_load_dwordx4 a[88:91], v6, s[4:7], s24 offen offset:2048 sc1
    v_mfma_f32_16x16x32_bf16 v[48:51], v[112:115], a[60:63], v[48:51]
    ds_read_b128 v[100:103], v3 offset:40960
    s_waitcnt lgkmcnt(4)
    v_mfma_f32_16x16x32_bf16 v[52:55], v[116:119], a[56:59], v[52:55]
    ds_read_b128 v[104:107], v3 offset:41984
    v_mfma_f32_16x16x32_bf16 v[56:59], v[116:119], a[60:63], v[56:59]
    buffer_load_dwordx4 a[92:95], v7, s[4:7], s24 offen offset:2048 sc1
    s_waitcnt lgkmcnt(4)
    v_mfma_f32_16x16x32_bf16 v[60:63], v[120:123], a[56:59], v[60:63]
    v_mfma_f32_16x16x32_bf16 v[64:67], v[120:123], a[60:63], v[64:67]
    s_waitcnt vmcnt(7) lgkmcnt(3)
    v_mfma_f32_16x16x32_bf16 v[36:39], v[92:95], a[64:67], v[36:39]
    ds_read_b128 v[108:111], v3 offset:43008
    buffer_load_dwordx4 a[96:99], v6, s[4:7], 0 offen offset:1024 sc1
    s_waitcnt vmcnt(7)
    v_mfma_f32_16x16x32_bf16 v[40:43], v[92:95], a[68:71], v[40:43]
    s_waitcnt lgkmcnt(3)
    v_mfma_f32_16x16x32_bf16 v[44:47], v[96:99], a[64:67], v[44:47]
    ds_read_b128 v[112:115], v3 offset:44032
    buffer_load_dwordx4 a[100:103], v7, s[4:7], 0 offen offset:1024 sc1
    v_mfma_f32_16x16x32_bf16 v[48:51], v[96:99], a[68:71], v[48:51]
    s_waitcnt lgkmcnt(3)
    v_mfma_f32_16x16x32_bf16 v[52:55], v[100:103], a[64:67], v[52:55]
    ds_read_b128 v[116:119], v3 offset:45056
    buffer_load_dwordx4 v[128:131], v8, s[4:7], 0 offen offset:0 sc1
    v_mfma_f32_16x16x32_bf16 v[56:59], v[100:103], a[68:71], v[56:59]
    s_waitcnt lgkmcnt(3)
    v_mfma_f32_16x16x32_bf16 v[60:63], v[104:107], a[64:67], v[60:63]
    ds_read_b128 v[120:123], v3 offset:46080
    buffer_load_dwordx4 v[132:135], v8, s[4:7], 0 offen offset:1024 sc1
    v_mfma_f32_16x16x32_bf16 v[64:67], v[104:107], a[68:71], v[64:67]
    s_waitcnt vmcnt(9) lgkmcnt(3)
    v_mfma_f32_16x16x32_bf16 v[36:39], v[108:111], a[72:75], v[36:39]
    ds_read_b128 v[92:95], v3 offset:47104
    s_waitcnt vmcnt(8)
    v_mfma_f32_16x16x32_bf16 v[40:43], v[108:111], a[76:79], v[40:43]
    buffer_load_dwordx4 a[104:107], v6, s[4:7], s21 offen offset:0 sc1
    s_waitcnt lgkmcnt(3)
    v_mfma_f32_16x16x32_bf16 v[44:47], v[112:115], a[72:75], v[44:47]
    ds_read_b128 v[96:99], v3 offset:48128
    v_mfma_f32_16x16x32_bf16 v[48:51], v[112:115], a[76:79], v[48:51]
    s_waitcnt lgkmcnt(3)
    v_mfma_f32_16x16x32_bf16 v[52:55], v[116:119], a[72:75], v[52:55]
    ds_read_b128 v[100:103], v3 offset:49152
    v_mfma_f32_16x16x32_bf16 v[56:59], v[116:119], a[76:79], v[56:59]
    buffer_load_dwordx4 a[108:111], v7, s[4:7], s21 offen offset:0 sc1
    s_waitcnt lgkmcnt(3)
    v_mfma_f32_16x16x32_bf16 v[60:63], v[120:123], a[72:75], v[60:63]
    ds_read_b128 v[104:107], v3 offset:50176
    v_mfma_f32_16x16x32_bf16 v[64:67], v[120:123], a[76:79], v[64:67]
    s_waitcnt vmcnt(9) lgkmcnt(3)
    v_mfma_f32_16x16x32_bf16 v[36:39], v[92:95], a[80:83], v[36:39]
    ds_read_b128 v[108:111], v3 offset:51200
    buffer_load_dwordx4 a[112:115], v6, s[4:7], s21 offen offset:2048 sc1
    s_waitcnt vmcnt(9)
    v_mfma_f32_16x16x32_bf16 v[40:43], v[92:95], a[84:87], v[40:43]
    s_waitcnt lgkmcnt(3)
    v_mfma_f32_16x16x32_bf16 v[44:47], v[96:99], a[80:83], v[44:47]
    ds_read_b128 v[112:115], v3 offset:52224
    buffer_load_dwordx4 a[116:119], v7, s[4:7], s21 offen offset:2048 sc1
    v_mfma_f32_16x16x32_bf16 v[48:51], v[96:99], a[84:87], v[48:51]
    s_waitcnt lgkmcnt(3)
    v_mfma_f32_16x16x32_bf16 v[52:55], v[100:103], a[80:83], v[52:55]
    ds_read_b128 v[116:119], v3 offset:53248
    s_add_u32 s15, s97, s26
    s_add_u32 s14, s97, 0
    s_add_u32 s15, s15, 81920
    s_mov_b32 m0, s14
    s_nop 0
    buffer_load_dwordx4 v1, s[4:7], s15 offen offset:0 lds
    v_mfma_f32_16x16x32_bf16 v[56:59], v[100:103], a[84:87], v[56:59]
    s_waitcnt lgkmcnt(3)
    v_mfma_f32_16x16x32_bf16 v[60:63], v[104:107], a[80:83], v[60:63]
    ds_read_b128 v[120:123], v3 offset:54272
    buffer_load_dwordx4 v1, s[4:7], s15 offen offset:1024 lds
    v_mfma_f32_16x16x32_bf16 v[64:67], v[104:107], a[84:87], v[64:67]
    s_waitcnt vmcnt(11) lgkmcnt(3)
    v_mfma_f32_16x16x32_bf16 v[36:39], v[108:111], a[88:91], v[36:39]
    ds_read_b128 v[92:95], v3 offset:55296
    buffer_load_dwordx4 a[120:123], v6, s[4:7], s22 offen offset:1024 sc1
    s_waitcnt vmcnt(11)
    v_mfma_f32_16x16x32_bf16 v[40:43], v[108:111], a[92:95], v[40:43]
    s_waitcnt lgkmcnt(3)
    v_mfma_f32_16x16x32_bf16 v[44:47], v[112:115], a[88:91], v[44:47]
    ds_read_b128 v[96:99], v3 offset:56320
    v_mfma_f32_16x16x32_bf16 v[48:51], v[112:115], a[92:95], v[48:51]
    buffer_load_dwordx4 a[124:127], v7, s[4:7], s22 offen offset:1024 sc1
    s_waitcnt lgkmcnt(3)
    v_mfma_f32_16x16x32_bf16 v[52:55], v[116:119], a[88:91], v[52:55]
    ds_read_b128 v[100:103], v3 offset:57344
    v_mfma_f32_16x16x32_bf16 v[56:59], v[116:119], a[92:95], v[56:59]
    s_waitcnt lgkmcnt(3)
    v_mfma_f32_16x16x32_bf16 v[60:63], v[120:123], a[88:91], v[60:63]
    ds_read_b128 v[104:107], v3 offset:58368
    buffer_load_dwordx4 v1, s[4:7], s15 offen offset:2048 lds
    v_mfma_f32_16x16x32_bf16 v[64:67], v[120:123], a[92:95], v[64:67]
    s_waitcnt vmcnt(12) lgkmcnt(3)
    v_mfma_f32_16x16x32_bf16 v[36:39], v[92:95], a[96:99], v[36:39]
    ds_read_b128 v[108:111], v3 offset:59392
    buffer_load_dwordx4 a[128:131], v6, s[4:7], s22 offen offset:3072 sc1
    s_waitcnt vmcnt(11)
    v_add_f32 v128, v128, v129
    s_waitcnt vmcnt(10)
    v_add_f32 v132, v132, v133
    v_mfma_f32_16x16x32_bf16 v[40:43], v[92:95], a[100:103], v[40:43]
    v_add_f32 v130, v130, v131
    s_waitcnt lgkmcnt(3)
    v_mfma_f32_16x16x32_bf16 v[44:47], v[96:99], a[96:99], v[44:47]
    ds_read_b128 v[112:115], v3 offset:60416
    v_add_f32 v134, v134, v135
    v_mfma_f32_16x16x32_bf16 v[48:51], v[96:99], a[100:103], v[48:51]
    buffer_load_dwordx4 a[132:135], v7, s[4:7], s22 offen offset:3072 sc1
    v_add_f32 v128, v128, v130
    s_waitcnt lgkmcnt(3)
    v_mfma_f32_16x16x32_bf16 v[52:55], v[100:103], a[96:99], v[52:55]
    ds_read_b128 v[116:119], v3 offset:61440
    v_add_f32 v132, v132, v134
    v_mov_b32 v129, v128
    v_mfma_f32_16x16x32_bf16 v[56:59], v[100:103], a[100:103], v[56:59]
    v_mov_b32 v133, v132
    s_waitcnt lgkmcnt(3)
    v_mfma_f32_16x16x32_bf16 v[60:63], v[104:107], a[96:99], v[60:63]
    ds_read_b128 v[120:123], v3 offset:62464
    buffer_load_dwordx4 v1, s[4:7], s15 offen offset:3072 lds
    v_permlane16_swap_b32 v128, v129
    v_mfma_f32_16x16x32_bf16 v[64:67], v[104:107], a[100:103], v[64:67]
    v_permlane16_swap_b32 v132, v133
    s_waitcnt vmcnt(11) lgkmcnt(3)
    v_mfma_f32_16x16x32_bf16 v[36:39], v[108:111], a[104:107], v[36:39]
    ds_read_b128 v[92:95], v3 offset:63488
    buffer_load_dwordx4 a[136:139], v6, s[4:7], s23 offen offset:2048 sc1
    v_add_f32 v128, v128, v129
    v_add_f32 v132, v132, v133
    s_waitcnt vmcnt(11)
    v_mfma_f32_16x16x32_bf16 v[40:43], v[108:111], a[108:111], v[40:43]
    v_mov_b32 v129, v128
    s_waitcnt lgkmcnt(3)
    v_mfma_f32_16x16x32_bf16 v[44:47], v[112:115], a[104:107], v[44:47]
    ds_read_b128 v[96:99], v3 offset:64512
    v_mov_b32 v133, v132
    v_mfma_f32_16x16x32_bf16 v[48:51], v[112:115], a[108:111], v[48:51]
    buffer_load_dwordx4 a[140:143], v7, s[4:7], s23 offen offset:2048 sc1
    v_permlane32_swap_b32 v128, v129
    s_waitcnt lgkmcnt(3)
    v_mfma_f32_16x16x32_bf16 v[52:55], v[116:119], a[104:107], v[52:55]
    ds_read_b128 v[100:103], v4 offset:0
    v_permlane32_swap_b32 v132, v133
    v_mul_f32 v128, 986500301, v128
    v_mfma_f32_16x16x32_bf16 v[56:59], v[116:119], a[108:111], v[56:59]
    v_mul_f32 v132, 986500301, v132
    s_waitcnt lgkmcnt(3)
    v_mfma_f32_16x16x32_bf16 v[60:63], v[120:123], a[104:107], v[60:63]
    ds_read_b128 v[104:107], v4 offset:1024
    s_add_u32 s15, s97, s26
    s_add_u32 s14, s97, 16384
    s_add_u32 s15, s15, 98304
    s_mov_b32 m0, s14
    s_nop 0
    buffer_load_dwordx4 v1, s[4:7], s15 offen offset:0 lds
    v_mul_f32 v129, 986500301, v129
    v_mfma_f32_16x16x32_bf16 v[64:67], v[120:123], a[108:111], v[64:67]
    v_mul_f32 v133, 986500301, v133
    s_waitcnt vmcnt(12) lgkmcnt(3)
    v_mfma_f32_16x16x32_bf16 v[36:39], v[92:95], a[112:115], v[36:39]
    ds_read_b128 v[108:111], v4 offset:2048
    buffer_load_dwordx4 a[144:147], v6, s[4:7], s24 offen offset:0 sc1
    v_fma_f32 v129, -v128, v128, v129
    v_fma_f32 v133, -v132, v132, v133
    s_waitcnt vmcnt(12)
    v_mfma_f32_16x16x32_bf16 v[40:43], v[92:95], a[116:119], v[40:43]
    v_max_f32 v129, 0, v129
    s_waitcnt lgkmcnt(3)
    v_mfma_f32_16x16x32_bf16 v[44:47], v[96:99], a[112:115], v[44:47]
    ds_read_b128 v[112:115], v4 offset:3072
    v_max_f32 v133, 0, v133
    v_mfma_f32_16x16x32_bf16 v[48:51], v[96:99], a[116:119], v[48:51]
    buffer_load_dwordx4 a[148:151], v7, s[4:7], s24 offen offset:0 sc1
    v_add_f32 v129, 925353388, v129
    s_waitcnt lgkmcnt(3)
    v_mfma_f32_16x16x32_bf16 v[52:55], v[100:103], a[112:115], v[52:55]
    ds_read_b128 v[116:119], v4 offset:4096
    v_add_f32 v133, 925353388, v133
    v_rsq_f32 v124, v129
    v_mfma_f32_16x16x32_bf16 v[56:59], v[100:103], a[116:119], v[56:59]
    v_rsq_f32 v125, v133
    s_waitcnt lgkmcnt(3)
    v_mfma_f32_16x16x32_bf16 v[60:63], v[104:107], a[112:115], v[60:63]
    ds_read_b128 v[120:123], v4 offset:5120
    buffer_load_dwordx4 v1, s[4:7], s15 offen offset:1024 lds
    v_mul_f32_e64 v126, -v128, v124
    v_mfma_f32_16x16x32_bf16 v[64:67], v[104:107], a[116:119], v[64:67]
    v_mul_f32_e64 v127, -v132, v125
    s_waitcnt vmcnt(11) lgkmcnt(3)
    v_mfma_f32_16x16x32_bf16 v[36:39], v[108:111], a[120:123], v[36:39]
    ds_read_b128 v[92:95], v4 offset:6144
    buffer_load_dwordx4 a[152:155], v6, s[4:7], s24 offen offset:3072 sc1
    ds_read_b128 v[160:163], v12 offset:512
    s_waitcnt vmcnt(11)
    v_mfma_f32_16x16x32_bf16 v[40:43], v[108:111], a[124:127], v[40:43]
    s_waitcnt lgkmcnt(4)
    v_mfma_f32_16x16x32_bf16 v[44:47], v[112:115], a[120:123], v[44:47]
    ds_read_b128 v[96:99], v4 offset:7168
    buffer_load_dwordx4 a[156:159], v7, s[4:7], s24 offen offset:3072 sc1
    v_mfma_f32_16x16x32_bf16 v[48:51], v[112:115], a[124:127], v[48:51]
    s_waitcnt lgkmcnt(4)
    v_mfma_f32_16x16x32_bf16 v[52:55], v[116:119], a[120:123], v[52:55]
    ds_read_b128 v[100:103], v4 offset:8192
    buffer_load_dwordx4 v1, s[4:7], s15 offen offset:2048 lds
    ds_read_b128 v[164:167], v12 offset:1024
    v_mfma_f32_16x16x32_bf16 v[56:59], v[116:119], a[124:127], v[56:59]
    s_waitcnt lgkmcnt(5)
    v_mfma_f32_16x16x32_bf16 v[60:63], v[120:123], a[120:123], v[60:63]
    ds_read_b128 v[104:107], v4 offset:9216
    buffer_load_dwordx4 v1, s[4:7], s15 offen offset:3072 lds
    v_mfma_f32_16x16x32_bf16 v[64:67], v[120:123], a[124:127], v[64:67]
    s_waitcnt vmcnt(12) lgkmcnt(5)
    v_mfma_f32_16x16x32_bf16 v[36:39], v[92:95], a[128:131], v[36:39]
    ds_read_b128 v[108:111], v4 offset:10240
    s_waitcnt lgkmcnt(2)
    v_fma_f32 v128, v160, v126, v164
    v_fma_f32 v129, v161, v126, v165
    s_waitcnt vmcnt(11)
    v_mfma_f32_16x16x32_bf16 v[40:43], v[92:95], a[132:135], v[40:43]
    v_fma_f32 v130, v162, v126, v166
    v_mfma_f32_16x16x32_bf16 v[44:47], v[96:99], a[128:131], v[44:47]
    ds_read_b128 v[112:115], v4 offset:11264
    v_fma_f32 v131, v163, v126, v167
    v_mfma_f32_16x16x32_bf16 v[48:51], v[96:99], a[132:135], v[48:51]
    v_fma_f32 v132, v160, v127, v164
    s_add_u32 s15, s97, s26
    s_add_u32 s14, s97, 32768
    s_add_u32 s15, s15, 114688
    s_mov_b32 m0, s14
    s_nop 0
    buffer_load_dwordx4 v1, s[4:7], s15 offen offset:0 lds
    v_mfma_f32_16x16x32_bf16 v[52:55], v[100:103], a[128:131], v[52:55]
    ds_read_b128 v[116:119], v4 offset:12288
    v_fma_f32 v133, v161, v127, v165
    v_fma_f32 v134, v162, v127, v166
    v_mfma_f32_16x16x32_bf16 v[56:59], v[100:103], a[132:135], v[56:59]
    v_fma_f32 v135, v163, v127, v167
    s_waitcnt lgkmcnt(3)
    v_mfma_f32_16x16x32_bf16 v[60:63], v[104:107], a[128:131], v[60:63]
    ds_read_b128 v[120:123], v4 offset:13312
    ds_read_b128 v[160:163], v12 offset:576
    v_mfma_f32_16x16x32_bf16 v[64:67], v[104:107], a[132:135], v[64:67]
    ds_read_b128 v[164:167], v12 offset:1088
    s_waitcnt vmcnt(10) lgkmcnt(5)
    v_mfma_f32_16x16x32_bf16 v[36:39], v[108:111], a[136:139], v[36:39]
    ds_read_b128 v[92:95], v4 offset:14336
    s_waitcnt lgkmcnt(1)
    v_fma_f32 v136, v160, v126, v164
    v_fma_f32 v137, v161, v126, v165
    s_waitcnt vmcnt(9)
    v_mfma_f32_16x16x32_bf16 v[40:43], v[108:111], a[140:143], v[40:43]
    v_fma_f32 v138, v162, v126, v166
    v_mfma_f32_16x16x32_bf16 v[44:47], v[112:115], a[136:139], v[44:47]
    ds_read_b128 v[96:99], v4 offset:15360
    v_fma_f32 v139, v163, v126, v167
    v_mfma_f32_16x16x32_bf16 v[48:51], v[112:115], a[140:143], v[48:51]
    v_fma_f32 v140, v160, v127, v164
    buffer_load_dwordx4 v1, s[4:7], s15 offen offset:1024 lds
    v_mfma_f32_16x16x32_bf16 v[52:55], v[116:119], a[136:139], v[52:55]
    ds_read_b128 v[100:103], v4 offset:16384
    v_fma_f32 v141, v161, v127, v165
    v_fma_f32 v142, v162, v127, v166
    v_mfma_f32_16x16x32_bf16 v[56:59], v[116:119], a[140:143], v[56:59]
    v_fma_f32 v143, v163, v127, v167
    v_mfma_f32_16x16x32_bf16 v[60:63], v[120:123], a[136:139], v[60:63]
    ds_read_b128 v[104:107], v4 offset:17408
    ds_read_b128 v[160:163], v12 offset:640
    v_mfma_f32_16x16x32_bf16 v[64:67], v[120:123], a[140:143], v[64:67]
    ds_read_b128 v[164:167], v12 offset:1152
    s_waitcnt vmcnt(8) lgkmcnt(5)
    v_mfma_f32_16x16x32_bf16 v[36:39], v[92:95], a[144:147], v[36:39]
    ds_read_b128 v[108:111], v4 offset:18432
    s_waitcnt lgkmcnt(1)
    v_fma_f32 v144, v160, v126, v164
    v_fma_f32 v145, v161, v126, v165
    s_waitcnt vmcnt(7)
    v_mfma_f32_16x16x32_bf16 v[40:43], v[92:95], a[148:151], v[40:43]
    v_fma_f32 v146, v162, v126, v166
    v_mfma_f32_16x16x32_bf16 v[44:47], v[96:99], a[144:147], v[44:47]
    ds_read_b128 v[112:115], v4 offset:19456
    v_fma_f32 v147, v163, v126, v167
    v_mfma_f32_16x16x32_bf16 v[48:51], v[96:99], a[148:151], v[48:51]
    v_fma_f32 v148, v160, v127, v164
    buffer_load_dwordx4 v1, s[4:7], s15 offen offset:2048 lds
    v_mfma_f32_16x16x32_bf16 v[52:55], v[100:103], a[144:147], v[52:55]
    ds_read_b128 v[116:119], v4 offset:20480
    v_fma_f32 v149, v161, v127, v165
    v_fma_f32 v150, v162, v127, v166
    v_mfma_f32_16x16x32_bf16 v[56:59], v[100:103], a[148:151], v[56:59]
    v_fma_f32 v151, v163, v127, v167
    v_mfma_f32_16x16x32_bf16 v[60:63], v[104:107], a[144:147], v[60:63]
    ds_read_b128 v[120:123], v4 offset:21504
    ds_read_b128 v[160:163], v12 offset:704
    v_mfma_f32_16x16x32_bf16 v[64:67], v[104:107], a[148:151], v[64:67]
    ds_read_b128 v[164:167], v12 offset:1216
    s_waitcnt vmcnt(6) lgkmcnt(5)
    v_mfma_f32_16x16x32_bf16 v[36:39], v[108:111], a[152:155], v[36:39]
    s_waitcnt lgkmcnt(0)
    v_fma_f32 v152, v160, v126, v164
    s_waitcnt vmcnt(5)
    v_mfma_f32_16x16x32_bf16 v[40:43], v[108:111], a[156:159], v[40:43]
    v_fma_f32 v153, v161, v126, v165
    v_mfma_f32_16x16x32_bf16 v[44:47], v[112:115], a[152:155], v[44:47]
    v_fma_f32 v154, v162, v126, v166
    v_mfma_f32_16x16x32_bf16 v[48:51], v[112:115], a[156:159], v[48:51]
    v_fma_f32 v155, v163, v126, v167
    buffer_load_dwordx4 v1, s[4:7], s15 offen offset:3072 lds
    v_mfma_f32_16x16x32_bf16 v[52:55], v[116:119], a[152:155], v[52:55]
    v_fma_f32 v156, v160, v127, v164
    v_mfma_f32_16x16x32_bf16 v[56:59], v[116:119], a[156:159], v[56:59]
    v_fma_f32 v157, v161, v127, v165
    v_mfma_f32_16x16x32_bf16 v[60:63], v[120:123], a[152:155], v[60:63]
    v_fma_f32 v158, v162, v127, v166
    v_mfma_f32_16x16x32_bf16 v[64:67], v[120:123], a[156:159], v[64:67]
    v_fma_f32 v159, v163, v127, v167
    s_waitcnt vmcnt(4)
    s_barrier
    ds_read_b128 v[92:95], v1 offset:0
    ds_read_b128 v[96:99], v1 offset:1024
    ds_read_b128 v[100:103], v1 offset:2048
    ds_read_b128 v[104:107], v1 offset:3072
    ds_read_b128 v[108:111], v1 offset:4096
    ds_read_b128 v[112:115], v1 offset:5120
    s_waitcnt lgkmcnt(3)
    v_mfma_f32_16x16x32_bf16 v[68:71], v[92:95], a[152:155], 0
    ds_read_b128 v[116:119], v1 offset:6144
    s_add_u32 s53, s35, 4096
    v_fma_f32 v36, v36, v124, v128
    v_mfma_f32_16x16x32_bf16 v[72:75], v[92:95], a[156:159], 0
    v_fma_f32 v37, v37, v124, v129
    v_fma_f32 v38, v38, v124, v130
    v_mfma_f32_16x16x32_bf16 v[76:79], v[96:99], a[152:155], 0
    ds_read_b128 v[120:123], v1 offset:7168
    v_fma_f32 v39, v39, v124, v131
    s_add_u32 s15, s96, s26
    s_add_u32 s14, s96, 49152
    s_add_u32 s15, s15, 131072
    s_mov_b32 m0, s14
    s_nop 0
    buffer_load_dwordx4 v1, s[4:7], s15 offen offset:0 lds
    v_mfma_f32_16x16x32_bf16 v[80:83], v[96:99], a[156:159], 0
    v_max_f32 v36, 0, v36
    v_max_f32 v37, 0, v37
    v_mfma_f32_16x16x32_bf16 v[84:87], v[100:103], a[152:155], 0
    ds_read_b128 v[164:167], v1 offset:8192
    v_max_f32 v38, 0, v38
    v_max_f32 v39, 0, v39
    v_mfma_f32_16x16x32_bf16 v[88:91], v[100:103], a[156:159], 0
    v_mul_f32 v36, v36, v36
    s_waitcnt lgkmcnt(3)
    v_mfma_f32_16x16x32_bf16 v[68:71], v[104:107], a[144:147], v[68:71]
    ds_read_b128 v[92:95], v1 offset:9216
    v_mul_f32 v37, v37, v37
    v_mul_f32 v38, v38, v38
    buffer_load_dwordx4 v1, s[4:7], s15 offen offset:1024 lds
    v_mfma_f32_16x16x32_bf16 v[72:75], v[104:107], a[148:151], v[72:75]
    v_mul_f32 v39, v39, v39
    v_cvt_pk_bf16_f32 v36, v36, v37
    v_mfma_f32_16x16x32_bf16 v[76:79], v[108:111], a[144:147], v[76:79]
    ds_read_b128 v[96:99], v1 offset:10240
    v_cvt_pk_bf16_f32 v37, v38, v39
    s_add_u32 s70, s28, 26624
    buffer_load_dwordx4 a[176:179], v1, s[4:7], s70 offen offset:0
    v_mfma_f32_16x16x32_bf16 v[80:83], v[108:111], a[148:151], v[80:83]
    v_fma_f32 v44, v44, v124, v136
    v_fma_f32 v45, v45, v124, v137
    v_mfma_f32_16x16x32_bf16 v[84:87], v[112:115], a[144:147], v[84:87]
    ds_read_b128 v[100:103], v1 offset:11264
    v_fma_f32 v46, v46, v124, v138
    v_fma_f32 v47, v47, v124, v139
    buffer_load_dwordx4 a[180:183], v1, s[4:7], s70 offen offset:1024
    v_mfma_f32_16x16x32_bf16 v[88:91], v[112:115], a[148:151], v[88:91]
    v_max_f32 v44, 0, v44
    s_waitcnt lgkmcnt(3)
    v_mfma_f32_16x16x32_bf16 v[68:71], v[116:119], a[136:139], v[68:71]
    ds_read_b128 v[104:107], v1 offset:12288
    v_max_f32 v45, 0, v45
    v_max_f32 v46, 0, v46
    v_mfma_f32_16x16x32_bf16 v[72:75], v[116:119], a[140:143], v[72:75]
    v_max_f32 v47, 0, v47
    v_mfma_f32_16x16x32_bf16 v[76:79], v[120:123], a[136:139], v[76:79]
    ds_read_b128 v[108:111], v1 offset:13312
    v_mul_f32 v44, v44, v44
    v_mul_f32 v45, v45, v45
    v_mfma_f32_16x16x32_bf16 v[80:83], v[120:123], a[140:143], v[80:83]
    v_mul_f32 v46, v46, v46
    v_mfma_f32_16x16x32_bf16 v[84:87], v[164:167], a[136:139], v[84:87]
    ds_read_b128 v[112:115], v1 offset:14336
    v_mul_f32_e64 v47, v47, v47
    v_cvt_pk_bf16_f32 v38, v44, v45
    v_mfma_f32_16x16x32_bf16 v[88:91], v[164:167], a[140:143], v[88:91]
    v_cvt_pk_bf16_f32 v39, v46, v47
    buffer_store_dwordx4 v[36:39], v1, s[4:7], s35 offen offset:0 sc1
    buffer_load_dwordx4 v1, s[4:7], s15 offen offset:2048 lds
    buffer_load_dwordx4 a[184:187], v1, s[4:7], s70 offen offset:2048
    s_waitcnt lgkmcnt(3)
    v_mfma_f32_16x16x32_bf16 v[68:71], v[92:95], a[128:131], v[68:71]
    ds_read_b128 v[116:119], v1 offset:15360
    v_fma_f32 v40, v40, v125, v132
    v_fma_f32 v41, v41, v125, v133
    v_mfma_f32_16x16x32_bf16 v[72:75], v[92:95], a[132:135], v[72:75]
    v_fma_f32 v42, v42, v125, v134
    buffer_load_dwordx4 a[188:191], v1, s[4:7], s70 offen offset:3072
    v_mfma_f32_16x16x32_bf16 v[76:79], v[96:99], a[128:131], v[76:79]
    ds_read_b128 v[120:123], v1 offset:16384
    v_fma_f32 v43, v43, v125, v135
    v_max_f32 v40, 0, v40
    v_mfma_f32_16x16x32_bf16 v[80:83], v[96:99], a[132:135], v[80:83]
    v_max_f32 v41, 0, v41
    v_mfma_f32_16x16x32_bf16 v[84:87], v[100:103], a[128:131], v[84:87]
    ds_read_b128 v[164:167], v1 offset:17408
    v_max_f32 v42, 0, v42
    v_max_f32 v43, 0, v43
    s_add_u32 s70, s28, 30720
    buffer_load_dwordx4 a[192:195], v1, s[4:7], s70 offen offset:0
    v_mfma_f32_16x16x32_bf16 v[88:91], v[100:103], a[132:135], v[88:91]
    v_mul_f32 v40, v40, v40
    s_waitcnt lgkmcnt(3)
    v_mfma_f32_16x16x32_bf16 v[68:71], v[104:107], a[120:123], v[68:71]
    ds_read_b128 v[92:95], v1 offset:18432
    v_mul_f32 v41, v41, v41
    v_mul_f32 v42, v42, v42
    v_mfma_f32_16x16x32_bf16 v[72:75], v[104:107], a[124:127], v[72:75]
    v_mul_f32 v43, v43, v43
    v_cvt_pk_bf16_f32 v40, v40, v41
    v_mfma_f32_16x16x32_bf16 v[76:79], v[108:111], a[120:123], v[76:79]
    ds_read_b128 v[96:99], v1 offset:19456
    v_cvt_pk_bf16_f32 v41, v42, v43
    buffer_load_dwordx4 a[196:199], v1, s[4:7], s70 offen offset:1024
    v_mfma_f32_16x16x32_bf16 v[80:83], v[108:111], a[124:127], v[80:83]
    v_fma_f32 v48, v48, v125, v140
    v_fma_f32 v49, v49, v125, v141
    v_mfma_f32_16x16x32_bf16 v[84:87], v[112:115], a[120:123], v[84:87]
    ds_read_b128 v[100:103], v1 offset:20480
    v_fma_f32 v50, v50, v125, v142
    v_fma_f32 v51, v51, v125, v143
    v_mfma_f32_16x16x32_bf16 v[88:91], v[112:115], a[124:127], v[88:91]
    v_max_f32 v48, 0, v48
    s_waitcnt lgkmcnt(3)
    v_mfma_f32_16x16x32_bf16 v[68:71], v[116:119], a[112:115], v[68:71]
    ds_read_b128 v[104:107], v1 offset:21504
    v_max_f32 v49, 0, v49
    v_max_f32 v50, 0, v50
    v_mfma_f32_16x16x32_bf16 v[72:75], v[116:119], a[116:119], v[72:75]
    v_max_f32 v51, 0, v51
    v_mfma_f32_16x16x32_bf16 v[76:79], v[120:123], a[112:115], v[76:79]
    ds_read_b128 v[108:111], v1 offset:22528
    v_mul_f32 v48, v48, v48
    v_mul_f32 v49, v49, v49
    v_mfma_f32_16x16x32_bf16 v[80:83], v[120:123], a[116:119], v[80:83]
    v_mul_f32 v50, v50, v50
    v_mfma_f32_16x16x32_bf16 v[84:87], v[164:167], a[112:115], v[84:87]
    ds_read_b128 v[112:115], v1 offset:23552
    v_mul_f32_e64 v51, v51, v51
    v_cvt_pk_bf16_f32 v42, v48, v49
    v_mfma_f32_16x16x32_bf16 v[88:91], v[164:167], a[116:119], v[88:91]
    v_cvt_pk_bf16_f32 v43, v50, v51
    buffer_store_dwordx4 v[40:43], v1, s[4:7], s35 offen offset:1024 sc1
    buffer_load_dwordx4 a[200:203], v1, s[4:7], s70 offen offset:2048
    buffer_load_dwordx4 a[204:207], v1, s[4:7], s70 offen offset:3072
    s_waitcnt lgkmcnt(3)
    v_mfma_f32_16x16x32_bf16 v[68:71], v[92:95], a[104:107], v[68:71]
    ds_read_b128 v[116:119], v1 offset:24576
    v_fma_f32 v52, v52, v124, v144
    v_fma_f32 v53, v53, v124, v145
    v_mfma_f32_16x16x32_bf16 v[72:75], v[92:95], a[108:111], v[72:75]
    v_fma_f32 v54, v54, v124, v146
    v_fma_f32 v55, v55, v124, v147
    v_mfma_f32_16x16x32_bf16 v[76:79], v[96:99], a[104:107], v[76:79]
    ds_read_b128 v[120:123], v1 offset:25600
    v_max_f32 v52, 0, v52
    s_add_u32 s70, s28, 34816
    buffer_load_dwordx4 a[208:211], v1, s[4:7], s70 offen offset:0
    v_mfma_f32_16x16x32_bf16 v[80:83], v[96:99], a[108:111], v[80:83]
    v_max_f32 v53, 0, v53
    v_max_f32 v54, 0, v54
    v_mfma_f32_16x16x32_bf16 v[84:87], v[100:103], a[104:107], v[84:87]
    ds_read_b128 v[164:167], v1 offset:26624
    v_max_f32 v55, 0, v55
    v_mul_f32 v52, v52, v52
    v_mfma_f32_16x16x32_bf16 v[88:91], v[100:103], a[108:111], v[88:91]
    v_mul_f32 v53, v53, v53
    s_waitcnt lgkmcnt(3)
    v_mfma_f32_16x16x32_bf16 v[68:71], v[104:107], a[96:99], v[68:71]
    ds_read_b128 v[92:95], v1 offset:27648
    v_mul_f32 v54, v54, v54
    v_mul_f32 v55, v55, v55
    v_mfma_f32_16x16x32_bf16 v[72:75], v[104:107], a[100:103], v[72:75]
    v_cvt_pk_bf16_f32 v52, v52, v53
    buffer_load_dwordx4 a[212:215], v1, s[4:7], s70 offen offset:1024
    v_mfma_f32_16x16x32_bf16 v[76:79], v[108:111], a[96:99], v[76:79]
    ds_read_b128 v[96:99], v1 offset:28672
    v_cvt_pk_bf16_f32 v53, v54, v55
    v_fma_f32 v60, v60, v124, v152
    v_mfma_f32_16x16x32_bf16 v[80:83], v[108:111], a[100:103], v[80:83]
    v_fma_f32 v61, v61, v124, v153
    v_mfma_f32_16x16x32_bf16 v[84:87], v[112:115], a[96:99], v[84:87]
    ds_read_b128 v[100:103], v1 offset:29696
    v_fma_f32 v62, v62, v124, v154
    v_fma_f32 v63, v63, v124, v155
    buffer_load_dwordx4 a[216:219], v1, s[4:7], s70 offen offset:2048
    v_mfma_f32_16x16x32_bf16 v[88:91], v[112:115], a[100:103], v[88:91]
    v_max_f32 v60, 0, v60
    s_waitcnt lgkmcnt(3)
    v_mfma_f32_16x16x32_bf16 v[68:71], v[116:119], a[88:91], v[68:71]
    s_waitcnt vmcnt(10)
    s_barrier
    v_mfma_f32_16x16x32_bf16 v[72:75], v[116:119], a[92:95], v[72:75]
    ds_read_b128 v[104:107], v1 offset:30720
    v_max_f32 v61, 0, v61
    v_max_f32 v62, 0, v62
    v_mfma_f32_16x16x32_bf16 v[76:79], v[120:123], a[88:91], v[76:79]
    ds_read_b128 v[108:111], v1 offset:31744
    v_max_f32 v63, 0, v63
    v_mul_f32 v60, v60, v60
    v_mfma_f32_16x16x32_bf16 v[80:83], v[120:123], a[92:95], v[80:83]
    ds_read_b128 v[112:115], v1 offset:32768
    v_mul_f32 v61, v61, v61
    v_mul_f32 v62, v62, v62
    v_mfma_f32_16x16x32_bf16 v[84:87], v[164:167], a[88:91], v[84:87]
    v_mul_f32_e64 v63, v63, v63
    v_cvt_pk_bf16_f32 v54, v60, v61
    v_mfma_f32_16x16x32_bf16 v[88:91], v[164:167], a[92:95], v[88:91]
    v_cvt_pk_bf16_f32 v55, v62, v63
    buffer_store_dwordx4 v[52:55], v1, s[4:7], s53 offen offset:0 sc1
    buffer_load_dwordx4 a[220:223], v1, s[4:7], s70 offen offset:3072
    s_add_u32 s71, s28, 47104
    buffer_load_dwordx4 a[156:159], v1, s[4:7], s71 offen offset:0
    buffer_load_dwordx4 a[152:155], v1, s[4:7], s71 offen offset:1024
    s_waitcnt lgkmcnt(3)
    v_mfma_f32_16x16x32_bf16 v[68:71], v[92:95], a[80:83], v[68:71]
    ds_read_b128 v[116:119], v1 offset:33792
    v_fma_f32 v56, v56, v125, v148
    v_fma_f32 v57, v57, v125, v149
    v_mfma_f32_16x16x32_bf16 v[72:75], v[92:95], a[84:87], v[72:75]
    v_fma_f32 v58, v58, v125, v150
    v_fma_f32 v59, v59, v125, v151
    v_mfma_f32_16x16x32_bf16 v[76:79], v[96:99], a[80:83], v[76:79]
    ds_read_b128 v[120:123], v1 offset:34816
    v_max_f32 v56, 0, v56
    buffer_load_dwordx4 a[148:151], v1, s[4:7], s71 offen offset:2048
    v_mfma_f32_16x16x32_bf16 v[80:83], v[96:99], a[84:87], v[80:83]
    v_max_f32 v57, 0, v57
    v_max_f32 v58, 0, v58
    v_mfma_f32_16x16x32_bf16 v[84:87], v[100:103], a[80:83], v[84:87]
    ds_read_b128 v[164:167], v1 offset:35840
    v_max_f32 v59, 0, v59
    v_mul_f32 v56, v56, v56
    v_mfma_f32_16x16x32_bf16 v[88:91], v[100:103], a[84:87], v[88:91]
    v_mul_f32 v57, v57, v57
    s_waitcnt lgkmcnt(3)
    v_mfma_f32_16x16x32_bf16 v[68:71], v[104:107], a[72:75], v[68:71]
    ds_read_b128 v[92:95], v1 offset:36864
    v_mul_f32 v58, v58, v58
    v_mul_f32 v59, v59, v59
    v_mfma_f32_16x16x32_bf16 v[72:75], v[104:107], a[76:79], v[72:75]
    v_cvt_pk_bf16_f32 v56, v56, v57
    v_cvt_pk_bf16_f32 v57, v58, v59
    v_mfma_f32_16x16x32_bf16 v[76:79], v[108:111], a[72:75], v[76:79]
    ds_read_b128 v[96:99], v1 offset:37888
    v_fma_f32 v64, v64, v125, v156
    buffer_load_dwordx4 a[144:147], v1, s[4:7], s71 offen offset:3072
    v_mfma_f32_16x16x32_bf16 v[80:83], v[108:111], a[76:79], v[80:83]
    v_fma_f32 v65, v65, v125, v157
    v_fma_f32 v66, v66, v125, v158
    v_mfma_f32_16x16x32_bf16 v[84:87], v[112:115], a[72:75], v[84:87]
    ds_read_b128 v[100:103], v1 offset:38912
    v_fma_f32 v67, v67, v125, v159
    v_max_f32 v64, 0, v64
    v_mfma_f32_16x16x32_bf16 v[88:91], v[112:115], a[76:79], v[88:91]
    v_max_f32 v65, 0, v65
    s_waitcnt lgkmcnt(3)
    v_mfma_f32_16x16x32_bf16 v[68:71], v[116:119], a[64:67], v[68:71]
    ds_read_b128 v[104:107], v1 offset:39936
    v_max_f32 v66, 0, v66
    v_max_f32 v67, 0, v67
    v_mfma_f32_16x16x32_bf16 v[72:75], v[116:119], a[68:71], v[72:75]
    v_mul_f32 v64, v64, v64
    v_mfma_f32_16x16x32_bf16 v[76:79], v[120:123], a[64:67], v[76:79]
    ds_read_b128 v[108:111], v1 offset:40960
    v_mul_f32 v65, v65, v65
    v_mfma_f32_16x16x32_bf16 v[80:83], v[120:123], a[68:71], v[80:83]
    v_mul_f32 v66, v66, v66
    v_mul_f32_e64 v67, v67, v67
    v_mfma_f32_16x16x32_bf16 v[84:87], v[164:167], a[64:67], v[84:87]
    ds_read_b128 v[112:115], v1 offset:41984
    v_cvt_pk_bf16_f32 v58, v64, v65
    v_mfma_f32_16x16x32_bf16 v[88:91], v[164:167], a[68:71], v[88:91]
    v_cvt_pk_bf16_f32 v59, v66, v67
    buffer_store_dwordx4 v[56:59], v1, s[4:7], s53 offen offset:1024 sc1
    s_add_u32 s71, s28, 51200
    buffer_load_dwordx4 a[140:143], v1, s[4:7], s71 offen offset:0
    buffer_load_dwordx4 a[136:139], v1, s[4:7], s71 offen offset:1024
    s_waitcnt lgkmcnt(3)
    v_mfma_f32_16x16x32_bf16 v[68:71], v[92:95], a[56:59], v[68:71]
    ds_read_b128 v[116:119], v1 offset:43008
    v_mfma_f32_16x16x32_bf16 v[72:75], v[92:95], a[60:63], v[72:75]
    v_mfma_f32_16x16x32_bf16 v[76:79], v[96:99], a[56:59], v[76:79]
    ds_read_b128 v[120:123], v1 offset:44032
    buffer_load_dwordx4 a[132:135], v1, s[4:7], s71 offen offset:2048
    v_mfma_f32_16x16x32_bf16 v[80:83], v[96:99], a[60:63], v[80:83]
    v_mfma_f32_16x16x32_bf16 v[84:87], v[100:103], a[56:59], v[84:87]
    ds_read_b128 v[164:167], v1 offset:45056
    v_mfma_f32_16x16x32_bf16 v[88:91], v[100:103], a[60:63], v[88:91]
    s_waitcnt lgkmcnt(3)
    v_mfma_f32_16x16x32_bf16 v[68:71], v[104:107], a[48:51], v[68:71]
    ds_read_b128 v[92:95], v1 offset:46080
    v_mfma_f32_16x16x32_bf16 v[72:75], v[104:107], a[52:55], v[72:75]
    v_mfma_f32_16x16x32_bf16 v[76:79], v[108:111], a[48:51], v[76:79]
    ds_read_b128 v[96:99], v1 offset:47104
    buffer_load_dwordx4 a[128:131], v1, s[4:7], s71 offen offset:3072
    v_mfma_f32_16x16x32_bf16 v[80:83], v[108:111], a[52:55], v[80:83]
    v_mfma_f32_16x16x32_bf16 v[84:87], v[112:115], a[48:51], v[84:87]
    ds_read_b128 v[100:103], v1 offset:48128
    v_mfma_f32_16x16x32_bf16 v[88:91], v[112:115], a[52:55], v[88:91]
    s_waitcnt lgkmcnt(3)
    v_mfma_f32_16x16x32_bf16 v[68:71], v[116:119], a[40:43], v[68:71]
    ds_read_b128 v[104:107], v1 offset:49152
    v_mfma_f32_16x16x32_bf16 v[72:75], v[116:119], a[44:47], v[72:75]
    s_add_u32 s71, s28, 55296
    buffer_load_dwordx4 a[124:127], v1, s[4:7], s71 offen offset:0
    v_mfma_f32_16x16x32_bf16 v[76:79], v[120:123], a[40:43], v[76:79]
    ds_read_b128 v[108:111], v1 offset:50176
    v_mfma_f32_16x16x32_bf16 v[80:83], v[120:123], a[44:47], v[80:83]
    v_mfma_f32_16x16x32_bf16 v[84:87], v[164:167], a[40:43], v[84:87]
    ds_read_b128 v[112:115], v1 offset:51200
    buffer_load_dwordx4 a[120:123], v1, s[4:7], s71 offen offset:1024
    v_mfma_f32_16x16x32_bf16 v[88:91], v[164:167], a[44:47], v[88:91]
    s_waitcnt lgkmcnt(3)
    v_mfma_f32_16x16x32_bf16 v[68:71], v[92:95], a[32:35], v[68:71]
    ds_read_b128 v[116:119], v1 offset:52224
    v_mfma_f32_16x16x32_bf16 v[72:75], v[92:95], a[36:39], v[72:75]
    v_mfma_f32_16x16x32_bf16 v[76:79], v[96:99], a[32:35], v[76:79]
    ds_read_b128 v[120:123], v1 offset:53248
    buffer_load_dwordx4 a[116:119], v1, s[4:7], s71 offen offset:2048
    v_mfma_f32_16x16x32_bf16 v[80:83], v[96:99], a[36:39], v[80:83]
    v_mfma_f32_16x16x32_bf16 v[84:87], v[100:103], a[32:35], v[84:87]
    ds_read_b128 v[164:167], v1 offset:54272
    v_mfma_f32_16x16x32_bf16 v[88:91], v[100:103], a[36:39], v[88:91]
    s_waitcnt lgkmcnt(3)
    v_mfma_f32_16x16x32_bf16 v[68:71], v[104:107], a[24:27], v[68:71]
    ds_read_b128 v[92:95], v1 offset:55296
    v_mfma_f32_16x16x32_bf16 v[72:75], v[104:107], a[28:31], v[72:75]
    v_mfma_f32_16x16x32_bf16 v[76:79], v[108:111], a[24:27], v[76:79]
    ds_read_b128 v[96:99], v1 offset:56320
    buffer_load_dwordx4 a[112:115], v1, s[4:7], s71 offen offset:3072
    v_mfma_f32_16x16x32_bf16 v[80:83], v[108:111], a[28:31], v[80:83]
    v_mfma_f32_16x16x32_bf16 v[84:87], v[112:115], a[24:27], v[84:87]
    ds_read_b128 v[100:103], v1 offset:57344
    v_mfma_f32_16x16x32_bf16 v[88:91], v[112:115], a[28:31], v[88:91]
    s_waitcnt lgkmcnt(3)
    v_mfma_f32_16x16x32_bf16 v[68:71], v[116:119], a[16:19], v[68:71]
    ds_read_b128 v[104:107], v1 offset:58368
    ds_read_b128 v[144:147], v12 offset:768
    v_mfma_f32_16x16x32_bf16 v[72:75], v[116:119], a[20:23], v[72:75]
    s_add_u32 s71, s28, 59392
    buffer_load_dwordx4 a[108:111], v1, s[4:7], s71 offen offset:0
    v_mfma_f32_16x16x32_bf16 v[76:79], v[120:123], a[16:19], v[76:79]
    ds_read_b128 v[108:111], v1 offset:59392
    v_mfma_f32_16x16x32_bf16 v[80:83], v[120:123], a[20:23], v[80:83]
    ds_read_b128 v[148:151], v12 offset:1280
    v_mfma_f32_16x16x32_bf16 v[84:87], v[164:167], a[16:19], v[84:87]
    ds_read_b128 v[112:115], v1 offset:60416
    buffer_load_dwordx4 a[104:107], v1, s[4:7], s71 offen offset:1024
    v_mfma_f32_16x16x32_bf16 v[88:91], v[164:167], a[20:23], v[88:91]
    s_waitcnt lgkmcnt(5)
    v_mfma_f32_16x16x32_bf16 v[68:71], v[92:95], a[8:11], v[68:71]
    ds_read_b128 v[152:155], v12 offset:832
    v_mfma_f32_16x16x32_bf16 v[72:75], v[92:95], a[12:15], v[72:75]
    s_add_u32 s3, s39, 1
    v_mov_b32 v15, s3
    s_add_u32 s3, s44, 4096
    s_waitcnt vmcnt(10)
    s_mov_b64 exec, 1
    buffer_store_dword v15, off, s[4:7], s3
    s_mov_b64 exec, -1
    v_mfma_f32_16x16x32_bf16 v[76:79], v[96:99], a[8:11], v[76:79]
    v_mfma_f32_16x16x32_bf16 v[80:83], v[96:99], a[12:15], v[80:83]
    ds_read_b128 v[156:159], v12 offset:1344
    v_mfma_f32_16x16x32_bf16 v[84:87], v[100:103], a[8:11], v[84:87]
    buffer_load_dwordx4 a[100:103], v1, s[4:7], s71 offen offset:2048
    v_mfma_f32_16x16x32_bf16 v[88:91], v[100:103], a[12:15], v[88:91]
    s_waitcnt lgkmcnt(2)
    v_mfma_f32_16x16x32_bf16 v[68:71], v[104:107], a[0:3], v[68:71]
    ds_read_b128 v[136:139], v12 offset:896
    v_mfma_f32_16x16x32_bf16 v[72:75], v[104:107], a[4:7], v[72:75]
    v_mfma_f32_16x16x32_bf16 v[76:79], v[108:111], a[0:3], v[76:79]
    buffer_load_dwordx4 a[96:99], v1, s[4:7], s71 offen offset:3072
    v_mfma_f32_16x16x32_bf16 v[80:83], v[108:111], a[4:7], v[80:83]
    ds_read_b128 v[140:143], v12 offset:1408
    v_mfma_f32_16x16x32_bf16 v[84:87], v[112:115], a[0:3], v[84:87]
    v_mfma_f32_16x16x32_bf16 v[88:91], v[112:115], a[4:7], v[88:91]
    v_pk_fma_f32 v[128:129], v[144:145], v[126:127], v[148:149] op_sel:[0,0,0] op_sel_hi:[1,0,1]
    v_pk_fma_f32 v[130:131], v[146:147], v[126:127], v[150:151] op_sel:[0,0,0] op_sel_hi:[1,0,1]
    v_pk_fma_f32 v[68:69], v[68:69], v[124:125], v[128:129] op_sel:[0,0,0] op_sel_hi:[1,0,1]
    v_pk_fma_f32 v[70:71], v[70:71], v[124:125], v[130:131] op_sel:[0,0,0] op_sel_hi:[1,0,1]
    v_max_f32 v68, 0, v68
    v_max_f32 v69, 0, v69
    v_max_f32 v70, 0, v70
    v_max_f32_e64 v71, 0, v71
    v_pk_mul_f32 v[68:69], v[68:69], v[68:69] op_sel:[0,0] op_sel_hi:[1,1]
    v_pk_mul_f32 v[70:71], v[70:71], v[70:71] op_sel:[0,0] op_sel_hi:[1,1]
    v_cvt_pk_bf16_f32 v68, v68, v69
    v_cvt_pk_bf16_f32 v69, v70, v71
    s_waitcnt lgkmcnt(2)
    v_pk_fma_f32 v[128:129], v[152:153], v[126:127], v[156:157] op_sel:[0,0,0] op_sel_hi:[1,0,1]
    v_pk_fma_f32 v[130:131], v[154:155], v[126:127], v[158:159] op_sel:[0,0,0] op_sel_hi:[1,0,1]
    v_pk_fma_f32 v[76:77], v[76:77], v[124:125], v[128:129] op_sel:[0,0,0] op_sel_hi:[1,0,1]
    v_pk_fma_f32 v[78:79], v[78:79], v[124:125], v[130:131] op_sel:[0,0,0] op_sel_hi:[1,0,1]
    v_max_f32 v76, 0, v76
    v_max_f32 v77, 0, v77
    v_max_f32 v78, 0, v78
    v_max_f32_e64 v79, 0, v79
    v_pk_mul_f32 v[76:77], v[76:77], v[76:77] op_sel:[0,0] op_sel_hi:[1,1]
    v_pk_mul_f32 v[78:79], v[78:79], v[78:79] op_sel:[0,0] op_sel_hi:[1,1]
    v_cvt_pk_bf16_f32 v70, v76, v77
    v_cvt_pk_bf16_f32 v71, v78, v79
    buffer_store_dwordx4 v[68:71], v1, s[4:7], s38 offen offset:0
    v_pk_fma_f32 v[132:133], v[144:145], v[126:127], v[148:149] op_sel:[0,1,0] op_sel_hi:[1,1,1]
    v_pk_fma_f32 v[134:135], v[146:147], v[126:127], v[150:151] op_sel:[0,1,0] op_sel_hi:[1,1,1]
    v_pk_fma_f32 v[72:73], v[72:73], v[124:125], v[132:133] op_sel:[0,1,0] op_sel_hi:[1,1,1]
    v_pk_fma_f32 v[74:75], v[74:75], v[124:125], v[134:135] op_sel:[0,1,0] op_sel_hi:[1,1,1]
    v_max_f32 v72, 0, v72
    v_max_f32 v73, 0, v73
    v_max_f32 v74, 0, v74
    v_max_f32 v75, 0, v75
    v_pk_mul_f32 v[72:73], v[72:73], v[72:73] op_sel:[0,0] op_sel_hi:[1,1]
    v_pk_mul_f32 v[74:75], v[74:75], v[74:75] op_sel:[0,0] op_sel_hi:[1,1]
    v_cvt_pk_bf16_f32 v72, v72, v73
    v_cvt_pk_bf16_f32 v73, v74, v75
    v_pk_fma_f32 v[132:133], v[152:153], v[126:127], v[156:157] op_sel:[0,1,0] op_sel_hi:[1,1,1]
    v_pk_fma_f32 v[134:135], v[154:155], v[126:127], v[158:159] op_sel:[0,1,0] op_sel_hi:[1,1,1]
    v_pk_fma_f32 v[80:81], v[80:81], v[124:125], v[132:133] op_sel:[0,1,0] op_sel_hi:[1,1,1]
    v_pk_fma_f32 v[82:83], v[82:83], v[124:125], v[134:135] op_sel:[0,1,0] op_sel_hi:[1,1,1]
    v_max_f32 v80, 0, v80
    v_max_f32 v81, 0, v81
    v_max_f32 v82, 0, v82
    v_max_f32 v83, 0, v83
    v_pk_mul_f32 v[80:81], v[80:81], v[80:81] op_sel:[0,0] op_sel_hi:[1,1]
    v_pk_mul_f32 v[82:83], v[82:83], v[82:83] op_sel:[0,0] op_sel_hi:[1,1]
    v_cvt_pk_bf16_f32 v74, v80, v81
    v_cvt_pk_bf16_f32 v75, v82, v83
    buffer_store_dwordx4 v[72:75], v1, s[4:7], s38 offen offset:1024
    s_waitcnt lgkmcnt(0)
    v_pk_fma_f32 v[128:129], v[136:137], v[126:127], v[140:141] op_sel:[0,0,0] op_sel_hi:[1,0,1]
    v_pk_fma_f32 v[130:131], v[138:139], v[126:127], v[142:143] op_sel:[0,0,0] op_sel_hi:[1,0,1]
    v_pk_fma_f32 v[84:85], v[84:85], v[124:125], v[128:129] op_sel:[0,0,0] op_sel_hi:[1,0,1]
    v_pk_fma_f32 v[86:87], v[86:87], v[124:125], v[130:131] op_sel:[0,0,0] op_sel_hi:[1,0,1]
    v_max_f32 v84, 0, v84
    v_max_f32 v85, 0, v85
    v_max_f32 v86, 0, v86
    v_max_f32_e64 v87, 0, v87
    v_pk_mul_f32 v[84:85], v[84:85], v[84:85] op_sel:[0,0] op_sel_hi:[1,1]
    v_pk_mul_f32 v[86:87], v[86:87], v[86:87] op_sel:[0,0] op_sel_hi:[1,1]
    v_cvt_pk_bf16_f32 v84, v84, v85
    v_cvt_pk_bf16_f32 v85, v86, v87
    buffer_store_dwordx2 v[84:85], v28, s[4:7], s36 offen offset:0
    v_pk_fma_f32 v[132:133], v[136:137], v[126:127], v[140:141] op_sel:[0,1,0] op_sel_hi:[1,1,1]
    v_pk_fma_f32 v[134:135], v[138:139], v[126:127], v[142:143] op_sel:[0,1,0] op_sel_hi:[1,1,1]
    v_pk_fma_f32 v[88:89], v[88:89], v[124:125], v[132:133] op_sel:[0,1,0] op_sel_hi:[1,1,1]
    v_pk_fma_f32 v[90:91], v[90:91], v[124:125], v[134:135] op_sel:[0,1,0] op_sel_hi:[1,1,1]
    v_max_f32 v88, 0, v88
    v_max_f32 v89, 0, v89
    v_max_f32 v90, 0, v90
    v_max_f32 v91, 0, v91
    v_pk_mul_f32 v[88:89], v[88:89], v[88:89] op_sel:[0,0] op_sel_hi:[1,1]
    v_pk_mul_f32 v[90:91], v[90:91], v[90:91] op_sel:[0,0] op_sel_hi:[1,1]
    v_cvt_pk_bf16_f32 v88, v88, v89
    v_cvt_pk_bf16_f32 v89, v90, v91
    buffer_store_dwordx2 v[88:89], v28, s[4:7], s36 offen offset:1024
    v_and_b32 v15, 127, v2
    v_add_u32 v15, 4096, v15
    buffer_load_dword v14, v15, s[4:7], s45 offen sc1
    s_add_u32 s70, s28, 38912
    buffer_load_dwordx4 a[224:227], v1, s[4:7], s70 offen offset:0
    buffer_load_dwordx4 a[228:231], v1, s[4:7], s70 offen offset:1024
    buffer_load_dwordx4 a[232:235], v1, s[4:7], s70 offen offset:2048
    buffer_load_dwordx4 a[236:239], v1, s[4:7], s70 offen offset:3072
    s_add_u32 s3, s16, 1
    s_and_b32 s3, s3, 3
    s_lshl_b32 s3, s3, 10
    v_add_u32 v144, s3, v1
    s_add_u32 s3, s16, 2
    s_and_b32 s3, s3, 3
    s_lshl_b32 s3, s3, 10
    v_add_u32 v145, s3, v1
    s_add_u32 s3, s16, 3
    s_and_b32 s3, s3, 3
    s_lshl_b32 s3, s3, 10
    v_add_u32 v146, s3, v1
    s_add_u32 s3, s16, 4
    s_and_b32 s3, s3, 3
    s_lshl_b32 s3, s3, 10
    v_add_u32 v147, s3, v1
    ds_read_b128 v[120:123], v12 offset:1536
    ds_read_b128 v[124:127], v12 offset:1600
    ds_read_b128 v[128:131], v12 offset:1664
    ds_read_b128 v[132:135], v12 offset:1728
    ds_read_b128 v[136:139], v12 offset:1792
    v_lshlrev_b32_e64 v96, 16, v16
    v_and_b32 v97, 0xffff0000, v16
    v_lshlrev_b32_e64 v98, 16, v17
    v_and_b32 v99, 0xffff0000, v17
    v_lshlrev_b32_e64 v100, 16, v18
    v_and_b32 v101, 0xffff0000, v18
    v_lshlrev_b32_e64 v102, 16, v19
    v_and_b32 v103, 0xffff0000, v19
    v_lshlrev_b32_e64 v104, 16, v20
    v_and_b32 v105, 0xffff0000, v20
    v_lshlrev_b32_e64 v106, 16, v21
    v_and_b32 v107, 0xffff0000, v21
    v_lshlrev_b32_e64 v108, 16, v22
    v_and_b32 v109, 0xffff0000, v22
    v_lshlrev_b32_e64 v110, 16, v23
    v_and_b32 v111, 0xffff0000, v23
    v_lshlrev_b32_e64 v112, 16, v24
    v_and_b32 v113, 0xffff0000, v24
    v_lshlrev_b32_e64 v114, 16, v25
    v_and_b32 v115, 0xffff0000, v25
    s_waitcnt lgkmcnt(4)
    v_pk_add_f32 v[96:97], v[96:97], v[120:121] op_sel:[0,0] op_sel_hi:[1,1]
    v_pk_add_f32 v[98:99], v[98:99], v[122:123] op_sel:[0,0] op_sel_hi:[1,1]
    s_waitcnt lgkmcnt(3)
    v_pk_add_f32 v[100:101], v[100:101], v[124:125] op_sel:[0,0] op_sel_hi:[1,1]
    v_pk_add_f32 v[102:103], v[102:103], v[126:127] op_sel:[0,0] op_sel_hi:[1,1]
    s_waitcnt lgkmcnt(2)
    v_pk_add_f32 v[104:105], v[104:105], v[128:129] op_sel:[0,0] op_sel_hi:[1,1]
    v_pk_add_f32 v[106:107], v[106:107], v[130:131] op_sel:[0,0] op_sel_hi:[1,1]
    s_waitcnt lgkmcnt(1)
    v_pk_add_f32 v[108:109], v[108:109], v[132:133] op_sel:[0,0] op_sel_hi:[1,1]
    v_pk_add_f32 v[110:111], v[110:111], v[134:135] op_sel:[0,0] op_sel_hi:[1,1]
    s_waitcnt lgkmcnt(0)
    v_pk_add_f32 v[112:113], v[112:113], v[136:137] op_sel:[0,0] op_sel_hi:[1,1]
    v_pk_add_f32 v[114:115], v[114:115], v[138:139] op_sel:[0,0] op_sel_hi:[1,1]
    s_add_u32 s52, s39, 1
    s_waitcnt vmcnt(4)
    v_cmp_ne_u32 vcc, s52, v14
    s_nop 1
    s_cbranch_vccz L_ok_16
    s_mov_b32 s60, 0
L_lp_15:
    v_and_b32 v15, 127, v2
    v_add_u32 v15, 4096, v15
    buffer_load_dword v14, v15, s[4:7], s45 offen sc1
    s_add_u32 s60, s60, 1
    s_cmp_gt_u32 s60, 0x40000
    s_cbranch_scc1 L_abort
    s_waitcnt vmcnt(0)
    v_cmp_ne_u32 vcc, s52, v14
    s_nop 1
    s_cbranch_vccnz L_lp_15
L_ok_16:
    s_lshl_b32 s53, s16, 15
    s_add_u32 s53, s53, s37
    s_add_u32 s53, s53, 90112
    buffer_load_dwordx4 a[0:3], v144, s[4:7], s53 offen sc1
    buffer_load_dwordx4 a[4:7], v145, s[4:7], s53 offen sc1
    buffer_load_dwordx4 a[8:11], v146, s[4:7], s53 offen sc1
    buffer_load_dwordx4 a[12:15], v147, s[4:7], s53 offen sc1
    s_add_u32 s53, s53, 4096
    buffer_load_dwordx4 a[16:19], v144, s[4:7], s53 offen sc1
    buffer_load_dwordx4 a[20:23], v145, s[4:7], s53 offen sc1
    buffer_load_dwordx4 a[24:27], v146, s[4:7], s53 offen sc1
    buffer_load_dwordx4 a[28:31], v147, s[4:7], s53 offen sc1
    s_waitcnt vmcnt(7)
    v_mfma_f32_16x16x32_bf16 v[36:39], v[168:171], a[0:3], 0
    s_add_u32 s53, s53, 4096
    buffer_load_dwordx4 a[32:35], v144, s[4:7], s53 offen sc1
    v_mfma_f32_16x16x32_bf16 v[40:43], v[172:175], a[0:3], 0
    v_mfma_f32_16x16x32_bf16 v[44:47], v[176:179], a[0:3], 0
    v_mfma_f32_16x16x32_bf16 v[48:51], v[180:183], a[0:3], 0
    buffer_load_dwordx4 a[36:39], v145, s[4:7], s53 offen sc1
    v_mfma_f32_16x16x32_bf16 v[52:55], v[184:187], a[0:3], 0
    s_waitcnt vmcnt(8)
    v_mfma_f32_16x16x32_bf16 v[56:59], v[168:171], a[4:7], 0
    v_mfma_f32_16x16x32_bf16 v[60:63], v[172:175], a[4:7], 0
    buffer_load_dwordx4 a[40:43], v146, s[4:7], s53 offen sc1
    v_mfma_f32_16x16x32_bf16 v[64:67], v[176:179], a[4:7], 0
    v_mfma_f32_16x16x32_bf16 v[68:71], v[180:183], a[4:7], 0
    v_mfma_f32_16x16x32_bf16 v[72:75], v[184:187], a[4:7], 0
    buffer_load_dwordx4 a[44:47], v147, s[4:7], s53 offen sc1
    s_waitcnt vmcnt(9)
    v_mfma_f32_16x16x32_bf16 v[76:79], v[168:171], a[8:11], 0
    v_mfma_f32_16x16x32_bf16 v[80:83], v[172:175], a[8:11], 0
    v_mfma_f32_16x16x32_bf16 v[84:87], v[176:179], a[8:11], 0
    s_add_u32 s53, s53, 4096
    buffer_load_dwordx4 a[48:51], v144, s[4:7], s53 offen sc1
    v_mfma_f32_16x16x32_bf16 v[88:91], v[180:183], a[8:11], 0
    v_mfma_f32_16x16x32_bf16 v[92:95], v[184:187], a[8:11], 0
    s_waitcnt vmcnt(9)
    v_mfma_f32_16x16x32_bf16 v[96:99], v[168:171], a[12:15], v[96:99]
    s_add_u32 s70, s28, 43008
    buffer_load_dwordx4 a[240:243], v1, s[4:7], s70 offen offset:0
    v_mfma_f32_16x16x32_bf16 v[100:103], v[172:175], a[12:15], v[100:103]
    v_mfma_f32_16x16x32_bf16 v[104:107], v[176:179], a[12:15], v[104:107]
    v_mfma_f32_16x16x32_bf16 v[108:111], v[180:183], a[12:15], v[108:111]
    buffer_load_dwordx4 a[244:247], v1, s[4:7], s70 offen offset:1024
    v_mfma_f32_16x16x32_bf16 v[112:115], v[184:187], a[12:15], v[112:115]
    s_waitcnt vmcnt(10)
    v_mfma_f32_16x16x32_bf16 v[36:39], v[188:191], a[16:19], v[36:39]
    s_add_u32 s3, s39, 1
    v_mov_b32 v15, s3
    s_mov_b64 exec, 1
    buffer_store_dword v15, off, s[4:7], s44
    s_mov_b64 exec, -1
    v_mfma_f32_16x16x32_bf16 v[40:43], v[192:195], a[16:19], v[40:43]
    v_mfma_f32_16x16x32_bf16 v[44:47], v[196:199], a[16:19], v[44:47]
    v_mfma_f32_16x16x32_bf16 v[48:51], v[200:203], a[16:19], v[48:51]
    buffer_load_dwordx4 a[52:55], v145, s[4:7], s53 offen sc1
    v_mfma_f32_16x16x32_bf16 v[52:55], v[204:207], a[16:19], v[52:55]
    s_waitcnt vmcnt(11)
    v_mfma_f32_16x16x32_bf16 v[56:59], v[188:191], a[20:23], v[56:59]
    v_mfma_f32_16x16x32_bf16 v[60:63], v[192:195], a[20:23], v[60:63]
    buffer_load_dwordx4 a[56:59], v146, s[4:7], s53 offen sc1
    v_mfma_f32_16x16x32_bf16 v[64:67], v[196:199], a[20:23], v[64:67]
    v_mfma_f32_16x16x32_bf16 v[68:71], v[200:203], a[20:23], v[68:71]
    v_mfma_f32_16x16x32_bf16 v[72:75], v[204:207], a[20:23], v[72:75]
    buffer_load_dwordx4 a[60:63], v147, s[4:7], s53 offen sc1
    s_waitcnt vmcnt(12)
    v_mfma_f32_16x16x32_bf16 v[76:79], v[188:191], a[24:27], v[76:79]
    v_mfma_f32_16x16x32_bf16 v[80:83], v[192:195], a[24:27], v[80:83]
    v_mfma_f32_16x16x32_bf16 v[84:87], v[196:199], a[24:27], v[84:87]
    s_add_u32 s53, s53, 4096
    buffer_load_dwordx4 a[64:67], v144, s[4:7], s53 offen sc1
    v_mfma_f32_16x16x32_bf16 v[88:91], v[200:203], a[24:27], v[88:91]
    v_mfma_f32_16x16x32_bf16 v[92:95], v[204:207], a[24:27], v[92:95]
    s_waitcnt vmcnt(12)
    v_mfma_f32_16x16x32_bf16 v[96:99], v[188:191], a[28:31], v[96:99]
    buffer_load_dwordx4 a[68:71], v145, s[4:7], s53 offen sc1
    v_mfma_f32_16x16x32_bf16 v[100:103], v[192:195], a[28:31], v[100:103]
    v_mfma_f32_16x16x32_bf16 v[104:107], v[196:199], a[28:31], v[104:107]
    v_mfma_f32_16x16x32_bf16 v[108:111], v[200:203], a[28:31], v[108:111]
    buffer_load_dwordx4 a[248:251], v1, s[4:7], s70 offen offset:2048
    v_mfma_f32_16x16x32_bf16 v[112:115], v[204:207], a[28:31], v[112:115]
    s_waitcnt vmcnt(13)
    v_mfma_f32_16x16x32_bf16 v[36:39], v[208:211], a[32:35], v[36:39]
    v_mfma_f32_16x16x32_bf16 v[40:43], v[212:215], a[32:35], v[40:43]
    buffer_load_dwordx4 a[72:75], v146, s[4:7], s53 offen sc1
    v_mfma_f32_16x16x32_bf16 v[44:47], v[216:219], a[32:35], v[44:47]
    v_mfma_f32_16x16x32_bf16 v[48:51], v[220:223], a[32:35], v[48:51]
    v_mfma_f32_16x16x32_bf16 v[52:55], v[224:227], a[32:35], v[52:55]
    buffer_load_dwordx4 a[76:79], v147, s[4:7], s53 offen sc1
    s_waitcnt vmcnt(14)
    v_mfma_f32_16x16x32_bf16 v[56:59], v[208:211], a[36:39], v[56:59]
    v_mfma_f32_16x16x32_bf16 v[60:63], v[212:215], a[36:39], v[60:63]
    v_mfma_f32_16x16x32_bf16 v[64:67], v[216:219], a[36:39], v[64:67]
    s_add_u32 s53, s53, 4096
    buffer_load_dwordx4 a[0:3], v144, s[4:7], s53 offen sc1
    v_mfma_f32_16x16x32_bf16 v[68:71], v[220:223], a[36:39], v[68:71]
    v_mfma_f32_16x16x32_bf16 v[72:75], v[224:227], a[36:39], v[72:75]
    s_waitcnt vmcnt(14)
    v_mfma_f32_16x16x32_bf16 v[76:79], v[208:211], a[40:43], v[76:79]
    v_mfma_f32_16x16x32_bf16 v[80:83], v[212:215], a[40:43], v[80:83]
    buffer_load_dwordx4 a[4:7], v145, s[4:7], s53 offen sc1
    v_mfma_f32_16x16x32_bf16 v[84:87], v[216:219], a[40:43], v[84:87]
    v_mfma_f32_16x16x32_bf16 v[88:91], v[220:223], a[40:43], v[88:91]
    v_mfma_f32_16x16x32_bf16 v[92:95], v[224:227], a[40:43], v[92:95]
    buffer_load_dwordx4 a[8:11], v146, s[4:7], s53 offen sc1
    s_waitcnt vmcnt(15)
    v_mfma_f32_16x16x32_bf16 v[96:99], v[208:211], a[44:47], v[96:99]
    v_mfma_f32_16x16x32_bf16 v[100:103], v[212:215], a[44:47], v[100:103]
    v_mfma_f32_16x16x32_bf16 v[104:107], v[216:219], a[44:47], v[104:107]
    buffer_load_dwordx4 a[252:255], v1, s[4:7], s70 offen offset:3072
    v_mfma_f32_16x16x32_bf16 v[108:111], v[220:223], a[44:47], v[108:111]
    v_mfma_f32_16x16x32_bf16 v[112:115], v[224:227], a[44:47], v[112:115]
    s_waitcnt vmcnt(15)
    v_mfma_f32_16x16x32_bf16 v[36:39], v[228:231], a[48:51], v[36:39]
    buffer_load_dwordx4 a[12:15], v147, s[4:7], s53 offen sc1
    v_mfma_f32_16x16x32_bf16 v[40:43], v[232:235], a[48:51], v[40:43]
    v_mfma_f32_16x16x32_bf16 v[44:47], v[236:239], a[48:51], v[44:47]
    v_mfma_f32_16x16x32_bf16 v[48:51], v[240:243], a[48:51], v[48:51]
    s_add_u32 s53, s53, 4096
    buffer_load_dwordx4 a[16:19], v144, s[4:7], s53 offen sc1
    v_mfma_f32_16x16x32_bf16 v[52:55], v[244:247], a[48:51], v[52:55]
    s_waitcnt vmcnt(13)
    v_mfma_f32_16x16x32_bf16 v[56:59], v[228:231], a[52:55], v[56:59]
    buffer_load_dwordx4 a[20:23], v145, s[4:7], s53 offen sc1
    v_mfma_f32_16x16x32_bf16 v[60:63], v[232:235], a[52:55], v[60:63]
    v_mfma_f32_16x16x32_bf16 v[64:67], v[236:239], a[52:55], v[64:67]
    v_mfma_f32_16x16x32_bf16 v[68:71], v[240:243], a[52:55], v[68:71]
    buffer_load_dwordx4 a[24:27], v146, s[4:7], s53 offen sc1
    v_mfma_f32_16x16x32_bf16 v[72:75], v[244:247], a[52:55], v[72:75]
    s_waitcnt vmcnt(14)
    v_mfma_f32_16x16x32_bf16 v[76:79], v[228:231], a[56:59], v[76:79]
    buffer_load_dwordx4 a[28:31], v147, s[4:7], s53 offen sc1
    v_mfma_f32_16x16x32_bf16 v[80:83], v[232:235], a[56:59], v[80:83]
    v_mfma_f32_16x16x32_bf16 v[84:87], v[236:239], a[56:59], v[84:87]
    v_mfma_f32_16x16x32_bf16 v[88:91], v[240:243], a[56:59], v[88:91]
    s_add_u32 s71, s28, 63488
    buffer_load_dwordx4 a[92:95], v1, s[4:7], s71 offen offset:0
    v_mfma_f32_16x16x32_bf16 v[92:95], v[244:247], a[56:59], v[92:95]
    s_waitcnt vmcnt(15)
    v_mfma_f32_16x16x32_bf16 v[96:99], v[228:231], a[60:63], v[96:99]
    buffer_load_dwordx4 a[88:91], v1, s[4:7], s71 offen offset:1024
    v_mfma_f32_16x16x32_bf16 v[100:103], v[232:235], a[60:63], v[100:103]
    v_mfma_f32_16x16x32_bf16 v[104:107], v[236:239], a[60:63], v[104:107]
    v_mfma_f32_16x16x32_bf16 v[108:111], v[240:243], a[60:63], v[108:111]
    v_and_b32 v15, 127, v2
    buffer_load_dword v14, v15, s[4:7], s45 offen sc1
    v_mfma_f32_16x16x32_bf16 v[112:115], v[244:247], a[60:63], v[112:115]
    s_waitcnt vmcnt(16)
    v_mfma_f32_16x16x32_bf16 v[36:39], v[248:251], a[64:67], v[36:39]
    v_mfma_f32_16x16x32_bf16 v[40:43], v[252:255], a[64:67], v[40:43]
    s_add_u32 s53, s53, 4096
    buffer_load_dwordx4 a[32:35], v144, s[4:7], s53 offen sc1
    v_mfma_f32_16x16x32_bf16 v[44:47], a[160:163], a[64:67], v[44:47]
    v_mfma_f32_16x16x32_bf16 v[48:51], a[164:167], a[64:67], v[48:51]
    v_mfma_f32_16x16x32_bf16 v[52:55], a[168:171], a[64:67], v[52:55]
    buffer_load_dwordx4 a[36:39], v145, s[4:7], s53 offen sc1
    s_waitcnt vmcnt(17)
    v_mfma_f32_16x16x32_bf16 v[56:59], v[248:251], a[68:71], v[56:59]
    v_mfma_f32_16x16x32_bf16 v[60:63], v[252:255], a[68:71], v[60:63]
    v_mfma_f32_16x16x32_bf16 v[64:67], a[160:163], a[68:71], v[64:67]
    buffer_load_dwordx4 a[40:43], v146, s[4:7], s53 offen sc1
    v_mfma_f32_16x16x32_bf16 v[68:71], a[164:167], a[68:71], v[68:71]
    v_mfma_f32_16x16x32_bf16 v[72:75], a[168:171], a[68:71], v[72:75]
    s_waitcnt vmcnt(16)
    v_mfma_f32_16x16x32_bf16 v[76:79], v[248:251], a[72:75], v[76:79]
    v_mfma_f32_16x16x32_bf16 v[80:83], v[252:255], a[72:75], v[80:83]
    buffer_load_dwordx4 a[44:47], v147, s[4:7], s53 offen sc1
    v_mfma_f32_16x16x32_bf16 v[84:87], a[160:163], a[72:75], v[84:87]
    v_mfma_f32_16x16x32_bf16 v[88:91], a[164:167], a[72:75], v[88:91]
    v_mfma_f32_16x16x32_bf16 v[92:95], a[168:171], a[72:75], v[92:95]
    buffer_load_dwordx4 a[84:87], v1, s[4:7], s71 offen offset:2048
    s_waitcnt vmcnt(17)
    v_mfma_f32_16x16x32_bf16 v[96:99], v[248:251], a[76:79], v[96:99]
    v_mfma_f32_16x16x32_bf16 v[100:103], v[252:255], a[76:79], v[100:103]
    v_mfma_f32_16x16x32_bf16 v[104:107], a[160:163], a[76:79], v[104:107]
    buffer_load_dwordx4 a[80:83], v1, s[4:7], s71 offen offset:3072
    v_mfma_f32_16x16x32_bf16 v[108:111], a[164:167], a[76:79], v[108:111]
    v_mfma_f32_16x16x32_bf16 v[112:115], a[168:171], a[76:79], v[112:115]
    s_waitcnt vmcnt(17)
    v_mfma_f32_16x16x32_bf16 v[36:39], a[172:175], a[0:3], v[36:39]
    s_add_u32 s52, s39, 1
    s_waitcnt vmcnt(6)
    v_cmp_ne_u32 vcc, s52, v14
    s_nop 4
    s_cbranch_vccz L_ok_19
    s_mov_b32 s60, 0
L_lp_18:
    v_and_b32 v15, 127, v2
    buffer_load_dword v14, v15, s[4:7], s45 offen sc1
    s_add_u32 s60, s60, 1
    s_cmp_gt_u32 s60, 0x40000
    s_cbranch_scc1 L_abort
    s_waitcnt vmcnt(0)
    v_cmp_ne_u32 vcc, s52, v14
    s_nop 1
    s_cbranch_vccnz L_lp_18
L_ok_19:
    v_mfma_f32_16x16x32_bf16 v[40:43], a[176:179], a[0:3], v[40:43]
    s_lshl_b32 s53, s16, 14
    s_add_u32 s53, s53, s37
    buffer_load_dwordx4 a[48:51], v144, s[4:7], s53 offen sc1
    v_mfma_f32_16x16x32_bf16 v[44:47], a[180:183], a[0:3], v[44:47]
    v_mfma_f32_16x16x32_bf16 v[48:51], a[184:187], a[0:3], v[48:51]
    v_mfma_f32_16x16x32_bf16 v[52:55], a[188:191], a[0:3], v[52:55]
    buffer_load_dwordx4 a[52:55], v145, s[4:7], s53 offen sc1
    v_mfma_f32_16x16x32_bf16 v[56:59], a[172:175], a[4:7], v[56:59]
    v_mfma_f32_16x16x32_bf16 v[60:63], a[176:179], a[4:7], v[60:63]
    buffer_load_dwordx4 a[56:59], v146, s[4:7], s53 offen sc1
    v_mfma_f32_16x16x32_bf16 v[64:67], a[180:183], a[4:7], v[64:67]
    v_mfma_f32_16x16x32_bf16 v[68:71], a[184:187], a[4:7], v[68:71]
    buffer_load_dwordx4 a[60:63], v147, s[4:7], s53 offen sc1
    v_mfma_f32_16x16x32_bf16 v[72:75], a[188:191], a[4:7], v[72:75]
    v_mfma_f32_16x16x32_bf16 v[76:79], a[172:175], a[8:11], v[76:79]
    v_mfma_f32_16x16x32_bf16 v[80:83], a[176:179], a[8:11], v[80:83]
    s_add_u32 s53, s53, 4096
    buffer_load_dwordx4 a[64:67], v144, s[4:7], s53 offen sc1
    v_mfma_f32_16x16x32_bf16 v[84:87], a[180:183], a[8:11], v[84:87]
    v_mfma_f32_16x16x32_bf16 v[88:91], a[184:187], a[8:11], v[88:91]
    s_add_u32 s71, s28, 67584
    buffer_load_dwordx4 v[148:151], v1, s[4:7], s71 offen offset:0
    v_mfma_f32_16x16x32_bf16 v[92:95], a[188:191], a[8:11], v[92:95]
    v_mfma_f32_16x16x32_bf16 v[96:99], a[172:175], a[12:15], v[96:99]
    s_add_u32 s83, s97, s25
    s_add_u32 s82, s97, 71680
    s_add_u32 s83, s83, 51200
    s_mov_b32 m0, s82
    s_nop 0
    buffer_load_dwordx4 v1, s[4:7], s83 offen offset:0 lds
    v_mfma_f32_16x16x32_bf16 v[100:103], a[176:179], a[12:15], v[100:103]
    v_mfma_f32_16x16x32_bf16 v[104:107], a[180:183], a[12:15], v[104:107]
    v_mfma_f32_16x16x32_bf16 v[108:111], a[184:187], a[12:15], v[108:111]
    buffer_load_dwordx4 v1, s[4:7], s83 offen offset:1024 lds
    v_mfma_f32_16x16x32_bf16 v[112:115], a[188:191], a[12:15], v[112:115]
    v_mfma_f32_16x16x32_bf16 v[36:39], a[192:195], a[16:19], v[36:39]
    buffer_load_dwordx4 a[68:71], v145, s[4:7], s53 offen sc1
    v_mfma_f32_16x16x32_bf16 v[40:43], a[196:199], a[16:19], v[40:43]
    v_mfma_f32_16x16x32_bf16 v[44:47], a[200:203], a[16:19], v[44:47]
    buffer_load_dwordx4 a[72:75], v146, s[4:7], s53 offen sc1
    v_mfma_f32_16x16x32_bf16 v[48:51], a[204:207], a[16:19], v[48:51]
    v_mfma_f32_16x16x32_bf16 v[52:55], a[208:211], a[16:19], v[52:55]
    v_mfma_f32_16x16x32_bf16 v[56:59], a[192:195], a[20:23], v[56:59]
    buffer_load_dwordx4 a[76:79], v147, s[4:7], s53 offen sc1
    v_mfma_f32_16x16x32_bf16 v[60:63], a[196:199], a[20:23], v[60:63]
    v_mfma_f32_16x16x32_bf16 v[64:67], a[200:203], a[20:23], v[64:67]
    s_add_u32 s53, s53, 4096
    buffer_load_dwordx4 a[0:3], v144, s[4:7], s53 offen sc1
    v_mfma_f32_16x16x32_bf16 v[68:71], a[204:207], a[20:23], v[68:71]
    v_mfma_f32_16x16x32_bf16 v[72:75], a[208:211], a[20:23], v[72:75]
    buffer_load_dwordx4 a[4:7], v145, s[4:7], s53 offen sc1
    v_mfma_f32_16x16x32_bf16 v[76:79], a[192:195], a[24:27], v[76:79]
    v_mfma_f32_16x16x32_bf16 v[80:83], a[196:199], a[24:27], v[80:83]
    buffer_load_dwordx4 v[152:155], v1, s[4:7], s71 offen offset:1024
    v_mfma_f32_16x16x32_bf16 v[84:87], a[200:203], a[24:27], v[84:87]
    v_mfma_f32_16x16x32_bf16 v[88:91], a[204:207], a[24:27], v[88:91]
    buffer_load_dwordx4 v[156:159], v1, s[4:7], s71 offen offset:2048
    v_mfma_f32_16x16x32_bf16 v[92:95], a[208:211], a[24:27], v[92:95]
    v_mfma_f32_16x16x32_bf16 v[96:99], a[192:195], a[28:31], v[96:99]
    v_mfma_f32_16x16x32_bf16 v[100:103], a[196:199], a[28:31], v[100:103]
    buffer_load_dwordx4 v1, s[4:7], s83 offen offset:2048 lds
    v_mfma_f32_16x16x32_bf16 v[104:107], a[200:203], a[28:31], v[104:107]
    v_mfma_f32_16x16x32_bf16 v[108:111], a[204:207], a[28:31], v[108:111]
    buffer_load_dwordx4 v1, s[4:7], s83 offen offset:3072 lds
    v_mfma_f32_16x16x32_bf16 v[112:115], a[208:211], a[28:31], v[112:115]
    s_waitcnt vmcnt(22)
    v_mfma_f32_16x16x32_bf16 v[36:39], a[212:215], a[32:35], v[36:39]
    s_barrier
    v_mfma_f32_16x16x32_bf16 v[40:43], a[216:219], a[32:35], v[40:43]
    buffer_load_dwordx4 a[8:11], v146, s[4:7], s53 offen sc1
    v_mfma_f32_16x16x32_bf16 v[44:47], a[220:223], a[32:35], v[44:47]
    v_mfma_f32_16x16x32_bf16 v[48:51], a[224:227], a[32:35], v[48:51]
    v_mfma_f32_16x16x32_bf16 v[52:55], a[228:231], a[32:35], v[52:55]
    buffer_load_dwordx4 a[12:15], v147, s[4:7], s53 offen sc1
    s_waitcnt vmcnt(23)
    v_mfma_f32_16x16x32_bf16 v[56:59], a[212:215], a[36:39], v[56:59]
    v_mfma_f32_16x16x32_bf16 v[60:63], a[216:219], a[36:39], v[60:63]
    s_add_u32 s53, s53, 4096
    buffer_load_dwordx4 a[16:19], v144, s[4:7], s53 offen sc1
    v_mfma_f32_16x16x32_bf16 v[64:67], a[220:223], a[36:39], v[64:67]
    v_mfma_f32_16x16x32_bf16 v[68:71], a[224:227], a[36:39], v[68:71]
    buffer_load_dwordx4 a[20:23], v145, s[4:7], s53 offen sc1
    v_mfma_f32_16x16x32_bf16 v[72:75], a[228:231], a[36:39], v[72:75]
    s_waitcnt vmcnt(24)
    v_mfma_f32_16x16x32_bf16 v[76:79], a[212:215], a[40:43], v[76:79]
    v_mfma_f32_16x16x32_bf16 v[80:83], a[216:219], a[40:43], v[80:83]
    buffer_load_dwordx4 a[24:27], v146, s[4:7], s53 offen sc1
    v_mfma_f32_16x16x32_bf16 v[84:87], a[220:223], a[40:43], v[84:87]
    v_mfma_f32_16x16x32_bf16 v[88:91], a[224:227], a[40:43], v[88:91]
    buffer_load_dwordx4 v[160:163], v1, s[4:7], s71 offen offset:3072
    v_mfma_f32_16x16x32_bf16 v[92:95], a[228:231], a[40:43], v[92:95]
    s_waitcnt vmcnt(25)
    v_mfma_f32_16x16x32_bf16 v[96:99], a[212:215], a[44:47], v[96:99]
    s_add_u32 s83, s97, s25
    s_add_u32 s82, s97, 88064
    s_add_u32 s83, s83, 67584
    s_mov_b32 m0, s82
    s_nop 0
    buffer_load_dwordx4 v1, s[4:7], s83 offen offset:0 lds
    v_mfma_f32_16x16x32_bf16 v[100:103], a[216:219], a[44:47], v[100:103]
    v_mfma_f32_16x16x32_bf16 v[104:107], a[220:223], a[44:47], v[104:107]
    v_mfma_f32_16x16x32_bf16 v[108:111], a[224:227], a[44:47], v[108:111]
    buffer_load_dwordx4 v1, s[4:7], s83 offen offset:1024 lds
    v_mfma_f32_16x16x32_bf16 v[112:115], a[228:231], a[44:47], v[112:115]
    s_waitcnt vmcnt(24)
    v_mfma_f32_16x16x32_bf16 v[36:39], a[232:235], a[48:51], v[36:39]
    buffer_load_dwordx4 a[28:31], v147, s[4:7], s53 offen sc1
    v_mfma_f32_16x16x32_bf16 v[40:43], a[236:239], a[48:51], v[40:43]
    v_mfma_f32_16x16x32_bf16 v[44:47], a[240:243], a[48:51], v[44:47]
    v_mfma_f32_16x16x32_bf16 v[48:51], a[244:247], a[48:51], v[48:51]
    s_add_u32 s53, s97, s37
    s_add_u32 s53, s53, 65536
    buffer_load_dwordx4 a[32:35], v144, s[4:7], s53 offen sc1
    v_mfma_f32_16x16x32_bf16 v[52:55], a[248:251], a[48:51], v[52:55]
    s_waitcnt vmcnt(25)
    v_mfma_f32_16x16x32_bf16 v[56:59], a[232:235], a[52:55], v[56:59]
    v_mfma_f32_16x16x32_bf16 v[60:63], a[236:239], a[52:55], v[60:63]
    buffer_load_dwordx4 a[36:39], v145, s[4:7], s53 offen sc1
    v_mfma_f32_16x16x32_bf16 v[64:67], a[240:243], a[52:55], v[64:67]
    v_mfma_f32_16x16x32_bf16 v[68:71], a[244:247], a[52:55], v[68:71]
    v_mfma_f32_16x16x32_bf16 v[72:75], a[248:251], a[52:55], v[72:75]
    buffer_load_dwordx4 a[40:43], v146, s[4:7], s53 offen sc1
    s_waitcnt vmcnt(26)
    v_mfma_f32_16x16x32_bf16 v[76:79], a[232:235], a[56:59], v[76:79]
    v_mfma_f32_16x16x32_bf16 v[80:83], a[236:239], a[56:59], v[80:83]
    v_mfma_f32_16x16x32_bf16 v[84:87], a[240:243], a[56:59], v[84:87]
    buffer_load_dwordx4 a[44:47], v147, s[4:7], s53 offen sc1
    v_mfma_f32_16x16x32_bf16 v[88:91], a[244:247], a[56:59], v[88:91]
    v_mfma_f32_16x16x32_bf16 v[92:95], a[248:251], a[56:59], v[92:95]
    s_waitcnt vmcnt(26)
    v_mfma_f32_16x16x32_bf16 v[96:99], a[232:235], a[60:63], v[96:99]
    buffer_load_dwordx4 v1, s[4:7], s83 offen offset:2048 lds
    v_mfma_f32_16x16x32_bf16 v[100:103], a[236:239], a[60:63], v[100:103]
    v_mfma_f32_16x16x32_bf16 v[104:107], a[240:243], a[60:63], v[104:107]
    v_mfma_f32_16x16x32_bf16 v[108:111], a[244:247], a[60:63], v[108:111]
    buffer_load_dwordx4 v1, s[4:7], s83 offen offset:3072 lds
    v_mfma_f32_16x16x32_bf16 v[112:115], a[248:251], a[60:63], v[112:115]
    s_waitcnt vmcnt(27)
    v_mfma_f32_16x16x32_bf16 v[36:39], a[252:255], a[64:67], v[36:39]
    v_mfma_f32_16x16x32_bf16 v[40:43], a[156:159], a[64:67], v[40:43]
    v_mfma_f32_16x16x32_bf16 v[44:47], a[152:155], a[64:67], v[44:47]
    s_lshr_b32 s53, s16, 1
    s_add_u32 s53, s53, 20
    s_lshl_b32 s53, s53, 12
    s_add_u32 s53, s53, s37
    buffer_load_dwordx4 a[48:51], v144, s[4:7], s53 offen sc1
    v_mfma_f32_16x16x32_bf16 v[48:51], a[148:151], a[64:67], v[48:51]
    v_mfma_f32_16x16x32_bf16 v[52:55], a[144:147], a[64:67], v[52:55]
    s_waitcnt vmcnt(24)
    v_mfma_f32_16x16x32_bf16 v[56:59], a[252:255], a[68:71], v[56:59]
    v_mfma_f32_16x16x32_bf16 v[60:63], a[156:159], a[68:71], v[60:63]
    v_mfma_f32_16x16x32_bf16 v[64:67], a[152:155], a[68:71], v[64:67]
    v_mfma_f32_16x16x32_bf16 v[68:71], a[148:151], a[68:71], v[68:71]
    v_mfma_f32_16x16x32_bf16 v[72:75], a[144:147], a[68:71], v[72:75]
    buffer_load_dwordx4 a[56:59], v146, s[4:7], s53 offen sc1
    s_waitcnt vmcnt(24)
    v_mfma_f32_16x16x32_bf16 v[76:79], a[252:255], a[72:75], v[76:79]
    v_mfma_f32_16x16x32_bf16 v[80:83], a[156:159], a[72:75], v[80:83]
    v_mfma_f32_16x16x32_bf16 v[84:87], a[152:155], a[72:75], v[84:87]
    v_mfma_f32_16x16x32_bf16 v[88:91], a[148:151], a[72:75], v[88:91]
    v_mfma_f32_16x16x32_bf16 v[92:95], a[144:147], a[72:75], v[92:95]
    s_waitcnt vmcnt(23)
    v_mfma_f32_16x16x32_bf16 v[96:99], a[252:255], a[76:79], v[96:99]
    v_mfma_f32_16x16x32_bf16 v[100:103], a[156:159], a[76:79], v[100:103]
    s_add_u32 s83, s97, s25
    s_add_u32 s82, s97, 104448
    s_add_u32 s83, s83, 83968
    s_mov_b32 m0, s82
    s_nop 0
    buffer_load_dwordx4 v1, s[4:7], s83 offen offset:0 lds
    v_mfma_f32_16x16x32_bf16 v[104:107], a[152:155], a[76:79], v[104:107]
    v_mfma_f32_16x16x32_bf16 v[108:111], a[148:151], a[76:79], v[108:111]
    v_mfma_f32_16x16x32_bf16 v[112:115], a[144:147], a[76:79], v[112:115]
    s_waitcnt vmcnt(23)
    v_mfma_f32_16x16x32_bf16 v[36:39], a[140:143], a[0:3], v[36:39]
    v_mfma_f32_16x16x32_bf16 v[40:43], a[136:139], a[0:3], v[40:43]
    v_mfma_f32_16x16x32_bf16 v[52:55], a[124:127], a[0:3], v[52:55]
    buffer_load_dwordx4 v1, s[4:7], s83 offen offset:1024 lds
    s_waitcnt vmcnt(16)
    v_mfma_f32_16x16x32_bf16 v[36:39], a[120:123], a[16:19], v[36:39]
    v_mfma_f32_16x16x32_bf16 v[40:43], a[116:119], a[16:19], v[40:43]
    v_mfma_f32_16x16x32_bf16 v[52:55], a[104:107], a[16:19], v[52:55]
    s_waitcnt vmcnt(9)
    v_mfma_f32_16x16x32_bf16 v[36:39], a[100:103], a[32:35], v[36:39]
    v_mfma_f32_16x16x32_bf16 v[40:43], a[96:99], a[32:35], v[40:43]
    v_mfma_f32_16x16x32_bf16 v[52:55], a[84:87], a[32:35], v[52:55]
    buffer_load_dwordx4 v1, s[4:7], s83 offen offset:2048 lds
    s_waitcnt vmcnt(4)
    v_mfma_f32_16x16x32_bf16 v[36:39], a[80:83], a[48:51], v[36:39]
    v_mfma_f32_16x16x32_bf16 v[40:43], v[148:151], a[48:51], v[40:43]
    v_mfma_f32_16x16x32_bf16 v[52:55], v[160:163], a[48:51], v[52:55]
    v_mfma_f32_16x16x32_bf16 v[56:59], a[140:143], a[4:7], v[56:59]
    v_mfma_f32_16x16x32_bf16 v[60:63], a[136:139], a[4:7], v[60:63]
    buffer_load_dwordx4 v1, s[4:7], s83 offen offset:3072 lds
    v_mfma_f32_16x16x32_bf16 v[72:75], a[124:127], a[4:7], v[72:75]
    v_mfma_f32_16x16x32_bf16 v[56:59], a[120:123], a[20:23], v[56:59]
    s_nop 0
    ds_write_b128 v29, v[36:39] offset:0
    v_mfma_f32_16x16x32_bf16 v[60:63], a[116:119], a[20:23], v[60:63]
    v_mfma_f32_16x16x32_bf16 v[72:75], a[104:107], a[20:23], v[72:75]
    ds_write_b128 v29, v[40:43] offset:1024
    v_mfma_f32_16x16x32_bf16 v[56:59], a[100:103], a[36:39], v[56:59]
    s_add_u32 s83, s97, s25
    s_add_u32 s82, s97, 120832
    s_add_u32 s83, s83, 100352
    s_mov_b32 m0, s82
    s_nop 0
    buffer_load_dwordx4 v1, s[4:7], s83 offen offset:0 lds
    v_mfma_f32_16x16x32_bf16 v[60:63], a[96:99], a[36:39], v[60:63]
    ds_write_b128 v29, v[52:55] offset:4096
    v_mfma_f32_16x16x32_bf16 v[72:75], a[84:87], a[36:39], v[72:75]
    v_mfma_f32_16x16x32_bf16 v[76:79], a[140:143], a[8:11], v[76:79]
    v_mfma_f32_16x16x32_bf16 v[80:83], a[136:139], a[8:11], v[80:83]
    v_mfma_f32_16x16x32_bf16 v[92:95], a[124:127], a[8:11], v[92:95]
    buffer_load_dwordx4 v1, s[4:7], s83 offen offset:1024 lds
    v_mfma_f32_16x16x32_bf16 v[76:79], a[120:123], a[24:27], v[76:79]
    ds_write_b128 v30, v[56:59] offset:0
    v_mfma_f32_16x16x32_bf16 v[80:83], a[116:119], a[24:27], v[80:83]
    v_mfma_f32_16x16x32_bf16 v[92:95], a[104:107], a[24:27], v[92:95]
    v_mfma_f32_16x16x32_bf16 v[76:79], a[100:103], a[40:43], v[76:79]
    ds_write_b128 v30, v[60:63] offset:1024
    v_mfma_f32_16x16x32_bf16 v[80:83], a[96:99], a[40:43], v[80:83]
    v_mfma_f32_16x16x32_bf16 v[92:95], a[84:87], a[40:43], v[92:95]
    buffer_load_dwordx4 v1, s[4:7], s83 offen offset:2048 lds
    s_waitcnt vmcnt(7)
    v_mfma_f32_16x16x32_bf16 v[76:79], a[80:83], a[56:59], v[76:79]
    ds_write_b128 v30, v[72:75] offset:4096
    v_mfma_f32_16x16x32_bf16 v[80:83], v[148:151], a[56:59], v[80:83]
    v_mfma_f32_16x16x32_bf16 v[92:95], v[160:163], a[56:59], v[92:95]
    v_mfma_f32_16x16x32_bf16 v[96:99], a[140:143], a[12:15], v[96:99]
    v_mfma_f32_16x16x32_bf16 v[100:103], a[136:139], a[12:15], v[100:103]
    v_mfma_f32_16x16x32_bf16 v[112:115], a[124:127], a[12:15], v[112:115]
    v_mfma_f32_16x16x32_bf16 v[96:99], a[120:123], a[28:31], v[96:99]
    s_nop 0
    ds_write_b128 v31, v[76:79] offset:0
    v_mfma_f32_16x16x32_bf16 v[100:103], a[116:119], a[28:31], v[100:103]
    buffer_load_dwordx4 v1, s[4:7], s83 offen offset:3072 lds
    v_mfma_f32_16x16x32_bf16 v[112:115], a[104:107], a[28:31], v[112:115]
    ds_write_b128 v31, v[80:83] offset:1024
    v_mfma_f32_16x16x32_bf16 v[96:99], a[100:103], a[44:47], v[96:99]
    v_mfma_f32_16x16x32_bf16 v[100:103], a[96:99], a[44:47], v[100:103]
    ds_write_b128 v31, v[92:95] offset:4096
    v_mfma_f32_16x16x32_bf16 v[112:115], a[84:87], a[44:47], v[112:115]
    v_mfma_f32_16x16x32_bf16 v[44:47], a[132:135], a[0:3], v[44:47]
    v_mfma_f32_16x16x32_bf16 v[48:51], a[128:131], a[0:3], v[48:51]
    v_mfma_f32_16x16x32_bf16 v[44:47], a[112:115], a[16:19], v[44:47]
    s_waitcnt lgkmcnt(0)
    s_barrier
    ds_read_b128 v[36:39], v32 offset:0
    v_mfma_f32_16x16x32_bf16 v[48:51], a[108:111], a[16:19], v[48:51]
    ds_read_b128 v[56:59], v32 offset:5120
    ds_read_b128 v[76:79], v32 offset:10240
    v_mfma_f32_16x16x32_bf16 v[44:47], a[92:95], a[32:35], v[44:47]
    ds_read_b128 v[40:43], v32 offset:1024
    ds_read_b128 v[60:63], v32 offset:6144
    v_mfma_f32_16x16x32_bf16 v[48:51], a[88:91], a[32:35], v[48:51]
    ds_read_b128 v[80:83], v32 offset:11264
    ds_read_b128 v[52:55], v32 offset:4096
    v_mfma_f32_16x16x32_bf16 v[44:47], v[152:155], a[48:51], v[44:47]
    ds_read_b128 v[72:75], v32 offset:9216
    ds_read_b128 v[92:95], v32 offset:14336
    v_mfma_f32_16x16x32_bf16 v[48:51], v[156:159], a[48:51], v[48:51]
    v_mov_b32 v140, 0
    v_mov_b32 v141, 0
    v_mfma_f32_16x16x32_bf16 v[64:67], a[132:135], a[4:7], v[64:67]
    v_mov_b32 v142, 0
    v_mov_b32_e64 v143, 0
    v_mfma_f32_16x16x32_bf16 v[68:71], a[128:131], a[4:7], v[68:71]
    v_mov_b32 v139, 0x3f803f80
    s_waitcnt lgkmcnt(8)
    v_add_f32 v96, v96, v36
    v_mfma_f32_16x16x32_bf16 v[64:67], a[112:115], a[20:23], v[64:67]
    v_add_f32 v97, v97, v37
    v_add_f32 v98, v98, v38
    v_mfma_f32_16x16x32_bf16 v[68:71], a[108:111], a[20:23], v[68:71]
    ds_write_b128 v29, v[44:47] offset:2048
    v_add_f32 v99, v99, v39
    s_waitcnt lgkmcnt(7)
    v_add_f32 v56, v56, v76
    v_mfma_f32_16x16x32_bf16 v[64:67], a[92:95], a[36:39], v[64:67]
    v_add_f32 v57, v57, v77
    v_add_f32 v58, v58, v78
    v_mfma_f32_16x16x32_bf16 v[68:71], a[88:91], a[36:39], v[68:71]
    ds_write_b128 v29, v[48:51] offset:3072
    v_add_f32 v59, v59, v79
    v_add_f32 v96, v96, v56
    v_mfma_f32_16x16x32_bf16 v[84:87], a[132:135], a[8:11], v[84:87]
    v_add_f32 v97, v97, v57
    v_add_f32 v98, v98, v58
    v_mfma_f32_16x16x32_bf16 v[88:91], a[128:131], a[8:11], v[88:91]
    v_add_f32 v99, v99, v59
    v_cvt_pk_bf16_f32 v16, v96, v97
    v_mfma_f32_16x16x32_bf16 v[84:87], a[112:115], a[24:27], v[84:87]
    v_cvt_pk_bf16_f32 v17, v98, v99
    s_waitcnt lgkmcnt(7)
    v_add_f32 v100, v100, v40
    v_mfma_f32_16x16x32_bf16 v[88:91], a[108:111], a[24:27], v[88:91]
    ds_write_b128 v30, v[64:67] offset:2048
    v_add_f32 v101, v101, v41
    v_add_f32 v102, v102, v42
    v_mfma_f32_16x16x32_bf16 v[84:87], a[92:95], a[40:43], v[84:87]
    v_add_f32 v103, v103, v43
    s_waitcnt lgkmcnt(6)
    v_add_f32 v60, v60, v80
    v_mfma_f32_16x16x32_bf16 v[88:91], a[88:91], a[40:43], v[88:91]
    ds_write_b128 v30, v[68:71] offset:3072
    v_add_f32 v61, v61, v81
    v_add_f32 v62, v62, v82
    v_mfma_f32_16x16x32_bf16 v[84:87], v[152:155], a[56:59], v[84:87]
    v_add_f32 v63, v63, v83
    v_add_f32 v100, v100, v60
    v_mfma_f32_16x16x32_bf16 v[88:91], v[156:159], a[56:59], v[88:91]
    v_add_f32 v101, v101, v61
    v_add_f32 v102, v102, v62
    v_mfma_f32_16x16x32_bf16 v[104:107], a[132:135], a[12:15], v[104:107]
    v_add_f32 v103, v103, v63
    v_cvt_pk_bf16_f32 v18, v100, v101
    v_mfma_f32_16x16x32_bf16 v[108:111], a[128:131], a[12:15], v[108:111]
    v_cvt_pk_bf16_f32 v19, v102, v103
    buffer_store_dwordx4 v[16:19], v10, s[4:7], 0 offen offset:0
    v_mfma_f32_16x16x32_bf16 v[104:107], a[112:115], a[28:31], v[104:107]
    s_waitcnt lgkmcnt(6)
    v_add_f32 v112, v112, v52
    v_add_f32 v113, v113, v53
    v_mfma_f32_16x16x32_bf16 v[108:111], a[108:111], a[28:31], v[108:111]
    ds_write_b128 v31, v[84:87] offset:2048
    v_add_f32 v114, v114, v54
    v_add_f32 v115, v115, v55
    v_mfma_f32_16x16x32_bf16 v[104:107], a[92:95], a[44:47], v[104:107]
    s_waitcnt lgkmcnt(5)
    v_add_f32 v72, v72, v92
    v_add_f32 v73, v73, v93
    v_mfma_f32_16x16x32_bf16 v[108:111], a[88:91], a[44:47], v[108:111]
    ds_write_b128 v31, v[88:91] offset:3072
    v_add_f32 v74, v74, v94
    v_add_f32 v75, v75, v95
    v_add_f32 v112, v112, v72
    v_add_f32 v113, v113, v73
    v_add_f32 v114, v114, v74
    v_add_f32 v115, v115, v75
    v_cvt_pk_bf16_f32 v24, v112, v113
    v_cvt_pk_bf16_f32 v25, v114, v115
    buffer_store_dwordx2 v[24:25], v11, s[4:7], 0 offen
    s_add_u32 s83, s97, s25
    s_add_u32 s82, s97, 137216
    s_add_u32 s83, s83, 116736
    s_mov_b32 m0, s82
    s_nop 0
    buffer_load_dwordx4 v1, s[4:7], s83 offen offset:0 lds
    buffer_load_dwordx4 v1, s[4:7], s83 offen offset:1024 lds
    buffer_load_dwordx4 v1, s[4:7], s83 offen offset:2048 lds
    buffer_load_dwordx4 v1, s[4:7], s83 offen offset:3072 lds
    v_dot2_f32_bf16 v140, v16, v139, v140
    v_dot2_f32_bf16 v141, v16, v16, v141
    v_dot2_f32_bf16 v142, v17, v139, v142
    v_dot2_f32_bf16 v143, v17, v17, v143
    v_dot2_f32_bf16 v140, v18, v139, v140
    v_dot2_f32_bf16 v141, v18, v18, v141
    v_dot2_f32_bf16 v142, v19, v139, v142
    v_dot2_f32_bf16 v143, v19, v19, v143
    v_dot2_f32_bf16 v140, v24, v139, v140
    v_dot2_f32_bf16 v141, v24, v24, v141
    v_dot2_f32_bf16 v142, v25, v139, v142
    v_dot2_f32_bf16 v143, v25, v25, v143
    s_add_u32 s3, s39, 2
    v_mov_b32 v15, s3
    s_add_u32 s3, s40, 20480
    s_waitcnt vmcnt(4)
    s_mov_b64 exec, 1
    buffer_store_dword v15, off, s[4:7], s3
    s_mov_b64 exec, -1
    s_waitcnt lgkmcnt(0)
    s_barrier
    ds_read_b128 v[44:47], v32 offset:2048
    ds_read_b128 v[64:67], v32 offset:7168
    ds_read_b128 v[84:87], v32 offset:12288
    ds_read_b128 v[48:51], v32 offset:3072
    ds_read_b128 v[68:71], v32 offset:8192
    ds_read_b128 v[88:91], v32 offset:13312
    s_waitcnt lgkmcnt(5)
    v_pk_add_f32 v[104:105], v[104:105], v[44:45] op_sel:[0,0] op_sel_hi:[1,1]
    v_pk_add_f32 v[106:107], v[106:107], v[46:47] op_sel:[0,0] op_sel_hi:[1,1]
    s_waitcnt lgkmcnt(3)
    v_pk_add_f32 v[64:65], v[64:65], v[84:85] op_sel:[0,0] op_sel_hi:[1,1]
    v_pk_add_f32 v[66:67], v[66:67], v[86:87] op_sel:[0,0] op_sel_hi:[1,1]
    v_pk_add_f32 v[104:105], v[104:105], v[64:65] op_sel:[0,0] op_sel_hi:[1,1]
    v_pk_add_f32 v[106:107], v[106:107], v[66:67] op_sel:[0,0] op_sel_hi:[1,1]
    v_cvt_pk_bf16_f32 v20, v104, v105
    v_cvt_pk_bf16_f32 v21, v106, v107
    v_dot2_f32_bf16 v140, v20, v139, v140
    v_dot2_f32_bf16 v141, v20, v20, v141
    v_dot2_f32_bf16 v142, v21, v139, v142
    v_dot2_f32_bf16 v143, v21, v21, v143
    s_waitcnt lgkmcnt(2)
    v_pk_add_f32 v[108:109], v[108:109], v[48:49] op_sel:[0,0] op_sel_hi:[1,1]
    v_pk_add_f32 v[110:111], v[110:111], v[50:51] op_sel:[0,0] op_sel_hi:[1,1]
    s_waitcnt lgkmcnt(0)
    v_pk_add_f32 v[68:69], v[68:69], v[88:89] op_sel:[0,0] op_sel_hi:[1,1]
    v_pk_add_f32 v[70:71], v[70:71], v[90:91] op_sel:[0,0] op_sel_hi:[1,1]
    v_pk_add_f32 v[108:109], v[108:109], v[68:69] op_sel:[0,0] op_sel_hi:[1,1]
    v_pk_add_f32 v[110:111], v[110:111], v[70:71] op_sel:[0,0] op_sel_hi:[1,1]
    v_cvt_pk_bf16_f32 v22, v108, v109
    v_cvt_pk_bf16_f32 v23, v110, v111
    buffer_store_dwordx4 v[20:23], v10, s[4:7], 0 offen offset:1024
    v_dot2_f32_bf16 v140, v22, v139, v140
    v_dot2_f32_bf16 v141, v22, v22, v141
    v_dot2_f32_bf16 v142, v23, v139, v142
    v_dot2_f32_bf16 v143, v23, v23, v143
    s_nop 2
    v_pk_add_f32 v[140:141], v[140:141], v[142:143] op_sel:[0,0] op_sel_hi:[1,1]
    s_nop 1
    v_permlane32_swap_b32 v140, v141
    v_add_f32 v140, v140, v141
    v_mov_b32 v141, v140
    s_nop 1
    v_permlane16_swap_b32 v140, v141
    v_add_f32 v140, v140, v141
    v_and_b32_e64 v15, 63, v2
    v_add_u32 v15, 20480, v15
    buffer_load_dword v14, v15, s[4:7], s41 offen sc1
    buffer_store_dword v140, v9, s[4:7], 0 offen
    s_waitcnt vmcnt(4)
    s_barrier
    ds_read_b128 v[76:79], v3 offset:6144
    ds_read_b128 v[80:83], v3 offset:7168
    ds_read_b128 v[84:87], v3 offset:8192
    ds_read_b128 v[88:91], v3 offset:9216
    ds_read_b128 v[92:95], v3 offset:10240
    s_add_u32 s52, s39, 2
    s_waitcnt vmcnt(1)
    v_cmp_ne_u32 vcc, s52, v14
    s_nop 1
    s_cbranch_vccz L_ok_22
    s_mov_b32 s60, 0
L_lp_21:
    v_and_b32_e64 v15, 63, v2
    v_add_u32 v15, 20480, v15
    buffer_load_dword v14, v15, s[4:7], s41 offen sc1
    s_add_u32 s60, s60, 1
    s_cmp_gt_u32 s60, 0x40000
    s_cbranch_scc1 L_abort
    s_waitcnt vmcnt(0)
    v_cmp_ne_u32 vcc, s52, v14
    s_nop 1
    s_cbranch_vccnz L_lp_21
L_ok_22:
    buffer_load_dwordx4 a[0:3], v6, s[4:7], 0 offen offset:0 sc1
    buffer_load_dwordx4 a[4:7], v7, s[4:7], 0 offen offset:0 sc1
    buffer_load_dwordx4 a[8:11], v6, s[4:7], 0 offen offset:2048 sc1
    buffer_load_dwordx4 a[12:15], v7, s[4:7], 0 offen offset:2048 sc1
    buffer_load_dwordx4 a[16:19], v6, s[4:7], 0 offen offset:3072 sc1
    buffer_load_dwordx4 a[20:23], v7, s[4:7], 0 offen offset:3072 sc1
    buffer_load_dwordx4 a[24:27], v6, s[4:7], s21 offen offset:1024 sc1
    buffer_load_dwordx4 a[28:31], v7, s[4:7], s21 offen offset:1024 sc1
    s_waitcnt vmcnt(7) lgkmcnt(4)
    v_mfma_f32_16x16x32_bf16 v[36:39], a[0:3], v[76:79], 0
    ds_read_b128 v[96:99], v3 offset:11264
    s_waitcnt vmcnt(6)
    v_mfma_f32_16x16x32_bf16 v[40:43], a[4:7], v[76:79], 0
    s_waitcnt lgkmcnt(4)
    v_mfma_f32_16x16x32_bf16 v[44:47], a[0:3], v[80:83], 0
    ds_read_b128 v[100:103], v3 offset:12288
    buffer_load_dwordx4 a[32:35], v6, s[4:7], s21 offen offset:3072 sc1
    v_mfma_f32_16x16x32_bf16 v[48:51], a[4:7], v[80:83], 0
    s_waitcnt lgkmcnt(4)
    v_mfma_f32_16x16x32_bf16 v[52:55], a[0:3], v[84:87], 0
    ds_read_b128 v[104:107], v3 offset:13312
    v_mfma_f32_16x16x32_bf16 v[56:59], a[4:7], v[84:87], 0
    s_waitcnt lgkmcnt(4)
    v_mfma_f32_16x16x32_bf16 v[60:63], a[0:3], v[88:91], 0
    ds_read_b128 v[108:111], v3 offset:14336
    v_mfma_f32_16x16x32_bf16 v[64:67], a[4:7], v[88:91], 0
    buffer_load_dwordx4 a[36:39], v7, s[4:7], s21 offen offset:3072 sc1
    s_waitcnt lgkmcnt(4)
    v_mfma_f32_16x16x32_bf16 v[68:71], a[0:3], v[92:95], 0
    ds_read_b128 v[112:115], v3 offset:15360
    v_mfma_f32_16x16x32_bf16 v[72:75], a[4:7], v[92:95], 0
    s_waitcnt vmcnt(7) lgkmcnt(4)
    v_mfma_f32_16x16x32_bf16 v[36:39], a[8:11], v[96:99], v[36:39]
    ds_read_b128 v[76:79], v3 offset:16384
    s_waitcnt vmcnt(6)
    v_mfma_f32_16x16x32_bf16 v[40:43], a[12:15], v[96:99], v[40:43]
    s_add_u32 s3, s39, 2
    v_mov_b32 v15, s3
    s_mov_b64 exec, 1
    buffer_store_dword v15, off, s[4:7], s40
    s_mov_b64 exec, -1
    s_waitcnt lgkmcnt(4)
    v_mfma_f32_16x16x32_bf16 v[44:47], a[8:11], v[100:103], v[44:47]
    ds_read_b128 v[80:83], v3 offset:17408
    v_mfma_f32_16x16x32_bf16 v[48:51], a[12:15], v[100:103], v[48:51]
    s_waitcnt lgkmcnt(4)
    v_mfma_f32_16x16x32_bf16 v[52:55], a[8:11], v[104:107], v[52:55]
    ds_read_b128 v[84:87], v3 offset:18432
    buffer_load_dwordx4 a[40:43], v6, s[4:7], s22 offen offset:0 sc1
    v_mfma_f32_16x16x32_bf16 v[56:59], a[12:15], v[104:107], v[56:59]
    s_waitcnt lgkmcnt(4)
    v_mfma_f32_16x16x32_bf16 v[60:63], a[8:11], v[108:111], v[60:63]
    ds_read_b128 v[88:91], v3 offset:19456
    v_mfma_f32_16x16x32_bf16 v[64:67], a[12:15], v[108:111], v[64:67]
    buffer_load_dwordx4 a[44:47], v7, s[4:7], s22 offen offset:0 sc1
    s_waitcnt lgkmcnt(4)
    v_mfma_f32_16x16x32_bf16 v[68:71], a[8:11], v[112:115], v[68:71]
    ds_read_b128 v[92:95], v3 offset:20480
    v_mfma_f32_16x16x32_bf16 v[72:75], a[12:15], v[112:115], v[72:75]
    s_waitcnt vmcnt(8) lgkmcnt(4)
    v_mfma_f32_16x16x32_bf16 v[36:39], a[16:19], v[76:79], v[36:39]
    ds_read_b128 v[96:99], v3 offset:21504
    s_waitcnt vmcnt(7)
    v_mfma_f32_16x16x32_bf16 v[40:43], a[20:23], v[76:79], v[40:43]
    s_waitcnt lgkmcnt(4)
    v_mfma_f32_16x16x32_bf16 v[44:47], a[16:19], v[80:83], v[44:47]
    ds_read_b128 v[100:103], v3 offset:22528
    buffer_load_dwordx4 a[48:51], v6, s[4:7], s22 offen offset:2048 sc1
    v_mfma_f32_16x16x32_bf16 v[48:51], a[20:23], v[80:83], v[48:51]
    s_waitcnt lgkmcnt(4)
    v_mfma_f32_16x16x32_bf16 v[52:55], a[16:19], v[84:87], v[52:55]
    ds_read_b128 v[104:107], v3 offset:23552
    v_mfma_f32_16x16x32_bf16 v[56:59], a[20:23], v[84:87], v[56:59]
    s_waitcnt lgkmcnt(4)
    v_mfma_f32_16x16x32_bf16 v[60:63], a[16:19], v[88:91], v[60:63]
    ds_read_b128 v[108:111], v3 offset:24576
    v_mfma_f32_16x16x32_bf16 v[64:67], a[20:23], v[88:91], v[64:67]
    buffer_load_dwordx4 a[52:55], v7, s[4:7], s22 offen offset:2048 sc1
    s_waitcnt lgkmcnt(4)
    v_mfma_f32_16x16x32_bf16 v[68:71], a[16:19], v[92:95], v[68:71]
    ds_read_b128 v[112:115], v3 offset:25600
    v_mfma_f32_16x16x32_bf16 v[72:75], a[20:23], v[92:95], v[72:75]
    s_waitcnt vmcnt(8) lgkmcnt(4)
    v_mfma_f32_16x16x32_bf16 v[36:39], a[24:27], v[96:99], v[36:39]
    ds_read_b128 v[76:79], v3 offset:26624
    s_waitcnt vmcnt(7)
    v_mfma_f32_16x16x32_bf16 v[40:43], a[28:31], v[96:99], v[40:43]
    buffer_load_dwordx4 a[56:59], v6, s[4:7], s23 offen offset:0 sc1
    s_waitcnt lgkmcnt(4)
    v_mfma_f32_16x16x32_bf16 v[44:47], a[24:27], v[100:103], v[44:47]
    ds_read_b128 v[80:83], v3 offset:27648
    v_mfma_f32_16x16x32_bf16 v[48:51], a[28:31], v[100:103], v[48:51]
    s_waitcnt lgkmcnt(4)
    v_mfma_f32_16x16x32_bf16 v[52:55], a[24:27], v[104:107], v[52:55]
    ds_read_b128 v[84:87], v3 offset:28672
    buffer_load_dwordx4 a[60:63], v7, s[4:7], s23 offen offset:0 sc1
    v_mfma_f32_16x16x32_bf16 v[56:59], a[28:31], v[104:107], v[56:59]
    s_waitcnt lgkmcnt(4)
    v_mfma_f32_16x16x32_bf16 v[60:63], a[24:27], v[108:111], v[60:63]
    ds_read_b128 v[88:91], v3 offset:29696
    v_mfma_f32_16x16x32_bf16 v[64:67], a[28:31], v[108:111], v[64:67]
    v_and_b32 v15, 63, v2
    buffer_load_dword v14, v15, s[4:7], s41 offen sc1
    s_waitcnt lgkmcnt(4)
    v_mfma_f32_16x16x32_bf16 v[68:71], a[24:27], v[112:115], v[68:71]
    ds_read_b128 v[92:95], v3 offset:30720
    v_mfma_f32_16x16x32_bf16 v[72:75], a[28:31], v[112:115], v[72:75]
    s_waitcnt vmcnt(9) lgkmcnt(4)
    v_mfma_f32_16x16x32_bf16 v[36:39], a[32:35], v[76:79], v[36:39]
    ds_read_b128 v[96:99], v3 offset:31744
    s_waitcnt vmcnt(8)
    v_mfma_f32_16x16x32_bf16 v[40:43], a[36:39], v[76:79], v[40:43]
    buffer_load_dwordx4 a[64:67], v6, s[4:7], s23 offen offset:1024 sc1
    s_waitcnt lgkmcnt(4)
    v_mfma_f32_16x16x32_bf16 v[44:47], a[32:35], v[80:83], v[44:47]
    ds_read_b128 v[100:103], v3 offset:32768
    v_mfma_f32_16x16x32_bf16 v[48:51], a[36:39], v[80:83], v[48:51]
    s_waitcnt lgkmcnt(4)
    v_mfma_f32_16x16x32_bf16 v[52:55], a[32:35], v[84:87], v[52:55]
    ds_read_b128 v[104:107], v3 offset:33792
    buffer_load_dwordx4 a[68:71], v7, s[4:7], s23 offen offset:1024 sc1
    v_mfma_f32_16x16x32_bf16 v[56:59], a[36:39], v[84:87], v[56:59]
    s_waitcnt lgkmcnt(4)
    v_mfma_f32_16x16x32_bf16 v[60:63], a[32:35], v[88:91], v[60:63]
    ds_read_b128 v[108:111], v3 offset:34816
    v_mfma_f32_16x16x32_bf16 v[64:67], a[36:39], v[88:91], v[64:67]
    s_add_u32 s85, s95, s25
    s_add_u32 s84, s95, 51200
    s_add_u32 s85, s85, 133120
    s_mov_b32 m0, s84
    s_nop 0
    buffer_load_dwordx4 v1, s[4:7], s85 offen offset:0 lds
    s_waitcnt lgkmcnt(4)
    v_mfma_f32_16x16x32_bf16 v[68:71], a[32:35], v[92:95], v[68:71]
    ds_read_b128 v[112:115], v3 offset:35840
    v_mfma_f32_16x16x32_bf16 v[72:75], a[36:39], v[92:95], v[72:75]
    s_waitcnt vmcnt(9) lgkmcnt(4)
    v_mfma_f32_16x16x32_bf16 v[36:39], a[40:43], v[96:99], v[36:39]
    ds_read_b128 v[76:79], v3 offset:36864
    s_waitcnt vmcnt(8)
    v_mfma_f32_16x16x32_bf16 v[40:43], a[44:47], v[96:99], v[40:43]
    s_waitcnt lgkmcnt(4)
    v_mfma_f32_16x16x32_bf16 v[44:47], a[40:43], v[100:103], v[44:47]
    ds_read_b128 v[80:83], v3 offset:37888
    buffer_load_dwordx4 a[72:75], v6, s[4:7], s23 offen offset:3072 sc1
    v_mfma_f32_16x16x32_bf16 v[48:51], a[44:47], v[100:103], v[48:51]
    s_waitcnt lgkmcnt(4)
    v_mfma_f32_16x16x32_bf16 v[52:55], a[40:43], v[104:107], v[52:55]
    ds_read_b128 v[84:87], v3 offset:38912
    v_mfma_f32_16x16x32_bf16 v[56:59], a[44:47], v[104:107], v[56:59]
    s_waitcnt lgkmcnt(4)
    v_mfma_f32_16x16x32_bf16 v[60:63], a[40:43], v[108:111], v[60:63]
    ds_read_b128 v[88:91], v3 offset:39936
    v_mfma_f32_16x16x32_bf16 v[64:67], a[44:47], v[108:111], v[64:67]
    buffer_load_dwordx4 a[76:79], v7, s[4:7], s23 offen offset:3072 sc1
    s_waitcnt lgkmcnt(4)
    v_mfma_f32_16x16x32_bf16 v[68:71], a[40:43], v[112:115], v[68:71]
    ds_read_b128 v[92:95], v3 offset:40960
    v_mfma_f32_16x16x32_bf16 v[72:75], a[44:47], v[112:115], v[72:75]
    s_waitcnt vmcnt(9) lgkmcnt(4)
    v_mfma_f32_16x16x32_bf16 v[36:39], a[48:51], v[76:79], v[36:39]
    ds_read_b128 v[96:99], v3 offset:41984
    s_waitcnt vmcnt(8)
    v_mfma_f32_16x16x32_bf16 v[40:43], a[52:55], v[76:79], v[40:43]
    buffer_load_dwordx4 a[80:83], v6, s[4:7], s24 offen offset:1024 sc1
    s_waitcnt lgkmcnt(4)
    v_mfma_f32_16x16x32_bf16 v[44:47], a[48:51], v[80:83], v[44:47]
    ds_read_b128 v[100:103], v3 offset:43008
    v_mfma_f32_16x16x32_bf16 v[48:51], a[52:55], v[80:83], v[48:51]
    s_waitcnt lgkmcnt(4)
    v_mfma_f32_16x16x32_bf16 v[52:55], a[48:51], v[84:87], v[52:55]
    ds_read_b128 v[104:107], v3 offset:44032
    buffer_load_dwordx4 a[84:87], v7, s[4:7], s24 offen offset:1024 sc1
    v_mfma_f32_16x16x32_bf16 v[56:59], a[52:55], v[84:87], v[56:59]
    s_waitcnt lgkmcnt(4)
    v_mfma_f32_16x16x32_bf16 v[60:63], a[48:51], v[88:91], v[60:63]
    ds_read_b128 v[108:111], v3 offset:45056
    v_mfma_f32_16x16x32_bf16 v[64:67], a[52:55], v[88:91], v[64:67]
    buffer_load_dwordx4 v1, s[4:7], s85 offen offset:1024 lds
    s_waitcnt lgkmcnt(4)
    v_mfma_f32_16x16x32_bf16 v[68:71], a[48:51], v[92:95], v[68:71]
    ds_read_b128 v[112:115], v3 offset:46080
    v_mfma_f32_16x16x32_bf16 v[72:75], a[52:55], v[92:95], v[72:75]
    s_waitcnt vmcnt(10) lgkmcnt(4)
    v_mfma_f32_16x16x32_bf16 v[36:39], a[56:59], v[96:99], v[36:39]
    s_add_u32 s52, s39, 2
    s_waitcnt vmcnt(8)
    v_cmp_ne_u32 vcc, s52, v14
    s_nop 4
    s_cbranch_vccz L_ok_25
    s_mov_b32 s60, 0
L_lp_24:
    v_and_b32 v15, 63, v2
    buffer_load_dword v14, v15, s[4:7], s41 offen sc1
    s_add_u32 s60, s60, 1
    s_cmp_gt_u32 s60, 0x40000
    s_cbranch_scc1 L_abort
    s_waitcnt vmcnt(0)
    v_cmp_ne_u32 vcc, s52, v14
    s_nop 1
    s_cbranch_vccnz L_lp_24
L_ok_25:
    v_mfma_f32_16x16x32_bf16 v[40:43], a[60:63], v[96:99], v[40:43]
    ds_read_b128 v[76:79], v3 offset:47104
    s_waitcnt lgkmcnt(4)
    v_mfma_f32_16x16x32_bf16 v[44:47], a[56:59], v[100:103], v[44:47]
    ds_read_b128 v[80:83], v3 offset:48128
    buffer_load_dwordx4 a[88:91], v6, s[4:7], s24 offen offset:2048 sc1
    v_mfma_f32_16x16x32_bf16 v[48:51], a[60:63], v[100:103], v[48:51]
    ds_read_b128 v[84:87], v3 offset:49152
    s_waitcnt lgkmcnt(5)
    v_mfma_f32_16x16x32_bf16 v[52:55], a[56:59], v[104:107], v[52:55]
    ds_read_b128 v[88:91], v3 offset:50176
    v_mfma_f32_16x16x32_bf16 v[56:59], a[60:63], v[104:107], v[56:59]
    ds_read_b128 v[92:95], v3 offset:51200
    s_waitcnt lgkmcnt(6)
    v_mfma_f32_16x16x32_bf16 v[60:63], a[56:59], v[108:111], v[60:63]
    v_mfma_f32_16x16x32_bf16 v[64:67], a[60:63], v[108:111], v[64:67]
    buffer_load_dwordx4 a[92:95], v7, s[4:7], s24 offen offset:2048 sc1
    s_waitcnt lgkmcnt(5)
    v_mfma_f32_16x16x32_bf16 v[68:71], a[56:59], v[112:115], v[68:71]
    v_mfma_f32_16x16x32_bf16 v[72:75], a[60:63], v[112:115], v[72:75]
    s_waitcnt vmcnt(9) lgkmcnt(4)
    v_mfma_f32_16x16x32_bf16 v[36:39], a[64:67], v[76:79], v[36:39]
    ds_read_b128 v[96:99], v3 offset:52224
    buffer_load_dwordx4 a[96:99], v6, s[4:7], 0 offen offset:1024 sc1
    s_waitcnt vmcnt(9)
    v_mfma_f32_16x16x32_bf16 v[40:43], a[68:71], v[76:79], v[40:43]
    s_waitcnt lgkmcnt(4)
    v_mfma_f32_16x16x32_bf16 v[44:47], a[64:67], v[80:83], v[44:47]
    ds_read_b128 v[100:103], v3 offset:53248
    buffer_load_dwordx4 a[100:103], v7, s[4:7], 0 offen offset:1024 sc1
    v_mfma_f32_16x16x32_bf16 v[48:51], a[68:71], v[80:83], v[48:51]
    s_waitcnt lgkmcnt(4)
    v_mfma_f32_16x16x32_bf16 v[52:55], a[64:67], v[84:87], v[52:55]
    ds_read_b128 v[104:107], v3 offset:54272
    s_add_u32 s85, s94, s25
    s_add_u32 s84, s94, 57344
    s_add_u32 s85, s85, 139264
    s_mov_b32 m0, s84
    s_nop 0
    buffer_load_dwordx4 v1, s[4:7], s85 offen offset:0 lds
    v_mfma_f32_16x16x32_bf16 v[56:59], a[68:71], v[84:87], v[56:59]
    s_waitcnt lgkmcnt(4)
    v_mfma_f32_16x16x32_bf16 v[60:63], a[64:67], v[88:91], v[60:63]
    ds_read_b128 v[108:111], v3 offset:55296
    buffer_load_dwordx4 v[144:147], v8, s[4:7], 0 offen offset:0 sc1
    v_mfma_f32_16x16x32_bf16 v[64:67], a[68:71], v[88:91], v[64:67]
    s_waitcnt lgkmcnt(4)
    v_mfma_f32_16x16x32_bf16 v[68:71], a[64:67], v[92:95], v[68:71]
    ds_read_b128 v[112:115], v3 offset:56320
    buffer_load_dwordx4 v[148:151], v8, s[4:7], 0 offen offset:1024 sc1
    v_mfma_f32_16x16x32_bf16 v[72:75], a[68:71], v[92:95], v[72:75]
    s_waitcnt vmcnt(11) lgkmcnt(4)
    v_mfma_f32_16x16x32_bf16 v[36:39], a[72:75], v[96:99], v[36:39]
    ds_read_b128 v[76:79], v3 offset:57344
    s_waitcnt vmcnt(10)
    v_mfma_f32_16x16x32_bf16 v[40:43], a[76:79], v[96:99], v[40:43]
    s_waitcnt lgkmcnt(4)
    v_mfma_f32_16x16x32_bf16 v[44:47], a[72:75], v[100:103], v[44:47]
    ds_read_b128 v[80:83], v3 offset:58368
    buffer_load_dwordx4 a[104:107], v6, s[4:7], s21 offen offset:0 sc1
    v_mfma_f32_16x16x32_bf16 v[48:51], a[76:79], v[100:103], v[48:51]
    s_waitcnt lgkmcnt(4)
    v_mfma_f32_16x16x32_bf16 v[52:55], a[72:75], v[104:107], v[52:55]
    ds_read_b128 v[84:87], v3 offset:59392
    v_mfma_f32_16x16x32_bf16 v[56:59], a[76:79], v[104:107], v[56:59]
    s_waitcnt lgkmcnt(4)
    v_mfma_f32_16x16x32_bf16 v[60:63], a[72:75], v[108:111], v[60:63]
    ds_read_b128 v[88:91], v3 offset:60416
    v_mfma_f32_16x16x32_bf16 v[64:67], a[76:79], v[108:111], v[64:67]
    buffer_load_dwordx4 a[108:111], v7, s[4:7], s21 offen offset:0 sc1
    s_waitcnt lgkmcnt(4)
    v_mfma_f32_16x16x32_bf16 v[68:71], a[72:75], v[112:115], v[68:71]
    ds_read_b128 v[92:95], v3 offset:61440
    v_mfma_f32_16x16x32_bf16 v[72:75], a[76:79], v[112:115], v[72:75]
    s_waitcnt vmcnt(11) lgkmcnt(4)
    v_mfma_f32_16x16x32_bf16 v[36:39], a[80:83], v[76:79], v[36:39]
    ds_read_b128 v[96:99], v3 offset:62464
    s_waitcnt vmcnt(10)
    v_mfma_f32_16x16x32_bf16 v[40:43], a[84:87], v[76:79], v[40:43]
    buffer_load_dwordx4 a[112:115], v6, s[4:7], s21 offen offset:2048 sc1
    s_waitcnt lgkmcnt(4)
    v_mfma_f32_16x16x32_bf16 v[44:47], a[80:83], v[80:83], v[44:47]
    ds_read_b128 v[100:103], v3 offset:63488
    v_mfma_f32_16x16x32_bf16 v[48:51], a[84:87], v[80:83], v[48:51]
    s_waitcnt lgkmcnt(4)
    v_mfma_f32_16x16x32_bf16 v[52:55], a[80:83], v[84:87], v[52:55]
    ds_read_b128 v[104:107], v3 offset:64512
    buffer_load_dwordx4 a[116:119], v7, s[4:7], s21 offen offset:2048 sc1
    v_mfma_f32_16x16x32_bf16 v[56:59], a[84:87], v[84:87], v[56:59]
    s_waitcnt lgkmcnt(4)
    v_mfma_f32_16x16x32_bf16 v[60:63], a[80:83], v[88:91], v[60:63]
    ds_read_b128 v[108:111], v4 offset:0
    v_mfma_f32_16x16x32_bf16 v[64:67], a[84:87], v[88:91], v[64:67]
    s_add_u32 s87, s97, s25
    s_add_u32 s86, s97, 0
    s_mov_b32 m0, s86
    s_nop 0
    buffer_load_dwordx4 v1, s[4:7], s87 offen offset:0 lds
    s_waitcnt lgkmcnt(4)
    v_mfma_f32_16x16x32_bf16 v[68:71], a[80:83], v[92:95], v[68:71]
    ds_read_b128 v[112:115], v4 offset:1024
    v_mfma_f32_16x16x32_bf16 v[72:75], a[84:87], v[92:95], v[72:75]
    s_waitcnt vmcnt(11) lgkmcnt(4)
    v_mfma_f32_16x16x32_bf16 v[36:39], a[88:91], v[96:99], v[36:39]
    ds_read_b128 v[76:79], v4 offset:2048
    s_waitcnt vmcnt(6)
    v_add_f32 v144, v144, v145
    v_mfma_f32_16x16x32_bf16 v[40:43], a[92:95], v[96:99], v[40:43]
    buffer_load_dwordx4 a[120:123], v6, s[4:7], s22 offen offset:1024 sc1
    s_waitcnt vmcnt(6)
    v_add_f32 v148, v148, v149
    s_waitcnt lgkmcnt(4)
    v_mfma_f32_16x16x32_bf16 v[44:47], a[88:91], v[100:103], v[44:47]
    ds_read_b128 v[80:83], v4 offset:3072
    v_add_f32 v146, v146, v147
    v_mfma_f32_16x16x32_bf16 v[48:51], a[92:95], v[100:103], v[48:51]
    v_add_f32 v150, v150, v151
    s_waitcnt lgkmcnt(4)
    v_mfma_f32_16x16x32_bf16 v[52:55], a[88:91], v[104:107], v[52:55]
    ds_read_b128 v[84:87], v4 offset:4096
    buffer_load_dwordx4 a[124:127], v7, s[4:7], s22 offen offset:1024 sc1
    v_add_f32 v144, v144, v146
    v_mfma_f32_16x16x32_bf16 v[56:59], a[92:95], v[104:107], v[56:59]
    v_add_f32 v148, v148, v150
    s_waitcnt lgkmcnt(4)
    v_mfma_f32_16x16x32_bf16 v[60:63], a[88:91], v[108:111], v[60:63]
    ds_read_b128 v[88:91], v4 offset:5120
    v_mov_b32 v145, v144
    v_mfma_f32_16x16x32_bf16 v[64:67], a[92:95], v[108:111], v[64:67]
    buffer_load_dwordx4 v1, s[4:7], s87 offen offset:1024 lds
    v_mov_b32 v149, v148
    s_waitcnt lgkmcnt(4)
    v_mfma_f32_16x16x32_bf16 v[68:71], a[88:91], v[112:115], v[68:71]
    ds_read_b128 v[92:95], v4 offset:6144
    v_permlane16_swap_b32 v144, v145
    v_mfma_f32_16x16x32_bf16 v[72:75], a[92:95], v[112:115], v[72:75]
    v_permlane16_swap_b32 v148, v149
    s_waitcnt lgkmcnt(4)
    v_mfma_f32_16x16x32_bf16 v[36:39], a[96:99], v[76:79], v[36:39]
    ds_read_b128 v[96:99], v4 offset:7168
    v_add_f32 v144, v144, v145
    v_mfma_f32_16x16x32_bf16 v[40:43], a[100:103], v[76:79], v[40:43]
    buffer_load_dwordx4 a[128:131], v6, s[4:7], s22 offen offset:3072 sc1
    v_add_f32 v148, v148, v149
    s_waitcnt lgkmcnt(4)
    v_mfma_f32_16x16x32_bf16 v[44:47], a[96:99], v[80:83], v[44:47]
    ds_read_b128 v[100:103], v4 offset:8192
    v_mov_b32 v145, v144
    v_mfma_f32_16x16x32_bf16 v[48:51], a[100:103], v[80:83], v[48:51]
    v_mov_b32 v149, v148
    s_waitcnt lgkmcnt(4)
    v_mfma_f32_16x16x32_bf16 v[52:55], a[96:99], v[84:87], v[52:55]
    ds_read_b128 v[104:107], v4 offset:9216
    buffer_load_dwordx4 a[132:135], v7, s[4:7], s22 offen offset:3072 sc1
    v_permlane32_swap_b32 v144, v145
    v_mfma_f32_16x16x32_bf16 v[56:59], a[100:103], v[84:87], v[56:59]
    v_permlane32_swap_b32 v148, v149
    s_waitcnt lgkmcnt(4)
    v_mfma_f32_16x16x32_bf16 v[60:63], a[96:99], v[88:91], v[60:63]
    ds_read_b128 v[108:111], v4 offset:10240
    v_mul_f32 v144, 986500301, v144
    v_mfma_f32_16x16x32_bf16 v[64:67], a[100:103], v[88:91], v[64:67]
    buffer_load_dwordx4 v1, s[4:7], s87 offen offset:2048 lds
    v_mul_f32 v148, 986500301, v148
    s_waitcnt lgkmcnt(4)
    v_mfma_f32_16x16x32_bf16 v[68:71], a[96:99], v[92:95], v[68:71]
    ds_read_b128 v[112:115], v4 offset:11264
    v_mul_f32 v145, 986500301, v145
    v_mfma_f32_16x16x32_bf16 v[72:75], a[100:103], v[92:95], v[72:75]
    v_mul_f32 v149, 986500301, v149
    s_waitcnt vmcnt(10) lgkmcnt(4)
    v_mfma_f32_16x16x32_bf16 v[36:39], a[104:107], v[96:99], v[36:39]
    ds_read_b128 v[76:79], v4 offset:12288
    v_fma_f32 v145, -v144, v144, v145
    s_waitcnt vmcnt(9)
    v_mfma_f32_16x16x32_bf16 v[40:43], a[108:111], v[96:99], v[40:43]
    buffer_load_dwordx4 a[136:139], v6, s[4:7], s23 offen offset:2048 sc1
    v_fma_f32 v149, -v148, v148, v149
    s_waitcnt lgkmcnt(4)
    v_mfma_f32_16x16x32_bf16 v[44:47], a[104:107], v[100:103], v[44:47]
    ds_read_b128 v[80:83], v4 offset:13312
    v_max_f32 v145, 0, v145
    v_mfma_f32_16x16x32_bf16 v[48:51], a[108:111], v[100:103], v[48:51]
    v_max_f32 v149, 0, v149
    s_waitcnt lgkmcnt(4)
    v_mfma_f32_16x16x32_bf16 v[52:55], a[104:107], v[104:107], v[52:55]
    ds_read_b128 v[84:87], v4 offset:14336
    buffer_load_dwordx4 a[140:143], v7, s[4:7], s23 offen offset:2048 sc1
    v_add_f32 v145, 925353388, v145
    v_mfma_f32_16x16x32_bf16 v[56:59], a[108:111], v[104:107], v[56:59]
    v_add_f32 v149, 925353388, v149
    s_waitcnt lgkmcnt(4)
    v_mfma_f32_16x16x32_bf16 v[60:63], a[104:107], v[108:111], v[60:63]
    ds_read_b128 v[88:91], v4 offset:15360
    v_rsq_f32 v132, v145
    v_mfma_f32_16x16x32_bf16 v[64:67], a[108:111], v[108:111], v[64:67]
    buffer_load_dwordx4 v1, s[4:7], s87 offen offset:3072 lds
    v_rsq_f32 v133, v149
    s_waitcnt lgkmcnt(4)
    v_mfma_f32_16x16x32_bf16 v[68:71], a[104:107], v[112:115], v[68:71]
    ds_read_b128 v[92:95], v4 offset:16384
    v_mul_f32_e64 v134, -v144, v132
    v_mfma_f32_16x16x32_bf16 v[72:75], a[108:111], v[112:115], v[72:75]
    v_mul_f32_e64 v135, -v148, v133
    s_waitcnt vmcnt(11) lgkmcnt(4)
    v_mfma_f32_16x16x32_bf16 v[36:39], a[112:115], v[76:79], v[36:39]
    ds_read_b128 v[96:99], v4 offset:17408
    s_lshl_b32 s3, s16, 8
    s_waitcnt vmcnt(10)
    v_mfma_f32_16x16x32_bf16 v[40:43], a[116:119], v[76:79], v[40:43]
    buffer_load_dwordx4 a[144:147], v6, s[4:7], s24 offen offset:0 sc1
    v_add_u32 v154, s3, v13
    s_waitcnt lgkmcnt(4)
    v_mfma_f32_16x16x32_bf16 v[44:47], a[112:115], v[80:83], v[44:47]
    ds_read_b128 v[100:103], v4 offset:18432
    v_add_u32 v155, s3, v12
    v_mfma_f32_16x16x32_bf16 v[48:51], a[116:119], v[80:83], v[48:51]
    s_waitcnt lgkmcnt(4)
    v_mfma_f32_16x16x32_bf16 v[52:55], a[112:115], v[84:87], v[52:55]
    ds_read_b128 v[104:107], v4 offset:19456
    buffer_load_dwordx4 a[148:151], v7, s[4:7], s24 offen offset:0 sc1
    ds_write_b32 v154, v132 offset:2048
    v_mfma_f32_16x16x32_bf16 v[56:59], a[116:119], v[84:87], v[56:59]
    ds_write_b32 v154, v134 offset:2176
    s_waitcnt lgkmcnt(6)
    v_mfma_f32_16x16x32_bf16 v[60:63], a[112:115], v[88:91], v[60:63]
    ds_read_b128 v[108:111], v4 offset:20480
    v_mfma_f32_16x16x32_bf16 v[64:67], a[116:119], v[88:91], v[64:67]
    s_add_u32 s87, s97, s25
    s_add_u32 s86, s97, 16384
    s_add_u32 s87, s87, 16384
    s_mov_b32 m0, s86
    s_nop 0
    buffer_load_dwordx4 v1, s[4:7], s87 offen offset:0 lds
    ds_write_b32 v154, v133 offset:2112
    s_waitcnt lgkmcnt(7)
    v_mfma_f32_16x16x32_bf16 v[68:71], a[112:115], v[92:95], v[68:71]
    ds_read_b128 v[112:115], v4 offset:21504
    ds_write_b32 v154, v135 offset:2240
    v_mfma_f32_16x16x32_bf16 v[72:75], a[116:119], v[92:95], v[72:75]
    s_waitcnt vmcnt(11) lgkmcnt(8)
    v_mfma_f32_16x16x32_bf16 v[36:39], a[120:123], v[96:99], v[36:39]
    s_barrier
    s_waitcnt vmcnt(10)
    v_mfma_f32_16x16x32_bf16 v[40:43], a[124:127], v[96:99], v[40:43]
    ds_read_b128 v[76:79], v1 offset:51200
    ds_read_b128 v[116:119], v155 offset:2048
    s_waitcnt lgkmcnt(9)
    v_mfma_f32_16x16x32_bf16 v[44:47], a[120:123], v[100:103], v[44:47]
    ds_read_b128 v[80:83], v1 offset:52224
    buffer_load_dwordx4 a[152:155], v6, s[4:7], s24 offen offset:3072 sc1
    v_mfma_f32_16x16x32_bf16 v[48:51], a[124:127], v[100:103], v[48:51]
    ds_read_b128 v[84:87], v1 offset:53248
    s_waitcnt lgkmcnt(10)
    v_mfma_f32_16x16x32_bf16 v[52:55], a[120:123], v[104:107], v[52:55]
    ds_read_b128 v[88:91], v1 offset:54272
    v_mfma_f32_16x16x32_bf16 v[56:59], a[124:127], v[104:107], v[56:59]
    ds_read_b128 v[92:95], v1 offset:55296
    buffer_load_dwordx4 a[156:159], v7, s[4:7], s24 offen offset:3072 sc1
    ds_read_b128 v[120:123], v155 offset:2112
    s_waitcnt lgkmcnt(10)
    v_mfma_f32_16x16x32_bf16 v[60:63], a[120:123], v[108:111], v[60:63]
    v_mfma_f32_16x16x32_bf16 v[64:67], a[124:127], v[108:111], v[64:67]
    s_waitcnt lgkmcnt(8)
    v_mfma_f32_16x16x32_bf16 v[68:71], a[120:123], v[112:115], v[68:71]
    buffer_load_dwordx4 v1, s[4:7], s87 offen offset:1024 lds
    v_mfma_f32_16x16x32_bf16 v[72:75], a[124:127], v[112:115], v[72:75]
    s_waitcnt vmcnt(11) lgkmcnt(6)
    v_mfma_f32_16x16x32_bf16 v[36:39], a[128:131], v[76:79], v[36:39]
    ds_read_b128 v[96:99], v1 offset:56320
    ds_read_b128 v[124:127], v155 offset:2176
    s_waitcnt vmcnt(10)
    v_mfma_f32_16x16x32_bf16 v[40:43], a[132:135], v[76:79], v[40:43]
    ds_read_b128 v[128:131], v155 offset:2240
    s_waitcnt lgkmcnt(7)
    v_mfma_f32_16x16x32_bf16 v[44:47], a[128:131], v[80:83], v[44:47]
    ds_read_b128 v[100:103], v1 offset:57344
    v_mov_b32 v156, 897988541
    v_mfma_f32_16x16x32_bf16 v[48:51], a[132:135], v[80:83], v[48:51]
    s_waitcnt lgkmcnt(7)
    v_mfma_f32_16x16x32_bf16 v[52:55], a[128:131], v[84:87], v[52:55]
    ds_read_b128 v[104:107], v1 offset:58368
    buffer_load_dwordx4 v1, s[4:7], s87 offen offset:2048 lds
    v_mov_b32 v157, 1069066811
    v_mfma_f32_16x16x32_bf16 v[56:59], a[132:135], v[84:87], v[56:59]
    v_mov_b32 v160, 3049365963
    s_waitcnt lgkmcnt(7)
    v_mfma_f32_16x16x32_bf16 v[60:63], a[128:131], v[88:91], v[60:63]
    ds_read_b128 v[108:111], v1 offset:59392
    v_mfma_f32_16x16x32_bf16 v[64:67], a[132:135], v[88:91], v[64:67]
    v_mov_b32 v158, 0xc47a0000
    s_waitcnt lgkmcnt(7)
    v_mfma_f32_16x16x32_bf16 v[68:71], a[128:131], v[92:95], v[68:71]
    ds_read_b128 v[112:115], v1 offset:60416
    v_mov_b32 v159, 0xff800000
    v_mfma_f32_16x16x32_bf16 v[72:75], a[132:135], v[92:95], v[72:75]
    s_waitcnt vmcnt(9) lgkmcnt(6)
    v_mfma_f32_16x16x32_bf16 v[36:39], a[136:139], v[96:99], v[36:39]
    ds_read_b128 v[76:79], v1 offset:61440
    ds_read_b32 v136, v13 offset:0
    s_waitcnt vmcnt(8)
    v_mfma_f32_16x16x32_bf16 v[40:43], a[140:143], v[96:99], v[40:43]
    s_waitcnt lgkmcnt(5)
    v_mfma_f32_16x16x32_bf16 v[44:47], a[136:139], v[100:103], v[44:47]
    ds_read_b128 v[80:83], v1 offset:62464
    v_mfma_f32_16x16x32_bf16 v[48:51], a[140:143], v[100:103], v[48:51]
    ds_read_b32 v137, v13 offset:64
    s_waitcnt lgkmcnt(6)
    v_mfma_f32_16x16x32_bf16 v[52:55], a[136:139], v[104:107], v[52:55]
    ds_read_b128 v[84:87], v1 offset:63488
    buffer_load_dwordx4 v1, s[4:7], s87 offen offset:3072 lds
    v_mfma_f32_16x16x32_bf16 v[56:59], a[140:143], v[104:107], v[56:59]
    s_waitcnt lgkmcnt(6)
    v_mfma_f32_16x16x32_bf16 v[60:63], a[136:139], v[108:111], v[60:63]
    ds_read_b128 v[88:91], v1 offset:64512
    ds_read_b32 v138, v13 offset:128
    v_mfma_f32_16x16x32_bf16 v[64:67], a[140:143], v[108:111], v[64:67]
    s_waitcnt lgkmcnt(7)
    v_mfma_f32_16x16x32_bf16 v[68:71], a[136:139], v[112:115], v[68:71]
    ds_read_b128 v[92:95], v3 offset:0
    v_mfma_f32_16x16x32_bf16 v[72:75], a[140:143], v[112:115], v[72:75]
    s_waitcnt vmcnt(7) lgkmcnt(7)
    v_mfma_f32_16x16x32_bf16 v[36:39], a[144:147], v[76:79], v[36:39]
    ds_read_b128 v[96:99], v3 offset:1024
    ds_read_b32 v139, v13 offset:192
    s_waitcnt vmcnt(6)
    v_mfma_f32_16x16x32_bf16 v[40:43], a[148:151], v[76:79], v[40:43]
    ds_read_b32 v140, v13 offset:256
    s_waitcnt lgkmcnt(8)
    v_mfma_f32_16x16x32_bf16 v[44:47], a[144:147], v[80:83], v[44:47]
    ds_read_b128 v[100:103], v3 offset:2048
    v_mfma_f32_16x16x32_bf16 v[48:51], a[148:151], v[80:83], v[48:51]
    v_cndmask_b32 v159, v159, v156, s[50:51]
    s_waitcnt lgkmcnt(7)
    v_mfma_f32_16x16x32_bf16 v[52:55], a[144:147], v[84:87], v[52:55]
    ds_read_b128 v[104:107], v3 offset:3072
    s_add_u32 s87, s97, s25
    s_add_u32 s86, s97, 32768
    s_add_u32 s87, s87, 32768
    s_mov_b32 m0, s86
    s_nop 0
    buffer_load_dwordx4 v1, s[4:7], s87 offen offset:0 lds
    v_mfma_f32_16x16x32_bf16 v[56:59], a[148:151], v[84:87], v[56:59]
    v_cndmask_b32 v156, 0, v156, s[50:51]
    s_waitcnt lgkmcnt(7)
    v_mfma_f32_16x16x32_bf16 v[60:63], a[144:147], v[88:91], v[60:63]
    ds_read_b128 v[108:111], v3 offset:4096
    v_cndmask_b32 v157, 0, v157, s[50:51]
    v_mfma_f32_16x16x32_bf16 v[64:67], a[148:151], v[88:91], v[64:67]
    s_waitcnt lgkmcnt(6)
    v_mfma_f32_16x16x32_bf16 v[68:71], a[144:147], v[92:95], v[68:71]
    ds_read_b128 v[112:115], v3 offset:5120
    v_cndmask_b32 v158, v158, v160, s[50:51]
    v_mfma_f32_16x16x32_bf16 v[72:75], a[148:151], v[92:95], v[72:75]
    s_waitcnt vmcnt(5) lgkmcnt(6)
    v_mfma_f32_16x16x32_bf16 v[36:39], a[152:155], v[96:99], v[36:39]
    v_mov_b32 v161, 3049365963
    s_waitcnt vmcnt(4)
    v_mfma_f32_16x16x32_bf16 v[40:43], a[156:159], v[96:99], v[40:43]
    s_waitcnt lgkmcnt(3)
    v_mfma_f32_16x16x32_bf16 v[44:47], a[152:155], v[100:103], v[44:47]
    v_mfma_f32_16x16x32_bf16 v[48:51], a[156:159], v[100:103], v[48:51]
    s_waitcnt lgkmcnt(2)
    v_mfma_f32_16x16x32_bf16 v[52:55], a[152:155], v[104:107], v[52:55]
    v_mfma_f32_16x16x32_bf16 v[56:59], a[156:159], v[104:107], v[56:59]
    v_mov_b32 v160, 0x3f803f80
    s_waitcnt lgkmcnt(1)
    v_mfma_f32_16x16x32_bf16 v[60:63], a[152:155], v[108:111], v[60:63]
    v_mfma_f32_16x16x32_bf16 v[64:67], a[156:159], v[108:111], v[64:67]
    s_waitcnt lgkmcnt(0)
    v_mfma_f32_16x16x32_bf16 v[68:71], a[152:155], v[112:115], v[68:71]
    v_mfma_f32_16x16x32_bf16 v[72:75], a[156:159], v[112:115], v[72:75]
    v_pk_fma_f32 v[144:145], v[124:125], v[136:137], s[76:77] op_sel:[0,0,0] op_sel_hi:[1,0,1]
    v_pk_fma_f32 v[148:149], v[128:129], v[136:137], s[76:77] op_sel:[0,0,0] op_sel_hi:[1,0,1]
    buffer_load_dwordx4 v1, s[4:7], s87 offen offset:1024 lds
    v_pk_fma_f32 v[146:147], v[126:127], v[136:137], s[76:77] op_sel:[0,0,0] op_sel_hi:[1,0,1]
    v_pk_fma_f32 v[150:151], v[130:131], v[136:137], s[76:77] op_sel:[0,0,0] op_sel_hi:[1,0,1]
    v_pk_fma_f32 v[36:37], v[36:37], v[116:117], v[144:145] op_sel:[0,0,0] op_sel_hi:[1,1,1]
    v_pk_fma_f32 v[40:41], v[40:41], v[120:121], v[148:149] op_sel:[0,0,0] op_sel_hi:[1,1,1]
    v_pk_fma_f32 v[38:39], v[38:39], v[118:119], v[146:147] op_sel:[0,0,0] op_sel_hi:[1,1,1]
    v_pk_fma_f32 v[42:43], v[42:43], v[122:123], v[150:151] op_sel:[0,0,0] op_sel_hi:[1,1,1]
    v_pk_fma_f32 v[144:145], v[36:37], s[78:79], v[160:161] op_sel:[0,0,1] op_sel_hi:[1,1,1]
    v_pk_fma_f32 v[148:149], v[40:41], s[78:79], v[160:161] op_sel:[0,0,1] op_sel_hi:[1,1,1]
    v_pk_fma_f32 v[146:147], v[38:39], s[78:79], v[160:161] op_sel:[0,0,1] op_sel_hi:[1,1,1]
    v_pk_fma_f32 v[150:151], v[42:43], s[78:79], v[160:161] op_sel:[0,0,1] op_sel_hi:[1,1,1]
    v_exp_f32_e64 v144, v144 clamp
    v_exp_f32_e64 v148, v148 clamp
    v_exp_f32_e64 v145, v145 clamp
    v_exp_f32_e64 v149, v149 clamp
    v_exp_f32_e64 v146, v146 clamp
    v_exp_f32_e64 v150, v150 clamp
    v_exp_f32_e64 v147, v147 clamp
    v_exp_f32_e64 v151, v151 clamp
    v_max_f32 v36, s76, v36
    v_max_f32 v40, s76, v40
    v_max_f32 v37, s76, v37
    v_max_f32 v41, s76, v41
    v_max_f32 v38, s76, v38
    v_max_f32 v42, s76, v42
    v_max_f32 v39, s76, v39
    v_max_f32_e64 v43, s76, v43
    v_pk_add_f32 v[36:37], v[36:37], v[144:145] op_sel:[0,0] op_sel_hi:[1,1]
    v_pk_add_f32 v[40:41], v[40:41], v[148:149] op_sel:[0,0] op_sel_hi:[1,1]
    v_pk_add_f32 v[38:39], v[38:39], v[146:147] op_sel:[0,0] op_sel_hi:[1,1]
    buffer_load_dwordx4 v1, s[4:7], s87 offen offset:2048 lds
    v_pk_add_f32 v[42:43], v[42:43], v[150:151] op_sel:[0,0] op_sel_hi:[1,1]
    v_cvt_pk_bf16_f32 v76, v36, v37
    v_cvt_pk_bf16_f32 v78, v40, v41
    v_cvt_pk_bf16_f32 v77, v38, v39
    v_cvt_pk_bf16_f32 v79, v42, v43
    v_pk_fma_f32 v[144:145], v[124:125], v[136:137], s[76:77] op_sel:[0,1,0] op_sel_hi:[1,1,1]
    v_pk_fma_f32 v[148:149], v[128:129], v[136:137], s[76:77] op_sel:[0,1,0] op_sel_hi:[1,1,1]
    v_pk_fma_f32 v[146:147], v[126:127], v[136:137], s[76:77] op_sel:[0,1,0] op_sel_hi:[1,1,1]
    v_pk_fma_f32 v[150:151], v[130:131], v[136:137], s[76:77] op_sel:[0,1,0] op_sel_hi:[1,1,1]
    v_pk_fma_f32 v[44:45], v[44:45], v[116:117], v[144:145] op_sel:[0,0,0] op_sel_hi:[1,1,1]
    v_pk_fma_f32 v[48:49], v[48:49], v[120:121], v[148:149] op_sel:[0,0,0] op_sel_hi:[1,1,1]
    v_pk_fma_f32 v[46:47], v[46:47], v[118:119], v[146:147] op_sel:[0,0,0] op_sel_hi:[1,1,1]
    v_pk_fma_f32 v[50:51], v[50:51], v[122:123], v[150:151] op_sel:[0,0,0] op_sel_hi:[1,1,1]
    v_pk_fma_f32 v[144:145], v[44:45], s[78:79], v[160:161] op_sel:[0,0,1] op_sel_hi:[1,1,1]
    v_pk_fma_f32 v[148:149], v[48:49], s[78:79], v[160:161] op_sel:[0,0,1] op_sel_hi:[1,1,1]
    v_pk_fma_f32 v[146:147], v[46:47], s[78:79], v[160:161] op_sel:[0,0,1] op_sel_hi:[1,1,1]
    v_pk_fma_f32 v[150:151], v[50:51], s[78:79], v[160:161] op_sel:[0,0,1] op_sel_hi:[1,1,1]
    v_exp_f32_e64 v144, v144 clamp
    v_exp_f32_e64 v148, v148 clamp
    v_exp_f32_e64 v145, v145 clamp
    v_exp_f32_e64 v149, v149 clamp
    v_exp_f32_e64 v146, v146 clamp
    v_exp_f32_e64 v150, v150 clamp
    v_exp_f32_e64 v147, v147 clamp
    v_exp_f32_e64 v151, v151 clamp
    v_max_f32 v44, s76, v44
    v_max_f32 v48, s76, v48
    v_max_f32 v45, s76, v45
    v_max_f32 v49, s76, v49
    buffer_load_dwordx4 v1, s[4:7], s87 offen offset:3072 lds
    v_max_f32 v46, s76, v46
    v_max_f32 v50, s76, v50
    v_max_f32 v47, s76, v47
    v_max_f32 v51, s76, v51
    v_pk_add_f32 v[44:45], v[44:45], v[144:145] op_sel:[0,0] op_sel_hi:[1,1]
    v_pk_add_f32 v[48:49], v[48:49], v[148:149] op_sel:[0,0] op_sel_hi:[1,1]
    v_pk_add_f32 v[46:47], v[46:47], v[146:147] op_sel:[0,0] op_sel_hi:[1,1]
    v_pk_add_f32 v[50:51], v[50:51], v[150:151] op_sel:[0,0] op_sel_hi:[1,1]
    v_cvt_pk_bf16_f32 v80, v44, v45
    v_cvt_pk_bf16_f32 v82, v48, v49
    v_cvt_pk_bf16_f32 v81, v46, v47
    v_cvt_pk_bf16_f32 v83, v50, v51
    v_pk_fma_f32 v[144:145], v[124:125], v[140:141], v[156:157] op_sel:[0,0,0] op_sel_hi:[1,0,0]
    v_pk_fma_f32 v[148:149], v[128:129], v[140:141], v[156:157] op_sel:[0,0,0] op_sel_hi:[1,0,0]
    v_pk_fma_f32 v[146:147], v[126:127], v[140:141], v[156:157] op_sel:[0,0,0] op_sel_hi:[1,0,0]
    v_pk_fma_f32 v[150:151], v[130:131], v[140:141], v[156:157] op_sel:[0,0,0] op_sel_hi:[1,0,0]
    v_pk_fma_f32 v[68:69], v[68:69], v[116:117], v[144:145] op_sel:[0,0,0] op_sel_hi:[1,1,1]
    v_pk_fma_f32 v[72:73], v[72:73], v[120:121], v[148:149] op_sel:[0,0,0] op_sel_hi:[1,1,1]
    v_pk_fma_f32 v[70:71], v[70:71], v[118:119], v[146:147] op_sel:[0,0,0] op_sel_hi:[1,1,1]
    v_pk_fma_f32 v[74:75], v[74:75], v[122:123], v[150:151] op_sel:[0,0,0] op_sel_hi:[1,1,1]
    v_pk_fma_f32 v[144:145], v[68:69], v[156:157], v[158:159] op_sel:[0,1,0] op_sel_hi:[1,1,0]
    v_pk_fma_f32 v[148:149], v[72:73], v[156:157], v[158:159] op_sel:[0,1,0] op_sel_hi:[1,1,0]
    v_pk_fma_f32 v[146:147], v[70:71], v[156:157], v[158:159] op_sel:[0,1,0] op_sel_hi:[1,1,0]
    v_pk_fma_f32 v[150:151], v[74:75], v[156:157], v[158:159] op_sel:[0,1,0] op_sel_hi:[1,1,0]
    v_exp_f32_e64 v144, v144 clamp
    v_exp_f32_e64 v148, v148 clamp
    v_exp_f32_e64 v145, v145 clamp
    v_exp_f32_e64 v149, v149 clamp
    v_exp_f32_e64 v146, v146 clamp
    s_add_u32 s87, s94, s25
    s_add_u32 s86, s94, 47104
    s_add_u32 s87, s87, 47104
    s_mov_b32 m0, s86
    s_nop 0
    buffer_load_dwordx4 v1, s[4:7], s87 offen offset:0 lds
    v_exp_f32_e64 v150, v150 clamp
    v_exp_f32_e64 v147, v147 clamp
    v_exp_f32_e64 v151, v151 clamp
    v_max_f32 v68, v159, v68
    v_max_f32 v72, v159, v72
    v_max_f32 v69, v159, v69
    v_max_f32 v73, v159, v73
    v_max_f32 v70, v159, v70
    v_max_f32 v74, v159, v74
    v_max_f32 v71, v159, v71
    v_max_f32_e64 v75, v159, v75
    v_pk_add_f32 v[68:69], v[68:69], v[144:145] op_sel:[0,0] op_sel_hi:[1,1]
    v_pk_add_f32 v[72:73], v[72:73], v[148:149] op_sel:[0,0] op_sel_hi:[1,1]
    v_pk_add_f32 v[70:71], v[70:71], v[146:147] op_sel:[0,0] op_sel_hi:[1,1]
    v_pk_add_f32 v[74:75], v[74:75], v[150:151] op_sel:[0,0] op_sel_hi:[1,1]
    v_cvt_pk_bf16_f32 v92, v68, v69
    v_cvt_pk_bf16_f32 v94, v72, v73
    v_cvt_pk_bf16_f32 v93, v70, v71
    v_cvt_pk_bf16_f32 v95, v74, v75
    v_cndmask_b32 v96, v92, v160, s[50:51]
    v_cndmask_b32 v97, v93, v160, s[50:51]
    v_cndmask_b32 v98, v94, v160, s[50:51]
    v_cndmask_b32 v99, v95, v160, s[50:51]
    s_nop 1
    v_mfma_f32_16x16x32_bf16 v[100:103], v[76:79], v[96:99], 0
    v_mfma_f32_16x16x32_bf16 v[104:107], v[80:83], v[96:99], 0
    v_mfma_f32_16x16x32_bf16 v[108:111], v[92:95], v[96:99], 0
    v_pk_mul_f32 v[144:145], v[124:125], v[138:139] op_sel:[0,0] op_sel_hi:[1,0]
    v_pk_mul_f32 v[148:149], v[128:129], v[138:139] op_sel:[0,0] op_sel_hi:[1,0]
    v_pk_mul_f32 v[146:147], v[126:127], v[138:139] op_sel:[0,0] op_sel_hi:[1,0]
    s_lshl_b32 s3, s18, 1
    s_and_b32 s101, s16, 1
    s_add_u32 s3, s3, s101
    s_mul_i32 s3, s3, 2816
    s_lshr_b32 s101, s16, 1
    s_lshl1_add_u32 s101, s17, s101
    s_mul_i32 s101, s101, 221184
    s_add_u32 s3, s3, s101
    s_add_u32 s3, s3, 13762560
    v_min_u32 v35, 84, v2
    v_lshlrev_b32 v35, 5, v35
    s_mov_b32 s101, 156672
    s_mov_b32 m0, s101
    s_nop 0
    buffer_load_dword v35, s[4:7], s3 offen lds
    v_pk_mul_f32 v[150:151], v[130:131], v[138:139] op_sel:[0,0] op_sel_hi:[1,0]
    v_pk_fma_f32 v[52:53], v[52:53], v[116:117], v[144:145] op_sel:[0,0,0] op_sel_hi:[1,1,1]
    v_pk_fma_f32 v[56:57], v[56:57], v[120:121], v[148:149] op_sel:[0,0,0] op_sel_hi:[1,1,1]
    v_pk_fma_f32 v[54:55], v[54:55], v[118:119], v[146:147] op_sel:[0,0,0] op_sel_hi:[1,1,1]
    v_pk_fma_f32 v[58:59], v[58:59], v[122:123], v[150:151] op_sel:[0,0,0] op_sel_hi:[1,1,1]
    v_cvt_pk_bf16_f32 v84, v52, v53
    v_cvt_pk_bf16_f32 v86, v56, v57
    v_cvt_pk_bf16_f32 v85, v54, v55
    v_cvt_pk_bf16_f32 v87, v58, v59
    s_nop 1
    v_mfma_f32_16x16x32_bf16 v[36:39], v[76:79], v[84:87], 0
    v_mfma_f32_16x16x32_bf16 v[40:43], v[92:95], v[84:87], 0
    v_pk_mul_f32 v[144:145], v[124:125], v[138:139] op_sel:[0,1] op_sel_hi:[1,1]
    v_pk_mul_f32 v[148:149], v[128:129], v[138:139] op_sel:[0,1] op_sel_hi:[1,1]
    v_pk_mul_f32 v[146:147], v[126:127], v[138:139] op_sel:[0,1] op_sel_hi:[1,1]
    v_pk_mul_f32 v[150:151], v[130:131], v[138:139] op_sel:[0,1] op_sel_hi:[1,1]
    v_pk_fma_f32 v[60:61], v[60:61], v[116:117], v[144:145] op_sel:[0,0,0] op_sel_hi:[1,1,1]
    v_pk_fma_f32 v[64:65], v[64:65], v[120:121], v[148:149] op_sel:[0,0,0] op_sel_hi:[1,1,1]
    v_pk_fma_f32 v[62:63], v[62:63], v[118:119], v[146:147] op_sel:[0,0,0] op_sel_hi:[1,1,1]
    v_pk_fma_f32 v[66:67], v[66:67], v[122:123], v[150:151] op_sel:[0,0,0] op_sel_hi:[1,1,1]
    v_cvt_pk_bf16_f32 v88, v60, v61
    v_cvt_pk_bf16_f32 v90, v64, v65
    v_cvt_pk_bf16_f32 v89, v62, v63
    v_cvt_pk_bf16_f32 v91, v66, v67
    s_nop 1
    v_mfma_f32_16x16x32_bf16 v[44:47], v[80:83], v[88:91], 0
    v_mfma_f32_16x16x32_bf16 v[48:51], v[92:95], v[88:91], 0
    v_cndmask_b32 v161, v100, v104, s[48:49]
    v_cndmask_b32 v162, v101, v105, s[48:49]
    v_cndmask_b32 v164, v102, v106, s[48:49]
    v_cndmask_b32 v165, v103, v107, s[48:49]
    v_cndmask_b32 v166, v108, v109, s[48:49]
    v_mov_b32 v167, 0x3e800000
    ds_write_b128 v33, v[164:167] offset:4096
    v_mov_b32 v151, 0x3e800000
    v_mov_b32 v155, 0x3e800000
    v_mov_b32 v159, 0x3e800000
    v_mov_b32 v163, 0x3e800000
    v_mov_b32 v148, v36
    v_mov_b32 v149, v37
    v_mov_b32 v150, v38
    ds_write_b128 v33, v[148:151]
    v_mov_b32 v152, v39
    v_mov_b32 v153, v40
    v_mov_b32 v154, v44
    ds_write_b128 v33, v[152:155] offset:1024
    v_mov_b32 v156, v45
    v_mov_b32 v157, v46
    v_mov_b32 v158, v47
    ds_write_b128 v33, v[156:159] offset:2048
    v_mov_b32 v160, v49
    ds_write_b128 v33, v[160:163] offset:3072
    s_waitcnt lgkmcnt(0)
    s_waitcnt vmcnt(1)
    s_barrier
    ds_read_b32 v100, v34 offset:0
    ds_read_b32 v101, v34 offset:5120
    ds_read_b32 v102, v34 offset:10240
    ds_read_b32 v103, v34 offset:15360
    ds_read_b32 v104, v34 offset:256
    ds_read_b32 v105, v34 offset:5376
    ds_read_b32 v106, v34 offset:10496
    ds_read_b32 v107, v34 offset:15616
    ds_read_b32 v108, v34 offset:512
    ds_read_b32 v109, v34 offset:5632
    ds_read_b32 v110, v34 offset:10752
    ds_read_b32 v111, v34 offset:15872
    ds_read_b32 v112, v34 offset:768
    ds_read_b32 v113, v34 offset:5888
    ds_read_b32 v114, v34 offset:11008
    ds_read_b32 v115, v34 offset:16128
    ds_read_b32 v116, v34 offset:1024
    ds_read_b32 v117, v34 offset:6144
    ds_read_b32 v118, v34 offset:11264
    ds_read_b32 v119, v34 offset:16384
    v_pk_add_f32 v[100:101], v[100:101], v[102:103] op_sel:[0,0] op_sel_hi:[1,1]
    v_add_f32 v100, v100, v101
    buffer_atomic_add_f32 v100, v2, s[4:7], s47 offen offset:0
    s_waitcnt lgkmcnt(12)
    v_pk_add_f32 v[104:105], v[104:105], v[106:107] op_sel:[0,0] op_sel_hi:[1,1]
    v_add_f32 v104, v104, v105
    buffer_atomic_add_f32 v104, v2, s[4:7], s47 offen offset:256
    s_waitcnt lgkmcnt(8)
    v_pk_add_f32 v[108:109], v[108:109], v[110:111] op_sel:[0,0] op_sel_hi:[1,1]
    v_add_f32 v108, v108, v109
    buffer_atomic_add_f32 v108, v2, s[4:7], s47 offen offset:512
    s_waitcnt lgkmcnt(4)
    v_pk_add_f32 v[112:113], v[112:113], v[114:115] op_sel:[0,0] op_sel_hi:[1,1]
    v_add_f32 v112, v112, v113
    buffer_atomic_add_f32 v112, v2, s[4:7], s47 offen offset:768
    s_waitcnt lgkmcnt(0)
    v_pk_add_f32 v[116:117], v[116:117], v[118:119] op_sel:[0,0] op_sel_hi:[1,1]
    v_add_f32 v116, v116, v117
    buffer_atomic_add_f32 v116, v2, s[4:7], s47 offen offset:1024
    ds_read_b128 v[76:79], v1 offset:0
    ds_read_b128 v[80:83], v1 offset:1024
    ds_read_b128 v[84:87], v5 offset:2048
    s_waitcnt lgkmcnt(2)
    v_mfma_f32_16x16x32_bf16 v[36:39], v[76:79], a[152:155], 0
    ds_read_b128 v[88:91], v1 offset:2560
    v_mfma_f32_16x16x32_bf16 v[40:43], v[76:79], a[156:159], 0
    s_waitcnt lgkmcnt(2)
    v_mfma_f32_16x16x32_bf16 v[44:47], v[80:83], a[152:155], 0
    ds_read_b128 v[92:95], v1 offset:3584
    v_mfma_f32_16x16x32_bf16 v[48:51], v[80:83], a[156:159], 0
    s_waitcnt lgkmcnt(2)
    v_mfma_f32_16x16x32_bf16 v[52:55], v[84:87], a[152:155], 0
    ds_read_b128 v[96:99], v5 offset:4608
    v_mfma_f32_16x16x32_bf16 v[56:59], v[84:87], a[156:159], 0
    s_waitcnt lgkmcnt(2)
    v_mfma_f32_16x16x32_bf16 v[36:39], v[88:91], a[144:147], v[36:39]
    ds_read_b128 v[76:79], v1 offset:5120
    v_mfma_f32_16x16x32_bf16 v[40:43], v[88:91], a[148:151], v[40:43]
    s_add_u32 s68, s27, 0
    buffer_load_dwordx4 a[156:159], v1, s[4:7], s68 offen offset:0
    s_waitcnt lgkmcnt(2)
    v_mfma_f32_16x16x32_bf16 v[44:47], v[92:95], a[144:147], v[44:47]
    ds_read_b128 v[80:83], v1 offset:6144
    v_mfma_f32_16x16x32_bf16 v[48:51], v[92:95], a[148:151], v[48:51]
    s_waitcnt lgkmcnt(2)
    v_mfma_f32_16x16x32_bf16 v[52:55], v[96:99], a[144:147], v[52:55]
    ds_read_b128 v[84:87], v5 offset:7168
    buffer_load_dwordx4 a[152:155], v1, s[4:7], s68 offen offset:1024
    v_mfma_f32_16x16x32_bf16 v[56:59], v[96:99], a[148:151], v[56:59]
    s_waitcnt lgkmcnt(2)
    v_mfma_f32_16x16x32_bf16 v[36:39], v[76:79], a[136:139], v[36:39]
    ds_read_b128 v[88:91], v1 offset:7680
    v_mfma_f32_16x16x32_bf16 v[40:43], v[76:79], a[140:143], v[40:43]
    buffer_load_dwordx4 a[148:151], v1, s[4:7], s68 offen offset:2048
    s_waitcnt lgkmcnt(2)
    v_mfma_f32_16x16x32_bf16 v[44:47], v[80:83], a[136:139], v[44:47]
    ds_read_b128 v[92:95], v1 offset:8704
    v_mfma_f32_16x16x32_bf16 v[48:51], v[80:83], a[140:143], v[48:51]
    s_waitcnt lgkmcnt(2)
    v_mfma_f32_16x16x32_bf16 v[52:55], v[84:87], a[136:139], v[52:55]
    ds_read_b128 v[96:99], v5 offset:9728
    buffer_load_dwordx4 a[144:147], v1, s[4:7], s68 offen offset:3072
    v_mfma_f32_16x16x32_bf16 v[56:59], v[84:87], a[140:143], v[56:59]
    s_waitcnt lgkmcnt(2)
    v_mfma_f32_16x16x32_bf16 v[36:39], v[88:91], a[128:131], v[36:39]
    ds_read_b128 v[76:79], v1 offset:10240
    v_mfma_f32_16x16x32_bf16 v[40:43], v[88:91], a[132:135], v[40:43]
    s_waitcnt lgkmcnt(2)
    v_mfma_f32_16x16x32_bf16 v[44:47], v[92:95], a[128:131], v[44:47]
    ds_read_b128 v[80:83], v1 offset:11264
    s_add_u32 s68, s27, 4096
    buffer_load_dwordx4 a[140:143], v1, s[4:7], s68 offen offset:0
    v_mfma_f32_16x16x32_bf16 v[48:51], v[92:95], a[132:135], v[48:51]
    s_waitcnt lgkmcnt(2)
    v_mfma_f32_16x16x32_bf16 v[52:55], v[96:99], a[128:131], v[52:55]
    ds_read_b128 v[84:87], v5 offset:12288
    v_mfma_f32_16x16x32_bf16 v[56:59], v[96:99], a[132:135], v[56:59]
    s_waitcnt lgkmcnt(2)
    v_mfma_f32_16x16x32_bf16 v[36:39], v[76:79], a[120:123], v[36:39]
    s_barrier
    v_mfma_f32_16x16x32_bf16 v[40:43], v[76:79], a[124:127], v[40:43]
    ds_read_b128 v[88:91], v1 offset:12800
    buffer_load_dwordx4 a[136:139], v1, s[4:7], s68 offen offset:1024
    s_waitcnt lgkmcnt(2)
    v_mfma_f32_16x16x32_bf16 v[44:47], v[80:83], a[120:123], v[44:47]
    ds_read_b128 v[92:95], v1 offset:13824
    v_mfma_f32_16x16x32_bf16 v[48:51], v[80:83], a[124:127], v[48:51]
    ds_read_b128 v[96:99], v5 offset:14848
    s_waitcnt lgkmcnt(3)
    v_mfma_f32_16x16x32_bf16 v[52:55], v[84:87], a[120:123], v[52:55]
    buffer_load_dwordx4 a[132:135], v1, s[4:7], s68 offen offset:2048
    v_mfma_f32_16x16x32_bf16 v[56:59], v[84:87], a[124:127], v[56:59]
    s_waitcnt lgkmcnt(2)
    v_mfma_f32_16x16x32_bf16 v[36:39], v[88:91], a[112:115], v[36:39]
    ds_read_b128 v[76:79], v1 offset:15360
    v_mfma_f32_16x16x32_bf16 v[40:43], v[88:91], a[116:119], v[40:43]
    buffer_load_dwordx4 a[128:131], v1, s[4:7], s68 offen offset:3072
    s_waitcnt lgkmcnt(2)
    v_mfma_f32_16x16x32_bf16 v[44:47], v[92:95], a[112:115], v[44:47]
    ds_read_b128 v[80:83], v1 offset:16384
    v_mfma_f32_16x16x32_bf16 v[48:51], v[92:95], a[116:119], v[48:51]
    s_waitcnt lgkmcnt(2)
    v_mfma_f32_16x16x32_bf16 v[52:55], v[96:99], a[112:115], v[52:55]
    ds_read_b128 v[84:87], v5 offset:17408
    s_add_u32 s68, s27, 8192
    buffer_load_dwordx4 a[124:127], v1, s[4:7], s68 offen offset:0
    v_mfma_f32_16x16x32_bf16 v[56:59], v[96:99], a[116:119], v[56:59]
    s_waitcnt lgkmcnt(2)
    v_mfma_f32_16x16x32_bf16 v[36:39], v[76:79], a[104:107], v[36:39]
    ds_read_b128 v[88:91], v1 offset:17920
    v_mfma_f32_16x16x32_bf16 v[40:43], v[76:79], a[108:111], v[40:43]
    s_waitcnt lgkmcnt(2)
    v_mfma_f32_16x16x32_bf16 v[44:47], v[80:83], a[104:107], v[44:47]
    ds_read_b128 v[92:95], v1 offset:18944
    buffer_load_dwordx4 a[120:123], v1, s[4:7], s68 offen offset:1024
    v_mfma_f32_16x16x32_bf16 v[48:51], v[80:83], a[108:111], v[48:51]
    s_waitcnt lgkmcnt(2)
    v_mfma_f32_16x16x32_bf16 v[52:55], v[84:87], a[104:107], v[52:55]
    ds_read_b128 v[96:99], v5 offset:19968
    v_mfma_f32_16x16x32_bf16 v[56:59], v[84:87], a[108:111], v[56:59]
    s_waitcnt lgkmcnt(2)
    v_mfma_f32_16x16x32_bf16 v[36:39], v[88:91], a[96:99], v[36:39]
    ds_read_b128 v[76:79], v1 offset:20480
    v_mfma_f32_16x16x32_bf16 v[40:43], v[88:91], a[100:103], v[40:43]
    buffer_load_dwordx4 a[116:119], v1, s[4:7], s68 offen offset:2048
    s_waitcnt lgkmcnt(2)
    v_mfma_f32_16x16x32_bf16 v[44:47], v[92:95], a[96:99], v[44:47]
    ds_read_b128 v[80:83], v1 offset:21504
    v_mfma_f32_16x16x32_bf16 v[48:51], v[92:95], a[100:103], v[48:51]
    s_waitcnt lgkmcnt(2)
    v_mfma_f32_16x16x32_bf16 v[52:55], v[96:99], a[96:99], v[52:55]
    ds_read_b128 v[84:87], v5 offset:22528
    buffer_load_dwordx4 a[112:115], v1, s[4:7], s68 offen offset:3072
    v_mfma_f32_16x16x32_bf16 v[56:59], v[96:99], a[100:103], v[56:59]
    s_waitcnt lgkmcnt(2)
    v_mfma_f32_16x16x32_bf16 v[36:39], v[76:79], a[88:91], v[36:39]
    ds_read_b128 v[88:91], v1 offset:23040
    v_mfma_f32_16x16x32_bf16 v[40:43], v[76:79], a[92:95], v[40:43]
    s_add_u32 s68, s27, 12288
    buffer_load_dwordx4 a[108:111], v1, s[4:7], s68 offen offset:0
    s_waitcnt lgkmcnt(2)
    v_mfma_f32_16x16x32_bf16 v[44:47], v[80:83], a[88:91], v[44:47]
    ds_read_b128 v[92:95], v1 offset:24064
    v_mfma_f32_16x16x32_bf16 v[48:51], v[80:83], a[92:95], v[48:51]
    s_waitcnt lgkmcnt(2)
    v_mfma_f32_16x16x32_bf16 v[52:55], v[84:87], a[88:91], v[52:55]
    ds_read_b128 v[96:99], v5 offset:25088
    buffer_load_dwordx4 a[104:107], v1, s[4:7], s68 offen offset:1024
    v_mfma_f32_16x16x32_bf16 v[56:59], v[84:87], a[92:95], v[56:59]
    s_waitcnt lgkmcnt(2)
    v_mfma_f32_16x16x32_bf16 v[36:39], v[88:91], a[80:83], v[36:39]
    ds_read_b128 v[76:79], v1 offset:25600
    v_mfma_f32_16x16x32_bf16 v[40:43], v[88:91], a[84:87], v[40:43]
    s_waitcnt lgkmcnt(2)
    v_mfma_f32_16x16x32_bf16 v[44:47], v[92:95], a[80:83], v[44:47]
    ds_read_b128 v[80:83], v1 offset:26624
    buffer_load_dwordx4 a[100:103], v1, s[4:7], s68 offen offset:2048
    v_mfma_f32_16x16x32_bf16 v[48:51], v[92:95], a[84:87], v[48:51]
    s_waitcnt lgkmcnt(2)
    v_mfma_f32_16x16x32_bf16 v[52:55], v[96:99], a[80:83], v[52:55]
    ds_read_b128 v[84:87], v5 offset:27648
    v_mfma_f32_16x16x32_bf16 v[56:59], v[96:99], a[84:87], v[56:59]
    s_waitcnt lgkmcnt(2)
    v_mfma_f32_16x16x32_bf16 v[36:39], v[76:79], a[72:75], v[36:39]
    ds_read_b128 v[88:91], v1 offset:28160
    v_mfma_f32_16x16x32_bf16 v[40:43], v[76:79], a[76:79], v[40:43]
    buffer_load_dwordx4 a[96:99], v1, s[4:7], s68 offen offset:3072
    s_waitcnt lgkmcnt(2)
    v_mfma_f32_16x16x32_bf16 v[44:47], v[80:83], a[72:75], v[44:47]
    ds_read_b128 v[92:95], v1 offset:29184
    v_mfma_f32_16x16x32_bf16 v[48:51], v[80:83], a[76:79], v[48:51]
    s_waitcnt lgkmcnt(2)
    v_mfma_f32_16x16x32_bf16 v[52:55], v[84:87], a[72:75], v[52:55]
    ds_read_b128 v[96:99], v5 offset:30208
    s_add_u32 s68, s27, 16384
    buffer_load_dwordx4 a[92:95], v1, s[4:7], s68 offen offset:0
    v_mfma_f32_16x16x32_bf16 v[56:59], v[84:87], a[76:79], v[56:59]
    s_waitcnt lgkmcnt(2)
    v_mfma_f32_16x16x32_bf16 v[36:39], v[88:91], a[64:67], v[36:39]
    ds_read_b128 v[76:79], v1 offset:30720
    v_mfma_f32_16x16x32_bf16 v[40:43], v[88:91], a[68:71], v[40:43]
    buffer_load_dwordx4 a[88:91], v1, s[4:7], s68 offen offset:1024
    s_waitcnt lgkmcnt(2)
    v_mfma_f32_16x16x32_bf16 v[44:47], v[92:95], a[64:67], v[44:47]
    ds_read_b128 v[80:83], v1 offset:31744
    v_mfma_f32_16x16x32_bf16 v[48:51], v[92:95], a[68:71], v[48:51]
    s_waitcnt lgkmcnt(2)
    v_mfma_f32_16x16x32_bf16 v[52:55], v[96:99], a[64:67], v[52:55]
    ds_read_b128 v[84:87], v5 offset:32768
    buffer_load_dwordx4 a[84:87], v1, s[4:7], s68 offen offset:2048
    v_mfma_f32_16x16x32_bf16 v[56:59], v[96:99], a[68:71], v[56:59]
    s_waitcnt lgkmcnt(2)
    v_mfma_f32_16x16x32_bf16 v[36:39], v[76:79], a[56:59], v[36:39]
    ds_read_b128 v[88:91], v1 offset:33280
    v_mfma_f32_16x16x32_bf16 v[40:43], v[76:79], a[60:63], v[40:43]
    buffer_load_dwordx4 a[80:83], v1, s[4:7], s68 offen offset:3072
    s_waitcnt lgkmcnt(2)
    v_mfma_f32_16x16x32_bf16 v[44:47], v[80:83], a[56:59], v[44:47]
    ds_read_b128 v[92:95], v1 offset:34304
    v_mfma_f32_16x16x32_bf16 v[48:51], v[80:83], a[60:63], v[48:51]
    s_waitcnt lgkmcnt(2)
    v_mfma_f32_16x16x32_bf16 v[52:55], v[84:87], a[56:59], v[52:55]
    ds_read_b128 v[96:99], v5 offset:35328
    s_add_u32 s89, s97, s26
    s_add_u32 s88, s97, 92160
    s_add_u32 s89, s89, 20480
    s_mov_b32 m0, s88
    s_nop 0
    buffer_load_dwordx4 v1, s[4:7], s89 offen offset:0 lds
    v_mfma_f32_16x16x32_bf16 v[56:59], v[84:87], a[60:63], v[56:59]
    s_waitcnt lgkmcnt(2)
    v_mfma_f32_16x16x32_bf16 v[36:39], v[88:91], a[48:51], v[36:39]
    ds_read_b128 v[76:79], v1 offset:35840
    s_add_u32 s68, s27, 20480
    buffer_load_dwordx4 v[116:119], v1, s[4:7], s68 offen offset:0
    v_mfma_f32_16x16x32_bf16 v[40:43], v[88:91], a[52:55], v[40:43]
    s_waitcnt lgkmcnt(2)
    v_mfma_f32_16x16x32_bf16 v[44:47], v[92:95], a[48:51], v[44:47]
    ds_read_b128 v[80:83], v1 offset:36864
    buffer_load_dwordx4 v[120:123], v1, s[4:7], s68 offen offset:1024
    v_mfma_f32_16x16x32_bf16 v[48:51], v[92:95], a[52:55], v[48:51]
    s_waitcnt lgkmcnt(2)
    v_mfma_f32_16x16x32_bf16 v[52:55], v[96:99], a[48:51], v[52:55]
    ds_read_b128 v[84:87], v5 offset:37888
    buffer_load_dwordx4 v1, s[4:7], s89 offen offset:1024 lds
    v_mfma_f32_16x16x32_bf16 v[56:59], v[96:99], a[52:55], v[56:59]
    s_waitcnt lgkmcnt(2)
    v_mfma_f32_16x16x32_bf16 v[36:39], v[76:79], a[40:43], v[36:39]
    ds_read_b128 v[88:91], v1 offset:38400
    v_mfma_f32_16x16x32_bf16 v[40:43], v[76:79], a[44:47], v[40:43]
    buffer_load_dwordx4 v[124:127], v1, s[4:7], s68 offen offset:2048
    s_waitcnt lgkmcnt(2)
    v_mfma_f32_16x16x32_bf16 v[44:47], v[80:83], a[40:43], v[44:47]
    ds_read_b128 v[92:95], v1 offset:39424
    v_mfma_f32_16x16x32_bf16 v[48:51], v[80:83], a[44:47], v[48:51]
    s_waitcnt lgkmcnt(2)
    v_mfma_f32_16x16x32_bf16 v[52:55], v[84:87], a[40:43], v[52:55]
    ds_read_b128 v[96:99], v5 offset:40448
    buffer_load_dwordx4 v[128:131], v1, s[4:7], s68 offen offset:3072
    v_mfma_f32_16x16x32_bf16 v[56:59], v[84:87], a[44:47], v[56:59]
    s_waitcnt lgkmcnt(2)
    v_mfma_f32_16x16x32_bf16 v[36:39], v[88:91], a[32:35], v[36:39]
    ds_read_b128 v[76:79], v1 offset:40960
    v_mfma_f32_16x16x32_bf16 v[40:43], v[88:91], a[36:39], v[40:43]
    s_add_u32 s68, s27, 24576
    buffer_load_dwordx4 v[164:167], v1, s[4:7], s68 offen offset:0
    s_waitcnt lgkmcnt(2)
    v_mfma_f32_16x16x32_bf16 v[44:47], v[92:95], a[32:35], v[44:47]
    ds_read_b128 v[80:83], v1 offset:41984
    v_mfma_f32_16x16x32_bf16 v[48:51], v[92:95], a[36:39], v[48:51]
    s_waitcnt lgkmcnt(2)
    v_mfma_f32_16x16x32_bf16 v[52:55], v[96:99], a[32:35], v[52:55]
    ds_read_b128 v[84:87], v5 offset:43008
    buffer_load_dwordx4 v1, s[4:7], s89 offen offset:2048 lds
    v_mfma_f32_16x16x32_bf16 v[56:59], v[96:99], a[36:39], v[56:59]
    s_waitcnt lgkmcnt(2)
    v_mfma_f32_16x16x32_bf16 v[36:39], v[76:79], a[24:27], v[36:39]
    ds_read_b128 v[88:91], v1 offset:43520
    v_mfma_f32_16x16x32_bf16 v[40:43], v[76:79], a[28:31], v[40:43]
    s_waitcnt lgkmcnt(2)
    v_mfma_f32_16x16x32_bf16 v[44:47], v[80:83], a[24:27], v[44:47]
    ds_read_b128 v[92:95], v1 offset:44544
    buffer_load_dwordx4 v1, s[4:7], s89 offen offset:3072 lds
    v_mfma_f32_16x16x32_bf16 v[48:51], v[80:83], a[28:31], v[48:51]
    s_waitcnt lgkmcnt(2)
    v_mfma_f32_16x16x32_bf16 v[52:55], v[84:87], a[24:27], v[52:55]
    ds_read_b128 v[96:99], v5 offset:45568
    v_mfma_f32_16x16x32_bf16 v[56:59], v[84:87], a[28:31], v[56:59]
    s_waitcnt lgkmcnt(2)
    v_mfma_f32_16x16x32_bf16 v[36:39], v[88:91], a[16:19], v[36:39]
    ds_read_b128 v[76:79], v1 offset:46080
    v_mfma_f32_16x16x32_bf16 v[40:43], v[88:91], a[20:23], v[40:43]
    s_waitcnt lgkmcnt(2)
    v_mfma_f32_16x16x32_bf16 v[44:47], v[92:95], a[16:19], v[44:47]
    ds_read_b128 v[80:83], v1 offset:47104
    v_mfma_f32_16x16x32_bf16 v[48:51], v[92:95], a[20:23], v[48:51]
    s_waitcnt lgkmcnt(2)
    v_mfma_f32_16x16x32_bf16 v[52:55], v[96:99], a[16:19], v[52:55]
    ds_read_b128 v[84:87], v5 offset:48128
    v_mfma_f32_16x16x32_bf16 v[56:59], v[96:99], a[20:23], v[56:59]
    s_waitcnt lgkmcnt(2)
    v_mfma_f32_16x16x32_bf16 v[36:39], v[76:79], a[8:11], v[36:39]
    ds_read_b128 v[88:91], v1 offset:48640
    v_mfma_f32_16x16x32_bf16 v[40:43], v[76:79], a[12:15], v[40:43]
    s_waitcnt lgkmcnt(2)
    v_mfma_f32_16x16x32_bf16 v[44:47], v[80:83], a[8:11], v[44:47]
    ds_read_b128 v[92:95], v1 offset:49664
    s_add_u32 s89, s97, s26
    s_add_u32 s88, s97, 108544
    s_add_u32 s89, s89, 36864
    s_mov_b32 m0, s88
    s_nop 0
    buffer_load_dwordx4 v1, s[4:7], s89 offen offset:0 lds
    v_mfma_f32_16x16x32_bf16 v[48:51], v[80:83], a[12:15], v[48:51]
    s_waitcnt lgkmcnt(2)
    v_mfma_f32_16x16x32_bf16 v[52:55], v[84:87], a[8:11], v[52:55]
    ds_read_b128 v[96:99], v5 offset:50688
    v_mfma_f32_16x16x32_bf16 v[56:59], v[84:87], a[12:15], v[56:59]
    s_waitcnt lgkmcnt(2)
    v_mfma_f32_16x16x32_bf16 v[36:39], v[88:91], a[0:3], v[36:39]
    ds_read_b128 v[76:79], v12 offset:320
    ds_read_b128 v[80:83], v12 offset:384
    v_mfma_f32_16x16x32_bf16 v[40:43], v[88:91], a[4:7], v[40:43]
    ds_read_b128 v[84:87], v12 offset:448
    s_waitcnt lgkmcnt(4)
    v_mfma_f32_16x16x32_bf16 v[44:47], v[92:95], a[0:3], v[44:47]
    v_mov_b32 v103, 0
    v_mov_b32 v107, 0
    v_mfma_f32_16x16x32_bf16 v[48:51], v[92:95], a[4:7], v[48:51]
    v_mov_b32 v111, 0
    s_waitcnt lgkmcnt(3)
    v_mfma_f32_16x16x32_bf16 v[52:55], v[96:99], a[0:3], v[52:55]
    v_mov_b32 v115, 0
    v_mov_b32 v65, 0
    v_mfma_f32_16x16x32_bf16 v[56:59], v[96:99], a[4:7], v[56:59]
    v_mov_b32 v71, 0
    s_barrier
    buffer_load_dwordx4 v[144:147], v1, s[4:7], s46 offen offset:0 sc1
    buffer_load_dwordx4 v[148:151], v1, s[4:7], s46 offen offset:1024 sc1
    buffer_load_dwordx4 v[152:155], v1, s[4:7], s46 offen offset:2048 sc1
    buffer_load_dwordx4 v[156:159], v1, s[4:7], s46 offen offset:3072 sc1
    buffer_load_dwordx4 v[160:163], v26, s[4:7], s46 offen offset:0 sc1
    buffer_load_dwordx4 v1, s[4:7], s89 offen offset:1024 lds
    buffer_load_dwordx4 v1, s[4:7], s89 offen offset:2048 lds
    buffer_load_dwordx4 v1, s[4:7], s89 offen offset:3072 lds
    s_add_u32 s89, s97, s26
    s_add_u32 s88, s97, 124928
    s_add_u32 s89, s89, 53248
    s_mov_b32 m0, s88
    s_nop 0
    buffer_load_dwordx4 v1, s[4:7], s89 offen offset:0 lds
    v_mov_b32 v143, 3049365963
    s_waitcnt lgkmcnt(2)
    v_pk_fma_f32 v[136:137], v[76:77], v[134:135], s[76:77] op_sel:[0,0,0] op_sel_hi:[1,0,1]
    v_pk_fma_f32 v[72:73], v[76:77], v[134:135], s[76:77] op_sel:[0,1,0] op_sel_hi:[1,1,1]
    v_pk_fma_f32 v[138:139], v[78:79], v[134:135], s[76:77] op_sel:[0,0,0] op_sel_hi:[1,0,1]
    v_pk_fma_f32 v[74:75], v[78:79], v[134:135], s[76:77] op_sel:[0,1,0] op_sel_hi:[1,1,1]
    v_pk_fma_f32 v[36:37], v[36:37], v[132:133], v[136:137] op_sel:[0,0,0] op_sel_hi:[1,0,1]
    v_pk_fma_f32 v[40:41], v[40:41], v[132:133], v[72:73] op_sel:[0,1,0] op_sel_hi:[1,1,1]
    v_pk_fma_f32 v[38:39], v[38:39], v[132:133], v[138:139] op_sel:[0,0,0] op_sel_hi:[1,0,1]
    v_pk_fma_f32 v[42:43], v[42:43], v[132:133], v[74:75] op_sel:[0,1,0] op_sel_hi:[1,1,1]
    v_pk_fma_f32 v[136:137], v[36:37], s[78:79], v[142:143] op_sel:[0,0,1] op_sel_hi:[1,1,1]
    v_pk_fma_f32 v[72:73], v[40:41], s[78:79], v[142:143] op_sel:[0,0,1] op_sel_hi:[1,1,1]
    v_pk_fma_f32 v[138:139], v[38:39], s[78:79], v[142:143] op_sel:[0,0,1] op_sel_hi:[1,1,1]
    v_pk_fma_f32 v[74:75], v[42:43], s[78:79], v[142:143] op_sel:[0,0,1] op_sel_hi:[1,1,1]
    v_exp_f32_e64 v136, v136 clamp
    v_exp_f32_e64 v72, v72 clamp
    v_exp_f32_e64 v137, v137 clamp
    v_exp_f32_e64 v73, v73 clamp
    v_exp_f32_e64 v138, v138 clamp
    v_exp_f32_e64 v74, v74 clamp
    v_exp_f32_e64 v139, v139 clamp
    v_exp_f32_e64 v75, v75 clamp
    v_max_f32 v36, s76, v36
    v_max_f32 v40, s76, v40
    v_max_f32 v37, s76, v37
    v_max_f32 v41, s76, v41
    v_max_f32 v38, s76, v38
    v_max_f32 v42, s76, v42
    v_max_f32 v39, s76, v39
    v_max_f32_e64 v43, s76, v43
    v_pk_add_f32 v[36:37], v[36:37], v[136:137] op_sel:[0,0] op_sel_hi:[1,1]
    v_pk_add_f32 v[40:41], v[40:41], v[72:73] op_sel:[0,0] op_sel_hi:[1,1]
    v_pk_add_f32 v[38:39], v[38:39], v[138:139] op_sel:[0,0] op_sel_hi:[1,1]
    v_pk_add_f32 v[42:43], v[42:43], v[74:75] op_sel:[0,0] op_sel_hi:[1,1]
    v_cvt_pk_bf16_f32 v60, v36, v37
    v_cvt_pk_bf16_f32 v66, v40, v41
    v_cvt_pk_bf16_f32 v61, v38, v39
    v_cvt_pk_bf16_f32 v67, v42, v43
    s_waitcnt lgkmcnt(1)
    v_pk_fma_f32 v[136:137], v[80:81], v[134:135], s[76:77] op_sel:[0,0,0] op_sel_hi:[1,0,1]
    v_pk_fma_f32 v[72:73], v[80:81], v[134:135], s[76:77] op_sel:[0,1,0] op_sel_hi:[1,1,1]
    v_pk_fma_f32 v[138:139], v[82:83], v[134:135], s[76:77] op_sel:[0,0,0] op_sel_hi:[1,0,1]
    v_pk_fma_f32 v[74:75], v[82:83], v[134:135], s[76:77] op_sel:[0,1,0] op_sel_hi:[1,1,1]
    v_pk_fma_f32 v[44:45], v[44:45], v[132:133], v[136:137] op_sel:[0,0,0] op_sel_hi:[1,0,1]
    v_pk_fma_f32 v[48:49], v[48:49], v[132:133], v[72:73] op_sel:[0,1,0] op_sel_hi:[1,1,1]
    v_pk_fma_f32 v[46:47], v[46:47], v[132:133], v[138:139] op_sel:[0,0,0] op_sel_hi:[1,0,1]
    v_pk_fma_f32 v[50:51], v[50:51], v[132:133], v[74:75] op_sel:[0,1,0] op_sel_hi:[1,1,1]
    v_pk_fma_f32 v[136:137], v[44:45], s[78:79], v[142:143] op_sel:[0,0,1] op_sel_hi:[1,1,1]
    v_pk_fma_f32 v[72:73], v[48:49], s[78:79], v[142:143] op_sel:[0,0,1] op_sel_hi:[1,1,1]
    v_pk_fma_f32 v[138:139], v[46:47], s[78:79], v[142:143] op_sel:[0,0,1] op_sel_hi:[1,1,1]
    v_pk_fma_f32 v[74:75], v[50:51], s[78:79], v[142:143] op_sel:[0,0,1] op_sel_hi:[1,1,1]
    v_exp_f32_e64 v136, v136 clamp
    v_exp_f32_e64 v72, v72 clamp
    v_exp_f32_e64 v137, v137 clamp
    v_exp_f32_e64 v73, v73 clamp
    v_exp_f32_e64 v138, v138 clamp
    v_exp_f32_e64 v74, v74 clamp
    v_exp_f32_e64 v139, v139 clamp
    v_exp_f32_e64 v75, v75 clamp
    v_max_f32 v44, s76, v44
    v_max_f32 v48, s76, v48
    v_max_f32 v45, s76, v45
    v_max_f32 v49, s76, v49
    v_max_f32 v46, s76, v46
    v_max_f32 v50, s76, v50
    v_max_f32 v47, s76, v47
    v_max_f32_e64 v51, s76, v51
    v_pk_add_f32 v[44:45], v[44:45], v[136:137] op_sel:[0,0] op_sel_hi:[1,1]
    v_pk_add_f32 v[48:49], v[48:49], v[72:73] op_sel:[0,0] op_sel_hi:[1,1]
    v_pk_add_f32 v[46:47], v[46:47], v[138:139] op_sel:[0,0] op_sel_hi:[1,1]
    v_pk_add_f32 v[50:51], v[50:51], v[74:75] op_sel:[0,0] op_sel_hi:[1,1]
    v_cvt_pk_bf16_f32 v63, v44, v45
    v_cvt_pk_bf16_f32 v69, v48, v49
    v_cvt_pk_bf16_f32 v64, v46, v47
    v_cvt_pk_bf16_f32 v70, v50, v51
    s_waitcnt lgkmcnt(0)
    v_pk_fma_f32 v[136:137], v[84:85], v[134:135], s[76:77] op_sel:[0,0,0] op_sel_hi:[1,0,1]
    v_pk_fma_f32 v[72:73], v[84:85], v[134:135], s[76:77] op_sel:[0,1,0] op_sel_hi:[1,1,1]
    v_pk_fma_f32 v[52:53], v[52:53], v[132:133], v[136:137] op_sel:[0,0,0] op_sel_hi:[1,0,1]
    v_pk_fma_f32 v[56:57], v[56:57], v[132:133], v[72:73] op_sel:[0,1,0] op_sel_hi:[1,1,1]
    v_pk_fma_f32 v[136:137], v[52:53], s[78:79], v[142:143] op_sel:[0,0,1] op_sel_hi:[1,1,1]
    v_pk_fma_f32 v[72:73], v[56:57], s[78:79], v[142:143] op_sel:[0,0,1] op_sel_hi:[1,1,1]
    v_exp_f32_e64 v136, v136 clamp
    v_exp_f32_e64 v72, v72 clamp
    v_exp_f32_e64 v137, v137 clamp
    v_exp_f32_e64 v73, v73 clamp
    v_max_f32 v52, s76, v52
    v_max_f32 v56, s76, v56
    v_max_f32 v53, s76, v53
    v_max_f32_e64 v57, s76, v57
    v_pk_add_f32 v[52:53], v[52:53], v[136:137] op_sel:[0,0] op_sel_hi:[1,1]
    v_pk_add_f32 v[56:57], v[56:57], v[72:73] op_sel:[0,0] op_sel_hi:[1,1]
    v_cvt_pk_bf16_f32 v62, v52, v53
    v_cvt_pk_bf16_f32 v68, v56, v57
    s_mov_b32 s52, 0x41800000
    s_waitcnt vmcnt(7)
    v_min_f32 v136, v147, v151
    s_waitcnt vmcnt(5)
    v_min3_f32 v136, v136, v155, v159
    s_waitcnt vmcnt(4)
    v_min_f32 v136, v136, v163
    v_cmp_gt_f32 vcc, s52, v136
    s_nop 1
    s_cbranch_vccz L_ok_28
    s_mov_b32 s60, 0
L_lp_27:
    s_sleep 4
    buffer_load_dwordx4 v[144:147], v1, s[4:7], s46 offen offset:0 sc1
    buffer_load_dwordx4 v[148:151], v1, s[4:7], s46 offen offset:1024 sc1
    buffer_load_dwordx4 v[152:155], v1, s[4:7], s46 offen offset:2048 sc1
    buffer_load_dwordx4 v[156:159], v1, s[4:7], s46 offen offset:3072 sc1
    buffer_load_dwordx4 v[160:163], v26, s[4:7], s46 offen offset:0 sc1
    s_add_u32 s60, s60, 1
    s_cmp_gt_u32 s60, 0x40000
    s_cbranch_scc1 L_abort
    s_waitcnt vmcnt(0)
    v_min_f32 v136, v147, v151
    v_min3_f32 v136, v136, v155, v159
    v_min_f32 v136, v136, v163
    v_cmp_gt_f32 vcc, s52, v136
    s_nop 1
    s_cbranch_vccnz L_lp_27
L_ok_28:
    v_cvt_pk_bf16_f32 v72, v157, v158
    v_cvt_pk_bf16_f32 v73, v160, v161
    v_cvt_pk_bf16_f32 v74, v162, 0
    v_cvt_pk_bf16_f32 v75, 0, v162
    v_cndmask_b32 v108, v72, 0, s[48:49]
    v_cndmask_b32 v109, v73, 0, s[48:49]
    v_cndmask_b32 v110, v74, 0, s[48:49]
    v_cndmask_b32 v112, 0, v75, s[48:49]
    v_cndmask_b32 v113, 0, v72, s[48:49]
    v_cndmask_b32 v114, 0, v73, s[48:49]
    v_cvt_pk_bf16_f32 v100, v144, v145
    v_mfma_f32_16x16x32_bf16 v[84:87], v[108:111], v[60:63], 0
    v_cvt_pk_bf16_f32 v101, v146, v148
    v_cvt_pk_bf16_f32 v102, v149, 0
    v_mfma_f32_16x16x32_bf16 v[96:99], v[108:111], v[66:69], 0
    v_cvt_pk_bf16_f32 v104, 0, v156
    v_cvt_pk_bf16_f32 v105, v150, v152
    v_mfma_f32_16x16x32_bf16 v[84:87], v[112:115], v[62:65], v[84:87]
    v_cvt_pk_bf16_f32 v106, v153, v154
    v_mfma_f32_16x16x32_bf16 v[96:99], v[112:115], v[68:71], v[96:99]
    v_mfma_f32_16x16x32_bf16 v[76:79], v[100:103], v[60:63], 0
    v_mfma_f32_16x16x32_bf16 v[80:83], v[104:107], v[62:65], 0
    v_mfma_f32_16x16x32_bf16 v[88:91], v[100:103], v[66:69], 0
    v_mfma_f32_16x16x32_bf16 v[92:95], v[104:107], v[68:71], 0
    s_nop 1
    v_pk_add_f32 v[84:85], v[84:85], s[76:77] op_sel:[0,0] op_sel_hi:[1,1]
    v_rcp_f32 v84, v84
    v_rcp_f32_e64 v85, v85
    v_pk_add_f32 v[96:97], v[96:97], s[76:77] op_sel:[0,0] op_sel_hi:[1,1]
    v_rcp_f32 v96, v96
    v_rcp_f32 v97, v97
    v_pk_mul_f32 v[86:87], v[86:87], v[84:85] op_sel:[0,0] op_sel_hi:[1,1]
    v_pk_mul_f32 v[76:77], v[76:77], v[84:85] op_sel:[0,0] op_sel_hi:[1,0]
    v_pk_mul_f32 v[78:79], v[78:79], v[84:85] op_sel:[0,0] op_sel_hi:[1,0]
    v_pk_mul_f32 v[80:81], v[80:81], v[84:85] op_sel:[0,1] op_sel_hi:[1,1]
    v_pk_mul_f32 v[82:83], v[82:83], v[84:85] op_sel:[0,1] op_sel_hi:[1,1]
    v_cvt_pk_bf16_f32 v40, v86, v87
    v_cvt_pk_bf16_f32 v36, v76, v77
    v_cvt_pk_bf16_f32 v37, v78, v79
    v_cvt_pk_bf16_f32 v38, v80, v81
    v_cvt_pk_bf16_f32 v39, v82, v83
    buffer_store_dwordx4 v[36:39], v1, s[4:7], s29 offen
    buffer_store_dword v40, v27, s[4:7], s29 offen
    v_pk_mul_f32 v[98:99], v[98:99], v[96:97] op_sel:[0,0] op_sel_hi:[1,1]
    v_pk_mul_f32 v[88:89], v[88:89], v[96:97] op_sel:[0,0] op_sel_hi:[1,0]
    v_pk_mul_f32 v[90:91], v[90:91], v[96:97] op_sel:[0,0] op_sel_hi:[1,0]
    v_pk_mul_f32 v[92:93], v[92:93], v[96:97] op_sel:[0,1] op_sel_hi:[1,1]
    v_pk_mul_f32 v[94:95], v[94:95], v[96:97] op_sel:[0,1] op_sel_hi:[1,1]
    v_cvt_pk_bf16_f32 v46, v98, v99
    v_cvt_pk_bf16_f32 v42, v88, v89
    v_cvt_pk_bf16_f32 v43, v90, v91
    v_cvt_pk_bf16_f32 v44, v92, v93
    v_cvt_pk_bf16_f32 v45, v94, v95
    buffer_store_dwordx4 v[42:45], v1, s[4:7], s30 offen
    buffer_store_dword v46, v27, s[4:7], s30 offen
    s_add_u32 s46, s46, 81920
    s_add_u32 s47, s47, 81920
    s_add_u32 s52, s39, 2
    v_mov_b32 v15, s52
    s_waitcnt vmcnt(0)
    s_mov_b64 exec, 1
    buffer_store_dword v15, off, s[4:7], s42
    s_mov_b64 exec, -1
    v_lshlrev_b32 v96, 16, v16
    v_and_b32 v97, 0xffff0000, v16
    v_lshlrev_b32_e64 v98, 16, v17
    v_and_b32 v99, 0xffff0000, v17
    v_lshlrev_b32_e64 v100, 16, v18
    v_and_b32 v101, 0xffff0000, v18
    v_lshlrev_b32_e64 v102, 16, v19
    v_and_b32 v103, 0xffff0000, v19
    v_lshlrev_b32_e64 v104, 16, v20
    v_and_b32 v105, 0xffff0000, v20
    v_lshlrev_b32_e64 v106, 16, v21
    v_and_b32 v107, 0xffff0000, v21
    v_lshlrev_b32_e64 v108, 16, v22
    v_and_b32 v109, 0xffff0000, v22
    v_lshlrev_b32_e64 v110, 16, v23
    v_and_b32 v111, 0xffff0000, v23
    v_lshlrev_b32_e64 v112, 16, v24
    v_and_b32 v113, 0xffff0000, v24
    v_lshlrev_b32_e64 v114, 16, v25
    v_and_b32 v115, 0xffff0000, v25
    v_and_b32 v15, 31, v2
    s_mov_b32 s60, 0
    s_add_u32 s52, s39, 2
L_poll_29:
    buffer_load_dword v14, v15, s[4:7], s43 offen sc1
    s_add_u32 s60, s60, 1
    s_cmp_gt_u32 s60, 0x40000
    s_cbranch_scc1 L_abort
    s_waitcnt vmcnt(0)
    v_cmp_ne_u32 vcc, s52, v14
    s_nop 1
    s_cbranch_vccnz L_poll_29
    buffer_load_dwordx4 a[0:3], v1, s[4:7], s31 offen offset:0 sc1
    buffer_load_dwordx4 a[4:7], v1, s[4:7], s31 offen offset:1024 sc1
    buffer_load_dwordx4 a[8:11], v1, s[4:7], s31 offen offset:2048 sc1
    buffer_load_dwordx4 a[12:15], v1, s[4:7], s31 offen offset:3072 sc1
    buffer_load_dwordx4 a[16:19], v26, s[4:7], s31 offen offset:0 sc1
    buffer_load_dwordx4 a[20:23], v1, s[4:7], s32 offen offset:0 sc1
    s_waitcnt vmcnt(5)
    v_mfma_f32_16x16x32_bf16 v[36:39], a[156:159], a[0:3], 0
    buffer_load_dwordx4 a[24:27], v1, s[4:7], s32 offen offset:1024 sc1
    v_mfma_f32_16x16x32_bf16 v[40:43], a[152:155], a[0:3], 0
    v_mfma_f32_16x16x32_bf16 v[52:55], a[140:143], a[0:3], 0
    buffer_load_dwordx4 a[28:31], v1, s[4:7], s32 offen offset:2048 sc1
    s_waitcnt vmcnt(6)
    v_mfma_f32_16x16x32_bf16 v[36:39], a[136:139], a[4:7], v[36:39]
    v_mfma_f32_16x16x32_bf16 v[40:43], a[132:135], a[4:7], v[40:43]
    buffer_load_dwordx4 a[32:35], v1, s[4:7], s32 offen offset:3072 sc1
    v_mfma_f32_16x16x32_bf16 v[52:55], a[120:123], a[4:7], v[52:55]
    s_waitcnt vmcnt(6)
    v_mfma_f32_16x16x32_bf16 v[36:39], a[116:119], a[8:11], v[36:39]
    v_mfma_f32_16x16x32_bf16 v[40:43], a[112:115], a[8:11], v[40:43]
    buffer_load_dwordx4 a[36:39], v26, s[4:7], s32 offen offset:0 sc1
    v_mfma_f32_16x16x32_bf16 v[52:55], a[100:103], a[8:11], v[52:55]
    s_waitcnt vmcnt(6)
    v_mfma_f32_16x16x32_bf16 v[36:39], a[96:99], a[12:15], v[36:39]
    buffer_load_dwordx4 a[40:43], v1, s[4:7], s33 offen offset:0 sc1
    v_mfma_f32_16x16x32_bf16 v[40:43], a[92:95], a[12:15], v[40:43]
    v_mfma_f32_16x16x32_bf16 v[52:55], a[80:83], a[12:15], v[52:55]
    buffer_load_dwordx4 a[44:47], v1, s[4:7], s33 offen offset:1024 sc1
    s_waitcnt vmcnt(7)
    v_mfma_f32_16x16x32_bf16 v[36:39], v[116:119], a[16:19], v[36:39]
    v_mfma_f32_16x16x32_bf16 v[40:43], v[120:123], a[16:19], v[40:43]
    buffer_load_dwordx4 a[48:51], v1, s[4:7], s33 offen offset:2048 sc1
    v_mfma_f32_16x16x32_bf16 v[52:55], v[164:167], a[16:19], v[52:55]
    s_waitcnt vmcnt(7)
    v_mfma_f32_16x16x32_bf16 v[56:59], a[156:159], a[20:23], 0
    buffer_load_dwordx4 a[52:55], v1, s[4:7], s33 offen offset:3072 sc1
    v_mfma_f32_16x16x32_bf16 v[60:63], a[152:155], a[20:23], 0
    v_mfma_f32_16x16x32_bf16 v[72:75], a[140:143], a[20:23], 0
    buffer_load_dwordx4 a[56:59], v26, s[4:7], s33 offen offset:0 sc1
    s_waitcnt vmcnt(8)
    v_mfma_f32_16x16x32_bf16 v[56:59], a[136:139], a[24:27], v[56:59]
    ds_write_b128 v29, v[36:39] offset:0
    v_mfma_f32_16x16x32_bf16 v[60:63], a[132:135], a[24:27], v[60:63]
    buffer_load_dwordx4 a[60:63], v1, s[4:7], s34 offen offset:0 sc1
    v_mfma_f32_16x16x32_bf16 v[72:75], a[120:123], a[24:27], v[72:75]
    s_waitcnt vmcnt(8)
    v_mfma_f32_16x16x32_bf16 v[56:59], a[116:119], a[28:31], v[56:59]
    v_mfma_f32_16x16x32_bf16 v[60:63], a[112:115], a[28:31], v[60:63]
    buffer_load_dwordx4 a[64:67], v1, s[4:7], s34 offen offset:1024 sc1
    ds_write_b128 v29, v[40:43] offset:1024
    v_mfma_f32_16x16x32_bf16 v[72:75], a[100:103], a[28:31], v[72:75]
    s_waitcnt vmcnt(8)
    v_mfma_f32_16x16x32_bf16 v[56:59], a[96:99], a[32:35], v[56:59]
    buffer_load_dwordx4 a[68:71], v1, s[4:7], s34 offen offset:2048 sc1
    v_mfma_f32_16x16x32_bf16 v[60:63], a[92:95], a[32:35], v[60:63]
    v_mfma_f32_16x16x32_bf16 v[72:75], a[80:83], a[32:35], v[72:75]
    buffer_load_dwordx4 a[72:75], v1, s[4:7], s34 offen offset:3072 sc1
    ds_write_b128 v29, v[52:55] offset:4096
    s_waitcnt vmcnt(9)
    v_mfma_f32_16x16x32_bf16 v[56:59], v[116:119], a[36:39], v[56:59]
    v_mfma_f32_16x16x32_bf16 v[60:63], v[120:123], a[36:39], v[60:63]
    buffer_load_dwordx4 a[76:79], v26, s[4:7], s34 offen offset:0 sc1
    v_mfma_f32_16x16x32_bf16 v[72:75], v[164:167], a[36:39], v[72:75]
    s_waitcnt vmcnt(9)
    v_mfma_f32_16x16x32_bf16 v[76:79], a[156:159], a[40:43], 0
    v_mfma_f32_16x16x32_bf16 v[80:83], a[152:155], a[40:43], 0
    v_mfma_f32_16x16x32_bf16 v[92:95], a[140:143], a[40:43], 0
    s_waitcnt vmcnt(8)
    v_mfma_f32_16x16x32_bf16 v[76:79], a[136:139], a[44:47], v[76:79]
    ds_write_b128 v30, v[56:59] offset:0
    v_mfma_f32_16x16x32_bf16 v[80:83], a[132:135], a[44:47], v[80:83]
    v_mfma_f32_16x16x32_bf16 v[92:95], a[120:123], a[44:47], v[92:95]
    s_waitcnt vmcnt(7)
    v_mfma_f32_16x16x32_bf16 v[76:79], a[116:119], a[48:51], v[76:79]
    v_mfma_f32_16x16x32_bf16 v[80:83], a[112:115], a[48:51], v[80:83]
    ds_write_b128 v30, v[60:63] offset:1024
    v_mfma_f32_16x16x32_bf16 v[92:95], a[100:103], a[48:51], v[92:95]
    s_waitcnt vmcnt(6)
    v_mfma_f32_16x16x32_bf16 v[76:79], a[96:99], a[52:55], v[76:79]
    v_mfma_f32_16x16x32_bf16 v[80:83], a[92:95], a[52:55], v[80:83]
    v_mfma_f32_16x16x32_bf16 v[92:95], a[80:83], a[52:55], v[92:95]
    ds_write_b128 v30, v[72:75] offset:4096
    s_waitcnt vmcnt(5)
    v_mfma_f32_16x16x32_bf16 v[76:79], v[116:119], a[56:59], v[76:79]
    v_mfma_f32_16x16x32_bf16 v[80:83], v[120:123], a[56:59], v[80:83]
    v_mfma_f32_16x16x32_bf16 v[92:95], v[164:167], a[56:59], v[92:95]
    s_waitcnt vmcnt(4)
    v_mfma_f32_16x16x32_bf16 v[96:99], a[156:159], a[60:63], v[96:99]
    v_mfma_f32_16x16x32_bf16 v[100:103], a[152:155], a[60:63], v[100:103]
    v_mfma_f32_16x16x32_bf16 v[112:115], a[140:143], a[60:63], v[112:115]
    s_waitcnt vmcnt(3)
    v_mfma_f32_16x16x32_bf16 v[96:99], a[136:139], a[64:67], v[96:99]
    ds_write_b128 v31, v[76:79] offset:0
    v_mfma_f32_16x16x32_bf16 v[100:103], a[132:135], a[64:67], v[100:103]
    v_mfma_f32_16x16x32_bf16 v[112:115], a[120:123], a[64:67], v[112:115]
    s_waitcnt vmcnt(2)
    v_mfma_f32_16x16x32_bf16 v[96:99], a[116:119], a[68:71], v[96:99]
    v_mfma_f32_16x16x32_bf16 v[100:103], a[112:115], a[68:71], v[100:103]
    ds_write_b128 v31, v[80:83] offset:1024
    v_mfma_f32_16x16x32_bf16 v[112:115], a[100:103], a[68:71], v[112:115]
    s_waitcnt vmcnt(1)
    v_mfma_f32_16x16x32_bf16 v[96:99], a[96:99], a[72:75], v[96:99]
    v_mfma_f32_16x16x32_bf16 v[100:103], a[92:95], a[72:75], v[100:103]
    v_mfma_f32_16x16x32_bf16 v[112:115], a[80:83], a[72:75], v[112:115]
    ds_write_b128 v31, v[92:95] offset:4096
    s_waitcnt vmcnt(0)
    v_mfma_f32_16x16x32_bf16 v[96:99], v[116:119], a[76:79], v[96:99]
    v_mfma_f32_16x16x32_bf16 v[100:103], v[120:123], a[76:79], v[100:103]
    v_mfma_f32_16x16x32_bf16 v[112:115], v[164:167], a[76:79], v[112:115]
    v_mfma_f32_16x16x32_bf16 v[44:47], a[148:151], a[0:3], 0
    v_mfma_f32_16x16x32_bf16 v[48:51], a[144:147], a[0:3], 0
    s_mov_b32 m0, s88
    s_nop 0
    buffer_load_dwordx4 v1, s[4:7], s89 offen offset:1024 lds
    v_mfma_f32_16x16x32_bf16 v[44:47], a[128:131], a[4:7], v[44:47]
    s_waitcnt lgkmcnt(0)
    s_barrier
    ds_read_b128 v[36:39], v32 offset:0
    v_mfma_f32_16x16x32_bf16 v[48:51], a[124:127], a[4:7], v[48:51]
    ds_read_b128 v[56:59], v32 offset:5120
    ds_read_b128 v[76:79], v32 offset:10240
    v_mfma_f32_16x16x32_bf16 v[44:47], a[108:111], a[8:11], v[44:47]
    buffer_load_dwordx4 v1, s[4:7], s89 offen offset:2048 lds
    ds_read_b128 v[40:43], v32 offset:1024
    ds_read_b128 v[60:63], v32 offset:6144
    v_mfma_f32_16x16x32_bf16 v[48:51], a[104:107], a[8:11], v[48:51]
    ds_read_b128 v[80:83], v32 offset:11264
    ds_read_b128 v[52:55], v32 offset:4096
    v_mfma_f32_16x16x32_bf16 v[44:47], a[88:91], a[12:15], v[44:47]
    ds_read_b128 v[72:75], v32 offset:9216
    ds_read_b128 v[92:95], v32 offset:14336
    v_mfma_f32_16x16x32_bf16 v[48:51], a[84:87], a[12:15], v[48:51]
    buffer_load_dwordx4 v1, s[4:7], s89 offen offset:3072 lds
    v_mov_b32 v140, 0
    v_mov_b32 v141, 0
    v_mfma_f32_16x16x32_bf16 v[44:47], v[124:127], a[16:19], v[44:47]
    v_mov_b32 v142, 0
    v_mov_b32_e64 v143, 0
    v_mfma_f32_16x16x32_bf16 v[48:51], v[128:131], a[16:19], v[48:51]
    v_mov_b32 v139, 0x3f803f80
    s_waitcnt lgkmcnt(8)
    v_add_f32 v96, v96, v36
    v_mfma_f32_16x16x32_bf16 v[64:67], a[148:151], a[20:23], 0
    v_add_f32 v97, v97, v37
    v_add_f32 v98, v98, v38
    v_mfma_f32_16x16x32_bf16 v[68:71], a[144:147], a[20:23], 0
    s_add_u32 s89, s96, s26
    s_add_u32 s88, s96, 141312
    s_add_u32 s89, s89, 69632
    s_mov_b32 m0, s88
    s_nop 0
    buffer_load_dwordx4 v1, s[4:7], s89 offen offset:0 lds
    v_add_f32 v99, v99, v39
    s_waitcnt lgkmcnt(6)
    v_add_f32 v56, v56, v76
    v_mfma_f32_16x16x32_bf16 v[64:67], a[128:131], a[24:27], v[64:67]
    v_add_f32 v57, v57, v77
    v_add_f32 v58, v58, v78
    v_mfma_f32_16x16x32_bf16 v[68:71], a[124:127], a[24:27], v[68:71]
    ds_write_b128 v29, v[44:47] offset:2048
    v_add_f32 v59, v59, v79
    v_add_f32 v96, v96, v56
    v_mfma_f32_16x16x32_bf16 v[64:67], a[108:111], a[28:31], v[64:67]
    buffer_load_dwordx4 v1, s[4:7], s89 offen offset:1024 lds
    v_add_f32 v97, v97, v57
    v_add_f32 v98, v98, v58
    v_mfma_f32_16x16x32_bf16 v[68:71], a[104:107], a[28:31], v[68:71]
    ds_write_b128 v29, v[48:51] offset:3072
    v_add_f32_e64 v99, v99, v59
    v_cvt_pk_bf16_f32 v16, v96, v97
    v_mfma_f32_16x16x32_bf16 v[64:67], a[88:91], a[32:35], v[64:67]
    v_cvt_pk_bf16_f32 v17, v98, v99
    s_waitcnt lgkmcnt(7)
    v_add_f32 v100, v100, v40
    v_mfma_f32_16x16x32_bf16 v[68:71], a[84:87], a[32:35], v[68:71]
    buffer_load_dwordx4 v1, s[4:7], s89 offen offset:2048 lds
    v_add_f32 v101, v101, v41
    v_add_f32 v102, v102, v42
    v_mfma_f32_16x16x32_bf16 v[64:67], v[124:127], a[36:39], v[64:67]
    v_add_f32 v103, v103, v43
    s_waitcnt lgkmcnt(5)
    v_add_f32 v60, v60, v80
    v_mfma_f32_16x16x32_bf16 v[68:71], v[128:131], a[36:39], v[68:71]
    v_add_f32 v61, v61, v81
    v_add_f32 v62, v62, v82
    v_mfma_f32_16x16x32_bf16 v[84:87], a[148:151], a[40:43], 0
    v_add_f32 v63, v63, v83
    v_add_f32 v100, v100, v60
    v_mfma_f32_16x16x32_bf16 v[88:91], a[144:147], a[40:43], 0
    s_add_u32 s13, s97, s26
    s_add_u32 s12, s97, 71680
    s_mov_b32 m0, s12
    s_nop 0
    buffer_load_dwordx4 v1, s[4:7], s13 offen offset:0 lds
    v_add_f32 v101, v101, v61
    v_add_f32 v102, v102, v62
    v_mfma_f32_16x16x32_bf16 v[84:87], a[128:131], a[44:47], v[84:87]
    v_add_f32_e64 v103, v103, v63
    v_cvt_pk_bf16_f32 v18, v100, v101
    v_mfma_f32_16x16x32_bf16 v[88:91], a[124:127], a[44:47], v[88:91]
    ds_write_b128 v30, v[64:67] offset:2048
    v_cvt_pk_bf16_f32 v19, v102, v103
    buffer_store_dwordx4 v[16:19], v10, s[4:7], 0 offen offset:0
    v_mfma_f32_16x16x32_bf16 v[84:87], a[108:111], a[48:51], v[84:87]
    buffer_load_dwordx4 v1, s[4:7], s13 offen offset:1024 lds
    s_waitcnt lgkmcnt(5)
    v_add_f32 v112, v112, v52
    v_add_f32 v113, v113, v53
    v_mfma_f32_16x16x32_bf16 v[88:91], a[104:107], a[48:51], v[88:91]
    ds_write_b128 v30, v[68:71] offset:3072
    v_add_f32 v114, v114, v54
    v_add_f32 v115, v115, v55
    v_mfma_f32_16x16x32_bf16 v[84:87], a[88:91], a[52:55], v[84:87]
    s_waitcnt lgkmcnt(4)
    v_add_f32 v72, v72, v92
    v_add_f32 v73, v73, v93
    v_mfma_f32_16x16x32_bf16 v[88:91], a[84:87], a[52:55], v[88:91]
    buffer_load_dwordx4 v1, s[4:7], s13 offen offset:2048 lds
    v_add_f32 v74, v74, v94
    v_add_f32 v75, v75, v95
    v_mfma_f32_16x16x32_bf16 v[84:87], v[124:127], a[56:59], v[84:87]
    v_add_f32 v112, v112, v72
    v_add_f32 v113, v113, v73
    v_mfma_f32_16x16x32_bf16 v[88:91], v[128:131], a[56:59], v[88:91]
    v_add_f32 v114, v114, v74
    v_add_f32 v115, v115, v75
    v_mfma_f32_16x16x32_bf16 v[104:107], a[148:151], a[60:63], v[104:107]
    v_cvt_pk_bf16_f32 v24, v112, v113
    v_cvt_pk_bf16_f32 v25, v114, v115
    v_mfma_f32_16x16x32_bf16 v[108:111], a[144:147], a[60:63], v[108:111]
    buffer_store_dwordx2 v[24:25], v11, s[4:7], 0 offen
    v_mfma_f32_16x16x32_bf16 v[104:107], a[128:131], a[64:67], v[104:107]
    v_mfma_f32_16x16x32_bf16 v[108:111], a[124:127], a[64:67], v[108:111]
    ds_write_b128 v31, v[84:87] offset:2048
    v_mfma_f32_16x16x32_bf16 v[104:107], a[108:111], a[68:71], v[104:107]
    v_mfma_f32_16x16x32_bf16 v[108:111], a[104:107], a[68:71], v[108:111]
    ds_write_b128 v31, v[88:91] offset:3072
    v_mfma_f32_16x16x32_bf16 v[104:107], a[88:91], a[72:75], v[104:107]
    v_mfma_f32_16x16x32_bf16 v[108:111], a[84:87], a[72:75], v[108:111]
    v_mfma_f32_16x16x32_bf16 v[104:107], v[124:127], a[76:79], v[104:107]
    v_mfma_f32_16x16x32_bf16 v[108:111], v[128:131], a[76:79], v[108:111]
    buffer_load_dwordx4 v1, s[4:7], s13 offen offset:3072 lds
    s_add_u32 s13, s94, s26
    s_add_u32 s12, s94, 88064
    s_add_u32 s13, s13, 16384
    s_mov_b32 m0, s12
    s_nop 0
    buffer_load_dwordx4 v1, s[4:7], s13 offen offset:0 lds
    v_dot2_f32_bf16 v140, v16, v139, v140
    v_dot2_f32_bf16 v141, v16, v16, v141
    v_dot2_f32_bf16 v142, v17, v139, v142
    v_dot2_f32_bf16 v143, v17, v17, v143
    v_dot2_f32_bf16 v140, v18, v139, v140
    v_dot2_f32_bf16 v141, v18, v18, v141
    v_dot2_f32_bf16 v142, v19, v139, v142
    v_dot2_f32_bf16 v143, v19, v19, v143
    v_dot2_f32_bf16 v140, v24, v139, v140
    v_dot2_f32_bf16 v141, v24, v24, v141
    v_dot2_f32_bf16 v142, v25, v139, v142
    v_dot2_f32_bf16 v143, v25, v25, v143
    s_add_u32 s3, s39, 3
    v_mov_b32 v15, s3
    s_add_u32 s3, s40, 20480
    s_waitcnt vmcnt(2)
    s_mov_b64 exec, 1
    buffer_store_dword v15, off, s[4:7], s3
    s_mov_b64 exec, -1
    s_waitcnt lgkmcnt(0)
    s_barrier
    ds_read_b128 v[44:47], v32 offset:2048
    ds_read_b128 v[64:67], v32 offset:7168
    ds_read_b128 v[84:87], v32 offset:12288
    ds_read_b128 v[48:51], v32 offset:3072
    ds_read_b128 v[68:71], v32 offset:8192
    ds_read_b128 v[88:91], v32 offset:13312
    s_waitcnt lgkmcnt(5)
    v_pk_add_f32 v[104:105], v[104:105], v[44:45] op_sel:[0,0] op_sel_hi:[1,1]
    v_pk_add_f32 v[106:107], v[106:107], v[46:47] op_sel:[0,0] op_sel_hi:[1,1]
    s_waitcnt lgkmcnt(3)
    v_pk_add_f32 v[64:65], v[64:65], v[84:85] op_sel:[0,0] op_sel_hi:[1,1]
    v_pk_add_f32 v[66:67], v[66:67], v[86:87] op_sel:[0,0] op_sel_hi:[1,1]
    v_pk_add_f32 v[104:105], v[104:105], v[64:65] op_sel:[0,0] op_sel_hi:[1,1]
    v_pk_add_f32 v[106:107], v[106:107], v[66:67] op_sel:[0,0] op_sel_hi:[1,1]
    v_cvt_pk_bf16_f32 v20, v104, v105
    v_cvt_pk_bf16_f32 v21, v106, v107
    v_dot2_f32_bf16 v140, v20, v139, v140
    v_dot2_f32_bf16 v141, v20, v20, v141
    v_dot2_f32_bf16 v142, v21, v139, v142
    v_dot2_f32_bf16 v143, v21, v21, v143
    s_waitcnt lgkmcnt(2)
    v_pk_add_f32 v[108:109], v[108:109], v[48:49] op_sel:[0,0] op_sel_hi:[1,1]
    v_pk_add_f32 v[110:111], v[110:111], v[50:51] op_sel:[0,0] op_sel_hi:[1,1]
    s_waitcnt lgkmcnt(0)
    v_pk_add_f32 v[68:69], v[68:69], v[88:89] op_sel:[0,0] op_sel_hi:[1,1]
    v_pk_add_f32 v[70:71], v[70:71], v[90:91] op_sel:[0,0] op_sel_hi:[1,1]
    v_pk_add_f32 v[108:109], v[108:109], v[68:69] op_sel:[0,0] op_sel_hi:[1,1]
    v_pk_add_f32 v[110:111], v[110:111], v[70:71] op_sel:[0,0] op_sel_hi:[1,1]
    v_cvt_pk_bf16_f32 v22, v108, v109
    v_cvt_pk_bf16_f32 v23, v110, v111
    buffer_store_dwordx4 v[20:23], v10, s[4:7], 0 offen offset:1024
    v_dot2_f32_bf16 v140, v22, v139, v140
    v_dot2_f32_bf16 v141, v22, v22, v141
    v_dot2_f32_bf16 v142, v23, v139, v142
    v_dot2_f32_bf16 v143, v23, v23, v143
    s_nop 2
    v_pk_add_f32 v[140:141], v[140:141], v[142:143] op_sel:[0,0] op_sel_hi:[1,1]
    s_nop 1
    v_permlane32_swap_b32 v140, v141
    v_add_f32 v140, v140, v141
    v_mov_b32 v141, v140
    s_nop 1
    v_permlane16_swap_b32 v140, v141
    v_add_f32 v140, v140, v141
    v_and_b32_e64 v15, 63, v2
    v_add_u32 v15, 20480, v15
    buffer_load_dword v14, v15, s[4:7], s41 offen sc1
    buffer_store_dword v140, v9, s[4:7], 0 offen
    s_waitcnt vmcnt(4)
    s_barrier
    ds_read_b128 v[92:95], v3 offset:6144
    ds_read_b128 v[96:99], v3 offset:7168
    ds_read_b128 v[100:103], v3 offset:8192
    ds_read_b128 v[104:107], v3 offset:9216
    s_add_u32 s52, s39, 3
    s_waitcnt vmcnt(1)
    v_cmp_ne_u32 vcc, s52, v14
    s_nop 1
    s_cbranch_vccz L_ok_32
    s_mov_b32 s60, 0
L_lp_31:
    v_and_b32_e64 v15, 63, v2
    v_add_u32 v15, 20480, v15
    buffer_load_dword v14, v15, s[4:7], s41 offen sc1
    s_add_u32 s60, s60, 1
    s_cmp_gt_u32 s60, 0x40000
    s_cbranch_scc1 L_abort
    s_waitcnt vmcnt(0)
    v_cmp_ne_u32 vcc, s52, v14
    s_nop 1
    s_cbranch_vccnz L_lp_31
L_ok_32:
    buffer_load_dwordx4 a[0:3], v6, s[4:7], 0 offen offset:0 sc1
    buffer_load_dwordx4 a[4:7], v7, s[4:7], 0 offen offset:0 sc1
    buffer_load_dwordx4 a[8:11], v6, s[4:7], 0 offen offset:2048 sc1
    buffer_load_dwordx4 a[12:15], v7, s[4:7], 0 offen offset:2048 sc1
    buffer_load_dwordx4 a[16:19], v6, s[4:7], 0 offen offset:3072 sc1
    buffer_load_dwordx4 a[20:23], v7, s[4:7], 0 offen offset:3072 sc1
    buffer_load_dwordx4 a[24:27], v6, s[4:7], s21 offen offset:1024 sc1
    buffer_load_dwordx4 a[28:31], v7, s[4:7], s21 offen offset:1024 sc1
    s_waitcnt vmcnt(7) lgkmcnt(3)
    v_mfma_f32_16x16x32_bf16 v[36:39], v[92:95], a[0:3], 0
    ds_read_b128 v[108:111], v3 offset:10240
    s_add_u32 s3, s39, 3
    v_mov_b32 v15, s3
    s_mov_b64 exec, 1
    buffer_store_dword v15, off, s[4:7], s40
    s_mov_b64 exec, -1
    s_waitcnt vmcnt(7)
    v_mfma_f32_16x16x32_bf16 v[40:43], v[92:95], a[4:7], 0
    s_waitcnt lgkmcnt(3)
    v_mfma_f32_16x16x32_bf16 v[44:47], v[96:99], a[0:3], 0
    ds_read_b128 v[112:115], v3 offset:11264
    v_mfma_f32_16x16x32_bf16 v[48:51], v[96:99], a[4:7], 0
    buffer_load_dwordx4 a[32:35], v6, s[4:7], s21 offen offset:3072 sc1
    s_waitcnt lgkmcnt(3)
    v_mfma_f32_16x16x32_bf16 v[52:55], v[100:103], a[0:3], 0
    ds_read_b128 v[116:119], v3 offset:12288
    v_mfma_f32_16x16x32_bf16 v[56:59], v[100:103], a[4:7], 0
    s_waitcnt lgkmcnt(3)
    v_mfma_f32_16x16x32_bf16 v[60:63], v[104:107], a[0:3], 0
    ds_read_b128 v[120:123], v3 offset:13312
    buffer_load_dwordx4 a[36:39], v7, s[4:7], s21 offen offset:3072 sc1
    v_mfma_f32_16x16x32_bf16 v[64:67], v[104:107], a[4:7], 0
    s_waitcnt vmcnt(8) lgkmcnt(3)
    v_mfma_f32_16x16x32_bf16 v[36:39], v[108:111], a[8:11], v[36:39]
    ds_read_b128 v[92:95], v3 offset:14336
    s_waitcnt vmcnt(7)
    v_mfma_f32_16x16x32_bf16 v[40:43], v[108:111], a[12:15], v[40:43]
    buffer_load_dwordx4 a[40:43], v6, s[4:7], s22 offen offset:0 sc1
    s_waitcnt lgkmcnt(3)
    v_mfma_f32_16x16x32_bf16 v[44:47], v[112:115], a[8:11], v[44:47]
    ds_read_b128 v[96:99], v3 offset:15360
    v_mfma_f32_16x16x32_bf16 v[48:51], v[112:115], a[12:15], v[48:51]
    s_waitcnt lgkmcnt(3)
    v_mfma_f32_16x16x32_bf16 v[52:55], v[116:119], a[8:11], v[52:55]
    ds_read_b128 v[100:103], v3 offset:16384
    v_mfma_f32_16x16x32_bf16 v[56:59], v[116:119], a[12:15], v[56:59]
    buffer_load_dwordx4 a[44:47], v7, s[4:7], s22 offen offset:0 sc1
    s_waitcnt lgkmcnt(3)
    v_mfma_f32_16x16x32_bf16 v[60:63], v[120:123], a[8:11], v[60:63]
    ds_read_b128 v[104:107], v3 offset:17408
    v_mfma_f32_16x16x32_bf16 v[64:67], v[120:123], a[12:15], v[64:67]
    s_waitcnt vmcnt(8) lgkmcnt(3)
    v_mfma_f32_16x16x32_bf16 v[36:39], v[92:95], a[16:19], v[36:39]
    ds_read_b128 v[108:111], v3 offset:18432
    s_waitcnt vmcnt(7)
    v_mfma_f32_16x16x32_bf16 v[40:43], v[92:95], a[20:23], v[40:43]
    buffer_load_dwordx4 a[48:51], v6, s[4:7], s22 offen offset:2048 sc1
    s_waitcnt lgkmcnt(3)
    v_mfma_f32_16x16x32_bf16 v[44:47], v[96:99], a[16:19], v[44:47]
    ds_read_b128 v[112:115], v3 offset:19456
    v_mfma_f32_16x16x32_bf16 v[48:51], v[96:99], a[20:23], v[48:51]
    s_waitcnt lgkmcnt(3)
    v_mfma_f32_16x16x32_bf16 v[52:55], v[100:103], a[16:19], v[52:55]
    ds_read_b128 v[116:119], v3 offset:20480
    v_mfma_f32_16x16x32_bf16 v[56:59], v[100:103], a[20:23], v[56:59]
    buffer_load_dwordx4 a[52:55], v7, s[4:7], s22 offen offset:2048 sc1
    s_waitcnt lgkmcnt(3)
    v_mfma_f32_16x16x32_bf16 v[60:63], v[104:107], a[16:19], v[60:63]
    ds_read_b128 v[120:123], v3 offset:21504
    v_mfma_f32_16x16x32_bf16 v[64:67], v[104:107], a[20:23], v[64:67]
    s_waitcnt vmcnt(8) lgkmcnt(3)
    v_mfma_f32_16x16x32_bf16 v[36:39], v[108:111], a[24:27], v[36:39]
    ds_read_b128 v[92:95], v3 offset:22528
    buffer_load_dwordx4 a[56:59], v6, s[4:7], s23 offen offset:0 sc1
    s_waitcnt vmcnt(8)
    v_mfma_f32_16x16x32_bf16 v[40:43], v[108:111], a[28:31], v[40:43]
    s_waitcnt lgkmcnt(3)
    v_mfma_f32_16x16x32_bf16 v[44:47], v[112:115], a[24:27], v[44:47]
    ds_read_b128 v[96:99], v3 offset:23552
    v_mfma_f32_16x16x32_bf16 v[48:51], v[112:115], a[28:31], v[48:51]
    buffer_load_dwordx4 a[60:63], v7, s[4:7], s23 offen offset:0 sc1
    s_waitcnt lgkmcnt(3)
    v_mfma_f32_16x16x32_bf16 v[52:55], v[116:119], a[24:27], v[52:55]
    ds_read_b128 v[100:103], v3 offset:24576
    v_mfma_f32_16x16x32_bf16 v[56:59], v[116:119], a[28:31], v[56:59]
    s_waitcnt lgkmcnt(3)
    v_mfma_f32_16x16x32_bf16 v[60:63], v[120:123], a[24:27], v[60:63]
    ds_read_b128 v[104:107], v3 offset:25600
    v_and_b32 v15, 63, v2
    buffer_load_dword v14, v15, s[4:7], s41 offen sc1
    v_mfma_f32_16x16x32_bf16 v[64:67], v[120:123], a[28:31], v[64:67]
    s_waitcnt vmcnt(8) lgkmcnt(3)
    v_mfma_f32_16x16x32_bf16 v[36:39], v[92:95], a[32:35], v[36:39]
    ds_read_b128 v[108:111], v3 offset:26624
    s_waitcnt vmcnt(7)
    v_mfma_f32_16x16x32_bf16 v[40:43], v[92:95], a[36:39], v[40:43]
    buffer_load_dwordx4 a[64:67], v6, s[4:7], s23 offen offset:1024 sc1
    s_waitcnt lgkmcnt(3)
    v_mfma_f32_16x16x32_bf16 v[44:47], v[96:99], a[32:35], v[44:47]
    ds_read_b128 v[112:115], v3 offset:27648
    v_mfma_f32_16x16x32_bf16 v[48:51], v[96:99], a[36:39], v[48:51]
    s_waitcnt lgkmcnt(3)
    v_mfma_f32_16x16x32_bf16 v[52:55], v[100:103], a[32:35], v[52:55]
    ds_read_b128 v[116:119], v3 offset:28672
    v_mfma_f32_16x16x32_bf16 v[56:59], v[100:103], a[36:39], v[56:59]
    buffer_load_dwordx4 a[68:71], v7, s[4:7], s23 offen offset:1024 sc1
    s_waitcnt lgkmcnt(3)
    v_mfma_f32_16x16x32_bf16 v[60:63], v[104:107], a[32:35], v[60:63]
    ds_read_b128 v[120:123], v3 offset:29696
    v_mfma_f32_16x16x32_bf16 v[64:67], v[104:107], a[36:39], v[64:67]
    s_waitcnt vmcnt(8) lgkmcnt(3)
    v_mfma_f32_16x16x32_bf16 v[36:39], v[108:111], a[40:43], v[36:39]
    ds_read_b128 v[92:95], v3 offset:30720
    s_waitcnt vmcnt(7)
    v_mfma_f32_16x16x32_bf16 v[40:43], v[108:111], a[44:47], v[40:43]
    buffer_load_dwordx4 a[72:75], v6, s[4:7], s23 offen offset:3072 sc1
    s_waitcnt lgkmcnt(3)
    v_mfma_f32_16x16x32_bf16 v[44:47], v[112:115], a[40:43], v[44:47]
    ds_read_b128 v[96:99], v3 offset:31744
    v_mfma_f32_16x16x32_bf16 v[48:51], v[112:115], a[44:47], v[48:51]
    s_waitcnt lgkmcnt(3)
    v_mfma_f32_16x16x32_bf16 v[52:55], v[116:119], a[40:43], v[52:55]
    ds_read_b128 v[100:103], v3 offset:32768
    v_mfma_f32_16x16x32_bf16 v[56:59], v[116:119], a[44:47], v[56:59]
    buffer_load_dwordx4 a[76:79], v7, s[4:7], s23 offen offset:3072 sc1
    s_waitcnt lgkmcnt(3)
    v_mfma_f32_16x16x32_bf16 v[60:63], v[120:123], a[40:43], v[60:63]
    ds_read_b128 v[104:107], v3 offset:33792
    v_mfma_f32_16x16x32_bf16 v[64:67], v[120:123], a[44:47], v[64:67]
    s_waitcnt vmcnt(8) lgkmcnt(3)
    v_mfma_f32_16x16x32_bf16 v[36:39], v[92:95], a[48:51], v[36:39]
    ds_read_b128 v[108:111], v3 offset:34816
    s_waitcnt vmcnt(7)
    v_mfma_f32_16x16x32_bf16 v[40:43], v[92:95], a[52:55], v[40:43]
    buffer_load_dwordx4 a[80:83], v6, s[4:7], s24 offen offset:1024 sc1
    s_waitcnt lgkmcnt(3)
    v_mfma_f32_16x16x32_bf16 v[44:47], v[96:99], a[48:51], v[44:47]
    ds_read_b128 v[112:115], v3 offset:35840
    v_mfma_f32_16x16x32_bf16 v[48:51], v[96:99], a[52:55], v[48:51]
    s_waitcnt lgkmcnt(3)
    v_mfma_f32_16x16x32_bf16 v[52:55], v[100:103], a[48:51], v[52:55]
    ds_read_b128 v[116:119], v3 offset:36864
    v_mfma_f32_16x16x32_bf16 v[56:59], v[100:103], a[52:55], v[56:59]
    buffer_load_dwordx4 a[84:87], v7, s[4:7], s24 offen offset:1024 sc1
    s_waitcnt lgkmcnt(3)
    v_mfma_f32_16x16x32_bf16 v[60:63], v[104:107], a[48:51], v[60:63]
    ds_read_b128 v[120:123], v3 offset:37888
    v_mfma_f32_16x16x32_bf16 v[64:67], v[104:107], a[52:55], v[64:67]
    s_waitcnt vmcnt(8) lgkmcnt(3)
    v_mfma_f32_16x16x32_bf16 v[36:39], v[108:111], a[56:59], v[36:39]
    s_add_u32 s52, s39, 3
    s_waitcnt vmcnt(6)
    v_cmp_ne_u32 vcc, s52, v14
    s_nop 4
    s_cbranch_vccz L_ok_35
    s_mov_b32 s60, 0
L_lp_34:
    v_and_b32 v15, 63, v2
    buffer_load_dword v14, v15, s[4:7], s41 offen sc1
    s_add_u32 s60, s60, 1
    s_cmp_gt_u32 s60, 0x40000
    s_cbranch_scc1 L_abort
    s_waitcnt vmcnt(0)
    v_cmp_ne_u32 vcc, s52, v14
    s_nop 1
    s_cbranch_vccnz L_lp_34
L_ok_35:
    v_mfma_f32_16x16x32_bf16 v[40:43], v[108:111], a[60:63], v[40:43]
    ds_read_b128 v[92:95], v3 offset:38912
    s_waitcnt lgkmcnt(3)
    v_mfma_f32_16x16x32_bf16 v[44:47], v[112:115], a[56:59], v[44:47]
    ds_read_b128 v[96:99], v3 offset:39936
    buffer_load_dwordx4 a[88:91], v6, s[4:7], s24 offen offset:2048 sc1
    v_mfma_f32_16x16x32_bf16 v[48:51], v[112:115], a[60:63], v[48:51]
    ds_read_b128 v[100:103], v3 offset:40960
    s_waitcnt lgkmcnt(4)
    v_mfma_f32_16x16x32_bf16 v[52:55], v[116:119], a[56:59], v[52:55]
    ds_read_b128 v[104:107], v3 offset:41984
    v_mfma_f32_16x16x32_bf16 v[56:59], v[116:119], a[60:63], v[56:59]
    buffer_load_dwordx4 a[92:95], v7, s[4:7], s24 offen offset:2048 sc1
    s_waitcnt lgkmcnt(4)
    v_mfma_f32_16x16x32_bf16 v[60:63], v[120:123], a[56:59], v[60:63]
    v_mfma_f32_16x16x32_bf16 v[64:67], v[120:123], a[60:63], v[64:67]
    s_waitcnt vmcnt(7) lgkmcnt(3)
    v_mfma_f32_16x16x32_bf16 v[36:39], v[92:95], a[64:67], v[36:39]
    ds_read_b128 v[108:111], v3 offset:43008
    buffer_load_dwordx4 a[96:99], v6, s[4:7], 0 offen offset:1024 sc1
    s_waitcnt vmcnt(7)
    v_mfma_f32_16x16x32_bf16 v[40:43], v[92:95], a[68:71], v[40:43]
    s_waitcnt lgkmcnt(3)
    v_mfma_f32_16x16x32_bf16 v[44:47], v[96:99], a[64:67], v[44:47]
    ds_read_b128 v[112:115], v3 offset:44032
    buffer_load_dwordx4 a[100:103], v7, s[4:7], 0 offen offset:1024 sc1
    v_mfma_f32_16x16x32_bf16 v[48:51], v[96:99], a[68:71], v[48:51]
    s_waitcnt lgkmcnt(3)
    v_mfma_f32_16x16x32_bf16 v[52:55], v[100:103], a[64:67], v[52:55]
    ds_read_b128 v[116:119], v3 offset:45056
    buffer_load_dwordx4 v[128:131], v8, s[4:7], 0 offen offset:0 sc1
    v_mfma_f32_16x16x32_bf16 v[56:59], v[100:103], a[68:71], v[56:59]
    s_waitcnt lgkmcnt(3)
    v_mfma_f32_16x16x32_bf16 v[60:63], v[104:107], a[64:67], v[60:63]
    ds_read_b128 v[120:123], v3 offset:46080
    buffer_load_dwordx4 v[132:135], v8, s[4:7], 0 offen offset:1024 sc1
    v_mfma_f32_16x16x32_bf16 v[64:67], v[104:107], a[68:71], v[64:67]
    s_waitcnt vmcnt(9) lgkmcnt(3)
    v_mfma_f32_16x16x32_bf16 v[36:39], v[108:111], a[72:75], v[36:39]
    ds_read_b128 v[92:95], v3 offset:47104
    s_waitcnt vmcnt(8)
    v_mfma_f32_16x16x32_bf16 v[40:43], v[108:111], a[76:79], v[40:43]
    buffer_load_dwordx4 a[104:107], v6, s[4:7], s21 offen offset:0 sc1
    s_waitcnt lgkmcnt(3)
    v_mfma_f32_16x16x32_bf16 v[44:47], v[112:115], a[72:75], v[44:47]
    ds_read_b128 v[96:99], v3 offset:48128
    v_mfma_f32_16x16x32_bf16 v[48:51], v[112:115], a[76:79], v[48:51]
    s_waitcnt lgkmcnt(3)
    v_mfma_f32_16x16x32_bf16 v[52:55], v[116:119], a[72:75], v[52:55]
    ds_read_b128 v[100:103], v3 offset:49152
    v_mfma_f32_16x16x32_bf16 v[56:59], v[116:119], a[76:79], v[56:59]
    buffer_load_dwordx4 a[108:111], v7, s[4:7], s21 offen offset:0 sc1
    s_waitcnt lgkmcnt(3)
    v_mfma_f32_16x16x32_bf16 v[60:63], v[120:123], a[72:75], v[60:63]
    ds_read_b128 v[104:107], v3 offset:50176
    v_mfma_f32_16x16x32_bf16 v[64:67], v[120:123], a[76:79], v[64:67]
    s_waitcnt vmcnt(9) lgkmcnt(3)
    v_mfma_f32_16x16x32_bf16 v[36:39], v[92:95], a[80:83], v[36:39]
    ds_read_b128 v[108:111], v3 offset:51200
    buffer_load_dwordx4 a[112:115], v6, s[4:7], s21 offen offset:2048 sc1
    s_waitcnt vmcnt(9)
    v_mfma_f32_16x16x32_bf16 v[40:43], v[92:95], a[84:87], v[40:43]
    s_waitcnt lgkmcnt(3)
    v_mfma_f32_16x16x32_bf16 v[44:47], v[96:99], a[80:83], v[44:47]
    ds_read_b128 v[112:115], v3 offset:52224
    buffer_load_dwordx4 a[116:119], v7, s[4:7], s21 offen offset:2048 sc1
    v_mfma_f32_16x16x32_bf16 v[48:51], v[96:99], a[84:87], v[48:51]
    s_waitcnt lgkmcnt(3)
    v_mfma_f32_16x16x32_bf16 v[52:55], v[100:103], a[80:83], v[52:55]
    ds_read_b128 v[116:119], v3 offset:53248
    s_add_u32 s15, s97, s26
    s_add_u32 s14, s97, 0
    s_add_u32 s15, s15, 81920
    s_mov_b32 m0, s14
    s_nop 0
    buffer_load_dwordx4 v1, s[4:7], s15 offen offset:0 lds
    v_mfma_f32_16x16x32_bf16 v[56:59], v[100:103], a[84:87], v[56:59]
    s_waitcnt lgkmcnt(3)
    v_mfma_f32_16x16x32_bf16 v[60:63], v[104:107], a[80:83], v[60:63]
    ds_read_b128 v[120:123], v3 offset:54272
    buffer_load_dwordx4 v1, s[4:7], s15 offen offset:1024 lds
    v_mfma_f32_16x16x32_bf16 v[64:67], v[104:107], a[84:87], v[64:67]
    s_waitcnt vmcnt(11) lgkmcnt(3)
    v_mfma_f32_16x16x32_bf16 v[36:39], v[108:111], a[88:91], v[36:39]
    ds_read_b128 v[92:95], v3 offset:55296
    buffer_load_dwordx4 a[120:123], v6, s[4:7], s22 offen offset:1024 sc1
    s_waitcnt vmcnt(11)
    v_mfma_f32_16x16x32_bf16 v[40:43], v[108:111], a[92:95], v[40:43]
    s_waitcnt lgkmcnt(3)
    v_mfma_f32_16x16x32_bf16 v[44:47], v[112:115], a[88:91], v[44:47]
    ds_read_b128 v[96:99], v3 offset:56320
    v_mfma_f32_16x16x32_bf16 v[48:51], v[112:115], a[92:95], v[48:51]
    buffer_load_dwordx4 a[124:127], v7, s[4:7], s22 offen offset:1024 sc1
    s_waitcnt lgkmcnt(3)
    v_mfma_f32_16x16x32_bf16 v[52:55], v[116:119], a[88:91], v[52:55]
    ds_read_b128 v[100:103], v3 offset:57344
    v_mfma_f32_16x16x32_bf16 v[56:59], v[116:119], a[92:95], v[56:59]
    s_waitcnt lgkmcnt(3)
    v_mfma_f32_16x16x32_bf16 v[60:63], v[120:123], a[88:91], v[60:63]
    ds_read_b128 v[104:107], v3 offset:58368
    buffer_load_dwordx4 v1, s[4:7], s15 offen offset:2048 lds
    v_mfma_f32_16x16x32_bf16 v[64:67], v[120:123], a[92:95], v[64:67]
    s_waitcnt vmcnt(12) lgkmcnt(3)
    v_mfma_f32_16x16x32_bf16 v[36:39], v[92:95], a[96:99], v[36:39]
    ds_read_b128 v[108:111], v3 offset:59392
    buffer_load_dwordx4 a[128:131], v6, s[4:7], s22 offen offset:3072 sc1
    s_waitcnt vmcnt(11)
    v_add_f32 v128, v128, v129
    s_waitcnt vmcnt(10)
    v_add_f32 v132, v132, v133
    v_mfma_f32_16x16x32_bf16 v[40:43], v[92:95], a[100:103], v[40:43]
    v_add_f32 v130, v130, v131
    s_waitcnt lgkmcnt(3)
    v_mfma_f32_16x16x32_bf16 v[44:47], v[96:99], a[96:99], v[44:47]
    ds_read_b128 v[112:115], v3 offset:60416
    v_add_f32 v134, v134, v135
    v_mfma_f32_16x16x32_bf16 v[48:51], v[96:99], a[100:103], v[48:51]
    buffer_load_dwordx4 a[132:135], v7, s[4:7], s22 offen offset:3072 sc1
    v_add_f32 v128, v128, v130
    s_waitcnt lgkmcnt(3)
    v_mfma_f32_16x16x32_bf16 v[52:55], v[100:103], a[96:99], v[52:55]
    ds_read_b128 v[116:119], v3 offset:61440
    v_add_f32 v132, v132, v134
    v_mov_b32 v129, v128
    v_mfma_f32_16x16x32_bf16 v[56:59], v[100:103], a[100:103], v[56:59]
    v_mov_b32 v133, v132
    s_waitcnt lgkmcnt(3)
    v_mfma_f32_16x16x32_bf16 v[60:63], v[104:107], a[96:99], v[60:63]
    ds_read_b128 v[120:123], v3 offset:62464
    buffer_load_dwordx4 v1, s[4:7], s15 offen offset:3072 lds
    v_permlane16_swap_b32 v128, v129
    v_mfma_f32_16x16x32_bf16 v[64:67], v[104:107], a[100:103], v[64:67]
    v_permlane16_swap_b32 v132, v133
    s_waitcnt vmcnt(11) lgkmcnt(3)
    v_mfma_f32_16x16x32_bf16 v[36:39], v[108:111], a[104:107], v[36:39]
    ds_read_b128 v[92:95], v3 offset:63488
    buffer_load_dwordx4 a[136:139], v6, s[4:7], s23 offen offset:2048 sc1
    v_add_f32 v128, v128, v129
    v_add_f32 v132, v132, v133
    s_waitcnt vmcnt(11)
    v_mfma_f32_16x16x32_bf16 v[40:43], v[108:111], a[108:111], v[40:43]
    v_mov_b32 v129, v128
    s_waitcnt lgkmcnt(3)
    v_mfma_f32_16x16x32_bf16 v[44:47], v[112:115], a[104:107], v[44:47]
    ds_read_b128 v[96:99], v3 offset:64512
    buffer_load_dwordx4 a[140:143], v7, s[4:7], s23 offen offset:2048 sc1
    v_mov_b32 v133, v132
    v_mfma_f32_16x16x32_bf16 v[48:51], v[112:115], a[108:111], v[48:51]
    v_permlane32_swap_b32 v128, v129
    s_waitcnt lgkmcnt(3)
    v_mfma_f32_16x16x32_bf16 v[52:55], v[116:119], a[104:107], v[52:55]
    ds_read_b128 v[100:103], v4 offset:0
    s_add_u32 s15, s97, s26
    s_add_u32 s14, s97, 16384
    s_add_u32 s15, s15, 98304
    s_mov_b32 m0, s14
    s_nop 0
    buffer_load_dwordx4 v1, s[4:7], s15 offen offset:0 lds
    v_permlane32_swap_b32 v132, v133
    v_mul_f32 v128, 986500301, v128
    v_mfma_f32_16x16x32_bf16 v[56:59], v[116:119], a[108:111], v[56:59]
    v_mul_f32 v132, 986500301, v132
    s_waitcnt lgkmcnt(3)
    v_mfma_f32_16x16x32_bf16 v[60:63], v[120:123], a[104:107], v[60:63]
    ds_read_b128 v[104:107], v4 offset:1024
    buffer_load_dwordx4 v1, s[4:7], s15 offen offset:1024 lds
    v_mul_f32 v129, 986500301, v129
    v_mfma_f32_16x16x32_bf16 v[64:67], v[120:123], a[108:111], v[64:67]
    v_mul_f32 v133, 986500301, v133
    s_waitcnt vmcnt(13) lgkmcnt(3)
    v_mfma_f32_16x16x32_bf16 v[36:39], v[92:95], a[112:115], v[36:39]
    ds_read_b128 v[108:111], v4 offset:2048
    buffer_load_dwordx4 a[144:147], v6, s[4:7], s24 offen offset:0 sc1
    v_fma_f32 v129, -v128, v128, v129
    v_fma_f32 v133, -v132, v132, v133
    s_waitcnt vmcnt(13)
    v_mfma_f32_16x16x32_bf16 v[40:43], v[92:95], a[116:119], v[40:43]
    v_max_f32 v129, 0, v129
    s_waitcnt lgkmcnt(3)
    v_mfma_f32_16x16x32_bf16 v[44:47], v[96:99], a[112:115], v[44:47]
    ds_read_b128 v[112:115], v4 offset:3072
    v_max_f32 v133, 0, v133
    v_mfma_f32_16x16x32_bf16 v[48:51], v[96:99], a[116:119], v[48:51]
    buffer_load_dwordx4 a[148:151], v7, s[4:7], s24 offen offset:0 sc1
    v_add_f32 v129, 925353388, v129
    s_waitcnt lgkmcnt(3)
    v_mfma_f32_16x16x32_bf16 v[52:55], v[100:103], a[112:115], v[52:55]
    ds_read_b128 v[116:119], v4 offset:4096
    v_add_f32 v133, 925353388, v133
    v_rsq_f32 v124, v129
    v_mfma_f32_16x16x32_bf16 v[56:59], v[100:103], a[116:119], v[56:59]
    v_rsq_f32 v125, v133
    s_waitcnt lgkmcnt(3)
    v_mfma_f32_16x16x32_bf16 v[60:63], v[104:107], a[112:115], v[60:63]
    ds_read_b128 v[120:123], v4 offset:5120
    buffer_load_dwordx4 v1, s[4:7], s15 offen offset:2048 lds
    v_mul_f32_e64 v126, -v128, v124
    v_mfma_f32_16x16x32_bf16 v[64:67], v[104:107], a[116:119], v[64:67]
    v_mul_f32_e64 v127, -v132, v125
    s_waitcnt vmcnt(12) lgkmcnt(3)
    v_mfma_f32_16x16x32_bf16 v[36:39], v[108:111], a[120:123], v[36:39]
    ds_read_b128 v[92:95], v4 offset:6144
    buffer_load_dwordx4 a[152:155], v6, s[4:7], s24 offen offset:3072 sc1
    ds_read_b128 v[160:163], v12 offset:512
    s_waitcnt vmcnt(12)
    v_mfma_f32_16x16x32_bf16 v[40:43], v[108:111], a[124:127], v[40:43]
    s_waitcnt lgkmcnt(4)
    v_mfma_f32_16x16x32_bf16 v[44:47], v[112:115], a[120:123], v[44:47]
    ds_read_b128 v[96:99], v4 offset:7168
    v_mfma_f32_16x16x32_bf16 v[48:51], v[112:115], a[124:127], v[48:51]
    buffer_load_dwordx4 a[156:159], v7, s[4:7], s24 offen offset:3072 sc1
    s_waitcnt lgkmcnt(4)
    v_mfma_f32_16x16x32_bf16 v[52:55], v[116:119], a[120:123], v[52:55]
    ds_read_b128 v[100:103], v4 offset:8192
    ds_read_b128 v[164:167], v12 offset:1024
    v_mfma_f32_16x16x32_bf16 v[56:59], v[116:119], a[124:127], v[56:59]
    s_waitcnt lgkmcnt(5)
    v_mfma_f32_16x16x32_bf16 v[60:63], v[120:123], a[120:123], v[60:63]
    ds_read_b128 v[104:107], v4 offset:9216
    buffer_load_dwordx4 v1, s[4:7], s15 offen offset:3072 lds
    v_mfma_f32_16x16x32_bf16 v[64:67], v[120:123], a[124:127], v[64:67]
    s_waitcnt vmcnt(12) lgkmcnt(5)
    v_mfma_f32_16x16x32_bf16 v[36:39], v[92:95], a[128:131], v[36:39]
    ds_read_b128 v[108:111], v4 offset:10240
    s_waitcnt lgkmcnt(2)
    v_fma_f32 v128, v160, v126, v164
    v_fma_f32 v129, v161, v126, v165
    s_waitcnt vmcnt(11)
    v_mfma_f32_16x16x32_bf16 v[40:43], v[92:95], a[132:135], v[40:43]
    v_fma_f32 v130, v162, v126, v166
    s_add_u32 s15, s97, s26
    s_add_u32 s14, s97, 32768
    s_add_u32 s15, s15, 114688
    s_mov_b32 m0, s14
    s_nop 0
    buffer_load_dwordx4 v1, s[4:7], s15 offen offset:0 lds
    v_mfma_f32_16x16x32_bf16 v[44:47], v[96:99], a[128:131], v[44:47]
    ds_read_b128 v[112:115], v4 offset:11264
    v_fma_f32 v131, v163, v126, v167
    v_mfma_f32_16x16x32_bf16 v[48:51], v[96:99], a[132:135], v[48:51]
    v_fma_f32 v132, v160, v127, v164
    v_mfma_f32_16x16x32_bf16 v[52:55], v[100:103], a[128:131], v[52:55]
    ds_read_b128 v[116:119], v4 offset:12288
    v_fma_f32 v133, v161, v127, v165
    v_fma_f32 v134, v162, v127, v166
    v_mfma_f32_16x16x32_bf16 v[56:59], v[100:103], a[132:135], v[56:59]
    v_fma_f32 v135, v163, v127, v167
    buffer_load_dwordx4 v1, s[4:7], s15 offen offset:1024 lds
    s_waitcnt lgkmcnt(3)
    v_mfma_f32_16x16x32_bf16 v[60:63], v[104:107], a[128:131], v[60:63]
    ds_read_b128 v[120:123], v4 offset:13312
    ds_read_b128 v[160:163], v12 offset:576
    v_mfma_f32_16x16x32_bf16 v[64:67], v[104:107], a[132:135], v[64:67]
    ds_read_b128 v[164:167], v12 offset:1088
    s_waitcnt vmcnt(11) lgkmcnt(5)
    v_mfma_f32_16x16x32_bf16 v[36:39], v[108:111], a[136:139], v[36:39]
    ds_read_b128 v[92:95], v4 offset:14336
    s_waitcnt lgkmcnt(1)
    v_fma_f32 v136, v160, v126, v164
    v_fma_f32 v137, v161, v126, v165
    s_waitcnt vmcnt(10)
    v_mfma_f32_16x16x32_bf16 v[40:43], v[108:111], a[140:143], v[40:43]
    v_fma_f32 v138, v162, v126, v166
    v_mfma_f32_16x16x32_bf16 v[44:47], v[112:115], a[136:139], v[44:47]
    ds_read_b128 v[96:99], v4 offset:15360
    v_fma_f32 v139, v163, v126, v167
    v_mfma_f32_16x16x32_bf16 v[48:51], v[112:115], a[140:143], v[48:51]
    v_fma_f32 v140, v160, v127, v164
    buffer_load_dwordx4 v1, s[4:7], s15 offen offset:2048 lds
    v_mfma_f32_16x16x32_bf16 v[52:55], v[116:119], a[136:139], v[52:55]
    ds_read_b128 v[100:103], v4 offset:16384
    v_fma_f32 v141, v161, v127, v165
    v_fma_f32 v142, v162, v127, v166
    v_mfma_f32_16x16x32_bf16 v[56:59], v[116:119], a[140:143], v[56:59]
    v_fma_f32 v143, v163, v127, v167
    v_mfma_f32_16x16x32_bf16 v[60:63], v[120:123], a[136:139], v[60:63]
    ds_read_b128 v[104:107], v4 offset:17408
    ds_read_b128 v[160:163], v12 offset:640
    v_mfma_f32_16x16x32_bf16 v[64:67], v[120:123], a[140:143], v[64:67]
    ds_read_b128 v[164:167], v12 offset:1152
    s_waitcnt vmcnt(8) lgkmcnt(5)
    v_mfma_f32_16x16x32_bf16 v[36:39], v[92:95], a[144:147], v[36:39]
    ds_read_b128 v[108:111], v4 offset:18432
    s_waitcnt lgkmcnt(1)
    v_fma_f32 v144, v160, v126, v164
    v_fma_f32 v145, v161, v126, v165
    s_waitcnt vmcnt(7)
    v_mfma_f32_16x16x32_bf16 v[40:43], v[92:95], a[148:151], v[40:43]
    v_fma_f32 v146, v162, v126, v166
    v_mfma_f32_16x16x32_bf16 v[44:47], v[96:99], a[144:147], v[44:47]
    ds_read_b128 v[112:115], v4 offset:19456
    v_fma_f32 v147, v163, v126, v167
    v_mfma_f32_16x16x32_bf16 v[48:51], v[96:99], a[148:151], v[48:51]
    v_fma_f32 v148, v160, v127, v164
    buffer_load_dwordx4 v1, s[4:7], s15 offen offset:3072 lds
    v_mfma_f32_16x16x32_bf16 v[52:55], v[100:103], a[144:147], v[52:55]
    ds_read_b128 v[116:119], v4 offset:20480
    v_fma_f32 v149, v161, v127, v165
    v_fma_f32 v150, v162, v127, v166
    v_mfma_f32_16x16x32_bf16 v[56:59], v[100:103], a[148:151], v[56:59]
    v_fma_f32 v151, v163, v127, v167
    v_mfma_f32_16x16x32_bf16 v[60:63], v[104:107], a[144:147], v[60:63]
    ds_read_b128 v[120:123], v4 offset:21504
    ds_read_b128 v[160:163], v12 offset:704
    v_mfma_f32_16x16x32_bf16 v[64:67], v[104:107], a[148:151], v[64:67]
    ds_read_b128 v[164:167], v12 offset:1216
    s_waitcnt vmcnt(6) lgkmcnt(5)
    v_mfma_f32_16x16x32_bf16 v[36:39], v[108:111], a[152:155], v[36:39]
    s_waitcnt lgkmcnt(0)
    v_fma_f32 v152, v160, v126, v164
    s_waitcnt vmcnt(5)
    v_mfma_f32_16x16x32_bf16 v[40:43], v[108:111], a[156:159], v[40:43]
    v_fma_f32 v153, v161, v126, v165
    v_mfma_f32_16x16x32_bf16 v[44:47], v[112:115], a[152:155], v[44:47]
    v_fma_f32 v154, v162, v126, v166
    v_mfma_f32_16x16x32_bf16 v[48:51], v[112:115], a[156:159], v[48:51]
    v_fma_f32 v155, v163, v126, v167
    s_add_u32 s15, s96, s26
    s_add_u32 s14, s96, 49152
    s_add_u32 s15, s15, 131072
    s_mov_b32 m0, s14
    s_nop 0
    buffer_load_dwordx4 v1, s[4:7], s15 offen offset:0 lds
    v_mfma_f32_16x16x32_bf16 v[52:55], v[116:119], a[152:155], v[52:55]
    v_fma_f32 v156, v160, v127, v164
    v_mfma_f32_16x16x32_bf16 v[56:59], v[116:119], a[156:159], v[56:59]
    v_fma_f32 v157, v161, v127, v165
    v_mfma_f32_16x16x32_bf16 v[60:63], v[120:123], a[152:155], v[60:63]
    v_fma_f32 v158, v162, v127, v166
    v_mfma_f32_16x16x32_bf16 v[64:67], v[120:123], a[156:159], v[64:67]
    v_fma_f32 v159, v163, v127, v167
    s_waitcnt vmcnt(5)
    s_barrier
    ds_read_b128 v[92:95], v1 offset:0
    ds_read_b128 v[96:99], v1 offset:1024
    ds_read_b128 v[100:103], v1 offset:2048
    ds_read_b128 v[104:107], v1 offset:3072
    ds_read_b128 v[108:111], v1 offset:4096
    ds_read_b128 v[112:115], v1 offset:5120
    s_waitcnt lgkmcnt(3)
    v_mfma_f32_16x16x32_bf16 v[68:71], v[92:95], a[152:155], 0
    ds_read_b128 v[116:119], v1 offset:6144
    s_add_u32 s53, s35, 4096
    v_fma_f32 v36, v36, v124, v128
    v_mfma_f32_16x16x32_bf16 v[72:75], v[92:95], a[156:159], 0
    v_fma_f32 v37, v37, v124, v129
    v_fma_f32 v38, v38, v124, v130
    v_mfma_f32_16x16x32_bf16 v[76:79], v[96:99], a[152:155], 0
    ds_read_b128 v[120:123], v1 offset:7168
    v_fma_f32 v39, v39, v124, v131
    buffer_load_dwordx4 v1, s[4:7], s15 offen offset:1024 lds
    v_mfma_f32_16x16x32_bf16 v[80:83], v[96:99], a[156:159], 0
    v_max_f32 v36, 0, v36
    v_max_f32 v37, 0, v37
    v_mfma_f32_16x16x32_bf16 v[84:87], v[100:103], a[152:155], 0
    ds_read_b128 v[164:167], v1 offset:8192
    v_max_f32 v38, 0, v38
    v_max_f32 v39, 0, v39
    v_mfma_f32_16x16x32_bf16 v[88:91], v[100:103], a[156:159], 0
    v_mul_f32 v36, v36, v36
    s_waitcnt lgkmcnt(3)
    v_mfma_f32_16x16x32_bf16 v[68:71], v[104:107], a[144:147], v[68:71]
    ds_read_b128 v[92:95], v1 offset:9216
    v_mul_f32 v37, v37, v37
    v_mul_f32 v38, v38, v38
    v_mfma_f32_16x16x32_bf16 v[72:75], v[104:107], a[148:151], v[72:75]
    v_mul_f32 v39, v39, v39
    v_cvt_pk_bf16_f32 v36, v36, v37
    v_mfma_f32_16x16x32_bf16 v[76:79], v[108:111], a[144:147], v[76:79]
    ds_read_b128 v[96:99], v1 offset:10240
    v_cvt_pk_bf16_f32 v37, v38, v39
    buffer_load_dwordx4 v1, s[4:7], s15 offen offset:2048 lds
    v_mfma_f32_16x16x32_bf16 v[80:83], v[108:111], a[148:151], v[80:83]
    v_fma_f32 v44, v44, v124, v136
    v_fma_f32 v45, v45, v124, v137
    v_mfma_f32_16x16x32_bf16 v[84:87], v[112:115], a[144:147], v[84:87]
    ds_read_b128 v[100:103], v1 offset:11264
    v_fma_f32 v46, v46, v124, v138
    v_fma_f32 v47, v47, v124, v139
    v_mfma_f32_16x16x32_bf16 v[88:91], v[112:115], a[148:151], v[88:91]
    v_max_f32 v44, 0, v44
    s_waitcnt lgkmcnt(3)
    v_mfma_f32_16x16x32_bf16 v[68:71], v[116:119], a[136:139], v[68:71]
    ds_read_b128 v[104:107], v1 offset:12288
    v_max_f32 v45, 0, v45
    v_max_f32 v46, 0, v46
    v_mfma_f32_16x16x32_bf16 v[72:75], v[116:119], a[140:143], v[72:75]
    v_max_f32 v47, 0, v47
    v_mfma_f32_16x16x32_bf16 v[76:79], v[120:123], a[136:139], v[76:79]
    ds_read_b128 v[108:111], v1 offset:13312
    v_mul_f32 v44, v44, v44
    v_mul_f32 v45, v45, v45
    v_mfma_f32_16x16x32_bf16 v[80:83], v[120:123], a[140:143], v[80:83]
    v_mul_f32 v46, v46, v46
    v_mfma_f32_16x16x32_bf16 v[84:87], v[164:167], a[136:139], v[84:87]
    ds_read_b128 v[112:115], v1 offset:14336
    v_mul_f32_e64 v47, v47, v47
    v_cvt_pk_bf16_f32 v38, v44, v45
    v_mfma_f32_16x16x32_bf16 v[88:91], v[164:167], a[140:143], v[88:91]
    v_cvt_pk_bf16_f32 v39, v46, v47
    buffer_store_dwordx4 v[36:39], v1, s[4:7], s35 offen offset:0 sc1
    s_waitcnt lgkmcnt(3)
    v_mfma_f32_16x16x32_bf16 v[68:71], v[92:95], a[128:131], v[68:71]
    ds_read_b128 v[116:119], v1 offset:15360
    v_fma_f32 v40, v40, v125, v132
    v_fma_f32 v41, v41, v125, v133
    v_mfma_f32_16x16x32_bf16 v[72:75], v[92:95], a[132:135], v[72:75]
    v_fma_f32 v42, v42, v125, v134
    s_add_u32 s71, s28, 47104
    buffer_load_dwordx4 a[156:159], v1, s[4:7], s71 offen offset:0
    v_mfma_f32_16x16x32_bf16 v[76:79], v[96:99], a[128:131], v[76:79]
    ds_read_b128 v[120:123], v1 offset:16384
    v_fma_f32 v43, v43, v125, v135
    v_max_f32 v40, 0, v40
    v_mfma_f32_16x16x32_bf16 v[80:83], v[96:99], a[132:135], v[80:83]
    v_max_f32 v41, 0, v41
    v_mfma_f32_16x16x32_bf16 v[84:87], v[100:103], a[128:131], v[84:87]
    ds_read_b128 v[164:167], v1 offset:17408
    v_max_f32 v42, 0, v42
    v_max_f32 v43, 0, v43
    buffer_load_dwordx4 a[152:155], v1, s[4:7], s71 offen offset:1024
    v_mfma_f32_16x16x32_bf16 v[88:91], v[100:103], a[132:135], v[88:91]
    v_mul_f32 v40, v40, v40
    s_waitcnt lgkmcnt(3)
    v_mfma_f32_16x16x32_bf16 v[68:71], v[104:107], a[120:123], v[68:71]
    ds_read_b128 v[92:95], v1 offset:18432
    v_mul_f32 v41, v41, v41
    v_mul_f32 v42, v42, v42
    v_mfma_f32_16x16x32_bf16 v[72:75], v[104:107], a[124:127], v[72:75]
    v_mul_f32 v43, v43, v43
    v_cvt_pk_bf16_f32 v40, v40, v41
    v_mfma_f32_16x16x32_bf16 v[76:79], v[108:111], a[120:123], v[76:79]
    ds_read_b128 v[96:99], v1 offset:19456
    v_cvt_pk_bf16_f32 v41, v42, v43
    buffer_load_dwordx4 a[148:151], v1, s[4:7], s71 offen offset:2048
    v_mfma_f32_16x16x32_bf16 v[80:83], v[108:111], a[124:127], v[80:83]
    v_fma_f32 v48, v48, v125, v140
    v_fma_f32 v49, v49, v125, v141
    v_mfma_f32_16x16x32_bf16 v[84:87], v[112:115], a[120:123], v[84:87]
    ds_read_b128 v[100:103], v1 offset:20480
    v_fma_f32 v50, v50, v125, v142
    v_fma_f32 v51, v51, v125, v143
    v_mfma_f32_16x16x32_bf16 v[88:91], v[112:115], a[124:127], v[88:91]
    v_max_f32 v48, 0, v48
    s_waitcnt lgkmcnt(3)
    v_mfma_f32_16x16x32_bf16 v[68:71], v[116:119], a[112:115], v[68:71]
    ds_read_b128 v[104:107], v1 offset:21504
    v_max_f32 v49, 0, v49
    v_max_f32 v50, 0, v50
    v_mfma_f32_16x16x32_bf16 v[72:75], v[116:119], a[116:119], v[72:75]
    v_max_f32 v51, 0, v51
    v_mfma_f32_16x16x32_bf16 v[76:79], v[120:123], a[112:115], v[76:79]
    ds_read_b128 v[108:111], v1 offset:22528
    v_mul_f32 v48, v48, v48
    v_mul_f32 v49, v49, v49
    v_mfma_f32_16x16x32_bf16 v[80:83], v[120:123], a[116:119], v[80:83]
    v_mul_f32 v50, v50, v50
    v_mfma_f32_16x16x32_bf16 v[84:87], v[164:167], a[112:115], v[84:87]
    ds_read_b128 v[112:115], v1 offset:23552
    v_mul_f32_e64 v51, v51, v51
    v_cvt_pk_bf16_f32 v42, v48, v49
    v_mfma_f32_16x16x32_bf16 v[88:91], v[164:167], a[116:119], v[88:91]
    v_cvt_pk_bf16_f32 v43, v50, v51
    buffer_store_dwordx4 v[40:43], v1, s[4:7], s35 offen offset:1024 sc1
    buffer_load_dwordx4 a[144:147], v1, s[4:7], s71 offen offset:3072
    s_waitcnt lgkmcnt(3)
    v_mfma_f32_16x16x32_bf16 v[68:71], v[92:95], a[104:107], v[68:71]
    ds_read_b128 v[116:119], v1 offset:24576
    v_fma_f32 v52, v52, v124, v144
    v_fma_f32 v53, v53, v124, v145
    v_mfma_f32_16x16x32_bf16 v[72:75], v[92:95], a[108:111], v[72:75]
    v_fma_f32 v54, v54, v124, v146
    v_fma_f32 v55, v55, v124, v147
    v_mfma_f32_16x16x32_bf16 v[76:79], v[96:99], a[104:107], v[76:79]
    ds_read_b128 v[120:123], v1 offset:25600
    v_max_f32 v52, 0, v52
    s_add_u32 s71, s28, 51200
    buffer_load_dwordx4 a[140:143], v1, s[4:7], s71 offen offset:0
    v_mfma_f32_16x16x32_bf16 v[80:83], v[96:99], a[108:111], v[80:83]
    v_max_f32 v53, 0, v53
    v_max_f32 v54, 0, v54
    v_mfma_f32_16x16x32_bf16 v[84:87], v[100:103], a[104:107], v[84:87]
    ds_read_b128 v[164:167], v1 offset:26624
    v_max_f32 v55, 0, v55
    v_mul_f32 v52, v52, v52
    v_mfma_f32_16x16x32_bf16 v[88:91], v[100:103], a[108:111], v[88:91]
    v_mul_f32 v53, v53, v53
    s_waitcnt lgkmcnt(3)
    v_mfma_f32_16x16x32_bf16 v[68:71], v[104:107], a[96:99], v[68:71]
    ds_read_b128 v[92:95], v1 offset:27648
    v_mul_f32 v54, v54, v54
    v_mul_f32 v55, v55, v55
    v_mfma_f32_16x16x32_bf16 v[72:75], v[104:107], a[100:103], v[72:75]
    v_cvt_pk_bf16_f32 v52, v52, v53
    buffer_load_dwordx4 a[136:139], v1, s[4:7], s71 offen offset:1024
    v_mfma_f32_16x16x32_bf16 v[76:79], v[108:111], a[96:99], v[76:79]
    ds_read_b128 v[96:99], v1 offset:28672
    v_cvt_pk_bf16_f32 v53, v54, v55
    v_fma_f32 v60, v60, v124, v152
    v_mfma_f32_16x16x32_bf16 v[80:83], v[108:111], a[100:103], v[80:83]
    v_fma_f32 v61, v61, v124, v153
    v_mfma_f32_16x16x32_bf16 v[84:87], v[112:115], a[96:99], v[84:87]
    ds_read_b128 v[100:103], v1 offset:29696
    v_fma_f32 v62, v62, v124, v154
    v_fma_f32 v63, v63, v124, v155
    buffer_load_dwordx4 a[132:135], v1, s[4:7], s71 offen offset:2048
    v_mfma_f32_16x16x32_bf16 v[88:91], v[112:115], a[100:103], v[88:91]
    v_max_f32 v60, 0, v60
    s_waitcnt lgkmcnt(3)
    v_mfma_f32_16x16x32_bf16 v[68:71], v[116:119], a[88:91], v[68:71]
    s_waitcnt vmcnt(9)
    s_barrier
    v_mfma_f32_16x16x32_bf16 v[72:75], v[116:119], a[92:95], v[72:75]
    ds_read_b128 v[104:107], v1 offset:30720
    v_max_f32 v61, 0, v61
    v_max_f32 v62, 0, v62
    v_mfma_f32_16x16x32_bf16 v[76:79], v[120:123], a[88:91], v[76:79]
    ds_read_b128 v[108:111], v1 offset:31744
    v_max_f32 v63, 0, v63
    v_mul_f32 v60, v60, v60
    v_mfma_f32_16x16x32_bf16 v[80:83], v[120:123], a[92:95], v[80:83]
    ds_read_b128 v[112:115], v1 offset:32768
    v_mul_f32 v61, v61, v61
    v_mul_f32 v62, v62, v62
    v_mfma_f32_16x16x32_bf16 v[84:87], v[164:167], a[88:91], v[84:87]
    v_mul_f32_e64 v63, v63, v63
    v_cvt_pk_bf16_f32 v54, v60, v61
    v_mfma_f32_16x16x32_bf16 v[88:91], v[164:167], a[92:95], v[88:91]
    v_cvt_pk_bf16_f32 v55, v62, v63
    buffer_store_dwordx4 v[52:55], v1, s[4:7], s53 offen offset:0 sc1
    buffer_load_dwordx4 a[128:131], v1, s[4:7], s71 offen offset:3072
    s_waitcnt lgkmcnt(3)
    v_mfma_f32_16x16x32_bf16 v[68:71], v[92:95], a[80:83], v[68:71]
    ds_read_b128 v[116:119], v1 offset:33792
    v_fma_f32 v56, v56, v125, v148
    v_fma_f32 v57, v57, v125, v149
    v_mfma_f32_16x16x32_bf16 v[72:75], v[92:95], a[84:87], v[72:75]
    v_fma_f32 v58, v58, v125, v150
    v_fma_f32 v59, v59, v125, v151
    v_mfma_f32_16x16x32_bf16 v[76:79], v[96:99], a[80:83], v[76:79]
    ds_read_b128 v[120:123], v1 offset:34816
    v_max_f32 v56, 0, v56
    s_add_u32 s71, s28, 55296
    buffer_load_dwordx4 a[124:127], v1, s[4:7], s71 offen offset:0
    v_mfma_f32_16x16x32_bf16 v[80:83], v[96:99], a[84:87], v[80:83]
    v_max_f32 v57, 0, v57
    v_max_f32 v58, 0, v58
    v_mfma_f32_16x16x32_bf16 v[84:87], v[100:103], a[80:83], v[84:87]
    ds_read_b128 v[164:167], v1 offset:35840
    v_max_f32 v59, 0, v59
    v_mul_f32 v56, v56, v56
    v_mfma_f32_16x16x32_bf16 v[88:91], v[100:103], a[84:87], v[88:91]
    v_mul_f32 v57, v57, v57
    s_waitcnt lgkmcnt(3)
    v_mfma_f32_16x16x32_bf16 v[68:71], v[104:107], a[72:75], v[68:71]
    ds_read_b128 v[92:95], v1 offset:36864
    v_mul_f32 v58, v58, v58
    v_mul_f32 v59, v59, v59
    v_mfma_f32_16x16x32_bf16 v[72:75], v[104:107], a[76:79], v[72:75]
    v_cvt_pk_bf16_f32 v56, v56, v57
    v_cvt_pk_bf16_f32 v57, v58, v59
    v_mfma_f32_16x16x32_bf16 v[76:79], v[108:111], a[72:75], v[76:79]
    ds_read_b128 v[96:99], v1 offset:37888
    v_fma_f32 v64, v64, v125, v156
    buffer_load_dwordx4 a[120:123], v1, s[4:7], s71 offen offset:1024
    v_mfma_f32_16x16x32_bf16 v[80:83], v[108:111], a[76:79], v[80:83]
    v_fma_f32 v65, v65, v125, v157
    v_fma_f32 v66, v66, v125, v158
    v_mfma_f32_16x16x32_bf16 v[84:87], v[112:115], a[72:75], v[84:87]
    ds_read_b128 v[100:103], v1 offset:38912
    v_fma_f32 v67, v67, v125, v159
    v_max_f32 v64, 0, v64
    v_mfma_f32_16x16x32_bf16 v[88:91], v[112:115], a[76:79], v[88:91]
    v_max_f32 v65, 0, v65
    s_waitcnt lgkmcnt(3)
    v_mfma_f32_16x16x32_bf16 v[68:71], v[116:119], a[64:67], v[68:71]
    ds_read_b128 v[104:107], v1 offset:39936
    v_max_f32 v66, 0, v66
    v_max_f32 v67, 0, v67
    v_mfma_f32_16x16x32_bf16 v[72:75], v[116:119], a[68:71], v[72:75]
    v_mul_f32 v64, v64, v64
    v_mfma_f32_16x16x32_bf16 v[76:79], v[120:123], a[64:67], v[76:79]
    ds_read_b128 v[108:111], v1 offset:40960
    v_mul_f32 v65, v65, v65
    v_mfma_f32_16x16x32_bf16 v[80:83], v[120:123], a[68:71], v[80:83]
    v_mul_f32 v66, v66, v66
    v_mul_f32_e64 v67, v67, v67
    v_mfma_f32_16x16x32_bf16 v[84:87], v[164:167], a[64:67], v[84:87]
    ds_read_b128 v[112:115], v1 offset:41984
    v_cvt_pk_bf16_f32 v58, v64, v65
    v_mfma_f32_16x16x32_bf16 v[88:91], v[164:167], a[68:71], v[88:91]
    v_cvt_pk_bf16_f32 v59, v66, v67
    buffer_store_dwordx4 v[56:59], v1, s[4:7], s53 offen offset:1024 sc1
    buffer_load_dwordx4 a[116:119], v1, s[4:7], s71 offen offset:2048
    buffer_load_dwordx4 a[112:115], v1, s[4:7], s71 offen offset:3072
    s_waitcnt lgkmcnt(3)
    v_mfma_f32_16x16x32_bf16 v[68:71], v[92:95], a[56:59], v[68:71]
    ds_read_b128 v[116:119], v1 offset:43008
    v_mfma_f32_16x16x32_bf16 v[72:75], v[92:95], a[60:63], v[72:75]
    v_mfma_f32_16x16x32_bf16 v[76:79], v[96:99], a[56:59], v[76:79]
    ds_read_b128 v[120:123], v1 offset:44032
    s_add_u32 s71, s28, 59392
    buffer_load_dwordx4 a[108:111], v1, s[4:7], s71 offen offset:0
    v_mfma_f32_16x16x32_bf16 v[80:83], v[96:99], a[60:63], v[80:83]
    v_mfma_f32_16x16x32_bf16 v[84:87], v[100:103], a[56:59], v[84:87]
    ds_read_b128 v[164:167], v1 offset:45056
    v_mfma_f32_16x16x32_bf16 v[88:91], v[100:103], a[60:63], v[88:91]
    s_waitcnt lgkmcnt(3)
    v_mfma_f32_16x16x32_bf16 v[68:71], v[104:107], a[48:51], v[68:71]
    ds_read_b128 v[92:95], v1 offset:46080
    v_mfma_f32_16x16x32_bf16 v[72:75], v[104:107], a[52:55], v[72:75]
    v_mfma_f32_16x16x32_bf16 v[76:79], v[108:111], a[48:51], v[76:79]
    ds_read_b128 v[96:99], v1 offset:47104
    buffer_load_dwordx4 a[104:107], v1, s[4:7], s71 offen offset:1024
    v_mfma_f32_16x16x32_bf16 v[80:83], v[108:111], a[52:55], v[80:83]
    v_mfma_f32_16x16x32_bf16 v[84:87], v[112:115], a[48:51], v[84:87]
    ds_read_b128 v[100:103], v1 offset:48128
    v_mfma_f32_16x16x32_bf16 v[88:91], v[112:115], a[52:55], v[88:91]
    s_waitcnt lgkmcnt(3)
    v_mfma_f32_16x16x32_bf16 v[68:71], v[116:119], a[40:43], v[68:71]
    ds_read_b128 v[104:107], v1 offset:49152
    v_mfma_f32_16x16x32_bf16 v[72:75], v[116:119], a[44:47], v[72:75]
    v_mfma_f32_16x16x32_bf16 v[76:79], v[120:123], a[40:43], v[76:79]
    ds_read_b128 v[108:111], v1 offset:50176
    buffer_load_dwordx4 a[100:103], v1, s[4:7], s71 offen offset:2048
    v_mfma_f32_16x16x32_bf16 v[80:83], v[120:123], a[44:47], v[80:83]
    v_mfma_f32_16x16x32_bf16 v[84:87], v[164:167], a[40:43], v[84:87]
    ds_read_b128 v[112:115], v1 offset:51200
    v_mfma_f32_16x16x32_bf16 v[88:91], v[164:167], a[44:47], v[88:91]
    s_waitcnt lgkmcnt(3)
    v_mfma_f32_16x16x32_bf16 v[68:71], v[92:95], a[32:35], v[68:71]
    ds_read_b128 v[116:119], v1 offset:52224
    v_mfma_f32_16x16x32_bf16 v[72:75], v[92:95], a[36:39], v[72:75]
    buffer_load_dwordx4 a[96:99], v1, s[4:7], s71 offen offset:3072
    v_mfma_f32_16x16x32_bf16 v[76:79], v[96:99], a[32:35], v[76:79]
    ds_read_b128 v[120:123], v1 offset:53248
    v_mfma_f32_16x16x32_bf16 v[80:83], v[96:99], a[36:39], v[80:83]
    v_mfma_f32_16x16x32_bf16 v[84:87], v[100:103], a[32:35], v[84:87]
    ds_read_b128 v[164:167], v1 offset:54272
    s_add_u32 s71, s28, 63488
    buffer_load_dwordx4 a[92:95], v1, s[4:7], s71 offen offset:0
    v_mfma_f32_16x16x32_bf16 v[88:91], v[100:103], a[36:39], v[88:91]
    s_waitcnt lgkmcnt(3)
    v_mfma_f32_16x16x32_bf16 v[68:71], v[104:107], a[24:27], v[68:71]
    ds_read_b128 v[92:95], v1 offset:55296
    v_mfma_f32_16x16x32_bf16 v[72:75], v[104:107], a[28:31], v[72:75]
    v_mfma_f32_16x16x32_bf16 v[76:79], v[108:111], a[24:27], v[76:79]
    ds_read_b128 v[96:99], v1 offset:56320
    buffer_load_dwordx4 a[88:91], v1, s[4:7], s71 offen offset:1024
    v_mfma_f32_16x16x32_bf16 v[80:83], v[108:111], a[28:31], v[80:83]
    v_mfma_f32_16x16x32_bf16 v[84:87], v[112:115], a[24:27], v[84:87]
    ds_read_b128 v[100:103], v1 offset:57344
    v_mfma_f32_16x16x32_bf16 v[88:91], v[112:115], a[28:31], v[88:91]
    s_waitcnt lgkmcnt(3)
    v_mfma_f32_16x16x32_bf16 v[68:71], v[116:119], a[16:19], v[68:71]
    ds_read_b128 v[104:107], v1 offset:58368
    ds_read_b128 v[144:147], v12 offset:768
    v_mfma_f32_16x16x32_bf16 v[72:75], v[116:119], a[20:23], v[72:75]
    v_mfma_f32_16x16x32_bf16 v[76:79], v[120:123], a[16:19], v[76:79]
    ds_read_b128 v[108:111], v1 offset:59392
    buffer_load_dwordx4 a[84:87], v1, s[4:7], s71 offen offset:2048
    v_mfma_f32_16x16x32_bf16 v[80:83], v[120:123], a[20:23], v[80:83]
    ds_read_b128 v[148:151], v12 offset:1280
    v_mfma_f32_16x16x32_bf16 v[84:87], v[164:167], a[16:19], v[84:87]
    ds_read_b128 v[112:115], v1 offset:60416
    v_mfma_f32_16x16x32_bf16 v[88:91], v[164:167], a[20:23], v[88:91]
    s_waitcnt lgkmcnt(5)
    v_mfma_f32_16x16x32_bf16 v[68:71], v[92:95], a[8:11], v[68:71]
    ds_read_b128 v[152:155], v12 offset:832
    v_mfma_f32_16x16x32_bf16 v[72:75], v[92:95], a[12:15], v[72:75]
    s_add_u32 s3, s39, 2
    v_mov_b32 v15, s3
    s_add_u32 s3, s44, 4096
    s_waitcnt vmcnt(9)
    s_mov_b64 exec, 1
    buffer_store_dword v15, off, s[4:7], s3
    s_mov_b64 exec, -1
    v_mfma_f32_16x16x32_bf16 v[76:79], v[96:99], a[8:11], v[76:79]
    v_mfma_f32_16x16x32_bf16 v[80:83], v[96:99], a[12:15], v[80:83]
    ds_read_b128 v[156:159], v12 offset:1344
    v_mfma_f32_16x16x32_bf16 v[84:87], v[100:103], a[8:11], v[84:87]
    buffer_load_dwordx4 a[80:83], v1, s[4:7], s71 offen offset:3072
    v_mfma_f32_16x16x32_bf16 v[88:91], v[100:103], a[12:15], v[88:91]
    s_waitcnt lgkmcnt(2)
    v_mfma_f32_16x16x32_bf16 v[68:71], v[104:107], a[0:3], v[68:71]
    ds_read_b128 v[136:139], v12 offset:896
    v_mfma_f32_16x16x32_bf16 v[72:75], v[104:107], a[4:7], v[72:75]
    v_mfma_f32_16x16x32_bf16 v[76:79], v[108:111], a[0:3], v[76:79]
    v_mfma_f32_16x16x32_bf16 v[80:83], v[108:111], a[4:7], v[80:83]
    ds_read_b128 v[140:143], v12 offset:1408
    v_mfma_f32_16x16x32_bf16 v[84:87], v[112:115], a[0:3], v[84:87]
    v_mfma_f32_16x16x32_bf16 v[88:91], v[112:115], a[4:7], v[88:91]
    v_pk_fma_f32 v[128:129], v[144:145], v[126:127], v[148:149] op_sel:[0,0,0] op_sel_hi:[1,0,1]
    v_pk_fma_f32 v[130:131], v[146:147], v[126:127], v[150:151] op_sel:[0,0,0] op_sel_hi:[1,0,1]
    v_pk_fma_f32 v[68:69], v[68:69], v[124:125], v[128:129] op_sel:[0,0,0] op_sel_hi:[1,0,1]
    v_pk_fma_f32 v[70:71], v[70:71], v[124:125], v[130:131] op_sel:[0,0,0] op_sel_hi:[1,0,1]
    v_max_f32 v68, 0, v68
    v_max_f32 v69, 0, v69
    v_max_f32 v70, 0, v70
    v_max_f32_e64 v71, 0, v71
    v_pk_mul_f32 v[68:69], v[68:69], v[68:69] op_sel:[0,0] op_sel_hi:[1,1]
    v_pk_mul_f32 v[70:71], v[70:71], v[70:71] op_sel:[0,0] op_sel_hi:[1,1]
    v_cvt_pk_bf16_f32 v68, v68, v69
    v_cvt_pk_bf16_f32 v69, v70, v71
    s_waitcnt lgkmcnt(2)
    v_pk_fma_f32 v[128:129], v[152:153], v[126:127], v[156:157] op_sel:[0,0,0] op_sel_hi:[1,0,1]
    v_pk_fma_f32 v[130:131], v[154:155], v[126:127], v[158:159] op_sel:[0,0,0] op_sel_hi:[1,0,1]
    v_pk_fma_f32 v[76:77], v[76:77], v[124:125], v[128:129] op_sel:[0,0,0] op_sel_hi:[1,0,1]
    v_pk_fma_f32 v[78:79], v[78:79], v[124:125], v[130:131] op_sel:[0,0,0] op_sel_hi:[1,0,1]
    v_max_f32 v76, 0, v76
    v_max_f32 v77, 0, v77
    v_max_f32 v78, 0, v78
    v_max_f32_e64 v79, 0, v79
    v_pk_mul_f32 v[76:77], v[76:77], v[76:77] op_sel:[0,0] op_sel_hi:[1,1]
    v_pk_mul_f32 v[78:79], v[78:79], v[78:79] op_sel:[0,0] op_sel_hi:[1,1]
    v_cvt_pk_bf16_f32 v70, v76, v77
    v_cvt_pk_bf16_f32 v71, v78, v79
    buffer_store_dwordx4 v[68:71], v1, s[4:7], s38 offen offset:0
    v_pk_fma_f32 v[132:133], v[144:145], v[126:127], v[148:149] op_sel:[0,1,0] op_sel_hi:[1,1,1]
    v_pk_fma_f32 v[134:135], v[146:147], v[126:127], v[150:151] op_sel:[0,1,0] op_sel_hi:[1,1,1]
    v_pk_fma_f32 v[72:73], v[72:73], v[124:125], v[132:133] op_sel:[0,1,0] op_sel_hi:[1,1,1]
    v_pk_fma_f32 v[74:75], v[74:75], v[124:125], v[134:135] op_sel:[0,1,0] op_sel_hi:[1,1,1]
    v_max_f32 v72, 0, v72
    v_max_f32 v73, 0, v73
    v_max_f32 v74, 0, v74
    v_max_f32 v75, 0, v75
    v_pk_mul_f32 v[72:73], v[72:73], v[72:73] op_sel:[0,0] op_sel_hi:[1,1]
    v_pk_mul_f32 v[74:75], v[74:75], v[74:75] op_sel:[0,0] op_sel_hi:[1,1]
    v_cvt_pk_bf16_f32 v72, v72, v73
    v_cvt_pk_bf16_f32 v73, v74, v75
    v_pk_fma_f32 v[132:133], v[152:153], v[126:127], v[156:157] op_sel:[0,1,0] op_sel_hi:[1,1,1]
    v_pk_fma_f32 v[134:135], v[154:155], v[126:127], v[158:159] op_sel:[0,1,0] op_sel_hi:[1,1,1]
    v_pk_fma_f32 v[80:81], v[80:81], v[124:125], v[132:133] op_sel:[0,1,0] op_sel_hi:[1,1,1]
    v_pk_fma_f32 v[82:83], v[82:83], v[124:125], v[134:135] op_sel:[0,1,0] op_sel_hi:[1,1,1]
    v_max_f32 v80, 0, v80
    v_max_f32 v81, 0, v81
    v_max_f32 v82, 0, v82
    v_max_f32 v83, 0, v83
    v_pk_mul_f32 v[80:81], v[80:81], v[80:81] op_sel:[0,0] op_sel_hi:[1,1]
    v_pk_mul_f32 v[82:83], v[82:83], v[82:83] op_sel:[0,0] op_sel_hi:[1,1]
    v_cvt_pk_bf16_f32 v74, v80, v81
    v_cvt_pk_bf16_f32 v75, v82, v83
    buffer_store_dwordx4 v[72:75], v1, s[4:7], s38 offen offset:1024
    s_waitcnt lgkmcnt(0)
    v_pk_fma_f32 v[128:129], v[136:137], v[126:127], v[140:141] op_sel:[0,0,0] op_sel_hi:[1,0,1]
    v_pk_fma_f32 v[130:131], v[138:139], v[126:127], v[142:143] op_sel:[0,0,0] op_sel_hi:[1,0,1]
    v_pk_fma_f32 v[84:85], v[84:85], v[124:125], v[128:129] op_sel:[0,0,0] op_sel_hi:[1,0,1]
    v_pk_fma_f32 v[86:87], v[86:87], v[124:125], v[130:131] op_sel:[0,0,0] op_sel_hi:[1,0,1]
    v_max_f32 v84, 0, v84
    v_max_f32 v85, 0, v85
    v_max_f32 v86, 0, v86
    v_max_f32_e64 v87, 0, v87
    v_pk_mul_f32 v[84:85], v[84:85], v[84:85] op_sel:[0,0] op_sel_hi:[1,1]
    v_pk_mul_f32 v[86:87], v[86:87], v[86:87] op_sel:[0,0] op_sel_hi:[1,1]
    v_cvt_pk_bf16_f32 v84, v84, v85
    v_cvt_pk_bf16_f32 v85, v86, v87
    buffer_store_dwordx2 v[84:85], v28, s[4:7], s36 offen offset:0
    v_pk_fma_f32 v[132:133], v[136:137], v[126:127], v[140:141] op_sel:[0,1,0] op_sel_hi:[1,1,1]
    v_pk_fma_f32 v[134:135], v[138:139], v[126:127], v[142:143] op_sel:[0,1,0] op_sel_hi:[1,1,1]
    v_pk_fma_f32 v[88:89], v[88:89], v[124:125], v[132:133] op_sel:[0,1,0] op_sel_hi:[1,1,1]
    v_pk_fma_f32 v[90:91], v[90:91], v[124:125], v[134:135] op_sel:[0,1,0] op_sel_hi:[1,1,1]
    v_max_f32 v88, 0, v88
    v_max_f32 v89, 0, v89
    v_max_f32 v90, 0, v90
    v_max_f32 v91, 0, v91
    v_pk_mul_f32 v[88:89], v[88:89], v[88:89] op_sel:[0,0] op_sel_hi:[1,1]
    v_pk_mul_f32 v[90:91], v[90:91], v[90:91] op_sel:[0,0] op_sel_hi:[1,1]
    v_cvt_pk_bf16_f32 v88, v88, v89
    v_cvt_pk_bf16_f32 v89, v90, v91
    buffer_store_dwordx2 v[88:89], v28, s[4:7], s36 offen offset:1024
    v_and_b32 v15, 127, v2
    v_add_u32 v15, 4096, v15
    buffer_load_dword v14, v15, s[4:7], s45 offen sc1
    s_add_u32 s71, s28, 67584
    buffer_load_dwordx4 v[148:151], v1, s[4:7], s71 offen offset:0
    buffer_load_dwordx4 v[152:155], v1, s[4:7], s71 offen offset:1024
    buffer_load_dwordx4 v[156:159], v1, s[4:7], s71 offen offset:2048
    buffer_load_dwordx4 v[160:163], v1, s[4:7], s71 offen offset:3072
    s_add_u32 s3, s16, 1
    s_and_b32 s3, s3, 3
    s_lshl_b32 s3, s3, 10
    v_add_u32 v144, s3, v1
    s_add_u32 s3, s16, 2
    s_and_b32 s3, s3, 3
    s_lshl_b32 s3, s3, 10
    v_add_u32 v145, s3, v1
    s_add_u32 s3, s16, 3
    s_and_b32 s3, s3, 3
    s_lshl_b32 s3, s3, 10
    v_add_u32 v146, s3, v1
    s_add_u32 s3, s16, 4
    s_and_b32 s3, s3, 3
    s_lshl_b32 s3, s3, 10
    v_add_u32 v147, s3, v1
    ds_read_b128 v[120:123], v12 offset:1536
    ds_read_b128 v[124:127], v12 offset:1600
    ds_read_b128 v[128:131], v12 offset:1664
    ds_read_b128 v[132:135], v12 offset:1728
    ds_read_b128 v[136:139], v12 offset:1792
    v_lshlrev_b32_e64 v96, 16, v16
    v_and_b32 v97, 0xffff0000, v16
    v_lshlrev_b32_e64 v98, 16, v17
    v_and_b32 v99, 0xffff0000, v17
    v_lshlrev_b32_e64 v100, 16, v18
    v_and_b32 v101, 0xffff0000, v18
    v_lshlrev_b32_e64 v102, 16, v19
    v_and_b32 v103, 0xffff0000, v19
    v_lshlrev_b32_e64 v104, 16, v20
    v_and_b32 v105, 0xffff0000, v20
    v_lshlrev_b32_e64 v106, 16, v21
    v_and_b32 v107, 0xffff0000, v21
    v_lshlrev_b32_e64 v108, 16, v22
    v_and_b32 v109, 0xffff0000, v22
    v_lshlrev_b32_e64 v110, 16, v23
    v_and_b32 v111, 0xffff0000, v23
    v_lshlrev_b32_e64 v112, 16, v24
    v_and_b32 v113, 0xffff0000, v24
    v_lshlrev_b32_e64 v114, 16, v25
    v_and_b32 v115, 0xffff0000, v25
    s_waitcnt lgkmcnt(4)
    v_pk_add_f32 v[96:97], v[96:97], v[120:121] op_sel:[0,0] op_sel_hi:[1,1]
    v_pk_add_f32 v[98:99], v[98:99], v[122:123] op_sel:[0,0] op_sel_hi:[1,1]
    s_waitcnt lgkmcnt(3)
    v_pk_add_f32 v[100:101], v[100:101], v[124:125] op_sel:[0,0] op_sel_hi:[1,1]
    v_pk_add_f32 v[102:103], v[102:103], v[126:127] op_sel:[0,0] op_sel_hi:[1,1]
    s_waitcnt lgkmcnt(2)
    v_pk_add_f32 v[104:105], v[104:105], v[128:129] op_sel:[0,0] op_sel_hi:[1,1]
    v_pk_add_f32 v[106:107], v[106:107], v[130:131] op_sel:[0,0] op_sel_hi:[1,1]
    s_waitcnt lgkmcnt(1)
    v_pk_add_f32 v[108:109], v[108:109], v[132:133] op_sel:[0,0] op_sel_hi:[1,1]
    v_pk_add_f32 v[110:111], v[110:111], v[134:135] op_sel:[0,0] op_sel_hi:[1,1]
    s_waitcnt lgkmcnt(0)
    v_pk_add_f32 v[112:113], v[112:113], v[136:137] op_sel:[0,0] op_sel_hi:[1,1]
    v_pk_add_f32 v[114:115], v[114:115], v[138:139] op_sel:[0,0] op_sel_hi:[1,1]
    s_add_u32 s52, s39, 2
    s_waitcnt vmcnt(4)
    v_cmp_ne_u32 vcc, s52, v14
    s_nop 1
    s_cbranch_vccz L_ok_38
    s_mov_b32 s60, 0
L_lp_37:
    v_and_b32 v15, 127, v2
    v_add_u32 v15, 4096, v15
    buffer_load_dword v14, v15, s[4:7], s45 offen sc1
    s_add_u32 s60, s60, 1
    s_cmp_gt_u32 s60, 0x40000
    s_cbranch_scc1 L_abort
    s_waitcnt vmcnt(0)
    v_cmp_ne_u32 vcc, s52, v14
    s_nop 1
    s_cbranch_vccnz L_lp_37
L_ok_38:
    s_lshl_b32 s53, s16, 15
    s_add_u32 s53, s53, s37
    s_add_u32 s53, s53, 90112
    buffer_load_dwordx4 a[0:3], v144, s[4:7], s53 offen sc1
    buffer_load_dwordx4 a[4:7], v145, s[4:7], s53 offen sc1
    buffer_load_dwordx4 a[8:11], v146, s[4:7], s53 offen sc1
    buffer_load_dwordx4 a[12:15], v147, s[4:7], s53 offen sc1
    s_add_u32 s53, s53, 4096
    buffer_load_dwordx4 a[16:19], v144, s[4:7], s53 offen sc1
    buffer_load_dwordx4 a[20:23], v145, s[4:7], s53 offen sc1
    buffer_load_dwordx4 a[24:27], v146, s[4:7], s53 offen sc1
    buffer_load_dwordx4 a[28:31], v147, s[4:7], s53 offen sc1
    s_waitcnt vmcnt(7)
    v_mfma_f32_16x16x32_bf16 v[36:39], v[168:171], a[0:3], 0
    v_mfma_f32_16x16x32_bf16 v[40:43], v[172:175], a[0:3], 0
    s_add_u32 s53, s53, 4096
    buffer_load_dwordx4 a[32:35], v144, s[4:7], s53 offen sc1
    v_mfma_f32_16x16x32_bf16 v[44:47], v[176:179], a[0:3], 0
    v_mfma_f32_16x16x32_bf16 v[48:51], v[180:183], a[0:3], 0
    v_mfma_f32_16x16x32_bf16 v[52:55], v[184:187], a[0:3], 0
    s_waitcnt vmcnt(7)
    v_mfma_f32_16x16x32_bf16 v[56:59], v[168:171], a[4:7], 0
    buffer_load_dwordx4 a[36:39], v145, s[4:7], s53 offen sc1
    v_mfma_f32_16x16x32_bf16 v[60:63], v[172:175], a[4:7], 0
    v_mfma_f32_16x16x32_bf16 v[64:67], v[176:179], a[4:7], 0
    v_mfma_f32_16x16x32_bf16 v[68:71], v[180:183], a[4:7], 0
    v_mfma_f32_16x16x32_bf16 v[72:75], v[184:187], a[4:7], 0
    buffer_load_dwordx4 a[40:43], v146, s[4:7], s53 offen sc1
    s_waitcnt vmcnt(8)
    v_mfma_f32_16x16x32_bf16 v[76:79], v[168:171], a[8:11], 0
    v_mfma_f32_16x16x32_bf16 v[80:83], v[172:175], a[8:11], 0
    v_mfma_f32_16x16x32_bf16 v[84:87], v[176:179], a[8:11], 0
    v_mfma_f32_16x16x32_bf16 v[88:91], v[180:183], a[8:11], 0
    buffer_load_dwordx4 a[44:47], v147, s[4:7], s53 offen sc1
    v_mfma_f32_16x16x32_bf16 v[92:95], v[184:187], a[8:11], 0
    s_waitcnt vmcnt(8)
    v_mfma_f32_16x16x32_bf16 v[96:99], v[168:171], a[12:15], v[96:99]
    v_mfma_f32_16x16x32_bf16 v[100:103], v[172:175], a[12:15], v[100:103]
    v_mfma_f32_16x16x32_bf16 v[104:107], v[176:179], a[12:15], v[104:107]
    s_add_u32 s53, s53, 4096
    buffer_load_dwordx4 a[48:51], v144, s[4:7], s53 offen sc1
    v_mfma_f32_16x16x32_bf16 v[108:111], v[180:183], a[12:15], v[108:111]
    v_mfma_f32_16x16x32_bf16 v[112:115], v[184:187], a[12:15], v[112:115]
    s_waitcnt vmcnt(8)
    v_mfma_f32_16x16x32_bf16 v[36:39], v[188:191], a[16:19], v[36:39]
    v_mfma_f32_16x16x32_bf16 v[40:43], v[192:195], a[16:19], v[40:43]
    s_add_u32 s3, s39, 2
    v_mov_b32 v15, s3
    s_mov_b64 exec, 1
    buffer_store_dword v15, off, s[4:7], s44
    s_mov_b64 exec, -1
    v_mfma_f32_16x16x32_bf16 v[44:47], v[196:199], a[16:19], v[44:47]
    v_mfma_f32_16x16x32_bf16 v[48:51], v[200:203], a[16:19], v[48:51]
    v_mfma_f32_16x16x32_bf16 v[52:55], v[204:207], a[16:19], v[52:55]
    buffer_load_dwordx4 a[52:55], v145, s[4:7], s53 offen sc1
    s_waitcnt vmcnt(9)
    v_mfma_f32_16x16x32_bf16 v[56:59], v[188:191], a[20:23], v[56:59]
    v_mfma_f32_16x16x32_bf16 v[60:63], v[192:195], a[20:23], v[60:63]
    v_mfma_f32_16x16x32_bf16 v[64:67], v[196:199], a[20:23], v[64:67]
    buffer_load_dwordx4 a[56:59], v146, s[4:7], s53 offen sc1
    v_mfma_f32_16x16x32_bf16 v[68:71], v[200:203], a[20:23], v[68:71]
    v_mfma_f32_16x16x32_bf16 v[72:75], v[204:207], a[20:23], v[72:75]
    s_waitcnt vmcnt(9)
    v_mfma_f32_16x16x32_bf16 v[76:79], v[188:191], a[24:27], v[76:79]
    v_mfma_f32_16x16x32_bf16 v[80:83], v[192:195], a[24:27], v[80:83]
    buffer_load_dwordx4 a[60:63], v147, s[4:7], s53 offen sc1
    v_mfma_f32_16x16x32_bf16 v[84:87], v[196:199], a[24:27], v[84:87]
    v_mfma_f32_16x16x32_bf16 v[88:91], v[200:203], a[24:27], v[88:91]
    v_mfma_f32_16x16x32_bf16 v[92:95], v[204:207], a[24:27], v[92:95]
    s_add_u32 s53, s53, 4096
    buffer_load_dwordx4 a[64:67], v144, s[4:7], s53 offen sc1
    s_waitcnt vmcnt(10)
    v_mfma_f32_16x16x32_bf16 v[96:99], v[188:191], a[28:31], v[96:99]
    v_mfma_f32_16x16x32_bf16 v[100:103], v[192:195], a[28:31], v[100:103]
    v_mfma_f32_16x16x32_bf16 v[104:107], v[196:199], a[28:31], v[104:107]
    buffer_load_dwordx4 a[68:71], v145, s[4:7], s53 offen sc1
    v_mfma_f32_16x16x32_bf16 v[108:111], v[200:203], a[28:31], v[108:111]
    v_mfma_f32_16x16x32_bf16 v[112:115], v[204:207], a[28:31], v[112:115]
    s_waitcnt vmcnt(10)
    v_mfma_f32_16x16x32_bf16 v[36:39], v[208:211], a[32:35], v[36:39]
    v_mfma_f32_16x16x32_bf16 v[40:43], v[212:215], a[32:35], v[40:43]
    buffer_load_dwordx4 a[72:75], v146, s[4:7], s53 offen sc1
    v_mfma_f32_16x16x32_bf16 v[44:47], v[216:219], a[32:35], v[44:47]
    v_mfma_f32_16x16x32_bf16 v[48:51], v[220:223], a[32:35], v[48:51]
    v_mfma_f32_16x16x32_bf16 v[52:55], v[224:227], a[32:35], v[52:55]
    s_waitcnt vmcnt(10)
    v_mfma_f32_16x16x32_bf16 v[56:59], v[208:211], a[36:39], v[56:59]
    buffer_load_dwordx4 a[76:79], v147, s[4:7], s53 offen sc1
    v_mfma_f32_16x16x32_bf16 v[60:63], v[212:215], a[36:39], v[60:63]
    v_mfma_f32_16x16x32_bf16 v[64:67], v[216:219], a[36:39], v[64:67]
    v_mfma_f32_16x16x32_bf16 v[68:71], v[220:223], a[36:39], v[68:71]
    v_mfma_f32_16x16x32_bf16 v[72:75], v[224:227], a[36:39], v[72:75]
    s_add_u32 s53, s53, 4096
    buffer_load_dwordx4 a[0:3], v144, s[4:7], s53 offen sc1
    s_waitcnt vmcnt(11)
    v_mfma_f32_16x16x32_bf16 v[76:79], v[208:211], a[40:43], v[76:79]
    v_mfma_f32_16x16x32_bf16 v[80:83], v[212:215], a[40:43], v[80:83]
    v_mfma_f32_16x16x32_bf16 v[84:87], v[216:219], a[40:43], v[84:87]
    v_mfma_f32_16x16x32_bf16 v[88:91], v[220:223], a[40:43], v[88:91]
    buffer_load_dwordx4 a[4:7], v145, s[4:7], s53 offen sc1
    v_mfma_f32_16x16x32_bf16 v[92:95], v[224:227], a[40:43], v[92:95]
    s_waitcnt vmcnt(11)
    v_mfma_f32_16x16x32_bf16 v[96:99], v[208:211], a[44:47], v[96:99]
    v_mfma_f32_16x16x32_bf16 v[100:103], v[212:215], a[44:47], v[100:103]
    v_mfma_f32_16x16x32_bf16 v[104:107], v[216:219], a[44:47], v[104:107]
    buffer_load_dwordx4 a[8:11], v146, s[4:7], s53 offen sc1
    v_mfma_f32_16x16x32_bf16 v[108:111], v[220:223], a[44:47], v[108:111]
    v_mfma_f32_16x16x32_bf16 v[112:115], v[224:227], a[44:47], v[112:115]
    s_waitcnt vmcnt(11)
    v_mfma_f32_16x16x32_bf16 v[36:39], v[228:231], a[48:51], v[36:39]
    v_mfma_f32_16x16x32_bf16 v[40:43], v[232:235], a[48:51], v[40:43]
    buffer_load_dwordx4 a[12:15], v147, s[4:7], s53 offen sc1
    v_mfma_f32_16x16x32_bf16 v[44:47], v[236:239], a[48:51], v[44:47]
    v_mfma_f32_16x16x32_bf16 v[48:51], v[240:243], a[48:51], v[48:51]
    v_mfma_f32_16x16x32_bf16 v[52:55], v[244:247], a[48:51], v[52:55]
    s_add_u32 s53, s53, 4096
    buffer_load_dwordx4 a[16:19], v144, s[4:7], s53 offen sc1
    s_waitcnt vmcnt(11)
    v_mfma_f32_16x16x32_bf16 v[56:59], v[228:231], a[52:55], v[56:59]
    v_mfma_f32_16x16x32_bf16 v[60:63], v[232:235], a[52:55], v[60:63]
    v_mfma_f32_16x16x32_bf16 v[64:67], v[236:239], a[52:55], v[64:67]
    buffer_load_dwordx4 a[20:23], v145, s[4:7], s53 offen sc1
    v_mfma_f32_16x16x32_bf16 v[68:71], v[240:243], a[52:55], v[68:71]
    v_mfma_f32_16x16x32_bf16 v[72:75], v[244:247], a[52:55], v[72:75]
    s_waitcnt vmcnt(11)
    v_mfma_f32_16x16x32_bf16 v[76:79], v[228:231], a[56:59], v[76:79]
    v_mfma_f32_16x16x32_bf16 v[80:83], v[232:235], a[56:59], v[80:83]
    buffer_load_dwordx4 a[24:27], v146, s[4:7], s53 offen sc1
    v_mfma_f32_16x16x32_bf16 v[84:87], v[236:239], a[56:59], v[84:87]
    v_mfma_f32_16x16x32_bf16 v[88:91], v[240:243], a[56:59], v[88:91]
    v_mfma_f32_16x16x32_bf16 v[92:95], v[244:247], a[56:59], v[92:95]
    buffer_load_dwordx4 a[28:31], v147, s[4:7], s53 offen sc1
    s_waitcnt vmcnt(12)
    v_mfma_f32_16x16x32_bf16 v[96:99], v[228:231], a[60:63], v[96:99]
    v_mfma_f32_16x16x32_bf16 v[100:103], v[232:235], a[60:63], v[100:103]
    v_mfma_f32_16x16x32_bf16 v[104:107], v[236:239], a[60:63], v[104:107]
    v_and_b32 v15, 127, v2
    buffer_load_dword v14, v15, s[4:7], s45 offen sc1
    v_mfma_f32_16x16x32_bf16 v[108:111], v[240:243], a[60:63], v[108:111]
    v_mfma_f32_16x16x32_bf16 v[112:115], v[244:247], a[60:63], v[112:115]
    s_waitcnt vmcnt(12)
    v_mfma_f32_16x16x32_bf16 v[36:39], v[248:251], a[64:67], v[36:39]
    v_mfma_f32_16x16x32_bf16 v[40:43], v[252:255], a[64:67], v[40:43]
    v_mfma_f32_16x16x32_bf16 v[44:47], a[160:163], a[64:67], v[44:47]
    s_add_u32 s53, s53, 4096
    buffer_load_dwordx4 a[32:35], v144, s[4:7], s53 offen sc1
    v_mfma_f32_16x16x32_bf16 v[48:51], a[164:167], a[64:67], v[48:51]
    v_mfma_f32_16x16x32_bf16 v[52:55], a[168:171], a[64:67], v[52:55]
    s_waitcnt vmcnt(12)
    v_mfma_f32_16x16x32_bf16 v[56:59], v[248:251], a[68:71], v[56:59]
    v_mfma_f32_16x16x32_bf16 v[60:63], v[252:255], a[68:71], v[60:63]
    v_mfma_f32_16x16x32_bf16 v[64:67], a[160:163], a[68:71], v[64:67]
    buffer_load_dwordx4 a[36:39], v145, s[4:7], s53 offen sc1
    v_mfma_f32_16x16x32_bf16 v[68:71], a[164:167], a[68:71], v[68:71]
    v_mfma_f32_16x16x32_bf16 v[72:75], a[168:171], a[68:71], v[72:75]
    s_waitcnt vmcnt(12)
    v_mfma_f32_16x16x32_bf16 v[76:79], v[248:251], a[72:75], v[76:79]
    v_mfma_f32_16x16x32_bf16 v[80:83], v[252:255], a[72:75], v[80:83]
    v_mfma_f32_16x16x32_bf16 v[84:87], a[160:163], a[72:75], v[84:87]
    buffer_load_dwordx4 a[40:43], v146, s[4:7], s53 offen sc1
    v_mfma_f32_16x16x32_bf16 v[88:91], a[164:167], a[72:75], v[88:91]
    v_mfma_f32_16x16x32_bf16 v[92:95], a[168:171], a[72:75], v[92:95]
    s_waitcnt vmcnt(12)
    v_mfma_f32_16x16x32_bf16 v[96:99], v[248:251], a[76:79], v[96:99]
    v_mfma_f32_16x16x32_bf16 v[100:103], v[252:255], a[76:79], v[100:103]
    v_mfma_f32_16x16x32_bf16 v[104:107], a[160:163], a[76:79], v[104:107]
    buffer_load_dwordx4 a[44:47], v147, s[4:7], s53 offen sc1
    v_mfma_f32_16x16x32_bf16 v[108:111], a[164:167], a[76:79], v[108:111]
    v_mfma_f32_16x16x32_bf16 v[112:115], a[168:171], a[76:79], v[112:115]
    s_waitcnt vmcnt(12)
    v_mfma_f32_16x16x32_bf16 v[36:39], a[172:175], a[0:3], v[36:39]
    s_add_u32 s52, s39, 2
    s_waitcnt vmcnt(4)
    v_cmp_ne_u32 vcc, s52, v14
    s_nop 4
    s_cbranch_vccz L_ok_41
    s_mov_b32 s60, 0
L_lp_40:
    v_and_b32 v15, 127, v2
    buffer_load_dword v14, v15, s[4:7], s45 offen sc1
    s_add_u32 s60, s60, 1
    s_cmp_gt_u32 s60, 0x40000
    s_cbranch_scc1 L_abort
    s_waitcnt vmcnt(0)
    v_cmp_ne_u32 vcc, s52, v14
    s_nop 1
    s_cbranch_vccnz L_lp_40
L_ok_41:
    v_mfma_f32_16x16x32_bf16 v[40:43], a[176:179], a[0:3], v[40:43]
    v_mfma_f32_16x16x32_bf16 v[44:47], a[180:183], a[0:3], v[44:47]
    s_lshl_b32 s53, s16, 14
    s_add_u32 s53, s53, s37
    buffer_load_dwordx4 a[48:51], v144, s[4:7], s53 offen sc1
    v_mfma_f32_16x16x32_bf16 v[48:51], a[184:187], a[0:3], v[48:51]
    v_mfma_f32_16x16x32_bf16 v[52:55], a[188:191], a[0:3], v[52:55]
    v_mfma_f32_16x16x32_bf16 v[56:59], a[172:175], a[4:7], v[56:59]
    v_mfma_f32_16x16x32_bf16 v[60:63], a[176:179], a[4:7], v[60:63]
    buffer_load_dwordx4 a[52:55], v145, s[4:7], s53 offen sc1
    v_mfma_f32_16x16x32_bf16 v[64:67], a[180:183], a[4:7], v[64:67]
    v_mfma_f32_16x16x32_bf16 v[68:71], a[184:187], a[4:7], v[68:71]
    v_mfma_f32_16x16x32_bf16 v[72:75], a[188:191], a[4:7], v[72:75]
    v_mfma_f32_16x16x32_bf16 v[76:79], a[172:175], a[8:11], v[76:79]
    buffer_load_dwordx4 a[56:59], v146, s[4:7], s53 offen sc1
    v_mfma_f32_16x16x32_bf16 v[80:83], a[176:179], a[8:11], v[80:83]
    v_mfma_f32_16x16x32_bf16 v[84:87], a[180:183], a[8:11], v[84:87]
    v_mfma_f32_16x16x32_bf16 v[88:91], a[184:187], a[8:11], v[88:91]
    buffer_load_dwordx4 a[60:63], v147, s[4:7], s53 offen sc1
    v_mfma_f32_16x16x32_bf16 v[92:95], a[188:191], a[8:11], v[92:95]
    v_mfma_f32_16x16x32_bf16 v[96:99], a[172:175], a[12:15], v[96:99]
    v_mfma_f32_16x16x32_bf16 v[100:103], a[176:179], a[12:15], v[100:103]
    v_mfma_f32_16x16x32_bf16 v[104:107], a[180:183], a[12:15], v[104:107]
    s_add_u32 s53, s53, 4096
    buffer_load_dwordx4 a[64:67], v144, s[4:7], s53 offen sc1
    v_mfma_f32_16x16x32_bf16 v[108:111], a[184:187], a[12:15], v[108:111]
    v_mfma_f32_16x16x32_bf16 v[112:115], a[188:191], a[12:15], v[112:115]
    v_mfma_f32_16x16x32_bf16 v[36:39], a[192:195], a[16:19], v[36:39]
    v_mfma_f32_16x16x32_bf16 v[40:43], a[196:199], a[16:19], v[40:43]
    buffer_load_dwordx4 a[68:71], v145, s[4:7], s53 offen sc1
    v_mfma_f32_16x16x32_bf16 v[44:47], a[200:203], a[16:19], v[44:47]
    v_mfma_f32_16x16x32_bf16 v[48:51], a[204:207], a[16:19], v[48:51]
    v_mfma_f32_16x16x32_bf16 v[52:55], a[208:211], a[16:19], v[52:55]
    v_mfma_f32_16x16x32_bf16 v[56:59], a[192:195], a[20:23], v[56:59]
    buffer_load_dwordx4 a[72:75], v146, s[4:7], s53 offen sc1
    v_mfma_f32_16x16x32_bf16 v[60:63], a[196:199], a[20:23], v[60:63]
    v_mfma_f32_16x16x32_bf16 v[64:67], a[200:203], a[20:23], v[64:67]
    v_mfma_f32_16x16x32_bf16 v[68:71], a[204:207], a[20:23], v[68:71]
    v_mfma_f32_16x16x32_bf16 v[72:75], a[208:211], a[20:23], v[72:75]
    buffer_load_dwordx4 a[76:79], v147, s[4:7], s53 offen sc1
    v_mfma_f32_16x16x32_bf16 v[76:79], a[192:195], a[24:27], v[76:79]
    v_mfma_f32_16x16x32_bf16 v[80:83], a[196:199], a[24:27], v[80:83]
    v_mfma_f32_16x16x32_bf16 v[84:87], a[200:203], a[24:27], v[84:87]
    v_mfma_f32_16x16x32_bf16 v[88:91], a[204:207], a[24:27], v[88:91]
    s_add_u32 s53, s53, 4096
    buffer_load_dwordx4 a[0:3], v144, s[4:7], s53 offen sc1
    v_mfma_f32_16x16x32_bf16 v[92:95], a[208:211], a[24:27], v[92:95]
    v_mfma_f32_16x16x32_bf16 v[96:99], a[192:195], a[28:31], v[96:99]
    v_mfma_f32_16x16x32_bf16 v[100:103], a[196:199], a[28:31], v[100:103]
    v_mfma_f32_16x16x32_bf16 v[104:107], a[200:203], a[28:31], v[104:107]
    buffer_load_dwordx4 a[4:7], v145, s[4:7], s53 offen sc1
    v_mfma_f32_16x16x32_bf16 v[108:111], a[204:207], a[28:31], v[108:111]
    v_mfma_f32_16x16x32_bf16 v[112:115], a[208:211], a[28:31], v[112:115]
    s_waitcnt vmcnt(13)
    v_mfma_f32_16x16x32_bf16 v[36:39], a[212:215], a[32:35], v[36:39]
    s_barrier
    v_mfma_f32_16x16x32_bf16 v[40:43], a[216:219], a[32:35], v[40:43]
    v_mfma_f32_16x16x32_bf16 v[44:47], a[220:223], a[32:35], v[44:47]
    buffer_load_dwordx4 a[8:11], v146, s[4:7], s53 offen sc1
    v_mfma_f32_16x16x32_bf16 v[48:51], a[224:227], a[32:35], v[48:51]
    v_mfma_f32_16x16x32_bf16 v[52:55], a[228:231], a[32:35], v[52:55]
    s_waitcnt vmcnt(13)
    v_mfma_f32_16x16x32_bf16 v[56:59], a[212:215], a[36:39], v[56:59]
    v_mfma_f32_16x16x32_bf16 v[60:63], a[216:219], a[36:39], v[60:63]
    buffer_load_dwordx4 a[12:15], v147, s[4:7], s53 offen sc1
    v_mfma_f32_16x16x32_bf16 v[64:67], a[220:223], a[36:39], v[64:67]
    v_mfma_f32_16x16x32_bf16 v[68:71], a[224:227], a[36:39], v[68:71]
    v_mfma_f32_16x16x32_bf16 v[72:75], a[228:231], a[36:39], v[72:75]
    s_waitcnt vmcnt(13)
    v_mfma_f32_16x16x32_bf16 v[76:79], a[212:215], a[40:43], v[76:79]
    s_add_u32 s53, s53, 4096
    buffer_load_dwordx4 a[16:19], v144, s[4:7], s53 offen sc1
    v_mfma_f32_16x16x32_bf16 v[80:83], a[216:219], a[40:43], v[80:83]
    v_mfma_f32_16x16x32_bf16 v[84:87], a[220:223], a[40:43], v[84:87]
    v_mfma_f32_16x16x32_bf16 v[88:91], a[224:227], a[40:43], v[88:91]
    buffer_load_dwordx4 a[20:23], v145, s[4:7], s53 offen sc1
    v_mfma_f32_16x16x32_bf16 v[92:95], a[228:231], a[40:43], v[92:95]
    s_waitcnt vmcnt(14)
    v_mfma_f32_16x16x32_bf16 v[96:99], a[212:215], a[44:47], v[96:99]
    v_mfma_f32_16x16x32_bf16 v[100:103], a[216:219], a[44:47], v[100:103]
    v_mfma_f32_16x16x32_bf16 v[104:107], a[220:223], a[44:47], v[104:107]
    buffer_load_dwordx4 a[24:27], v146, s[4:7], s53 offen sc1
    v_mfma_f32_16x16x32_bf16 v[108:111], a[224:227], a[44:47], v[108:111]
    v_mfma_f32_16x16x32_bf16 v[112:115], a[228:231], a[44:47], v[112:115]
    s_waitcnt vmcnt(14)
    v_mfma_f32_16x16x32_bf16 v[36:39], a[232:235], a[48:51], v[36:39]
    v_mfma_f32_16x16x32_bf16 v[40:43], a[236:239], a[48:51], v[40:43]
    buffer_load_dwordx4 a[28:31], v147, s[4:7], s53 offen sc1
    v_mfma_f32_16x16x32_bf16 v[44:47], a[240:243], a[48:51], v[44:47]
    v_mfma_f32_16x16x32_bf16 v[48:51], a[244:247], a[48:51], v[48:51]
    v_mfma_f32_16x16x32_bf16 v[52:55], a[248:251], a[48:51], v[52:55]
    s_waitcnt vmcnt(14)
    v_mfma_f32_16x16x32_bf16 v[56:59], a[232:235], a[52:55], v[56:59]
    s_add_u32 s53, s97, s37
    s_add_u32 s53, s53, 65536
    buffer_load_dwordx4 a[32:35], v144, s[4:7], s53 offen sc1
    v_mfma_f32_16x16x32_bf16 v[60:63], a[236:239], a[52:55], v[60:63]
    v_mfma_f32_16x16x32_bf16 v[64:67], a[240:243], a[52:55], v[64:67]
    v_mfma_f32_16x16x32_bf16 v[68:71], a[244:247], a[52:55], v[68:71]
    v_mfma_f32_16x16x32_bf16 v[72:75], a[248:251], a[52:55], v[72:75]
    buffer_load_dwordx4 a[36:39], v145, s[4:7], s53 offen sc1
    s_waitcnt vmcnt(15)
    v_mfma_f32_16x16x32_bf16 v[76:79], a[232:235], a[56:59], v[76:79]
    v_mfma_f32_16x16x32_bf16 v[80:83], a[236:239], a[56:59], v[80:83]
    v_mfma_f32_16x16x32_bf16 v[84:87], a[240:243], a[56:59], v[84:87]
    v_mfma_f32_16x16x32_bf16 v[88:91], a[244:247], a[56:59], v[88:91]
    buffer_load_dwordx4 a[40:43], v146, s[4:7], s53 offen sc1
    v_mfma_f32_16x16x32_bf16 v[92:95], a[248:251], a[56:59], v[92:95]
    s_waitcnt vmcnt(15)
    v_mfma_f32_16x16x32_bf16 v[96:99], a[232:235], a[60:63], v[96:99]
    v_mfma_f32_16x16x32_bf16 v[100:103], a[236:239], a[60:63], v[100:103]
    v_mfma_f32_16x16x32_bf16 v[104:107], a[240:243], a[60:63], v[104:107]
    buffer_load_dwordx4 a[44:47], v147, s[4:7], s53 offen sc1
    v_mfma_f32_16x16x32_bf16 v[108:111], a[244:247], a[60:63], v[108:111]
    v_mfma_f32_16x16x32_bf16 v[112:115], a[248:251], a[60:63], v[112:115]
    s_waitcnt vmcnt(15)
    v_mfma_f32_16x16x32_bf16 v[36:39], a[252:255], a[64:67], v[36:39]
    v_mfma_f32_16x16x32_bf16 v[40:43], a[156:159], a[64:67], v[40:43]
    v_mfma_f32_16x16x32_bf16 v[44:47], a[152:155], a[64:67], v[44:47]
    v_mfma_f32_16x16x32_bf16 v[48:51], a[148:151], a[64:67], v[48:51]
    v_mfma_f32_16x16x32_bf16 v[52:55], a[144:147], a[64:67], v[52:55]
    s_lshr_b32 s53, s16, 1
    s_add_u32 s53, s53, 20
    s_lshl_b32 s53, s53, 12
    s_add_u32 s53, s53, s37
    buffer_load_dwordx4 a[48:51], v144, s[4:7], s53 offen sc1
    s_waitcnt vmcnt(15)
    v_mfma_f32_16x16x32_bf16 v[56:59], a[252:255], a[68:71], v[56:59]
    v_mfma_f32_16x16x32_bf16 v[60:63], a[156:159], a[68:71], v[60:63]
    v_mfma_f32_16x16x32_bf16 v[64:67], a[152:155], a[68:71], v[64:67]
    v_mfma_f32_16x16x32_bf16 v[68:71], a[148:151], a[68:71], v[68:71]
    v_mfma_f32_16x16x32_bf16 v[72:75], a[144:147], a[68:71], v[72:75]
    s_waitcnt vmcnt(14)
    v_mfma_f32_16x16x32_bf16 v[76:79], a[252:255], a[72:75], v[76:79]
    v_mfma_f32_16x16x32_bf16 v[80:83], a[156:159], a[72:75], v[80:83]
    v_mfma_f32_16x16x32_bf16 v[84:87], a[152:155], a[72:75], v[84:87]
    v_mfma_f32_16x16x32_bf16 v[88:91], a[148:151], a[72:75], v[88:91]
    v_mfma_f32_16x16x32_bf16 v[92:95], a[144:147], a[72:75], v[92:95]
    buffer_load_dwordx4 a[56:59], v146, s[4:7], s53 offen sc1
    s_waitcnt vmcnt(14)
    v_mfma_f32_16x16x32_bf16 v[96:99], a[252:255], a[76:79], v[96:99]
    v_mfma_f32_16x16x32_bf16 v[100:103], a[156:159], a[76:79], v[100:103]
    v_mfma_f32_16x16x32_bf16 v[104:107], a[152:155], a[76:79], v[104:107]
    v_mfma_f32_16x16x32_bf16 v[108:111], a[148:151], a[76:79], v[108:111]
    v_mfma_f32_16x16x32_bf16 v[112:115], a[144:147], a[76:79], v[112:115]
    s_waitcnt vmcnt(13)
    v_mfma_f32_16x16x32_bf16 v[36:39], a[140:143], a[0:3], v[36:39]
    v_mfma_f32_16x16x32_bf16 v[40:43], a[136:139], a[0:3], v[40:43]
    v_mfma_f32_16x16x32_bf16 v[52:55], a[124:127], a[0:3], v[52:55]
    s_waitcnt vmcnt(9)
    v_mfma_f32_16x16x32_bf16 v[36:39], a[120:123], a[16:19], v[36:39]
    v_mfma_f32_16x16x32_bf16 v[40:43], a[116:119], a[16:19], v[40:43]
    v_mfma_f32_16x16x32_bf16 v[52:55], a[104:107], a[16:19], v[52:55]
    s_waitcnt vmcnt(5)
    v_mfma_f32_16x16x32_bf16 v[36:39], a[100:103], a[32:35], v[36:39]
    v_mfma_f32_16x16x32_bf16 v[40:43], a[96:99], a[32:35], v[40:43]
    v_mfma_f32_16x16x32_bf16 v[52:55], a[84:87], a[32:35], v[52:55]
    s_waitcnt vmcnt(1)
    v_mfma_f32_16x16x32_bf16 v[36:39], a[80:83], a[48:51], v[36:39]
    v_mfma_f32_16x16x32_bf16 v[40:43], v[148:151], a[48:51], v[40:43]
    v_mfma_f32_16x16x32_bf16 v[52:55], v[160:163], a[48:51], v[52:55]
    v_mfma_f32_16x16x32_bf16 v[56:59], a[140:143], a[4:7], v[56:59]
    v_mfma_f32_16x16x32_bf16 v[60:63], a[136:139], a[4:7], v[60:63]
    v_mfma_f32_16x16x32_bf16 v[72:75], a[124:127], a[4:7], v[72:75]
    v_mfma_f32_16x16x32_bf16 v[56:59], a[120:123], a[20:23], v[56:59]
    s_nop 1
    ds_write_b128 v29, v[36:39] offset:0
    v_mfma_f32_16x16x32_bf16 v[60:63], a[116:119], a[20:23], v[60:63]
    v_mfma_f32_16x16x32_bf16 v[72:75], a[104:107], a[20:23], v[72:75]
    ds_write_b128 v29, v[40:43] offset:1024
    v_mfma_f32_16x16x32_bf16 v[56:59], a[100:103], a[36:39], v[56:59]
    v_mfma_f32_16x16x32_bf16 v[60:63], a[96:99], a[36:39], v[60:63]
    ds_write_b128 v29, v[52:55] offset:4096
    v_mfma_f32_16x16x32_bf16 v[72:75], a[84:87], a[36:39], v[72:75]
    v_mfma_f32_16x16x32_bf16 v[76:79], a[140:143], a[8:11], v[76:79]
    v_mfma_f32_16x16x32_bf16 v[80:83], a[136:139], a[8:11], v[80:83]
    v_mfma_f32_16x16x32_bf16 v[92:95], a[124:127], a[8:11], v[92:95]
    v_mfma_f32_16x16x32_bf16 v[76:79], a[120:123], a[24:27], v[76:79]
    s_nop 0
    ds_write_b128 v30, v[56:59] offset:0
    v_mfma_f32_16x16x32_bf16 v[80:83], a[116:119], a[24:27], v[80:83]
    v_mfma_f32_16x16x32_bf16 v[92:95], a[104:107], a[24:27], v[92:95]
    v_mfma_f32_16x16x32_bf16 v[76:79], a[100:103], a[40:43], v[76:79]
    ds_write_b128 v30, v[60:63] offset:1024
    v_mfma_f32_16x16x32_bf16 v[80:83], a[96:99], a[40:43], v[80:83]
    v_mfma_f32_16x16x32_bf16 v[92:95], a[84:87], a[40:43], v[92:95]
    s_waitcnt vmcnt(0)
    v_mfma_f32_16x16x32_bf16 v[76:79], a[80:83], a[56:59], v[76:79]
    ds_write_b128 v30, v[72:75] offset:4096
    v_mfma_f32_16x16x32_bf16 v[80:83], v[148:151], a[56:59], v[80:83]
    v_mfma_f32_16x16x32_bf16 v[92:95], v[160:163], a[56:59], v[92:95]
    v_mfma_f32_16x16x32_bf16 v[96:99], a[140:143], a[12:15], v[96:99]
    v_mfma_f32_16x16x32_bf16 v[100:103], a[136:139], a[12:15], v[100:103]
    v_mfma_f32_16x16x32_bf16 v[112:115], a[124:127], a[12:15], v[112:115]
    v_mfma_f32_16x16x32_bf16 v[96:99], a[120:123], a[28:31], v[96:99]
    s_nop 0
    ds_write_b128 v31, v[76:79] offset:0
    v_mfma_f32_16x16x32_bf16 v[100:103], a[116:119], a[28:31], v[100:103]
    v_mfma_f32_16x16x32_bf16 v[112:115], a[104:107], a[28:31], v[112:115]
    ds_write_b128 v31, v[80:83] offset:1024
    v_mfma_f32_16x16x32_bf16 v[96:99], a[100:103], a[44:47], v[96:99]
    v_mfma_f32_16x16x32_bf16 v[100:103], a[96:99], a[44:47], v[100:103]
    ds_write_b128 v31, v[92:95] offset:4096
    v_mfma_f32_16x16x32_bf16 v[112:115], a[84:87], a[44:47], v[112:115]
    v_mfma_f32_16x16x32_bf16 v[44:47], a[132:135], a[0:3], v[44:47]
    v_mfma_f32_16x16x32_bf16 v[48:51], a[128:131], a[0:3], v[48:51]
    v_mfma_f32_16x16x32_bf16 v[44:47], a[112:115], a[16:19], v[44:47]
    s_waitcnt lgkmcnt(0)
    s_barrier
    ds_read_b128 v[36:39], v32 offset:0
    v_mfma_f32_16x16x32_bf16 v[48:51], a[108:111], a[16:19], v[48:51]
    ds_read_b128 v[56:59], v32 offset:5120
    ds_read_b128 v[76:79], v32 offset:10240
    v_mfma_f32_16x16x32_bf16 v[44:47], a[92:95], a[32:35], v[44:47]
    ds_read_b128 v[40:43], v32 offset:1024
    ds_read_b128 v[60:63], v32 offset:6144
    v_mfma_f32_16x16x32_bf16 v[48:51], a[88:91], a[32:35], v[48:51]
    ds_read_b128 v[80:83], v32 offset:11264
    ds_read_b128 v[52:55], v32 offset:4096
    v_mfma_f32_16x16x32_bf16 v[44:47], v[152:155], a[48:51], v[44:47]
    ds_read_b128 v[72:75], v32 offset:9216
    ds_read_b128 v[92:95], v32 offset:14336
    v_mfma_f32_16x16x32_bf16 v[48:51], v[156:159], a[48:51], v[48:51]
    v_lshrrev_b32 v148, 6, v2
    v_lshlrev_b32 v148, 4, v148
    v_mfma_f32_16x16x32_bf16 v[64:67], a[132:135], a[4:7], v[64:67]
    v_and_b32_e64 v149, 60, v2
    v_mul_u32_u24 v149, 320, v149
    v_mfma_f32_16x16x32_bf16 v[68:71], a[128:131], a[4:7], v[68:71]
    v_add_u32 v148, v148, v149
    s_and_b32 s3, s20, 1
    s_mul_i32 s3, s3, 4294967112
    s_add_u32 s3, s3, 128
    s_add_u32 s54, s3, s61
    v_mfma_f32_16x16x32_bf16 v[64:67], a[112:115], a[20:23], v[64:67]
    s_waitcnt lgkmcnt(8)
    v_add_f32 v96, v96, v36
    v_add_f32 v97, v97, v37
    v_mfma_f32_16x16x32_bf16 v[68:71], a[108:111], a[20:23], v[68:71]
    ds_write_b128 v29, v[44:47] offset:2048
    v_add_f32 v98, v98, v38
    v_add_f32 v99, v99, v39
    v_mfma_f32_16x16x32_bf16 v[64:67], a[92:95], a[36:39], v[64:67]
    s_waitcnt lgkmcnt(7)
    v_add_f32 v56, v56, v76
    v_add_f32 v57, v57, v77
    v_mfma_f32_16x16x32_bf16 v[68:71], a[88:91], a[36:39], v[68:71]
    ds_write_b128 v29, v[48:51] offset:3072
    v_add_f32 v58, v58, v78
    v_add_f32 v59, v59, v79
    v_mfma_f32_16x16x32_bf16 v[84:87], a[132:135], a[8:11], v[84:87]
    v_add_f32 v96, v96, v56
    v_add_f32 v97, v97, v57
    v_mfma_f32_16x16x32_bf16 v[88:91], a[128:131], a[8:11], v[88:91]
    v_add_f32 v98, v98, v58
    v_add_f32_e64 v99, v99, v59
    v_mfma_f32_16x16x32_bf16 v[84:87], a[112:115], a[24:27], v[84:87]
    v_cvt_pk_bf16_f32 v16, v96, v97
    v_cvt_pk_bf16_f32 v17, v98, v99
    v_mfma_f32_16x16x32_bf16 v[88:91], a[108:111], a[24:27], v[88:91]
    ds_write_b128 v30, v[64:67] offset:2048
    s_waitcnt lgkmcnt(8)
    v_add_f32 v100, v100, v40
    v_add_f32 v101, v101, v41
    v_mfma_f32_16x16x32_bf16 v[84:87], a[92:95], a[40:43], v[84:87]
    v_add_f32 v102, v102, v42
    v_add_f32 v103, v103, v43
    v_mfma_f32_16x16x32_bf16 v[88:91], a[88:91], a[40:43], v[88:91]
    ds_write_b128 v30, v[68:71] offset:3072
    s_waitcnt lgkmcnt(7)
    v_add_f32 v60, v60, v80
    v_add_f32 v61, v61, v81
    v_mfma_f32_16x16x32_bf16 v[84:87], v[152:155], a[56:59], v[84:87]
    v_add_f32 v62, v62, v82
    v_add_f32 v63, v63, v83
    v_mfma_f32_16x16x32_bf16 v[88:91], v[156:159], a[56:59], v[88:91]
    v_add_f32 v100, v100, v60
    v_add_f32 v101, v101, v61
    v_mfma_f32_16x16x32_bf16 v[104:107], a[132:135], a[12:15], v[104:107]
    v_add_f32 v102, v102, v62
    v_add_f32 v103, v103, v63
    v_mfma_f32_16x16x32_bf16 v[108:111], a[128:131], a[12:15], v[108:111]
    v_cvt_pk_bf16_f32 v18, v100, v101
    v_cvt_pk_bf16_f32 v19, v102, v103
    v_mfma_f32_16x16x32_bf16 v[104:107], a[112:115], a[28:31], v[104:107]
    buffer_store_dwordx4 v[16:19], v148, s[8:11], s61 offen offset:0
    s_waitcnt lgkmcnt(6)
    v_add_f32 v112, v112, v52
    v_mfma_f32_16x16x32_bf16 v[108:111], a[108:111], a[28:31], v[108:111]
    ds_write_b128 v31, v[84:87] offset:2048
    v_add_f32 v113, v113, v53
    v_add_f32 v114, v114, v54
    v_mfma_f32_16x16x32_bf16 v[104:107], a[92:95], a[44:47], v[104:107]
    v_add_f32 v115, v115, v55
    s_waitcnt lgkmcnt(5)
    v_add_f32 v72, v72, v92
    v_mfma_f32_16x16x32_bf16 v[108:111], a[88:91], a[44:47], v[108:111]
    ds_write_b128 v31, v[88:91] offset:3072
    v_add_f32 v73, v73, v93
    v_add_f32 v74, v74, v94
    v_add_f32 v75, v75, v95
    v_add_f32 v112, v112, v72
    v_add_f32 v113, v113, v73
    v_add_f32 v114, v114, v74
    v_add_f32 v115, v115, v75
    v_cvt_pk_bf16_f32 v24, v112, v113
    v_cvt_pk_bf16_f32 v25, v114, v115
    buffer_store_dwordx2 v[24:25], v148, s[8:11], s54 offen
    s_waitcnt lgkmcnt(0)
    s_barrier
    ds_read_b128 v[44:47], v32 offset:2048
    ds_read_b128 v[64:67], v32 offset:7168
    ds_read_b128 v[84:87], v32 offset:12288
    ds_read_b128 v[48:51], v32 offset:3072
    ds_read_b128 v[68:71], v32 offset:8192
    ds_read_b128 v[88:91], v32 offset:13312
    s_waitcnt lgkmcnt(5)
    v_pk_add_f32 v[104:105], v[104:105], v[44:45] op_sel:[0,0] op_sel_hi:[1,1]
    v_pk_add_f32 v[106:107], v[106:107], v[46:47] op_sel:[0,0] op_sel_hi:[1,1]
    s_waitcnt lgkmcnt(3)
    v_pk_add_f32 v[64:65], v[64:65], v[84:85] op_sel:[0,0] op_sel_hi:[1,1]
    v_pk_add_f32 v[66:67], v[66:67], v[86:87] op_sel:[0,0] op_sel_hi:[1,1]
    v_pk_add_f32 v[104:105], v[104:105], v[64:65] op_sel:[0,0] op_sel_hi:[1,1]
    v_pk_add_f32 v[106:107], v[106:107], v[66:67] op_sel:[0,0] op_sel_hi:[1,1]
    v_cvt_pk_bf16_f32 v20, v104, v105
    v_cvt_pk_bf16_f32 v21, v106, v107
    s_waitcnt lgkmcnt(2)
    v_pk_add_f32 v[108:109], v[108:109], v[48:49] op_sel:[0,0] op_sel_hi:[1,1]
    v_pk_add_f32 v[110:111], v[110:111], v[50:51] op_sel:[0,0] op_sel_hi:[1,1]
    s_waitcnt lgkmcnt(0)
    v_pk_add_f32 v[68:69], v[68:69], v[88:89] op_sel:[0,0] op_sel_hi:[1,1]
    v_pk_add_f32 v[70:71], v[70:71], v[90:91] op_sel:[0,0] op_sel_hi:[1,1]
    v_pk_add_f32 v[108:109], v[108:109], v[68:69] op_sel:[0,0] op_sel_hi:[1,1]
    v_pk_add_f32 v[110:111], v[110:111], v[70:71] op_sel:[0,0] op_sel_hi:[1,1]
    v_cvt_pk_bf16_f32 v22, v108, v109
    v_cvt_pk_bf16_f32 v23, v110, v111
    buffer_store_dwordx4 v[20:23], v148, s[8:11], s61 offen offset:64
    s_endpgm
    s_nop 1
L_abort:
    s_load_dwordx2 s[52:53], s[0:1], 72
    v_mov_b32 v40, 0
    v_mov_b32 v41, 1
    s_waitcnt lgkmcnt(0)
    global_atomic_add v40, v41, s[52:53]
    s_waitcnt vmcnt(0) lgkmcnt(0)
L_exit:
    s_endpgm
L_slow:
    v_cvt_pk_bf16_f32 v72, v157, v158
    v_cvt_pk_bf16_f32 v73, v160, v161
    v_cvt_pk_bf16_f32 v74, v162, 0
    v_cvt_pk_bf16_f32 v75, 0, v162
    v_cndmask_b32 v108, v72, 0, s[48:49]
    v_cndmask_b32 v109, v73, 0, s[48:49]
    v_cndmask_b32 v110, v74, 0, s[48:49]
    v_cndmask_b32 v112, 0, v75, s[48:49]
    v_cndmask_b32 v113, 0, v72, s[48:49]
    v_cndmask_b32 v114, 0, v73, s[48:49]
    v_cvt_pk_bf16_f32 v100, v144, v145
    v_mfma_f32_16x16x32_bf16 v[84:87], v[108:111], v[60:63], 0
    v_cvt_pk_bf16_f32 v101, v146, v148
    v_cvt_pk_bf16_f32 v102, v149, 0
    v_mfma_f32_16x16x32_bf16 v[96:99], v[108:111], v[66:69], 0
    v_cvt_pk_bf16_f32 v104, 0, v156
    v_cvt_pk_bf16_f32 v105, v150, v152
    v_mfma_f32_16x16x32_bf16 v[84:87], v[112:115], v[62:65], v[84:87]
    v_cvt_pk_bf16_f32 v106, v153, v154
    v_mfma_f32_16x16x32_bf16 v[96:99], v[112:115], v[68:71], v[96:99]
    v_mfma_f32_16x16x32_bf16 v[76:79], v[100:103], v[60:63], 0
    v_mfma_f32_16x16x32_bf16 v[80:83], v[104:107], v[62:65], 0
    v_mfma_f32_16x16x32_bf16 v[88:91], v[100:103], v[66:69], 0
    v_mfma_f32_16x16x32_bf16 v[92:95], v[104:107], v[68:71], 0
    s_nop 1
    v_pk_add_f32 v[84:85], v[84:85], s[76:77] op_sel:[0,0] op_sel_hi:[1,1]
    v_rcp_f32 v84, v84
    v_rcp_f32 v85, v85
    v_pk_add_f32 v[96:97], v[96:97], s[76:77] op_sel:[0,0] op_sel_hi:[1,1]
    v_rcp_f32 v96, v96
    v_rcp_f32 v97, v97
    v_pk_mul_f32 v[86:87], v[86:87], v[84:85] op_sel:[0,0] op_sel_hi:[1,1]
    v_pk_mul_f32 v[76:77], v[76:77], v[84:85] op_sel:[0,0] op_sel_hi:[1,0]
    v_pk_mul_f32 v[78:79], v[78:79], v[84:85] op_sel:[0,0] op_sel_hi:[1,0]
    v_pk_mul_f32 v[80:81], v[80:81], v[84:85] op_sel:[0,1] op_sel_hi:[1,1]
    v_pk_mul_f32 v[82:83], v[82:83], v[84:85] op_sel:[0,1] op_sel_hi:[1,1]
    v_cvt_pk_bf16_f32 v40, v86, v87
    v_cvt_pk_bf16_f32 v36, v76, v77
    v_cvt_pk_bf16_f32 v37, v78, v79
    v_cvt_pk_bf16_f32 v38, v80, v81
    v_cvt_pk_bf16_f32 v39, v82, v83
    buffer_store_dwordx4 v[36:39], v1, s[4:7], s29 offen sc1
    buffer_store_dword v40, v27, s[4:7], s29 offen sc1
    v_pk_mul_f32 v[98:99], v[98:99], v[96:97] op_sel:[0,0] op_sel_hi:[1,1]
    v_pk_mul_f32 v[88:89], v[88:89], v[96:97] op_sel:[0,0] op_sel_hi:[1,0]
    v_pk_mul_f32 v[90:91], v[90:91], v[96:97] op_sel:[0,0] op_sel_hi:[1,0]
    v_pk_mul_f32 v[92:93], v[92:93], v[96:97] op_sel:[0,1] op_sel_hi:[1,1]
    v_pk_mul_f32 v[94:95], v[94:95], v[96:97] op_sel:[0,1] op_sel_hi:[1,1]
    v_cvt_pk_bf16_f32 v46, v98, v99
    v_cvt_pk_bf16_f32 v42, v88, v89
    v_cvt_pk_bf16_f32 v43, v90, v91
    v_cvt_pk_bf16_f32 v44, v92, v93
    v_cvt_pk_bf16_f32 v45, v94, v95
    buffer_store_dwordx4 v[42:45], v1, s[4:7], s30 offen sc1
    buffer_store_dword v46, v27, s[4:7], s30 offen sc1
    s_add_u32 s46, s46, 81920
    s_add_u32 s47, s47, 81920
    s_add_u32 s52, s39, 1
    v_mov_b32 v15, s52
    s_mov_b32 m0, s88
    s_nop 0
    buffer_load_dwordx4 v1, s[4:7], s89 offen offset:3072 lds
    s_add_u32 s89, s96, s26
    s_add_u32 s88, s96, 141312
    s_add_u32 s89, s89, 69632
    s_mov_b32 m0, s88
    s_nop 0
    buffer_load_dwordx4 v1, s[4:7], s89 offen offset:0 lds
    buffer_load_dwordx4 v1, s[4:7], s89 offen offset:1024 lds
    buffer_load_dwordx4 v1, s[4:7], s89 offen offset:2048 lds
    s_waitcnt vmcnt(4)
    s_mov_b64 exec, 1
    buffer_store_dword v15, off, s[4:7], s42 sc1
    s_mov_b64 exec, -1
    v_lshlrev_b32_e64 v96, 16, v16
    v_and_b32 v97, 0xffff0000, v16
    v_lshlrev_b32_e64 v98, 16, v17
    v_and_b32 v99, 0xffff0000, v17
    v_lshlrev_b32_e64 v100, 16, v18
    v_and_b32 v101, 0xffff0000, v18
    v_lshlrev_b32_e64 v102, 16, v19
    v_and_b32 v103, 0xffff0000, v19
    v_lshlrev_b32_e64 v104, 16, v20
    v_and_b32 v105, 0xffff0000, v20
    v_lshlrev_b32_e64 v106, 16, v21
    v_and_b32 v107, 0xffff0000, v21
    v_lshlrev_b32_e64 v108, 16, v22
    v_and_b32 v109, 0xffff0000, v22
    v_lshlrev_b32_e64 v110, 16, v23
    v_and_b32 v111, 0xffff0000, v23
    v_lshlrev_b32_e64 v112, 16, v24
    v_and_b32 v113, 0xffff0000, v24
    v_lshlrev_b32_e64 v114, 16, v25
    v_and_b32 v115, 0xffff0000, v25
    v_and_b32 v15, 31, v2
    s_mov_b32 s60, 0
    s_add_u32 s52, s39, 1
L_poll_1007:
    buffer_load_dword v14, v15, s[4:7], s43 offen sc1
    s_add_u32 s60, s60, 1
    s_cmp_gt_u32 s60, 0x40000
    s_cbranch_scc1 L_abort
    s_waitcnt vmcnt(0)
    v_cmp_ne_u32 vcc, s52, v14
    s_nop 1
    s_cbranch_vccnz L_poll_1007
    buffer_load_dwordx4 a[0:3], v1, s[4:7], s31 offen offset:0 sc1
    buffer_load_dwordx4 a[4:7], v1, s[4:7], s31 offen offset:1024 sc1
    buffer_load_dwordx4 a[8:11], v1, s[4:7], s31 offen offset:2048 sc1
    buffer_load_dwordx4 a[12:15], v1, s[4:7], s31 offen offset:3072 sc1
    buffer_load_dwordx4 a[16:19], v26, s[4:7], s31 offen offset:0 sc1
    buffer_load_dwordx4 a[20:23], v1, s[4:7], s32 offen offset:0 sc1
    s_waitcnt vmcnt(5)
    v_mfma_f32_16x16x32_bf16 v[36:39], a[156:159], a[0:3], 0
    buffer_load_dwordx4 a[24:27], v1, s[4:7], s32 offen offset:1024 sc1
    v_mfma_f32_16x16x32_bf16 v[40:43], a[152:155], a[0:3], 0
    v_mfma_f32_16x16x32_bf16 v[52:55], a[140:143], a[0:3], 0
    buffer_load_dwordx4 a[28:31], v1, s[4:7], s32 offen offset:2048 sc1
    s_waitcnt vmcnt(6)
    v_mfma_f32_16x16x32_bf16 v[36:39], a[136:139], a[4:7], v[36:39]
    v_mfma_f32_16x16x32_bf16 v[40:43], a[132:135], a[4:7], v[40:43]
    buffer_load_dwordx4 a[32:35], v1, s[4:7], s32 offen offset:3072 sc1
    v_mfma_f32_16x16x32_bf16 v[52:55], a[120:123], a[4:7], v[52:55]
    s_waitcnt vmcnt(6)
    v_mfma_f32_16x16x32_bf16 v[36:39], a[116:119], a[8:11], v[36:39]
    v_mfma_f32_16x16x32_bf16 v[40:43], a[112:115], a[8:11], v[40:43]
    buffer_load_dwordx4 a[36:39], v26, s[4:7], s32 offen offset:0 sc1
    v_mfma_f32_16x16x32_bf16 v[52:55], a[100:103], a[8:11], v[52:55]
    s_waitcnt vmcnt(6)
    v_mfma_f32_16x16x32_bf16 v[36:39], a[96:99], a[12:15], v[36:39]
    buffer_load_dwordx4 a[40:43], v1, s[4:7], s33 offen offset:0 sc1
    v_mfma_f32_16x16x32_bf16 v[40:43], a[92:95], a[12:15], v[40:43]
    v_mfma_f32_16x16x32_bf16 v[52:55], a[80:83], a[12:15], v[52:55]
    buffer_load_dwordx4 a[44:47], v1, s[4:7], s33 offen offset:1024 sc1
    s_waitcnt vmcnt(7)
    v_mfma_f32_16x16x32_bf16 v[36:39], v[116:119], a[16:19], v[36:39]
    v_mfma_f32_16x16x32_bf16 v[40:43], v[120:123], a[16:19], v[40:43]
    buffer_load_dwordx4 a[48:51], v1, s[4:7], s33 offen offset:2048 sc1
    v_mfma_f32_16x16x32_bf16 v[52:55], v[164:167], a[16:19], v[52:55]
    s_waitcnt vmcnt(7)
    v_mfma_f32_16x16x32_bf16 v[56:59], a[156:159], a[20:23], 0
    buffer_load_dwordx4 a[52:55], v1, s[4:7], s33 offen offset:3072 sc1
    v_mfma_f32_16x16x32_bf16 v[60:63], a[152:155], a[20:23], 0
    v_mfma_f32_16x16x32_bf16 v[72:75], a[140:143], a[20:23], 0
    buffer_load_dwordx4 a[56:59], v26, s[4:7], s33 offen offset:0 sc1
    s_waitcnt vmcnt(8)
    v_mfma_f32_16x16x32_bf16 v[56:59], a[136:139], a[24:27], v[56:59]
    ds_write_b128 v29, v[36:39] offset:0
    v_mfma_f32_16x16x32_bf16 v[60:63], a[132:135], a[24:27], v[60:63]
    buffer_load_dwordx4 a[60:63], v1, s[4:7], s34 offen offset:0 sc1
    v_mfma_f32_16x16x32_bf16 v[72:75], a[120:123], a[24:27], v[72:75]
    s_waitcnt vmcnt(8)
    v_mfma_f32_16x16x32_bf16 v[56:59], a[116:119], a[28:31], v[56:59]
    v_mfma_f32_16x16x32_bf16 v[60:63], a[112:115], a[28:31], v[60:63]
    buffer_load_dwordx4 a[64:67], v1, s[4:7], s34 offen offset:1024 sc1
    ds_write_b128 v29, v[40:43] offset:1024
    v_mfma_f32_16x16x32_bf16 v[72:75], a[100:103], a[28:31], v[72:75]
    s_waitcnt vmcnt(8)
    v_mfma_f32_16x16x32_bf16 v[56:59], a[96:99], a[32:35], v[56:59]
    buffer_load_dwordx4 a[68:71], v1, s[4:7], s34 offen offset:2048 sc1
    v_mfma_f32_16x16x32_bf16 v[60:63], a[92:95], a[32:35], v[60:63]
    v_mfma_f32_16x16x32_bf16 v[72:75], a[80:83], a[32:35], v[72:75]
    buffer_load_dwordx4 a[72:75], v1, s[4:7], s34 offen offset:3072 sc1
    ds_write_b128 v29, v[52:55] offset:4096
    s_waitcnt vmcnt(9)
    v_mfma_f32_16x16x32_bf16 v[56:59], v[116:119], a[36:39], v[56:59]
    v_mfma_f32_16x16x32_bf16 v[60:63], v[120:123], a[36:39], v[60:63]
    buffer_load_dwordx4 a[76:79], v26, s[4:7], s34 offen offset:0 sc1
    v_mfma_f32_16x16x32_bf16 v[72:75], v[164:167], a[36:39], v[72:75]
    s_waitcnt vmcnt(9)
    v_mfma_f32_16x16x32_bf16 v[76:79], a[156:159], a[40:43], 0
    v_mfma_f32_16x16x32_bf16 v[80:83], a[152:155], a[40:43], 0
    v_mfma_f32_16x16x32_bf16 v[92:95], a[140:143], a[40:43], 0
    s_waitcnt vmcnt(8)
    v_mfma_f32_16x16x32_bf16 v[76:79], a[136:139], a[44:47], v[76:79]
    ds_write_b128 v30, v[56:59] offset:0
    v_mfma_f32_16x16x32_bf16 v[80:83], a[132:135], a[44:47], v[80:83]
    v_mfma_f32_16x16x32_bf16 v[92:95], a[120:123], a[44:47], v[92:95]
    s_waitcnt vmcnt(7)
    v_mfma_f32_16x16x32_bf16 v[76:79], a[116:119], a[48:51], v[76:79]
    v_mfma_f32_16x16x32_bf16 v[80:83], a[112:115], a[48:51], v[80:83]
    ds_write_b128 v30, v[60:63] offset:1024
    v_mfma_f32_16x16x32_bf16 v[92:95], a[100:103], a[48:51], v[92:95]
    s_waitcnt vmcnt(6)
    v_mfma_f32_16x16x32_bf16 v[76:79], a[96:99], a[52:55], v[76:79]
    v_mfma_f32_16x16x32_bf16 v[80:83], a[92:95], a[52:55], v[80:83]
    v_mfma_f32_16x16x32_bf16 v[92:95], a[80:83], a[52:55], v[92:95]
    ds_write_b128 v30, v[72:75] offset:4096
    s_waitcnt vmcnt(5)
    v_mfma_f32_16x16x32_bf16 v[76:79], v[116:119], a[56:59], v[76:79]
    v_mfma_f32_16x16x32_bf16 v[80:83], v[120:123], a[56:59], v[80:83]
    v_mfma_f32_16x16x32_bf16 v[92:95], v[164:167], a[56:59], v[92:95]
    s_waitcnt vmcnt(4)
    v_mfma_f32_16x16x32_bf16 v[96:99], a[156:159], a[60:63], v[96:99]
    v_mfma_f32_16x16x32_bf16 v[100:103], a[152:155], a[60:63], v[100:103]
    v_mfma_f32_16x16x32_bf16 v[112:115], a[140:143], a[60:63], v[112:115]
    s_waitcnt vmcnt(3)
    v_mfma_f32_16x16x32_bf16 v[96:99], a[136:139], a[64:67], v[96:99]
    ds_write_b128 v31, v[76:79] offset:0
    v_mfma_f32_16x16x32_bf16 v[100:103], a[132:135], a[64:67], v[100:103]
    v_mfma_f32_16x16x32_bf16 v[112:115], a[120:123], a[64:67], v[112:115]
    s_waitcnt vmcnt(2)
    v_mfma_f32_16x16x32_bf16 v[96:99], a[116:119], a[68:71], v[96:99]
    v_mfma_f32_16x16x32_bf16 v[100:103], a[112:115], a[68:71], v[100:103]
    ds_write_b128 v31, v[80:83] offset:1024
    v_mfma_f32_16x16x32_bf16 v[112:115], a[100:103], a[68:71], v[112:115]
    s_waitcnt vmcnt(1)
    v_mfma_f32_16x16x32_bf16 v[96:99], a[96:99], a[72:75], v[96:99]
    v_mfma_f32_16x16x32_bf16 v[100:103], a[92:95], a[72:75], v[100:103]
    v_mfma_f32_16x16x32_bf16 v[112:115], a[80:83], a[72:75], v[112:115]
    ds_write_b128 v31, v[92:95] offset:4096
    s_waitcnt vmcnt(0)
    v_mfma_f32_16x16x32_bf16 v[96:99], v[116:119], a[76:79], v[96:99]
    v_mfma_f32_16x16x32_bf16 v[100:103], v[120:123], a[76:79], v[100:103]
    v_mfma_f32_16x16x32_bf16 v[112:115], v[164:167], a[76:79], v[112:115]
    v_mfma_f32_16x16x32_bf16 v[44:47], a[148:151], a[0:3], 0
    v_mfma_f32_16x16x32_bf16 v[48:51], a[144:147], a[0:3], 0
    s_add_u32 s13, s97, s26
    s_add_u32 s12, s97, 71680
    s_mov_b32 m0, s12
    s_nop 0
    buffer_load_dwordx4 v1, s[4:7], s13 offen offset:0 lds
    v_mfma_f32_16x16x32_bf16 v[44:47], a[128:131], a[4:7], v[44:47]
    s_waitcnt lgkmcnt(0)
    s_barrier
    ds_read_b128 v[36:39], v32 offset:0
    v_mfma_f32_16x16x32_bf16 v[48:51], a[124:127], a[4:7], v[48:51]
    ds_read_b128 v[56:59], v32 offset:5120
    ds_read_b128 v[76:79], v32 offset:10240
    v_mfma_f32_16x16x32_bf16 v[44:47], a[108:111], a[8:11], v[44:47]
    buffer_load_dwordx4 v1, s[4:7], s13 offen offset:1024 lds
    ds_read_b128 v[40:43], v32 offset:1024
    ds_read_b128 v[60:63], v32 offset:6144
    v_mfma_f32_16x16x32_bf16 v[48:51], a[104:107], a[8:11], v[48:51]
    ds_read_b128 v[80:83], v32 offset:11264
    ds_read_b128 v[52:55], v32 offset:4096
    v_mfma_f32_16x16x32_bf16 v[44:47], a[88:91], a[12:15], v[44:47]
    ds_read_b128 v[72:75], v32 offset:9216
    ds_read_b128 v[92:95], v32 offset:14336
    v_mfma_f32_16x16x32_bf16 v[48:51], a[84:87], a[12:15], v[48:51]
    buffer_load_dwordx4 v1, s[4:7], s13 offen offset:2048 lds
    v_mov_b32 v140, 0
    v_mov_b32 v141, 0
    v_mfma_f32_16x16x32_bf16 v[44:47], v[124:127], a[16:19], v[44:47]
    v_mov_b32 v142, 0
    v_mov_b32 v143, 0
    v_mfma_f32_16x16x32_bf16 v[48:51], v[128:131], a[16:19], v[48:51]
    v_mov_b32 v139, 0x3f803f80
    s_waitcnt lgkmcnt(8)
    v_add_f32 v96, v96, v36
    v_mfma_f32_16x16x32_bf16 v[64:67], a[148:151], a[20:23], 0
    v_add_f32 v97, v97, v37
    v_add_f32 v98, v98, v38
    v_mfma_f32_16x16x32_bf16 v[68:71], a[144:147], a[20:23], 0
    buffer_load_dwordx4 v1, s[4:7], s13 offen offset:3072 lds
    v_add_f32 v99, v99, v39
    s_waitcnt lgkmcnt(6)
    v_add_f32 v56, v56, v76
    v_mfma_f32_16x16x32_bf16 v[64:67], a[128:131], a[24:27], v[64:67]
    v_add_f32 v57, v57, v77
    v_add_f32 v58, v58, v78
    v_mfma_f32_16x16x32_bf16 v[68:71], a[124:127], a[24:27], v[68:71]
    ds_write_b128 v29, v[44:47] offset:2048
    v_add_f32 v59, v59, v79
    v_add_f32 v96, v96, v56
    v_mfma_f32_16x16x32_bf16 v[64:67], a[108:111], a[28:31], v[64:67]
    s_add_u32 s13, s94, s26
    s_add_u32 s12, s94, 88064
    s_add_u32 s13, s13, 16384
    s_mov_b32 m0, s12
    s_nop 0
    buffer_load_dwordx4 v1, s[4:7], s13 offen offset:0 lds
    v_add_f32 v97, v97, v57
    v_add_f32 v98, v98, v58
    v_mfma_f32_16x16x32_bf16 v[68:71], a[104:107], a[28:31], v[68:71]
    ds_write_b128 v29, v[48:51] offset:3072
    v_add_f32_e64 v99, v99, v59
    v_cvt_pk_bf16_f32 v16, v96, v97
    v_mfma_f32_16x16x32_bf16 v[64:67], a[88:91], a[32:35], v[64:67]
    v_cvt_pk_bf16_f32 v17, v98, v99
    s_waitcnt lgkmcnt(7)
    v_add_f32 v100, v100, v40
    v_mfma_f32_16x16x32_bf16 v[68:71], a[84:87], a[32:35], v[68:71]
    s_add_u32 s69, s28, 8192
    buffer_load_dwordx4 v[200:203], v1, s[4:7], s69 offen offset:0
    v_add_f32 v101, v101, v41
    v_add_f32 v102, v102, v42
    v_mfma_f32_16x16x32_bf16 v[64:67], v[124:127], a[36:39], v[64:67]
    v_add_f32 v103, v103, v43
    s_waitcnt lgkmcnt(5)
    v_add_f32 v60, v60, v80
    v_mfma_f32_16x16x32_bf16 v[68:71], v[128:131], a[36:39], v[68:71]
    v_add_f32 v61, v61, v81
    v_add_f32 v62, v62, v82
    v_mfma_f32_16x16x32_bf16 v[84:87], a[148:151], a[40:43], 0
    v_add_f32 v63, v63, v83
    v_add_f32 v100, v100, v60
    v_mfma_f32_16x16x32_bf16 v[88:91], a[144:147], a[40:43], 0
    buffer_load_dwordx4 v[204:207], v1, s[4:7], s69 offen offset:1024
    v_add_f32 v101, v101, v61
    v_add_f32 v102, v102, v62
    v_mfma_f32_16x16x32_bf16 v[84:87], a[128:131], a[44:47], v[84:87]
    v_add_f32 v103, v103, v63
    v_cvt_pk_bf16_f32 v18, v100, v101
    v_mfma_f32_16x16x32_bf16 v[88:91], a[124:127], a[44:47], v[88:91]
    ds_write_b128 v30, v[64:67] offset:2048
    v_cvt_pk_bf16_f32 v19, v102, v103
    buffer_store_dwordx4 v[16:19], v10, s[4:7], 0 offen offset:0 sc1
    v_mfma_f32_16x16x32_bf16 v[84:87], a[108:111], a[48:51], v[84:87]
    buffer_load_dwordx4 v[208:211], v1, s[4:7], s69 offen offset:2048
    s_waitcnt lgkmcnt(5)
    v_add_f32 v112, v112, v52
    v_add_f32 v113, v113, v53
    v_mfma_f32_16x16x32_bf16 v[88:91], a[104:107], a[48:51], v[88:91]
    ds_write_b128 v30, v[68:71] offset:3072
    v_add_f32 v114, v114, v54
    v_add_f32 v115, v115, v55
    v_mfma_f32_16x16x32_bf16 v[84:87], a[88:91], a[52:55], v[84:87]
    s_waitcnt lgkmcnt(4)
    v_add_f32 v72, v72, v92
    v_add_f32 v73, v73, v93
    v_mfma_f32_16x16x32_bf16 v[88:91], a[84:87], a[52:55], v[88:91]
    buffer_load_dwordx4 v[212:215], v1, s[4:7], s69 offen offset:3072
    v_add_f32 v74, v74, v94
    v_add_f32 v75, v75, v95
    v_mfma_f32_16x16x32_bf16 v[84:87], v[124:127], a[56:59], v[84:87]
    v_add_f32 v112, v112, v72
    v_add_f32 v113, v113, v73
    v_mfma_f32_16x16x32_bf16 v[88:91], v[128:131], a[56:59], v[88:91]
    v_add_f32 v114, v114, v74
    v_add_f32 v115, v115, v75
    v_mfma_f32_16x16x32_bf16 v[104:107], a[148:151], a[60:63], v[104:107]
    v_cvt_pk_bf16_f32 v24, v112, v113
    v_cvt_pk_bf16_f32 v25, v114, v115
    v_mfma_f32_16x16x32_bf16 v[108:111], a[144:147], a[60:63], v[108:111]
    buffer_store_dwordx2 v[24:25], v11, s[4:7], 0 offen sc1
    v_mfma_f32_16x16x32_bf16 v[104:107], a[128:131], a[64:67], v[104:107]
    s_add_u32 s69, s28, 12288
    buffer_load_dwordx4 v[216:219], v1, s[4:7], s69 offen offset:0
    v_mfma_f32_16x16x32_bf16 v[108:111], a[124:127], a[64:67], v[108:111]
    ds_write_b128 v31, v[84:87] offset:2048
    v_mfma_f32_16x16x32_bf16 v[104:107], a[108:111], a[68:71], v[104:107]
    v_mfma_f32_16x16x32_bf16 v[108:111], a[104:107], a[68:71], v[108:111]
    ds_write_b128 v31, v[88:91] offset:3072
    v_mfma_f32_16x16x32_bf16 v[104:107], a[88:91], a[72:75], v[104:107]
    v_mfma_f32_16x16x32_bf16 v[108:111], a[84:87], a[72:75], v[108:111]
    buffer_load_dwordx4 v[220:223], v1, s[4:7], s69 offen offset:1024
    v_mfma_f32_16x16x32_bf16 v[104:107], v[124:127], a[76:79], v[104:107]
    v_mfma_f32_16x16x32_bf16 v[108:111], v[128:131], a[76:79], v[108:111]
    buffer_load_dwordx4 v[224:227], v1, s[4:7], s69 offen offset:2048
    buffer_load_dwordx4 v[228:231], v1, s[4:7], s69 offen offset:3072
    s_add_u32 s69, s28, 16384
    buffer_load_dwordx4 v[232:235], v1, s[4:7], s69 offen offset:0
    buffer_load_dwordx4 v[236:239], v1, s[4:7], s69 offen offset:1024
    buffer_load_dwordx4 v[240:243], v1, s[4:7], s69 offen offset:2048
    buffer_load_dwordx4 v[244:247], v1, s[4:7], s69 offen offset:3072
    s_add_u32 s69, s28, 20480
    buffer_load_dwordx4 v[248:251], v1, s[4:7], s69 offen offset:0
    buffer_load_dwordx4 v[252:255], v1, s[4:7], s69 offen offset:1024
    v_dot2_f32_bf16 v140, v16, v139, v140
    v_dot2_f32_bf16 v141, v16, v16, v141
    v_dot2_f32_bf16 v142, v17, v139, v142
    v_dot2_f32_bf16 v143, v17, v17, v143
    v_dot2_f32_bf16 v140, v18, v139, v140
    v_dot2_f32_bf16 v141, v18, v18, v141
    v_dot2_f32_bf16 v142, v19, v139, v142
    v_dot2_f32_bf16 v143, v19, v19, v143
    v_dot2_f32_bf16 v140, v24, v139, v140
    v_dot2_f32_bf16 v141, v24, v24, v141
    v_dot2_f32_bf16 v142, v25, v139, v142
    v_dot2_f32_bf16 v143, v25, v25, v143
    s_add_u32 s3, s39, 1
    v_mov_b32 v15, s3
    s_add_u32 s3, s40, 20480
    s_waitcnt vmcnt(10)
    s_mov_b64 exec, 1
    buffer_store_dword v15, off, s[4:7], s3 sc1
    s_mov_b64 exec, -1
    s_waitcnt lgkmcnt(0)
    s_barrier
    ds_read_b128 v[44:47], v32 offset:2048
    ds_read_b128 v[64:67], v32 offset:7168
    ds_read_b128 v[84:87], v32 offset:12288
    ds_read_b128 v[48:51], v32 offset:3072
    ds_read_b128 v[68:71], v32 offset:8192
    ds_read_b128 v[88:91], v32 offset:13312
    s_waitcnt lgkmcnt(5)
    v_pk_add_f32 v[104:105], v[104:105], v[44:45] op_sel:[0,0] op_sel_hi:[1,1]
    v_pk_add_f32 v[106:107], v[106:107], v[46:47] op_sel:[0,0] op_sel_hi:[1,1]
    s_waitcnt lgkmcnt(3)
    v_pk_add_f32 v[64:65], v[64:65], v[84:85] op_sel:[0,0] op_sel_hi:[1,1]
    v_pk_add_f32 v[66:67], v[66:67], v[86:87] op_sel:[0,0] op_sel_hi:[1,1]
    v_pk_add_f32 v[104:105], v[104:105], v[64:65] op_sel:[0,0] op_sel_hi:[1,1]
    v_pk_add_f32 v[106:107], v[106:107], v[66:67] op_sel:[0,0] op_sel_hi:[1,1]
    v_cvt_pk_bf16_f32 v20, v104, v105
    v_cvt_pk_bf16_f32 v21, v106, v107
    v_dot2_f32_bf16 v140, v20, v139, v140
    v_dot2_f32_bf16 v141, v20, v20, v141
    v_dot2_f32_bf16 v142, v21, v139, v142
    v_dot2_f32_bf16 v143, v21, v21, v143
    s_waitcnt lgkmcnt(2)
    v_pk_add_f32 v[108:109], v[108:109], v[48:49] op_sel:[0,0] op_sel_hi:[1,1]
    v_pk_add_f32 v[110:111], v[110:111], v[50:51] op_sel:[0,0] op_sel_hi:[1,1]
    s_waitcnt lgkmcnt(0)
    v_pk_add_f32 v[68:69], v[68:69], v[88:89] op_sel:[0,0] op_sel_hi:[1,1]
    v_pk_add_f32 v[70:71], v[70:71], v[90:91] op_sel:[0,0] op_sel_hi:[1,1]
    v_pk_add_f32 v[108:109], v[108:109], v[68:69] op_sel:[0,0] op_sel_hi:[1,1]
    v_pk_add_f32 v[110:111], v[110:111], v[70:71] op_sel:[0,0] op_sel_hi:[1,1]
    v_cvt_pk_bf16_f32 v22, v108, v109
    v_cvt_pk_bf16_f32 v23, v110, v111
    buffer_store_dwordx4 v[20:23], v10, s[4:7], 0 offen offset:1024 sc1
    v_dot2_f32_bf16 v140, v22, v139, v140
    v_dot2_f32_bf16 v141, v22, v22, v141
    v_dot2_f32_bf16 v142, v23, v139, v142
    v_dot2_f32_bf16 v143, v23, v23, v143
    s_nop 2
    v_pk_add_f32 v[140:141], v[140:141], v[142:143] op_sel:[0,0] op_sel_hi:[1,1]
    s_nop 1
    v_permlane32_swap_b32 v140, v141
    v_add_f32 v140, v140, v141
    v_mov_b32 v141, v140
    s_nop 1
    v_permlane16_swap_b32 v140, v141
    v_add_f32 v140, v140, v141
    v_and_b32 v15, 63, v2
    v_add_u32 v15, 20480, v15
    buffer_load_dword v14, v15, s[4:7], s41 offen sc1
    buffer_store_dword v140, v9, s[4:7], 0 offen sc1
    s_barrier
    ds_read_b128 v[92:95], v3 offset:6144
    ds_read_b128 v[96:99], v3 offset:7168
    ds_read_b128 v[100:103], v3 offset:8192
    ds_read_b128 v[104:107], v3 offset:9216
    s_add_u32 s70, s28, 22528
    buffer_load_dwordx4 a[160:163], v1, s[4:7], s70 offen offset:0
    buffer_load_dwordx4 a[164:167], v1, s[4:7], s70 offen offset:1024
    buffer_load_dwordx4 a[168:171], v1, s[4:7], s70 offen offset:2048
    buffer_load_dwordx4 a[172:175], v1, s[4:7], s70 offen offset:3072
    s_add_u32 s52, s39, 1
    s_waitcnt vmcnt(5)
    v_cmp_ne_u32 vcc, s52, v14
    s_nop 1
    s_cbranch_vccz L_ok_1010
    s_mov_b32 s60, 0
L_lp_1009:
    v_and_b32 v15, 63, v2
    v_add_u32 v15, 20480, v15
    buffer_load_dword v14, v15, s[4:7], s41 offen sc1
    s_add_u32 s60, s60, 1
    s_cmp_gt_u32 s60, 0x40000
    s_cbranch_scc1 L_abort
    s_waitcnt vmcnt(0)
    v_cmp_ne_u32 vcc, s52, v14
    s_nop 1
    s_cbranch_vccnz L_lp_1009
L_ok_1010:
    buffer_load_dwordx4 a[0:3], v6, s[4:7], 0 offen offset:0 sc1
    buffer_load_dwordx4 a[4:7], v7, s[4:7], 0 offen offset:0 sc1
    buffer_load_dwordx4 a[8:11], v6, s[4:7], 0 offen offset:2048 sc1
    buffer_load_dwordx4 a[12:15], v7, s[4:7], 0 offen offset:2048 sc1
    buffer_load_dwordx4 a[16:19], v6, s[4:7], 0 offen offset:3072 sc1
    buffer_load_dwordx4 a[20:23], v7, s[4:7], 0 offen offset:3072 sc1
    buffer_load_dwordx4 a[24:27], v6, s[4:7], s21 offen offset:1024 sc1
    buffer_load_dwordx4 a[28:31], v7, s[4:7], s21 offen offset:1024 sc1
    s_waitcnt vmcnt(7) lgkmcnt(3)
    v_mfma_f32_16x16x32_bf16 v[36:39], v[92:95], a[0:3], 0
    ds_read_b128 v[108:111], v3 offset:10240
    s_add_u32 s3, s39, 1
    v_mov_b32 v15, s3
    s_mov_b64 exec, 1
    buffer_store_dword v15, off, s[4:7], s40 sc1
    s_mov_b64 exec, -1
    s_waitcnt vmcnt(7)
    v_mfma_f32_16x16x32_bf16 v[40:43], v[92:95], a[4:7], 0
    s_waitcnt lgkmcnt(3)
    v_mfma_f32_16x16x32_bf16 v[44:47], v[96:99], a[0:3], 0
    ds_read_b128 v[112:115], v3 offset:11264
    v_mfma_f32_16x16x32_bf16 v[48:51], v[96:99], a[4:7], 0
    buffer_load_dwordx4 a[32:35], v6, s[4:7], s21 offen offset:3072 sc1
    s_waitcnt lgkmcnt(3)
    v_mfma_f32_16x16x32_bf16 v[52:55], v[100:103], a[0:3], 0
    ds_read_b128 v[116:119], v3 offset:12288
    v_mfma_f32_16x16x32_bf16 v[56:59], v[100:103], a[4:7], 0
    s_waitcnt lgkmcnt(3)
    v_mfma_f32_16x16x32_bf16 v[60:63], v[104:107], a[0:3], 0
    ds_read_b128 v[120:123], v3 offset:13312
    buffer_load_dwordx4 a[36:39], v7, s[4:7], s21 offen offset:3072 sc1
    v_mfma_f32_16x16x32_bf16 v[64:67], v[104:107], a[4:7], 0
    s_waitcnt vmcnt(8) lgkmcnt(3)
    v_mfma_f32_16x16x32_bf16 v[36:39], v[108:111], a[8:11], v[36:39]
    ds_read_b128 v[92:95], v3 offset:14336
    s_waitcnt vmcnt(7)
    v_mfma_f32_16x16x32_bf16 v[40:43], v[108:111], a[12:15], v[40:43]
    buffer_load_dwordx4 a[40:43], v6, s[4:7], s22 offen offset:0 sc1
    s_waitcnt lgkmcnt(3)
    v_mfma_f32_16x16x32_bf16 v[44:47], v[112:115], a[8:11], v[44:47]
    ds_read_b128 v[96:99], v3 offset:15360
    v_mfma_f32_16x16x32_bf16 v[48:51], v[112:115], a[12:15], v[48:51]
    s_waitcnt lgkmcnt(3)
    v_mfma_f32_16x16x32_bf16 v[52:55], v[116:119], a[8:11], v[52:55]
    ds_read_b128 v[100:103], v3 offset:16384
    v_mfma_f32_16x16x32_bf16 v[56:59], v[116:119], a[12:15], v[56:59]
    buffer_load_dwordx4 a[44:47], v7, s[4:7], s22 offen offset:0 sc1
    s_waitcnt lgkmcnt(3)
    v_mfma_f32_16x16x32_bf16 v[60:63], v[120:123], a[8:11], v[60:63]
    ds_read_b128 v[104:107], v3 offset:17408
    v_mfma_f32_16x16x32_bf16 v[64:67], v[120:123], a[12:15], v[64:67]
    s_waitcnt vmcnt(8) lgkmcnt(3)
    v_mfma_f32_16x16x32_bf16 v[36:39], v[92:95], a[16:19], v[36:39]
    ds_read_b128 v[108:111], v3 offset:18432
    s_waitcnt vmcnt(7)
    v_mfma_f32_16x16x32_bf16 v[40:43], v[92:95], a[20:23], v[40:43]
    buffer_load_dwordx4 a[48:51], v6, s[4:7], s22 offen offset:2048 sc1
    s_waitcnt lgkmcnt(3)
    v_mfma_f32_16x16x32_bf16 v[44:47], v[96:99], a[16:19], v[44:47]
    ds_read_b128 v[112:115], v3 offset:19456
    v_mfma_f32_16x16x32_bf16 v[48:51], v[96:99], a[20:23], v[48:51]
    s_waitcnt lgkmcnt(3)
    v_mfma_f32_16x16x32_bf16 v[52:55], v[100:103], a[16:19], v[52:55]
    ds_read_b128 v[116:119], v3 offset:20480
    v_mfma_f32_16x16x32_bf16 v[56:59], v[100:103], a[20:23], v[56:59]
    buffer_load_dwordx4 a[52:55], v7, s[4:7], s22 offen offset:2048 sc1
    s_waitcnt lgkmcnt(3)
    v_mfma_f32_16x16x32_bf16 v[60:63], v[104:107], a[16:19], v[60:63]
    ds_read_b128 v[120:123], v3 offset:21504
    v_mfma_f32_16x16x32_bf16 v[64:67], v[104:107], a[20:23], v[64:67]
    s_waitcnt vmcnt(8) lgkmcnt(3)
    v_mfma_f32_16x16x32_bf16 v[36:39], v[108:111], a[24:27], v[36:39]
    ds_read_b128 v[92:95], v3 offset:22528
    buffer_load_dwordx4 a[56:59], v6, s[4:7], s23 offen offset:0 sc1
    s_waitcnt vmcnt(8)
    v_mfma_f32_16x16x32_bf16 v[40:43], v[108:111], a[28:31], v[40:43]
    s_waitcnt lgkmcnt(3)
    v_mfma_f32_16x16x32_bf16 v[44:47], v[112:115], a[24:27], v[44:47]
    ds_read_b128 v[96:99], v3 offset:23552
    v_mfma_f32_16x16x32_bf16 v[48:51], v[112:115], a[28:31], v[48:51]
    buffer_load_dwordx4 a[60:63], v7, s[4:7], s23 offen offset:0 sc1
    s_waitcnt lgkmcnt(3)
    v_mfma_f32_16x16x32_bf16 v[52:55], v[116:119], a[24:27], v[52:55]
    ds_read_b128 v[100:103], v3 offset:24576
    v_mfma_f32_16x16x32_bf16 v[56:59], v[116:119], a[28:31], v[56:59]
    s_waitcnt lgkmcnt(3)
    v_mfma_f32_16x16x32_bf16 v[60:63], v[120:123], a[24:27], v[60:63]
    ds_read_b128 v[104:107], v3 offset:25600
    v_and_b32 v15, 63, v2
    buffer_load_dword v14, v15, s[4:7], s41 offen sc1
    v_mfma_f32_16x16x32_bf16 v[64:67], v[120:123], a[28:31], v[64:67]
    s_waitcnt vmcnt(8) lgkmcnt(3)
    v_mfma_f32_16x16x32_bf16 v[36:39], v[92:95], a[32:35], v[36:39]
    ds_read_b128 v[108:111], v3 offset:26624
    s_waitcnt vmcnt(7)
    v_mfma_f32_16x16x32_bf16 v[40:43], v[92:95], a[36:39], v[40:43]
    buffer_load_dwordx4 a[64:67], v6, s[4:7], s23 offen offset:1024 sc1
    s_waitcnt lgkmcnt(3)
    v_mfma_f32_16x16x32_bf16 v[44:47], v[96:99], a[32:35], v[44:47]
    ds_read_b128 v[112:115], v3 offset:27648
    v_mfma_f32_16x16x32_bf16 v[48:51], v[96:99], a[36:39], v[48:51]
    s_waitcnt lgkmcnt(3)
    v_mfma_f32_16x16x32_bf16 v[52:55], v[100:103], a[32:35], v[52:55]
    ds_read_b128 v[116:119], v3 offset:28672
    v_mfma_f32_16x16x32_bf16 v[56:59], v[100:103], a[36:39], v[56:59]
    buffer_load_dwordx4 a[68:71], v7, s[4:7], s23 offen offset:1024 sc1
    s_waitcnt lgkmcnt(3)
    v_mfma_f32_16x16x32_bf16 v[60:63], v[104:107], a[32:35], v[60:63]
    ds_read_b128 v[120:123], v3 offset:29696
    v_mfma_f32_16x16x32_bf16 v[64:67], v[104:107], a[36:39], v[64:67]
    s_waitcnt vmcnt(8) lgkmcnt(3)
    v_mfma_f32_16x16x32_bf16 v[36:39], v[108:111], a[40:43], v[36:39]
    ds_read_b128 v[92:95], v3 offset:30720
    s_waitcnt vmcnt(7)
    v_mfma_f32_16x16x32_bf16 v[40:43], v[108:111], a[44:47], v[40:43]
    buffer_load_dwordx4 a[72:75], v6, s[4:7], s23 offen offset:3072 sc1
    s_waitcnt lgkmcnt(3)
    v_mfma_f32_16x16x32_bf16 v[44:47], v[112:115], a[40:43], v[44:47]
    ds_read_b128 v[96:99], v3 offset:31744
    v_mfma_f32_16x16x32_bf16 v[48:51], v[112:115], a[44:47], v[48:51]
    s_waitcnt lgkmcnt(3)
    v_mfma_f32_16x16x32_bf16 v[52:55], v[116:119], a[40:43], v[52:55]
    ds_read_b128 v[100:103], v3 offset:32768
    v_mfma_f32_16x16x32_bf16 v[56:59], v[116:119], a[44:47], v[56:59]
    buffer_load_dwordx4 a[76:79], v7, s[4:7], s23 offen offset:3072 sc1
    s_waitcnt lgkmcnt(3)
    v_mfma_f32_16x16x32_bf16 v[60:63], v[120:123], a[40:43], v[60:63]
    ds_read_b128 v[104:107], v3 offset:33792
    v_mfma_f32_16x16x32_bf16 v[64:67], v[120:123], a[44:47], v[64:67]
    s_waitcnt vmcnt(8) lgkmcnt(3)
    v_mfma_f32_16x16x32_bf16 v[36:39], v[92:95], a[48:51], v[36:39]
    ds_read_b128 v[108:111], v3 offset:34816
    s_waitcnt vmcnt(7)
    v_mfma_f32_16x16x32_bf16 v[40:43], v[92:95], a[52:55], v[40:43]
    buffer_load_dwordx4 a[80:83], v6, s[4:7], s24 offen offset:1024 sc1
    s_waitcnt lgkmcnt(3)
    v_mfma_f32_16x16x32_bf16 v[44:47], v[96:99], a[48:51], v[44:47]
    ds_read_b128 v[112:115], v3 offset:35840
    v_mfma_f32_16x16x32_bf16 v[48:51], v[96:99], a[52:55], v[48:51]
    s_waitcnt lgkmcnt(3)
    v_mfma_f32_16x16x32_bf16 v[52:55], v[100:103], a[48:51], v[52:55]
    ds_read_b128 v[116:119], v3 offset:36864
    v_mfma_f32_16x16x32_bf16 v[56:59], v[100:103], a[52:55], v[56:59]
    buffer_load_dwordx4 a[84:87], v7, s[4:7], s24 offen offset:1024 sc1
    s_waitcnt lgkmcnt(3)
    v_mfma_f32_16x16x32_bf16 v[60:63], v[104:107], a[48:51], v[60:63]
    ds_read_b128 v[120:123], v3 offset:37888
    v_mfma_f32_16x16x32_bf16 v[64:67], v[104:107], a[52:55], v[64:67]
    s_waitcnt vmcnt(8) lgkmcnt(3)
    v_mfma_f32_16x16x32_bf16 v[36:39], v[108:111], a[56:59], v[36:39]
    s_add_u32 s52, s39, 1
    s_waitcnt vmcnt(6)
    v_cmp_ne_u32 vcc, s52, v14
    s_nop 4
    s_cbranch_vccz L_ok_1013
    s_mov_b32 s60, 0
L_lp_1012:
    v_and_b32 v15, 63, v2
    buffer_load_dword v14, v15, s[4:7], s41 offen sc1
    s_add_u32 s60, s60, 1
    s_cmp_gt_u32 s60, 0x40000
    s_cbranch_scc1 L_abort
    s_waitcnt vmcnt(0)
    v_cmp_ne_u32 vcc, s52, v14
    s_nop 1
    s_cbranch_vccnz L_lp_1012
L_ok_1013:
    v_mfma_f32_16x16x32_bf16 v[40:43], v[108:111], a[60:63], v[40:43]
    ds_read_b128 v[92:95], v3 offset:38912
    s_waitcnt lgkmcnt(3)
    v_mfma_f32_16x16x32_bf16 v[44:47], v[112:115], a[56:59], v[44:47]
    ds_read_b128 v[96:99], v3 offset:39936
    buffer_load_dwordx4 a[88:91], v6, s[4:7], s24 offen offset:2048 sc1
    v_mfma_f32_16x16x32_bf16 v[48:51], v[112:115], a[60:63], v[48:51]
    ds_read_b128 v[100:103], v3 offset:40960
    s_waitcnt lgkmcnt(4)
    v_mfma_f32_16x16x32_bf16 v[52:55], v[116:119], a[56:59], v[52:55]
    ds_read_b128 v[104:107], v3 offset:41984
    v_mfma_f32_16x16x32_bf16 v[56:59], v[116:119], a[60:63], v[56:59]
    buffer_load_dwordx4 a[92:95], v7, s[4:7], s24 offen offset:2048 sc1
    s_waitcnt lgkmcnt(4)
    v_mfma_f32_16x16x32_bf16 v[60:63], v[120:123], a[56:59], v[60:63]
    v_mfma_f32_16x16x32_bf16 v[64:67], v[120:123], a[60:63], v[64:67]
    s_waitcnt vmcnt(7) lgkmcnt(3)
    v_mfma_f32_16x16x32_bf16 v[36:39], v[92:95], a[64:67], v[36:39]
    ds_read_b128 v[108:111], v3 offset:43008
    buffer_load_dwordx4 a[96:99], v6, s[4:7], 0 offen offset:1024 sc1
    s_waitcnt vmcnt(7)
    v_mfma_f32_16x16x32_bf16 v[40:43], v[92:95], a[68:71], v[40:43]
    s_waitcnt lgkmcnt(3)
    v_mfma_f32_16x16x32_bf16 v[44:47], v[96:99], a[64:67], v[44:47]
    ds_read_b128 v[112:115], v3 offset:44032
    buffer_load_dwordx4 a[100:103], v7, s[4:7], 0 offen offset:1024 sc1
    v_mfma_f32_16x16x32_bf16 v[48:51], v[96:99], a[68:71], v[48:51]
    s_waitcnt lgkmcnt(3)
    v_mfma_f32_16x16x32_bf16 v[52:55], v[100:103], a[64:67], v[52:55]
    ds_read_b128 v[116:119], v3 offset:45056
    buffer_load_dwordx4 v[128:131], v8, s[4:7], 0 offen offset:0 sc1
    v_mfma_f32_16x16x32_bf16 v[56:59], v[100:103], a[68:71], v[56:59]
    s_waitcnt lgkmcnt(3)
    v_mfma_f32_16x16x32_bf16 v[60:63], v[104:107], a[64:67], v[60:63]
    ds_read_b128 v[120:123], v3 offset:46080
    buffer_load_dwordx4 v[132:135], v8, s[4:7], 0 offen offset:1024 sc1
    v_mfma_f32_16x16x32_bf16 v[64:67], v[104:107], a[68:71], v[64:67]
    s_waitcnt vmcnt(9) lgkmcnt(3)
    v_mfma_f32_16x16x32_bf16 v[36:39], v[108:111], a[72:75], v[36:39]
    ds_read_b128 v[92:95], v3 offset:47104
    s_waitcnt vmcnt(8)
    v_mfma_f32_16x16x32_bf16 v[40:43], v[108:111], a[76:79], v[40:43]
    buffer_load_dwordx4 a[104:107], v6, s[4:7], s21 offen offset:0 sc1
    s_waitcnt lgkmcnt(3)
    v_mfma_f32_16x16x32_bf16 v[44:47], v[112:115], a[72:75], v[44:47]
    ds_read_b128 v[96:99], v3 offset:48128
    v_mfma_f32_16x16x32_bf16 v[48:51], v[112:115], a[76:79], v[48:51]
    s_waitcnt lgkmcnt(3)
    v_mfma_f32_16x16x32_bf16 v[52:55], v[116:119], a[72:75], v[52:55]
    ds_read_b128 v[100:103], v3 offset:49152
    v_mfma_f32_16x16x32_bf16 v[56:59], v[116:119], a[76:79], v[56:59]
    buffer_load_dwordx4 a[108:111], v7, s[4:7], s21 offen offset:0 sc1
    s_waitcnt lgkmcnt(3)
    v_mfma_f32_16x16x32_bf16 v[60:63], v[120:123], a[72:75], v[60:63]
    ds_read_b128 v[104:107], v3 offset:50176
    v_mfma_f32_16x16x32_bf16 v[64:67], v[120:123], a[76:79], v[64:67]
    s_waitcnt vmcnt(9) lgkmcnt(3)
    v_mfma_f32_16x16x32_bf16 v[36:39], v[92:95], a[80:83], v[36:39]
    ds_read_b128 v[108:111], v3 offset:51200
    buffer_load_dwordx4 a[112:115], v6, s[4:7], s21 offen offset:2048 sc1
    s_waitcnt vmcnt(9)
    v_mfma_f32_16x16x32_bf16 v[40:43], v[92:95], a[84:87], v[40:43]
    s_waitcnt lgkmcnt(3)
    v_mfma_f32_16x16x32_bf16 v[44:47], v[96:99], a[80:83], v[44:47]
    ds_read_b128 v[112:115], v3 offset:52224
    buffer_load_dwordx4 a[116:119], v7, s[4:7], s21 offen offset:2048 sc1
    v_mfma_f32_16x16x32_bf16 v[48:51], v[96:99], a[84:87], v[48:51]
    s_waitcnt lgkmcnt(3)
    v_mfma_f32_16x16x32_bf16 v[52:55], v[100:103], a[80:83], v[52:55]
    ds_read_b128 v[116:119], v3 offset:53248
    s_add_u32 s15, s97, s26
    s_add_u32 s14, s97, 0
    s_add_u32 s15, s15, 81920
    s_mov_b32 m0, s14
    s_nop 0
    buffer_load_dwordx4 v1, s[4:7], s15 offen offset:0 lds
    v_mfma_f32_16x16x32_bf16 v[56:59], v[100:103], a[84:87], v[56:59]
    s_waitcnt lgkmcnt(3)
    v_mfma_f32_16x16x32_bf16 v[60:63], v[104:107], a[80:83], v[60:63]
    ds_read_b128 v[120:123], v3 offset:54272
    buffer_load_dwordx4 v1, s[4:7], s15 offen offset:1024 lds
    v_mfma_f32_16x16x32_bf16 v[64:67], v[104:107], a[84:87], v[64:67]
    s_waitcnt vmcnt(11) lgkmcnt(3)
    v_mfma_f32_16x16x32_bf16 v[36:39], v[108:111], a[88:91], v[36:39]
    ds_read_b128 v[92:95], v3 offset:55296
    buffer_load_dwordx4 a[120:123], v6, s[4:7], s22 offen offset:1024 sc1
    s_waitcnt vmcnt(11)
    v_mfma_f32_16x16x32_bf16 v[40:43], v[108:111], a[92:95], v[40:43]
    s_waitcnt lgkmcnt(3)
    v_mfma_f32_16x16x32_bf16 v[44:47], v[112:115], a[88:91], v[44:47]
    ds_read_b128 v[96:99], v3 offset:56320
    v_mfma_f32_16x16x32_bf16 v[48:51], v[112:115], a[92:95], v[48:51]
    buffer_load_dwordx4 a[124:127], v7, s[4:7], s22 offen offset:1024 sc1
    s_waitcnt lgkmcnt(3)
    v_mfma_f32_16x16x32_bf16 v[52:55], v[116:119], a[88:91], v[52:55]
    ds_read_b128 v[100:103], v3 offset:57344
    v_mfma_f32_16x16x32_bf16 v[56:59], v[116:119], a[92:95], v[56:59]
    s_waitcnt lgkmcnt(3)
    v_mfma_f32_16x16x32_bf16 v[60:63], v[120:123], a[88:91], v[60:63]
    ds_read_b128 v[104:107], v3 offset:58368
    buffer_load_dwordx4 v1, s[4:7], s15 offen offset:2048 lds
    v_mfma_f32_16x16x32_bf16 v[64:67], v[120:123], a[92:95], v[64:67]
    s_waitcnt vmcnt(12) lgkmcnt(3)
    v_mfma_f32_16x16x32_bf16 v[36:39], v[92:95], a[96:99], v[36:39]
    ds_read_b128 v[108:111], v3 offset:59392
    buffer_load_dwordx4 a[128:131], v6, s[4:7], s22 offen offset:3072 sc1
    s_waitcnt vmcnt(11)
    v_add_f32 v128, v128, v129
    s_waitcnt vmcnt(10)
    v_add_f32 v132, v132, v133
    v_mfma_f32_16x16x32_bf16 v[40:43], v[92:95], a[100:103], v[40:43]
    v_add_f32 v130, v130, v131
    s_waitcnt lgkmcnt(3)
    v_mfma_f32_16x16x32_bf16 v[44:47], v[96:99], a[96:99], v[44:47]
    ds_read_b128 v[112:115], v3 offset:60416
    v_add_f32 v134, v134, v135
    v_mfma_f32_16x16x32_bf16 v[48:51], v[96:99], a[100:103], v[48:51]
    buffer_load_dwordx4 a[132:135], v7, s[4:7], s22 offen offset:3072 sc1
    v_add_f32 v128, v128, v130
    s_waitcnt lgkmcnt(3)
    v_mfma_f32_16x16x32_bf16 v[52:55], v[100:103], a[96:99], v[52:55]
    ds_read_b128 v[116:119], v3 offset:61440
    v_add_f32 v132, v132, v134
    v_mov_b32 v129, v128
    v_mfma_f32_16x16x32_bf16 v[56:59], v[100:103], a[100:103], v[56:59]
    v_mov_b32 v133, v132
    s_waitcnt lgkmcnt(3)
    v_mfma_f32_16x16x32_bf16 v[60:63], v[104:107], a[96:99], v[60:63]
    ds_read_b128 v[120:123], v3 offset:62464
    buffer_load_dwordx4 v1, s[4:7], s15 offen offset:3072 lds
    v_permlane16_swap_b32 v128, v129
    v_mfma_f32_16x16x32_bf16 v[64:67], v[104:107], a[100:103], v[64:67]
    v_permlane16_swap_b32 v132, v133
    s_waitcnt vmcnt(11) lgkmcnt(3)
    v_mfma_f32_16x16x32_bf16 v[36:39], v[108:111], a[104:107], v[36:39]
    ds_read_b128 v[92:95], v3 offset:63488
    buffer_load_dwordx4 a[136:139], v6, s[4:7], s23 offen offset:2048 sc1
    v_add_f32 v128, v128, v129
    v_add_f32 v132, v132, v133
    s_waitcnt vmcnt(11)
    v_mfma_f32_16x16x32_bf16 v[40:43], v[108:111], a[108:111], v[40:43]
    v_mov_b32 v129, v128
    s_waitcnt lgkmcnt(3)
    v_mfma_f32_16x16x32_bf16 v[44:47], v[112:115], a[104:107], v[44:47]
    ds_read_b128 v[96:99], v3 offset:64512
    v_mov_b32 v133, v132
    v_mfma_f32_16x16x32_bf16 v[48:51], v[112:115], a[108:111], v[48:51]
    buffer_load_dwordx4 a[140:143], v7, s[4:7], s23 offen offset:2048 sc1
    v_permlane32_swap_b32 v128, v129
    s_waitcnt lgkmcnt(3)
    v_mfma_f32_16x16x32_bf16 v[52:55], v[116:119], a[104:107], v[52:55]
    ds_read_b128 v[100:103], v4 offset:0
    v_permlane32_swap_b32 v132, v133
    v_mul_f32 v128, 986500301, v128
    v_mfma_f32_16x16x32_bf16 v[56:59], v[116:119], a[108:111], v[56:59]
    v_mul_f32 v132, 986500301, v132
    s_waitcnt lgkmcnt(3)
    v_mfma_f32_16x16x32_bf16 v[60:63], v[120:123], a[104:107], v[60:63]
    ds_read_b128 v[104:107], v4 offset:1024
    s_add_u32 s15, s97, s26
    s_add_u32 s14, s97, 16384
    s_add_u32 s15, s15, 98304
    s_mov_b32 m0, s14
    s_nop 0
    buffer_load_dwordx4 v1, s[4:7], s15 offen offset:0 lds
    v_mul_f32 v129, 986500301, v129
    v_mfma_f32_16x16x32_bf16 v[64:67], v[120:123], a[108:111], v[64:67]
    v_mul_f32 v133, 986500301, v133
    s_waitcnt vmcnt(12) lgkmcnt(3)
    v_mfma_f32_16x16x32_bf16 v[36:39], v[92:95], a[112:115], v[36:39]
    ds_read_b128 v[108:111], v4 offset:2048
    buffer_load_dwordx4 a[144:147], v6, s[4:7], s24 offen offset:0 sc1
    v_fma_f32 v129, -v128, v128, v129
    v_fma_f32 v133, -v132, v132, v133
    s_waitcnt vmcnt(12)
    v_mfma_f32_16x16x32_bf16 v[40:43], v[92:95], a[116:119], v[40:43]
    v_max_f32 v129, 0, v129
    s_waitcnt lgkmcnt(3)
    v_mfma_f32_16x16x32_bf16 v[44:47], v[96:99], a[112:115], v[44:47]
    ds_read_b128 v[112:115], v4 offset:3072
    v_max_f32 v133, 0, v133
    v_mfma_f32_16x16x32_bf16 v[48:51], v[96:99], a[116:119], v[48:51]
    buffer_load_dwordx4 a[148:151], v7, s[4:7], s24 offen offset:0 sc1
    v_add_f32 v129, 925353388, v129
    s_waitcnt lgkmcnt(3)
    v_mfma_f32_16x16x32_bf16 v[52:55], v[100:103], a[112:115], v[52:55]
    ds_read_b128 v[116:119], v4 offset:4096
    v_add_f32 v133, 925353388, v133
    v_rsq_f32 v124, v129
    v_mfma_f32_16x16x32_bf16 v[56:59], v[100:103], a[116:119], v[56:59]
    v_rsq_f32 v125, v133
    s_waitcnt lgkmcnt(3)
    v_mfma_f32_16x16x32_bf16 v[60:63], v[104:107], a[112:115], v[60:63]
    ds_read_b128 v[120:123], v4 offset:5120
    buffer_load_dwordx4 v1, s[4:7], s15 offen offset:1024 lds
    v_mul_f32_e64 v126, -v128, v124
    v_mfma_f32_16x16x32_bf16 v[64:67], v[104:107], a[116:119], v[64:67]
    v_mul_f32_e64 v127, -v132, v125
    s_waitcnt vmcnt(11) lgkmcnt(3)
    v_mfma_f32_16x16x32_bf16 v[36:39], v[108:111], a[120:123], v[36:39]
    ds_read_b128 v[92:95], v4 offset:6144
    buffer_load_dwordx4 a[152:155], v6, s[4:7], s24 offen offset:3072 sc1
    ds_read_b128 v[160:163], v12 offset:512
    s_waitcnt vmcnt(11)
    v_mfma_f32_16x16x32_bf16 v[40:43], v[108:111], a[124:127], v[40:43]
    s_waitcnt lgkmcnt(4)
    v_mfma_f32_16x16x32_bf16 v[44:47], v[112:115], a[120:123], v[44:47]
    ds_read_b128 v[96:99], v4 offset:7168
    buffer_load_dwordx4 a[156:159], v7, s[4:7], s24 offen offset:3072 sc1
    v_mfma_f32_16x16x32_bf16 v[48:51], v[112:115], a[124:127], v[48:51]
    s_waitcnt lgkmcnt(4)
    v_mfma_f32_16x16x32_bf16 v[52:55], v[116:119], a[120:123], v[52:55]
    ds_read_b128 v[100:103], v4 offset:8192
    buffer_load_dwordx4 v1, s[4:7], s15 offen offset:2048 lds
    ds_read_b128 v[164:167], v12 offset:1024
    v_mfma_f32_16x16x32_bf16 v[56:59], v[116:119], a[124:127], v[56:59]
    s_waitcnt lgkmcnt(5)
    v_mfma_f32_16x16x32_bf16 v[60:63], v[120:123], a[120:123], v[60:63]
    ds_read_b128 v[104:107], v4 offset:9216
    buffer_load_dwordx4 v1, s[4:7], s15 offen offset:3072 lds
    v_mfma_f32_16x16x32_bf16 v[64:67], v[120:123], a[124:127], v[64:67]
    s_waitcnt vmcnt(12) lgkmcnt(5)
    v_mfma_f32_16x16x32_bf16 v[36:39], v[92:95], a[128:131], v[36:39]
    ds_read_b128 v[108:111], v4 offset:10240
    s_waitcnt lgkmcnt(2)
    v_fma_f32 v128, v160, v126, v164
    v_fma_f32 v129, v161, v126, v165
    s_waitcnt vmcnt(11)
    v_mfma_f32_16x16x32_bf16 v[40:43], v[92:95], a[132:135], v[40:43]
    v_fma_f32 v130, v162, v126, v166
    v_mfma_f32_16x16x32_bf16 v[44:47], v[96:99], a[128:131], v[44:47]
    ds_read_b128 v[112:115], v4 offset:11264
    v_fma_f32 v131, v163, v126, v167
    v_mfma_f32_16x16x32_bf16 v[48:51], v[96:99], a[132:135], v[48:51]
    v_fma_f32 v132, v160, v127, v164
    s_add_u32 s15, s97, s26
    s_add_u32 s14, s97, 32768
    s_add_u32 s15, s15, 114688
    s_mov_b32 m0, s14
    s_nop 0
    buffer_load_dwordx4 v1, s[4:7], s15 offen offset:0 lds
    v_mfma_f32_16x16x32_bf16 v[52:55], v[100:103], a[128:131], v[52:55]
    ds_read_b128 v[116:119], v4 offset:12288
    v_fma_f32 v133, v161, v127, v165
    v_fma_f32 v134, v162, v127, v166
    v_mfma_f32_16x16x32_bf16 v[56:59], v[100:103], a[132:135], v[56:59]
    v_fma_f32 v135, v163, v127, v167
    s_waitcnt lgkmcnt(3)
    v_mfma_f32_16x16x32_bf16 v[60:63], v[104:107], a[128:131], v[60:63]
    ds_read_b128 v[120:123], v4 offset:13312
    ds_read_b128 v[160:163], v12 offset:576
    v_mfma_f32_16x16x32_bf16 v[64:67], v[104:107], a[132:135], v[64:67]
    ds_read_b128 v[164:167], v12 offset:1088
    s_waitcnt vmcnt(10) lgkmcnt(5)
    v_mfma_f32_16x16x32_bf16 v[36:39], v[108:111], a[136:139], v[36:39]
    ds_read_b128 v[92:95], v4 offset:14336
    s_waitcnt lgkmcnt(1)
    v_fma_f32 v136, v160, v126, v164
    v_fma_f32 v137, v161, v126, v165
    s_waitcnt vmcnt(9)
    v_mfma_f32_16x16x32_bf16 v[40:43], v[108:111], a[140:143], v[40:43]
    v_fma_f32 v138, v162, v126, v166
    v_mfma_f32_16x16x32_bf16 v[44:47], v[112:115], a[136:139], v[44:47]
    ds_read_b128 v[96:99], v4 offset:15360
    v_fma_f32 v139, v163, v126, v167
    v_mfma_f32_16x16x32_bf16 v[48:51], v[112:115], a[140:143], v[48:51]
    v_fma_f32 v140, v160, v127, v164
    buffer_load_dwordx4 v1, s[4:7], s15 offen offset:1024 lds
    v_mfma_f32_16x16x32_bf16 v[52:55], v[116:119], a[136:139], v[52:55]
    ds_read_b128 v[100:103], v4 offset:16384
    v_fma_f32 v141, v161, v127, v165
    v_fma_f32 v142, v162, v127, v166
    v_mfma_f32_16x16x32_bf16 v[56:59], v[116:119], a[140:143], v[56:59]
    v_fma_f32 v143, v163, v127, v167
    v_mfma_f32_16x16x32_bf16 v[60:63], v[120:123], a[136:139], v[60:63]
    ds_read_b128 v[104:107], v4 offset:17408
    ds_read_b128 v[160:163], v12 offset:640
    v_mfma_f32_16x16x32_bf16 v[64:67], v[120:123], a[140:143], v[64:67]
    ds_read_b128 v[164:167], v12 offset:1152
    s_waitcnt vmcnt(8) lgkmcnt(5)
    v_mfma_f32_16x16x32_bf16 v[36:39], v[92:95], a[144:147], v[36:39]
    ds_read_b128 v[108:111], v4 offset:18432
    s_waitcnt lgkmcnt(1)
    v_fma_f32 v144, v160, v126, v164
    v_fma_f32 v145, v161, v126, v165
    s_waitcnt vmcnt(7)
    v_mfma_f32_16x16x32_bf16 v[40:43], v[92:95], a[148:151], v[40:43]
    v_fma_f32 v146, v162, v126, v166
    v_mfma_f32_16x16x32_bf16 v[44:47], v[96:99], a[144:147], v[44:47]
    ds_read_b128 v[112:115], v4 offset:19456
    v_fma_f32 v147, v163, v126, v167
    v_mfma_f32_16x16x32_bf16 v[48:51], v[96:99], a[148:151], v[48:51]
    v_fma_f32 v148, v160, v127, v164
    buffer_load_dwordx4 v1, s[4:7], s15 offen offset:2048 lds
    v_mfma_f32_16x16x32_bf16 v[52:55], v[100:103], a[144:147], v[52:55]
    ds_read_b128 v[116:119], v4 offset:20480
    v_fma_f32 v149, v161, v127, v165
    v_fma_f32 v150, v162, v127, v166
    v_mfma_f32_16x16x32_bf16 v[56:59], v[100:103], a[148:151], v[56:59]
    v_fma_f32 v151, v163, v127, v167
    v_mfma_f32_16x16x32_bf16 v[60:63], v[104:107], a[144:147], v[60:63]
    ds_read_b128 v[120:123], v4 offset:21504
    ds_read_b128 v[160:163], v12 offset:704
    v_mfma_f32_16x16x32_bf16 v[64:67], v[104:107], a[148:151], v[64:67]
    ds_read_b128 v[164:167], v12 offset:1216
    s_waitcnt vmcnt(6) lgkmcnt(5)
    v_mfma_f32_16x16x32_bf16 v[36:39], v[108:111], a[152:155], v[36:39]
    s_waitcnt lgkmcnt(0)
    v_fma_f32 v152, v160, v126, v164
    s_waitcnt vmcnt(5)
    v_mfma_f32_16x16x32_bf16 v[40:43], v[108:111], a[156:159], v[40:43]
    v_fma_f32 v153, v161, v126, v165
    v_mfma_f32_16x16x32_bf16 v[44:47], v[112:115], a[152:155], v[44:47]
    v_fma_f32 v154, v162, v126, v166
    v_mfma_f32_16x16x32_bf16 v[48:51], v[112:115], a[156:159], v[48:51]
    v_fma_f32 v155, v163, v126, v167
    buffer_load_dwordx4 v1, s[4:7], s15 offen offset:3072 lds
    v_mfma_f32_16x16x32_bf16 v[52:55], v[116:119], a[152:155], v[52:55]
    v_fma_f32 v156, v160, v127, v164
    v_mfma_f32_16x16x32_bf16 v[56:59], v[116:119], a[156:159], v[56:59]
    v_fma_f32 v157, v161, v127, v165
    v_mfma_f32_16x16x32_bf16 v[60:63], v[120:123], a[152:155], v[60:63]
    v_fma_f32 v158, v162, v127, v166
    v_mfma_f32_16x16x32_bf16 v[64:67], v[120:123], a[156:159], v[64:67]
    v_fma_f32 v159, v163, v127, v167
    s_waitcnt vmcnt(4)
    s_barrier
    ds_read_b128 v[92:95], v1 offset:0
    ds_read_b128 v[96:99], v1 offset:1024
    ds_read_b128 v[100:103], v1 offset:2048
    ds_read_b128 v[104:107], v1 offset:3072
    ds_read_b128 v[108:111], v1 offset:4096
    ds_read_b128 v[112:115], v1 offset:5120
    s_waitcnt lgkmcnt(3)
    v_mfma_f32_16x16x32_bf16 v[68:71], v[92:95], a[152:155], 0
    ds_read_b128 v[116:119], v1 offset:6144
    s_add_u32 s53, s35, 4096
    v_fma_f32 v36, v36, v124, v128
    v_mfma_f32_16x16x32_bf16 v[72:75], v[92:95], a[156:159], 0
    v_fma_f32 v37, v37, v124, v129
    v_fma_f32 v38, v38, v124, v130
    v_mfma_f32_16x16x32_bf16 v[76:79], v[96:99], a[152:155], 0
    ds_read_b128 v[120:123], v1 offset:7168
    v_fma_f32 v39, v39, v124, v131
    s_add_u32 s15, s96, s26
    s_add_u32 s14, s96, 49152
    s_add_u32 s15, s15, 131072
    s_mov_b32 m0, s14
    s_nop 0
    buffer_load_dwordx4 v1, s[4:7], s15 offen offset:0 lds
    v_mfma_f32_16x16x32_bf16 v[80:83], v[96:99], a[156:159], 0
    v_max_f32 v36, 0, v36
    v_max_f32 v37, 0, v37
    v_mfma_f32_16x16x32_bf16 v[84:87], v[100:103], a[152:155], 0
    ds_read_b128 v[164:167], v1 offset:8192
    v_max_f32 v38, 0, v38
    v_max_f32 v39, 0, v39
    v_mfma_f32_16x16x32_bf16 v[88:91], v[100:103], a[156:159], 0
    v_mul_f32 v36, v36, v36
    s_waitcnt lgkmcnt(3)
    v_mfma_f32_16x16x32_bf16 v[68:71], v[104:107], a[144:147], v[68:71]
    ds_read_b128 v[92:95], v1 offset:9216
    v_mul_f32 v37, v37, v37
    v_mul_f32 v38, v38, v38
    buffer_load_dwordx4 v1, s[4:7], s15 offen offset:1024 lds
    v_mfma_f32_16x16x32_bf16 v[72:75], v[104:107], a[148:151], v[72:75]
    v_mul_f32 v39, v39, v39
    v_cvt_pk_bf16_f32 v36, v36, v37
    v_mfma_f32_16x16x32_bf16 v[76:79], v[108:111], a[144:147], v[76:79]
    ds_read_b128 v[96:99], v1 offset:10240
    v_cvt_pk_bf16_f32 v37, v38, v39
    s_add_u32 s70, s28, 26624
    buffer_load_dwordx4 a[176:179], v1, s[4:7], s70 offen offset:0
    v_mfma_f32_16x16x32_bf16 v[80:83], v[108:111], a[148:151], v[80:83]
    v_fma_f32 v44, v44, v124, v136
    v_fma_f32 v45, v45, v124, v137
    v_mfma_f32_16x16x32_bf16 v[84:87], v[112:115], a[144:147], v[84:87]
    ds_read_b128 v[100:103], v1 offset:11264
    v_fma_f32 v46, v46, v124, v138
    v_fma_f32 v47, v47, v124, v139
    buffer_load_dwordx4 a[180:183], v1, s[4:7], s70 offen offset:1024
    v_mfma_f32_16x16x32_bf16 v[88:91], v[112:115], a[148:151], v[88:91]
    v_max_f32 v44, 0, v44
    s_waitcnt lgkmcnt(3)
    v_mfma_f32_16x16x32_bf16 v[68:71], v[116:119], a[136:139], v[68:71]
    ds_read_b128 v[104:107], v1 offset:12288
    v_max_f32 v45, 0, v45
    v_max_f32 v46, 0, v46
    v_mfma_f32_16x16x32_bf16 v[72:75], v[116:119], a[140:143], v[72:75]
    v_max_f32 v47, 0, v47
    v_mfma_f32_16x16x32_bf16 v[76:79], v[120:123], a[136:139], v[76:79]
    ds_read_b128 v[108:111], v1 offset:13312
    v_mul_f32 v44, v44, v44
    v_mul_f32 v45, v45, v45
    v_mfma_f32_16x16x32_bf16 v[80:83], v[120:123], a[140:143], v[80:83]
    v_mul_f32 v46, v46, v46
    v_mfma_f32_16x16x32_bf16 v[84:87], v[164:167], a[136:139], v[84:87]
    ds_read_b128 v[112:115], v1 offset:14336
    v_mul_f32_e64 v47, v47, v47
    v_cvt_pk_bf16_f32 v38, v44, v45
    v_mfma_f32_16x16x32_bf16 v[88:91], v[164:167], a[140:143], v[88:91]
    v_cvt_pk_bf16_f32 v39, v46, v47
    buffer_store_dwordx4 v[36:39], v1, s[4:7], s35 offen offset:0 sc1
    buffer_load_dwordx4 v1, s[4:7], s15 offen offset:2048 lds
    buffer_load_dwordx4 a[184:187], v1, s[4:7], s70 offen offset:2048
    s_waitcnt lgkmcnt(3)
    v_mfma_f32_16x16x32_bf16 v[68:71], v[92:95], a[128:131], v[68:71]
    ds_read_b128 v[116:119], v1 offset:15360
    v_fma_f32 v40, v40, v125, v132
    v_fma_f32 v41, v41, v125, v133
    v_mfma_f32_16x16x32_bf16 v[72:75], v[92:95], a[132:135], v[72:75]
    v_fma_f32 v42, v42, v125, v134
    buffer_load_dwordx4 a[188:191], v1, s[4:7], s70 offen offset:3072
    v_mfma_f32_16x16x32_bf16 v[76:79], v[96:99], a[128:131], v[76:79]
    ds_read_b128 v[120:123], v1 offset:16384
    v_fma_f32 v43, v43, v125, v135
    v_max_f32 v40, 0, v40
    v_mfma_f32_16x16x32_bf16 v[80:83], v[96:99], a[132:135], v[80:83]
    v_max_f32 v41, 0, v41
    v_mfma_f32_16x16x32_bf16 v[84:87], v[100:103], a[128:131], v[84:87]
    ds_read_b128 v[164:167], v1 offset:17408
    v_max_f32 v42, 0, v42
    v_max_f32 v43, 0, v43
    s_add_u32 s70, s28, 30720
    buffer_load_dwordx4 a[192:195], v1, s[4:7], s70 offen offset:0
    v_mfma_f32_16x16x32_bf16 v[88:91], v[100:103], a[132:135], v[88:91]
    v_mul_f32 v40, v40, v40
    s_waitcnt lgkmcnt(3)
    v_mfma_f32_16x16x32_bf16 v[68:71], v[104:107], a[120:123], v[68:71]
    ds_read_b128 v[92:95], v1 offset:18432
    v_mul_f32 v41, v41, v41
    v_mul_f32 v42, v42, v42
    v_mfma_f32_16x16x32_bf16 v[72:75], v[104:107], a[124:127], v[72:75]
    v_mul_f32 v43, v43, v43
    v_cvt_pk_bf16_f32 v40, v40, v41
    v_mfma_f32_16x16x32_bf16 v[76:79], v[108:111], a[120:123], v[76:79]
    ds_read_b128 v[96:99], v1 offset:19456
    v_cvt_pk_bf16_f32 v41, v42, v43
    buffer_load_dwordx4 a[196:199], v1, s[4:7], s70 offen offset:1024
    v_mfma_f32_16x16x32_bf16 v[80:83], v[108:111], a[124:127], v[80:83]
    v_fma_f32 v48, v48, v125, v140
    v_fma_f32 v49, v49, v125, v141
    v_mfma_f32_16x16x32_bf16 v[84:87], v[112:115], a[120:123], v[84:87]
    ds_read_b128 v[100:103], v1 offset:20480
    v_fma_f32 v50, v50, v125, v142
    v_fma_f32 v51, v51, v125, v143
    v_mfma_f32_16x16x32_bf16 v[88:91], v[112:115], a[124:127], v[88:91]
    v_max_f32 v48, 0, v48
    s_waitcnt lgkmcnt(3)
    v_mfma_f32_16x16x32_bf16 v[68:71], v[116:119], a[112:115], v[68:71]
    ds_read_b128 v[104:107], v1 offset:21504
    v_max_f32 v49, 0, v49
    v_max_f32 v50, 0, v50
    v_mfma_f32_16x16x32_bf16 v[72:75], v[116:119], a[116:119], v[72:75]
    v_max_f32 v51, 0, v51
    v_mfma_f32_16x16x32_bf16 v[76:79], v[120:123], a[112:115], v[76:79]
    ds_read_b128 v[108:111], v1 offset:22528
    v_mul_f32 v48, v48, v48
    v_mul_f32 v49, v49, v49
    v_mfma_f32_16x16x32_bf16 v[80:83], v[120:123], a[116:119], v[80:83]
    v_mul_f32 v50, v50, v50
    v_mfma_f32_16x16x32_bf16 v[84:87], v[164:167], a[112:115], v[84:87]
    ds_read_b128 v[112:115], v1 offset:23552
    v_mul_f32_e64 v51, v51, v51
    v_cvt_pk_bf16_f32 v42, v48, v49
    v_mfma_f32_16x16x32_bf16 v[88:91], v[164:167], a[116:119], v[88:91]
    v_cvt_pk_bf16_f32 v43, v50, v51
    buffer_store_dwordx4 v[40:43], v1, s[4:7], s35 offen offset:1024 sc1
    buffer_load_dwordx4 a[200:203], v1, s[4:7], s70 offen offset:2048
    buffer_load_dwordx4 a[204:207], v1, s[4:7], s70 offen offset:3072
    s_waitcnt lgkmcnt(3)
    v_mfma_f32_16x16x32_bf16 v[68:71], v[92:95], a[104:107], v[68:71]
    ds_read_b128 v[116:119], v1 offset:24576
    v_fma_f32 v52, v52, v124, v144
    v_fma_f32 v53, v53, v124, v145
    v_mfma_f32_16x16x32_bf16 v[72:75], v[92:95], a[108:111], v[72:75]
    v_fma_f32 v54, v54, v124, v146
    v_fma_f32 v55, v55, v124, v147
    v_mfma_f32_16x16x32_bf16 v[76:79], v[96:99], a[104:107], v[76:79]
    ds_read_b128 v[120:123], v1 offset:25600
    v_max_f32 v52, 0, v52
    s_add_u32 s70, s28, 34816
    buffer_load_dwordx4 a[208:211], v1, s[4:7], s70 offen offset:0
    v_mfma_f32_16x16x32_bf16 v[80:83], v[96:99], a[108:111], v[80:83]
    v_max_f32 v53, 0, v53
    v_max_f32 v54, 0, v54
    v_mfma_f32_16x16x32_bf16 v[84:87], v[100:103], a[104:107], v[84:87]
    ds_read_b128 v[164:167], v1 offset:26624
    v_max_f32 v55, 0, v55
    v_mul_f32 v52, v52, v52
    v_mfma_f32_16x16x32_bf16 v[88:91], v[100:103], a[108:111], v[88:91]
    v_mul_f32 v53, v53, v53
    s_waitcnt lgkmcnt(3)
    v_mfma_f32_16x16x32_bf16 v[68:71], v[104:107], a[96:99], v[68:71]
    ds_read_b128 v[92:95], v1 offset:27648
    v_mul_f32 v54, v54, v54
    v_mul_f32 v55, v55, v55
    v_mfma_f32_16x16x32_bf16 v[72:75], v[104:107], a[100:103], v[72:75]
    v_cvt_pk_bf16_f32 v52, v52, v53
    buffer_load_dwordx4 a[212:215], v1, s[4:7], s70 offen offset:1024
    v_mfma_f32_16x16x32_bf16 v[76:79], v[108:111], a[96:99], v[76:79]
    ds_read_b128 v[96:99], v1 offset:28672
    v_cvt_pk_bf16_f32 v53, v54, v55
    v_fma_f32 v60, v60, v124, v152
    v_mfma_f32_16x16x32_bf16 v[80:83], v[108:111], a[100:103], v[80:83]
    v_fma_f32 v61, v61, v124, v153
    v_mfma_f32_16x16x32_bf16 v[84:87], v[112:115], a[96:99], v[84:87]
    ds_read_b128 v[100:103], v1 offset:29696
    v_fma_f32 v62, v62, v124, v154
    v_fma_f32 v63, v63, v124, v155
    buffer_load_dwordx4 a[216:219], v1, s[4:7], s70 offen offset:2048
    v_mfma_f32_16x16x32_bf16 v[88:91], v[112:115], a[100:103], v[88:91]
    v_max_f32 v60, 0, v60
    s_waitcnt lgkmcnt(3)
    v_mfma_f32_16x16x32_bf16 v[68:71], v[116:119], a[88:91], v[68:71]
    s_waitcnt vmcnt(10)
    s_barrier
    v_mfma_f32_16x16x32_bf16 v[72:75], v[116:119], a[92:95], v[72:75]
    ds_read_b128 v[104:107], v1 offset:30720
    v_max_f32 v61, 0, v61
    v_max_f32 v62, 0, v62
    v_mfma_f32_16x16x32_bf16 v[76:79], v[120:123], a[88:91], v[76:79]
    ds_read_b128 v[108:111], v1 offset:31744
    v_max_f32 v63, 0, v63
    v_mul_f32 v60, v60, v60
    v_mfma_f32_16x16x32_bf16 v[80:83], v[120:123], a[92:95], v[80:83]
    ds_read_b128 v[112:115], v1 offset:32768
    v_mul_f32 v61, v61, v61
    v_mul_f32 v62, v62, v62
    v_mfma_f32_16x16x32_bf16 v[84:87], v[164:167], a[88:91], v[84:87]
    v_mul_f32_e64 v63, v63, v63
    v_cvt_pk_bf16_f32 v54, v60, v61
    v_mfma_f32_16x16x32_bf16 v[88:91], v[164:167], a[92:95], v[88:91]
    v_cvt_pk_bf16_f32 v55, v62, v63
    buffer_store_dwordx4 v[52:55], v1, s[4:7], s53 offen offset:0 sc1
    buffer_load_dwordx4 a[220:223], v1, s[4:7], s70 offen offset:3072
    s_add_u32 s71, s28, 47104
    buffer_load_dwordx4 a[156:159], v1, s[4:7], s71 offen offset:0
    buffer_load_dwordx4 a[152:155], v1, s[4:7], s71 offen offset:1024
    s_waitcnt lgkmcnt(3)
    v_mfma_f32_16x16x32_bf16 v[68:71], v[92:95], a[80:83], v[68:71]
    ds_read_b128 v[116:119], v1 offset:33792
    v_fma_f32 v56, v56, v125, v148
    v_fma_f32 v57, v57, v125, v149
    v_mfma_f32_16x16x32_bf16 v[72:75], v[92:95], a[84:87], v[72:75]
    v_fma_f32 v58, v58, v125, v150
    v_fma_f32 v59, v59, v125, v151
    v_mfma_f32_16x16x32_bf16 v[76:79], v[96:99], a[80:83], v[76:79]
    ds_read_b128 v[120:123], v1 offset:34816
    v_max_f32 v56, 0, v56
    buffer_load_dwordx4 a[148:151], v1, s[4:7], s71 offen offset:2048
    v_mfma_f32_16x16x32_bf16 v[80:83], v[96:99], a[84:87], v[80:83]
    v_max_f32 v57, 0, v57
    v_max_f32 v58, 0, v58
    v_mfma_f32_16x16x32_bf16 v[84:87], v[100:103], a[80:83], v[84:87]
    ds_read_b128 v[164:167], v1 offset:35840
    v_max_f32 v59, 0, v59
    v_mul_f32 v56, v56, v56
    v_mfma_f32_16x16x32_bf16 v[88:91], v[100:103], a[84:87], v[88:91]
    v_mul_f32 v57, v57, v57
    s_waitcnt lgkmcnt(3)
    v_mfma_f32_16x16x32_bf16 v[68:71], v[104:107], a[72:75], v[68:71]
    ds_read_b128 v[92:95], v1 offset:36864
    v_mul_f32 v58, v58, v58
    v_mul_f32 v59, v59, v59
    v_mfma_f32_16x16x32_bf16 v[72:75], v[104:107], a[76:79], v[72:75]
    v_cvt_pk_bf16_f32 v56, v56, v57
    v_cvt_pk_bf16_f32 v57, v58, v59
    v_mfma_f32_16x16x32_bf16 v[76:79], v[108:111], a[72:75], v[76:79]
    ds_read_b128 v[96:99], v1 offset:37888
    v_fma_f32 v64, v64, v125, v156
    buffer_load_dwordx4 a[144:147], v1, s[4:7], s71 offen offset:3072
    v_mfma_f32_16x16x32_bf16 v[80:83], v[108:111], a[76:79], v[80:83]
    v_fma_f32 v65, v65, v125, v157
    v_fma_f32 v66, v66, v125, v158
    v_mfma_f32_16x16x32_bf16 v[84:87], v[112:115], a[72:75], v[84:87]
    ds_read_b128 v[100:103], v1 offset:38912
    v_fma_f32 v67, v67, v125, v159
    v_max_f32 v64, 0, v64
    v_mfma_f32_16x16x32_bf16 v[88:91], v[112:115], a[76:79], v[88:91]
    v_max_f32 v65, 0, v65
    s_waitcnt lgkmcnt(3)
    v_mfma_f32_16x16x32_bf16 v[68:71], v[116:119], a[64:67], v[68:71]
    ds_read_b128 v[104:107], v1 offset:39936
    v_max_f32 v66, 0, v66
    v_max_f32 v67, 0, v67
    v_mfma_f32_16x16x32_bf16 v[72:75], v[116:119], a[68:71], v[72:75]
    v_mul_f32 v64, v64, v64
    v_mfma_f32_16x16x32_bf16 v[76:79], v[120:123], a[64:67], v[76:79]
    ds_read_b128 v[108:111], v1 offset:40960
    v_mul_f32 v65, v65, v65
    v_mfma_f32_16x16x32_bf16 v[80:83], v[120:123], a[68:71], v[80:83]
    v_mul_f32 v66, v66, v66
    v_mul_f32_e64 v67, v67, v67
    v_mfma_f32_16x16x32_bf16 v[84:87], v[164:167], a[64:67], v[84:87]
    ds_read_b128 v[112:115], v1 offset:41984
    v_cvt_pk_bf16_f32 v58, v64, v65
    v_mfma_f32_16x16x32_bf16 v[88:91], v[164:167], a[68:71], v[88:91]
    v_cvt_pk_bf16_f32 v59, v66, v67
    buffer_store_dwordx4 v[56:59], v1, s[4:7], s53 offen offset:1024 sc1
    s_add_u32 s71, s28, 51200
    buffer_load_dwordx4 a[140:143], v1, s[4:7], s71 offen offset:0
    buffer_load_dwordx4 a[136:139], v1, s[4:7], s71 offen offset:1024
    s_waitcnt lgkmcnt(3)
    v_mfma_f32_16x16x32_bf16 v[68:71], v[92:95], a[56:59], v[68:71]
    ds_read_b128 v[116:119], v1 offset:43008
    v_mfma_f32_16x16x32_bf16 v[72:75], v[92:95], a[60:63], v[72:75]
    v_mfma_f32_16x16x32_bf16 v[76:79], v[96:99], a[56:59], v[76:79]
    ds_read_b128 v[120:123], v1 offset:44032
    buffer_load_dwordx4 a[132:135], v1, s[4:7], s71 offen offset:2048
    v_mfma_f32_16x16x32_bf16 v[80:83], v[96:99], a[60:63], v[80:83]
    v_mfma_f32_16x16x32_bf16 v[84:87], v[100:103], a[56:59], v[84:87]
    ds_read_b128 v[164:167], v1 offset:45056
    v_mfma_f32_16x16x32_bf16 v[88:91], v[100:103], a[60:63], v[88:91]
    s_waitcnt lgkmcnt(3)
    v_mfma_f32_16x16x32_bf16 v[68:71], v[104:107], a[48:51], v[68:71]
    ds_read_b128 v[92:95], v1 offset:46080
    v_mfma_f32_16x16x32_bf16 v[72:75], v[104:107], a[52:55], v[72:75]
    v_mfma_f32_16x16x32_bf16 v[76:79], v[108:111], a[48:51], v[76:79]
    ds_read_b128 v[96:99], v1 offset:47104
    buffer_load_dwordx4 a[128:131], v1, s[4:7], s71 offen offset:3072
    v_mfma_f32_16x16x32_bf16 v[80:83], v[108:111], a[52:55], v[80:83]
    v_mfma_f32_16x16x32_bf16 v[84:87], v[112:115], a[48:51], v[84:87]
    ds_read_b128 v[100:103], v1 offset:48128
    v_mfma_f32_16x16x32_bf16 v[88:91], v[112:115], a[52:55], v[88:91]
    s_waitcnt lgkmcnt(3)
    v_mfma_f32_16x16x32_bf16 v[68:71], v[116:119], a[40:43], v[68:71]
    ds_read_b128 v[104:107], v1 offset:49152
    v_mfma_f32_16x16x32_bf16 v[72:75], v[116:119], a[44:47], v[72:75]
    s_add_u32 s71, s28, 55296
    buffer_load_dwordx4 a[124:127], v1, s[4:7], s71 offen offset:0
    v_mfma_f32_16x16x32_bf16 v[76:79], v[120:123], a[40:43], v[76:79]
    ds_read_b128 v[108:111], v1 offset:50176
    v_mfma_f32_16x16x32_bf16 v[80:83], v[120:123], a[44:47], v[80:83]
    v_mfma_f32_16x16x32_bf16 v[84:87], v[164:167], a[40:43], v[84:87]
    ds_read_b128 v[112:115], v1 offset:51200
    buffer_load_dwordx4 a[120:123], v1, s[4:7], s71 offen offset:1024
    v_mfma_f32_16x16x32_bf16 v[88:91], v[164:167], a[44:47], v[88:91]
    s_waitcnt lgkmcnt(3)
    v_mfma_f32_16x16x32_bf16 v[68:71], v[92:95], a[32:35], v[68:71]
    ds_read_b128 v[116:119], v1 offset:52224
    v_mfma_f32_16x16x32_bf16 v[72:75], v[92:95], a[36:39], v[72:75]
    v_mfma_f32_16x16x32_bf16 v[76:79], v[96:99], a[32:35], v[76:79]
    ds_read_b128 v[120:123], v1 offset:53248
    buffer_load_dwordx4 a[116:119], v1, s[4:7], s71 offen offset:2048
    v_mfma_f32_16x16x32_bf16 v[80:83], v[96:99], a[36:39], v[80:83]
    v_mfma_f32_16x16x32_bf16 v[84:87], v[100:103], a[32:35], v[84:87]
    ds_read_b128 v[164:167], v1 offset:54272
    v_mfma_f32_16x16x32_bf16 v[88:91], v[100:103], a[36:39], v[88:91]
    s_waitcnt lgkmcnt(3)
    v_mfma_f32_16x16x32_bf16 v[68:71], v[104:107], a[24:27], v[68:71]
    ds_read_b128 v[92:95], v1 offset:55296
    v_mfma_f32_16x16x32_bf16 v[72:75], v[104:107], a[28:31], v[72:75]
    v_mfma_f32_16x16x32_bf16 v[76:79], v[108:111], a[24:27], v[76:79]
    ds_read_b128 v[96:99], v1 offset:56320
    buffer_load_dwordx4 a[112:115], v1, s[4:7], s71 offen offset:3072
    v_mfma_f32_16x16x32_bf16 v[80:83], v[108:111], a[28:31], v[80:83]
    v_mfma_f32_16x16x32_bf16 v[84:87], v[112:115], a[24:27], v[84:87]
    ds_read_b128 v[100:103], v1 offset:57344
    v_mfma_f32_16x16x32_bf16 v[88:91], v[112:115], a[28:31], v[88:91]
    s_waitcnt lgkmcnt(3)
    v_mfma_f32_16x16x32_bf16 v[68:71], v[116:119], a[16:19], v[68:71]
    ds_read_b128 v[104:107], v1 offset:58368
    ds_read_b128 v[144:147], v12 offset:768
    v_mfma_f32_16x16x32_bf16 v[72:75], v[116:119], a[20:23], v[72:75]
    s_add_u32 s71, s28, 59392
    buffer_load_dwordx4 a[108:111], v1, s[4:7], s71 offen offset:0
    v_mfma_f32_16x16x32_bf16 v[76:79], v[120:123], a[16:19], v[76:79]
    ds_read_b128 v[108:111], v1 offset:59392
    v_mfma_f32_16x16x32_bf16 v[80:83], v[120:123], a[20:23], v[80:83]
    ds_read_b128 v[148:151], v12 offset:1280
    v_mfma_f32_16x16x32_bf16 v[84:87], v[164:167], a[16:19], v[84:87]
    ds_read_b128 v[112:115], v1 offset:60416
    buffer_load_dwordx4 a[104:107], v1, s[4:7], s71 offen offset:1024
    v_mfma_f32_16x16x32_bf16 v[88:91], v[164:167], a[20:23], v[88:91]
    s_waitcnt lgkmcnt(5)
    v_mfma_f32_16x16x32_bf16 v[68:71], v[92:95], a[8:11], v[68:71]
    ds_read_b128 v[152:155], v12 offset:832
    v_mfma_f32_16x16x32_bf16 v[72:75], v[92:95], a[12:15], v[72:75]
    s_add_u32 s3, s39, 1
    v_mov_b32 v15, s3
    s_add_u32 s3, s44, 4096
    s_waitcnt vmcnt(10)
    s_mov_b64 exec, 1
    buffer_store_dword v15, off, s[4:7], s3 sc1
    s_mov_b64 exec, -1
    v_mfma_f32_16x16x32_bf16 v[76:79], v[96:99], a[8:11], v[76:79]
    v_mfma_f32_16x16x32_bf16 v[80:83], v[96:99], a[12:15], v[80:83]
    ds_read_b128 v[156:159], v12 offset:1344
    v_mfma_f32_16x16x32_bf16 v[84:87], v[100:103], a[8:11], v[84:87]
    buffer_load_dwordx4 a[100:103], v1, s[4:7], s71 offen offset:2048
    v_mfma_f32_16x16x32_bf16 v[88:91], v[100:103], a[12:15], v[88:91]
    s_waitcnt lgkmcnt(2)
    v_mfma_f32_16x16x32_bf16 v[68:71], v[104:107], a[0:3], v[68:71]
    ds_read_b128 v[136:139], v12 offset:896
    v_mfma_f32_16x16x32_bf16 v[72:75], v[104:107], a[4:7], v[72:75]
    v_mfma_f32_16x16x32_bf16 v[76:79], v[108:111], a[0:3], v[76:79]
    buffer_load_dwordx4 a[96:99], v1, s[4:7], s71 offen offset:3072
    v_mfma_f32_16x16x32_bf16 v[80:83], v[108:111], a[4:7], v[80:83]
    ds_read_b128 v[140:143], v12 offset:1408
    v_mfma_f32_16x16x32_bf16 v[84:87], v[112:115], a[0:3], v[84:87]
    v_mfma_f32_16x16x32_bf16 v[88:91], v[112:115], a[4:7], v[88:91]
    v_pk_fma_f32 v[128:129], v[144:145], v[126:127], v[148:149] op_sel:[0,0,0] op_sel_hi:[1,0,1]
    v_pk_fma_f32 v[130:131], v[146:147], v[126:127], v[150:151] op_sel:[0,0,0] op_sel_hi:[1,0,1]
    v_pk_fma_f32 v[68:69], v[68:69], v[124:125], v[128:129] op_sel:[0,0,0] op_sel_hi:[1,0,1]
    v_pk_fma_f32 v[70:71], v[70:71], v[124:125], v[130:131] op_sel:[0,0,0] op_sel_hi:[1,0,1]
    v_max_f32 v68, 0, v68
    v_max_f32 v69, 0, v69
    v_max_f32 v70, 0, v70
    v_max_f32_e64 v71, 0, v71
    v_pk_mul_f32 v[68:69], v[68:69], v[68:69] op_sel:[0,0] op_sel_hi:[1,1]
    v_pk_mul_f32 v[70:71], v[70:71], v[70:71] op_sel:[0,0] op_sel_hi:[1,1]
    v_cvt_pk_bf16_f32 v68, v68, v69
    v_cvt_pk_bf16_f32 v69, v70, v71
    s_waitcnt lgkmcnt(2)
    v_pk_fma_f32 v[128:129], v[152:153], v[126:127], v[156:157] op_sel:[0,0,0] op_sel_hi:[1,0,1]
    v_pk_fma_f32 v[130:131], v[154:155], v[126:127], v[158:159] op_sel:[0,0,0] op_sel_hi:[1,0,1]
    v_pk_fma_f32 v[76:77], v[76:77], v[124:125], v[128:129] op_sel:[0,0,0] op_sel_hi:[1,0,1]
    v_pk_fma_f32 v[78:79], v[78:79], v[124:125], v[130:131] op_sel:[0,0,0] op_sel_hi:[1,0,1]
    v_max_f32 v76, 0, v76
    v_max_f32 v77, 0, v77
    v_max_f32 v78, 0, v78
    v_max_f32_e64 v79, 0, v79
    v_pk_mul_f32 v[76:77], v[76:77], v[76:77] op_sel:[0,0] op_sel_hi:[1,1]
    v_pk_mul_f32 v[78:79], v[78:79], v[78:79] op_sel:[0,0] op_sel_hi:[1,1]
    v_cvt_pk_bf16_f32 v70, v76, v77
    v_cvt_pk_bf16_f32 v71, v78, v79
    buffer_store_dwordx4 v[68:71], v1, s[4:7], s38 offen offset:0 sc1
    v_pk_fma_f32 v[132:133], v[144:145], v[126:127], v[148:149] op_sel:[0,1,0] op_sel_hi:[1,1,1]
    v_pk_fma_f32 v[134:135], v[146:147], v[126:127], v[150:151] op_sel:[0,1,0] op_sel_hi:[1,1,1]
    v_pk_fma_f32 v[72:73], v[72:73], v[124:125], v[132:133] op_sel:[0,1,0] op_sel_hi:[1,1,1]
    v_pk_fma_f32 v[74:75], v[74:75], v[124:125], v[134:135] op_sel:[0,1,0] op_sel_hi:[1,1,1]
    v_max_f32 v72, 0, v72
    v_max_f32 v73, 0, v73
    v_max_f32 v74, 0, v74
    v_max_f32 v75, 0, v75
    v_pk_mul_f32 v[72:73], v[72:73], v[72:73] op_sel:[0,0] op_sel_hi:[1,1]
    v_pk_mul_f32 v[74:75], v[74:75], v[74:75] op_sel:[0,0] op_sel_hi:[1,1]
    v_cvt_pk_bf16_f32 v72, v72, v73
    v_cvt_pk_bf16_f32 v73, v74, v75
    v_pk_fma_f32 v[132:133], v[152:153], v[126:127], v[156:157] op_sel:[0,1,0] op_sel_hi:[1,1,1]
    v_pk_fma_f32 v[134:135], v[154:155], v[126:127], v[158:159] op_sel:[0,1,0] op_sel_hi:[1,1,1]
    v_pk_fma_f32 v[80:81], v[80:81], v[124:125], v[132:133] op_sel:[0,1,0] op_sel_hi:[1,1,1]
    v_pk_fma_f32 v[82:83], v[82:83], v[124:125], v[134:135] op_sel:[0,1,0] op_sel_hi:[1,1,1]
    v_max_f32 v80, 0, v80
    v_max_f32 v81, 0, v81
    v_max_f32 v82, 0, v82
    v_max_f32 v83, 0, v83
    v_pk_mul_f32 v[80:81], v[80:81], v[80:81] op_sel:[0,0] op_sel_hi:[1,1]
    v_pk_mul_f32 v[82:83], v[82:83], v[82:83] op_sel:[0,0] op_sel_hi:[1,1]
    v_cvt_pk_bf16_f32 v74, v80, v81
    v_cvt_pk_bf16_f32 v75, v82, v83
    buffer_store_dwordx4 v[72:75], v1, s[4:7], s38 offen offset:1024 sc1
    s_waitcnt lgkmcnt(0)
    v_pk_fma_f32 v[128:129], v[136:137], v[126:127], v[140:141] op_sel:[0,0,0] op_sel_hi:[1,0,1]
    v_pk_fma_f32 v[130:131], v[138:139], v[126:127], v[142:143] op_sel:[0,0,0] op_sel_hi:[1,0,1]
    v_pk_fma_f32 v[84:85], v[84:85], v[124:125], v[128:129] op_sel:[0,0,0] op_sel_hi:[1,0,1]
    v_pk_fma_f32 v[86:87], v[86:87], v[124:125], v[130:131] op_sel:[0,0,0] op_sel_hi:[1,0,1]
    v_max_f32 v84, 0, v84
    v_max_f32 v85, 0, v85
    v_max_f32 v86, 0, v86
    v_max_f32_e64 v87, 0, v87
    v_pk_mul_f32 v[84:85], v[84:85], v[84:85] op_sel:[0,0] op_sel_hi:[1,1]
    v_pk_mul_f32 v[86:87], v[86:87], v[86:87] op_sel:[0,0] op_sel_hi:[1,1]
    v_cvt_pk_bf16_f32 v84, v84, v85
    v_cvt_pk_bf16_f32 v85, v86, v87
    buffer_store_dwordx2 v[84:85], v28, s[4:7], s36 offen offset:0 sc1
    v_pk_fma_f32 v[132:133], v[136:137], v[126:127], v[140:141] op_sel:[0,1,0] op_sel_hi:[1,1,1]
    v_pk_fma_f32 v[134:135], v[138:139], v[126:127], v[142:143] op_sel:[0,1,0] op_sel_hi:[1,1,1]
    v_pk_fma_f32 v[88:89], v[88:89], v[124:125], v[132:133] op_sel:[0,1,0] op_sel_hi:[1,1,1]
    v_pk_fma_f32 v[90:91], v[90:91], v[124:125], v[134:135] op_sel:[0,1,0] op_sel_hi:[1,1,1]
    v_max_f32 v88, 0, v88
    v_max_f32 v89, 0, v89
    v_max_f32 v90, 0, v90
    v_max_f32 v91, 0, v91
    v_pk_mul_f32 v[88:89], v[88:89], v[88:89] op_sel:[0,0] op_sel_hi:[1,1]
    v_pk_mul_f32 v[90:91], v[90:91], v[90:91] op_sel:[0,0] op_sel_hi:[1,1]
    v_cvt_pk_bf16_f32 v88, v88, v89
    v_cvt_pk_bf16_f32 v89, v90, v91
    buffer_store_dwordx2 v[88:89], v28, s[4:7], s36 offen offset:1024 sc1
    v_and_b32 v15, 127, v2
    v_add_u32 v15, 4096, v15
    buffer_load_dword v14, v15, s[4:7], s45 offen sc1
    s_add_u32 s70, s28, 38912
    buffer_load_dwordx4 a[224:227], v1, s[4:7], s70 offen offset:0
    buffer_load_dwordx4 a[228:231], v1, s[4:7], s70 offen offset:1024
    buffer_load_dwordx4 a[232:235], v1, s[4:7], s70 offen offset:2048
    buffer_load_dwordx4 a[236:239], v1, s[4:7], s70 offen offset:3072
    s_add_u32 s3, s16, 1
    s_and_b32 s3, s3, 3
    s_lshl_b32 s3, s3, 10
    v_add_u32 v144, s3, v1
    s_add_u32 s3, s16, 2
    s_and_b32 s3, s3, 3
    s_lshl_b32 s3, s3, 10
    v_add_u32 v145, s3, v1
    s_add_u32 s3, s16, 3
    s_and_b32 s3, s3, 3
    s_lshl_b32 s3, s3, 10
    v_add_u32 v146, s3, v1
    s_add_u32 s3, s16, 4
    s_and_b32 s3, s3, 3
    s_lshl_b32 s3, s3, 10
    v_add_u32 v147, s3, v1
    ds_read_b128 v[120:123], v12 offset:1536
    ds_read_b128 v[124:127], v12 offset:1600
    ds_read_b128 v[128:131], v12 offset:1664
    ds_read_b128 v[132:135], v12 offset:1728
    ds_read_b128 v[136:139], v12 offset:1792
    v_lshlrev_b32_e64 v96, 16, v16
    v_and_b32 v97, 0xffff0000, v16
    v_lshlrev_b32_e64 v98, 16, v17
    v_and_b32 v99, 0xffff0000, v17
    v_lshlrev_b32_e64 v100, 16, v18
    v_and_b32 v101, 0xffff0000, v18
    v_lshlrev_b32_e64 v102, 16, v19
    v_and_b32 v103, 0xffff0000, v19
    v_lshlrev_b32_e64 v104, 16, v20
    v_and_b32 v105, 0xffff0000, v20
    v_lshlrev_b32_e64 v106, 16, v21
    v_and_b32 v107, 0xffff0000, v21
    v_lshlrev_b32_e64 v108, 16, v22
    v_and_b32 v109, 0xffff0000, v22
    v_lshlrev_b32_e64 v110, 16, v23
    v_and_b32 v111, 0xffff0000, v23
    v_lshlrev_b32_e64 v112, 16, v24
    v_and_b32 v113, 0xffff0000, v24
    v_lshlrev_b32_e64 v114, 16, v25
    v_and_b32 v115, 0xffff0000, v25
    s_waitcnt lgkmcnt(4)
    v_pk_add_f32 v[96:97], v[96:97], v[120:121] op_sel:[0,0] op_sel_hi:[1,1]
    v_pk_add_f32 v[98:99], v[98:99], v[122:123] op_sel:[0,0] op_sel_hi:[1,1]
    s_waitcnt lgkmcnt(3)
    v_pk_add_f32 v[100:101], v[100:101], v[124:125] op_sel:[0,0] op_sel_hi:[1,1]
    v_pk_add_f32 v[102:103], v[102:103], v[126:127] op_sel:[0,0] op_sel_hi:[1,1]
    s_waitcnt lgkmcnt(2)
    v_pk_add_f32 v[104:105], v[104:105], v[128:129] op_sel:[0,0] op_sel_hi:[1,1]
    v_pk_add_f32 v[106:107], v[106:107], v[130:131] op_sel:[0,0] op_sel_hi:[1,1]
    s_waitcnt lgkmcnt(1)
    v_pk_add_f32 v[108:109], v[108:109], v[132:133] op_sel:[0,0] op_sel_hi:[1,1]
    v_pk_add_f32 v[110:111], v[110:111], v[134:135] op_sel:[0,0] op_sel_hi:[1,1]
    s_waitcnt lgkmcnt(0)
    v_pk_add_f32 v[112:113], v[112:113], v[136:137] op_sel:[0,0] op_sel_hi:[1,1]
    v_pk_add_f32 v[114:115], v[114:115], v[138:139] op_sel:[0,0] op_sel_hi:[1,1]
    s_add_u32 s52, s39, 1
    s_waitcnt vmcnt(4)
    v_cmp_ne_u32 vcc, s52, v14
    s_nop 1
    s_cbranch_vccz L_ok_1016
    s_mov_b32 s60, 0
L_lp_1015:
    v_and_b32 v15, 127, v2
    v_add_u32 v15, 4096, v15
    buffer_load_dword v14, v15, s[4:7], s45 offen sc1
    s_add_u32 s60, s60, 1
    s_cmp_gt_u32 s60, 0x40000
    s_cbranch_scc1 L_abort
    s_waitcnt vmcnt(0)
    v_cmp_ne_u32 vcc, s52, v14
    s_nop 1
    s_cbranch_vccnz L_lp_1015
L_ok_1016:
    s_lshl_b32 s53, s16, 15
    s_add_u32 s53, s53, s37
    s_add_u32 s53, s53, 90112
    buffer_load_dwordx4 a[0:3], v144, s[4:7], s53 offen sc1
    buffer_load_dwordx4 a[4:7], v145, s[4:7], s53 offen sc1
    buffer_load_dwordx4 a[8:11], v146, s[4:7], s53 offen sc1
    buffer_load_dwordx4 a[12:15], v147, s[4:7], s53 offen sc1
    s_add_u32 s53, s53, 4096
    buffer_load_dwordx4 a[16:19], v144, s[4:7], s53 offen sc1
    buffer_load_dwordx4 a[20:23], v145, s[4:7], s53 offen sc1
    buffer_load_dwordx4 a[24:27], v146, s[4:7], s53 offen sc1
    buffer_load_dwordx4 a[28:31], v147, s[4:7], s53 offen sc1
    s_waitcnt vmcnt(7)
    v_mfma_f32_16x16x32_bf16 v[36:39], v[168:171], a[0:3], 0
    s_add_u32 s53, s53, 4096
    buffer_load_dwordx4 a[32:35], v144, s[4:7], s53 offen sc1
    v_mfma_f32_16x16x32_bf16 v[40:43], v[172:175], a[0:3], 0
    v_mfma_f32_16x16x32_bf16 v[44:47], v[176:179], a[0:3], 0
    v_mfma_f32_16x16x32_bf16 v[48:51], v[180:183], a[0:3], 0
    buffer_load_dwordx4 a[36:39], v145, s[4:7], s53 offen sc1
    v_mfma_f32_16x16x32_bf16 v[52:55], v[184:187], a[0:3], 0
    s_waitcnt vmcnt(8)
    v_mfma_f32_16x16x32_bf16 v[56:59], v[168:171], a[4:7], 0
    v_mfma_f32_16x16x32_bf16 v[60:63], v[172:175], a[4:7], 0
    buffer_load_dwordx4 a[40:43], v146, s[4:7], s53 offen sc1
    v_mfma_f32_16x16x32_bf16 v[64:67], v[176:179], a[4:7], 0
    v_mfma_f32_16x16x32_bf16 v[68:71], v[180:183], a[4:7], 0
    v_mfma_f32_16x16x32_bf16 v[72:75], v[184:187], a[4:7], 0
    buffer_load_dwordx4 a[44:47], v147, s[4:7], s53 offen sc1
    s_waitcnt vmcnt(9)
    v_mfma_f32_16x16x32_bf16 v[76:79], v[168:171], a[8:11], 0
    v_mfma_f32_16x16x32_bf16 v[80:83], v[172:175], a[8:11], 0
    v_mfma_f32_16x16x32_bf16 v[84:87], v[176:179], a[8:11], 0
    s_add_u32 s53, s53, 4096
    buffer_load_dwordx4 a[48:51], v144, s[4:7], s53 offen sc1
    v_mfma_f32_16x16x32_bf16 v[88:91], v[180:183], a[8:11], 0
    v_mfma_f32_16x16x32_bf16 v[92:95], v[184:187], a[8:11], 0
    s_waitcnt vmcnt(9)
    v_mfma_f32_16x16x32_bf16 v[96:99], v[168:171], a[12:15], v[96:99]
    s_add_u32 s70, s28, 43008
    buffer_load_dwordx4 a[240:243], v1, s[4:7], s70 offen offset:0
    v_mfma_f32_16x16x32_bf16 v[100:103], v[172:175], a[12:15], v[100:103]
    v_mfma_f32_16x16x32_bf16 v[104:107], v[176:179], a[12:15], v[104:107]
    v_mfma_f32_16x16x32_bf16 v[108:111], v[180:183], a[12:15], v[108:111]
    buffer_load_dwordx4 a[244:247], v1, s[4:7], s70 offen offset:1024
    v_mfma_f32_16x16x32_bf16 v[112:115], v[184:187], a[12:15], v[112:115]
    s_waitcnt vmcnt(10)
    v_mfma_f32_16x16x32_bf16 v[36:39], v[188:191], a[16:19], v[36:39]
    s_add_u32 s3, s39, 1
    v_mov_b32 v15, s3
    s_mov_b64 exec, 1
    buffer_store_dword v15, off, s[4:7], s44 sc1
    s_mov_b64 exec, -1
    v_mfma_f32_16x16x32_bf16 v[40:43], v[192:195], a[16:19], v[40:43]
    v_mfma_f32_16x16x32_bf16 v[44:47], v[196:199], a[16:19], v[44:47]
    v_mfma_f32_16x16x32_bf16 v[48:51], v[200:203], a[16:19], v[48:51]
    buffer_load_dwordx4 a[52:55], v145, s[4:7], s53 offen sc1
    v_mfma_f32_16x16x32_bf16 v[52:55], v[204:207], a[16:19], v[52:55]
    s_waitcnt vmcnt(11)
    v_mfma_f32_16x16x32_bf16 v[56:59], v[188:191], a[20:23], v[56:59]
    v_mfma_f32_16x16x32_bf16 v[60:63], v[192:195], a[20:23], v[60:63]
    buffer_load_dwordx4 a[56:59], v146, s[4:7], s53 offen sc1
    v_mfma_f32_16x16x32_bf16 v[64:67], v[196:199], a[20:23], v[64:67]
    v_mfma_f32_16x16x32_bf16 v[68:71], v[200:203], a[20:23], v[68:71]
    v_mfma_f32_16x16x32_bf16 v[72:75], v[204:207], a[20:23], v[72:75]
    buffer_load_dwordx4 a[60:63], v147, s[4:7], s53 offen sc1
    s_waitcnt vmcnt(12)
    v_mfma_f32_16x16x32_bf16 v[76:79], v[188:191], a[24:27], v[76:79]
    v_mfma_f32_16x16x32_bf16 v[80:83], v[192:195], a[24:27], v[80:83]
    v_mfma_f32_16x16x32_bf16 v[84:87], v[196:199], a[24:27], v[84:87]
    s_add_u32 s53, s53, 4096
    buffer_load_dwordx4 a[64:67], v144, s[4:7], s53 offen sc1
    v_mfma_f32_16x16x32_bf16 v[88:91], v[200:203], a[24:27], v[88:91]
    v_mfma_f32_16x16x32_bf16 v[92:95], v[204:207], a[24:27], v[92:95]
    s_waitcnt vmcnt(12)
    v_mfma_f32_16x16x32_bf16 v[96:99], v[188:191], a[28:31], v[96:99]
    buffer_load_dwordx4 a[68:71], v145, s[4:7], s53 offen sc1
    v_mfma_f32_16x16x32_bf16 v[100:103], v[192:195], a[28:31], v[100:103]
    v_mfma_f32_16x16x32_bf16 v[104:107], v[196:199], a[28:31], v[104:107]
    v_mfma_f32_16x16x32_bf16 v[108:111], v[200:203], a[28:31], v[108:111]
    buffer_load_dwordx4 a[248:251], v1, s[4:7], s70 offen offset:2048
    v_mfma_f32_16x16x32_bf16 v[112:115], v[204:207], a[28:31], v[112:115]
    s_waitcnt vmcnt(13)
    v_mfma_f32_16x16x32_bf16 v[36:39], v[208:211], a[32:35], v[36:39]
    v_mfma_f32_16x16x32_bf16 v[40:43], v[212:215], a[32:35], v[40:43]
    buffer_load_dwordx4 a[72:75], v146, s[4:7], s53 offen sc1
    v_mfma_f32_16x16x32_bf16 v[44:47], v[216:219], a[32:35], v[44:47]
    v_mfma_f32_16x16x32_bf16 v[48:51], v[220:223], a[32:35], v[48:51]
    v_mfma_f32_16x16x32_bf16 v[52:55], v[224:227], a[32:35], v[52:55]
    buffer_load_dwordx4 a[76:79], v147, s[4:7], s53 offen sc1
    s_waitcnt vmcnt(14)
    v_mfma_f32_16x16x32_bf16 v[56:59], v[208:211], a[36:39], v[56:59]
    v_mfma_f32_16x16x32_bf16 v[60:63], v[212:215], a[36:39], v[60:63]
    v_mfma_f32_16x16x32_bf16 v[64:67], v[216:219], a[36:39], v[64:67]
    s_add_u32 s53, s53, 4096
    buffer_load_dwordx4 a[0:3], v144, s[4:7], s53 offen sc1
    v_mfma_f32_16x16x32_bf16 v[68:71], v[220:223], a[36:39], v[68:71]
    v_mfma_f32_16x16x32_bf16 v[72:75], v[224:227], a[36:39], v[72:75]
    s_waitcnt vmcnt(14)
    v_mfma_f32_16x16x32_bf16 v[76:79], v[208:211], a[40:43], v[76:79]
    v_mfma_f32_16x16x32_bf16 v[80:83], v[212:215], a[40:43], v[80:83]
    buffer_load_dwordx4 a[4:7], v145, s[4:7], s53 offen sc1
    v_mfma_f32_16x16x32_bf16 v[84:87], v[216:219], a[40:43], v[84:87]
    v_mfma_f32_16x16x32_bf16 v[88:91], v[220:223], a[40:43], v[88:91]
    v_mfma_f32_16x16x32_bf16 v[92:95], v[224:227], a[40:43], v[92:95]
    buffer_load_dwordx4 a[8:11], v146, s[4:7], s53 offen sc1
    s_waitcnt vmcnt(15)
    v_mfma_f32_16x16x32_bf16 v[96:99], v[208:211], a[44:47], v[96:99]
    v_mfma_f32_16x16x32_bf16 v[100:103], v[212:215], a[44:47], v[100:103]
    v_mfma_f32_16x16x32_bf16 v[104:107], v[216:219], a[44:47], v[104:107]
    buffer_load_dwordx4 a[252:255], v1, s[4:7], s70 offen offset:3072
    v_mfma_f32_16x16x32_bf16 v[108:111], v[220:223], a[44:47], v[108:111]
    v_mfma_f32_16x16x32_bf16 v[112:115], v[224:227], a[44:47], v[112:115]
    s_waitcnt vmcnt(15)
    v_mfma_f32_16x16x32_bf16 v[36:39], v[228:231], a[48:51], v[36:39]
    buffer_load_dwordx4 a[12:15], v147, s[4:7], s53 offen sc1
    v_mfma_f32_16x16x32_bf16 v[40:43], v[232:235], a[48:51], v[40:43]
    v_mfma_f32_16x16x32_bf16 v[44:47], v[236:239], a[48:51], v[44:47]
    v_mfma_f32_16x16x32_bf16 v[48:51], v[240:243], a[48:51], v[48:51]
    s_add_u32 s53, s53, 4096
    buffer_load_dwordx4 a[16:19], v144, s[4:7], s53 offen sc1
    v_mfma_f32_16x16x32_bf16 v[52:55], v[244:247], a[48:51], v[52:55]
    s_waitcnt vmcnt(13)
    v_mfma_f32_16x16x32_bf16 v[56:59], v[228:231], a[52:55], v[56:59]
    buffer_load_dwordx4 a[20:23], v145, s[4:7], s53 offen sc1
    v_mfma_f32_16x16x32_bf16 v[60:63], v[232:235], a[52:55], v[60:63]
    v_mfma_f32_16x16x32_bf16 v[64:67], v[236:239], a[52:55], v[64:67]
    v_mfma_f32_16x16x32_bf16 v[68:71], v[240:243], a[52:55], v[68:71]
    buffer_load_dwordx4 a[24:27], v146, s[4:7], s53 offen sc1
    v_mfma_f32_16x16x32_bf16 v[72:75], v[244:247], a[52:55], v[72:75]
    s_waitcnt vmcnt(14)
    v_mfma_f32_16x16x32_bf16 v[76:79], v[228:231], a[56:59], v[76:79]
    buffer_load_dwordx4 a[28:31], v147, s[4:7], s53 offen sc1
    v_mfma_f32_16x16x32_bf16 v[80:83], v[232:235], a[56:59], v[80:83]
    v_mfma_f32_16x16x32_bf16 v[84:87], v[236:239], a[56:59], v[84:87]
    v_mfma_f32_16x16x32_bf16 v[88:91], v[240:243], a[56:59], v[88:91]
    s_add_u32 s71, s28, 63488
    buffer_load_dwordx4 a[92:95], v1, s[4:7], s71 offen offset:0
    v_mfma_f32_16x16x32_bf16 v[92:95], v[244:247], a[56:59], v[92:95]
    s_waitcnt vmcnt(15)
    v_mfma_f32_16x16x32_bf16 v[96:99], v[228:231], a[60:63], v[96:99]
    buffer_load_dwordx4 a[88:91], v1, s[4:7], s71 offen offset:1024
    v_mfma_f32_16x16x32_bf16 v[100:103], v[232:235], a[60:63], v[100:103]
    v_mfma_f32_16x16x32_bf16 v[104:107], v[236:239], a[60:63], v[104:107]
    v_mfma_f32_16x16x32_bf16 v[108:111], v[240:243], a[60:63], v[108:111]
    v_and_b32 v15, 127, v2
    buffer_load_dword v14, v15, s[4:7], s45 offen sc1
    v_mfma_f32_16x16x32_bf16 v[112:115], v[244:247], a[60:63], v[112:115]
    s_waitcnt vmcnt(16)
    v_mfma_f32_16x16x32_bf16 v[36:39], v[248:251], a[64:67], v[36:39]
    v_mfma_f32_16x16x32_bf16 v[40:43], v[252:255], a[64:67], v[40:43]
    s_add_u32 s53, s53, 4096
    buffer_load_dwordx4 a[32:35], v144, s[4:7], s53 offen sc1
    v_mfma_f32_16x16x32_bf16 v[44:47], a[160:163], a[64:67], v[44:47]
    v_mfma_f32_16x16x32_bf16 v[48:51], a[164:167], a[64:67], v[48:51]
    v_mfma_f32_16x16x32_bf16 v[52:55], a[168:171], a[64:67], v[52:55]
    buffer_load_dwordx4 a[36:39], v145, s[4:7], s53 offen sc1
    s_waitcnt vmcnt(17)
    v_mfma_f32_16x16x32_bf16 v[56:59], v[248:251], a[68:71], v[56:59]
    v_mfma_f32_16x16x32_bf16 v[60:63], v[252:255], a[68:71], v[60:63]
    v_mfma_f32_16x16x32_bf16 v[64:67], a[160:163], a[68:71], v[64:67]
    buffer_load_dwordx4 a[40:43], v146, s[4:7], s53 offen sc1
    v_mfma_f32_16x16x32_bf16 v[68:71], a[164:167], a[68:71], v[68:71]
    v_mfma_f32_16x16x32_bf16 v[72:75], a[168:171], a[68:71], v[72:75]
    s_waitcnt vmcnt(16)
    v_mfma_f32_16x16x32_bf16 v[76:79], v[248:251], a[72:75], v[76:79]
    v_mfma_f32_16x16x32_bf16 v[80:83], v[252:255], a[72:75], v[80:83]
    buffer_load_dwordx4 a[44:47], v147, s[4:7], s53 offen sc1
    v_mfma_f32_16x16x32_bf16 v[84:87], a[160:163], a[72:75], v[84:87]
    v_mfma_f32_16x16x32_bf16 v[88:91], a[164:167], a[72:75], v[88:91]
    v_mfma_f32_16x16x32_bf16 v[92:95], a[168:171], a[72:75], v[92:95]
    buffer_load_dwordx4 a[84:87], v1, s[4:7], s71 offen offset:2048
    s_waitcnt vmcnt(17)
    v_mfma_f32_16x16x32_bf16 v[96:99], v[248:251], a[76:79], v[96:99]
    v_mfma_f32_16x16x32_bf16 v[100:103], v[252:255], a[76:79], v[100:103]
    v_mfma_f32_16x16x32_bf16 v[104:107], a[160:163], a[76:79], v[104:107]
    buffer_load_dwordx4 a[80:83], v1, s[4:7], s71 offen offset:3072
    v_mfma_f32_16x16x32_bf16 v[108:111], a[164:167], a[76:79], v[108:111]
    v_mfma_f32_16x16x32_bf16 v[112:115], a[168:171], a[76:79], v[112:115]
    s_waitcnt vmcnt(17)
    v_mfma_f32_16x16x32_bf16 v[36:39], a[172:175], a[0:3], v[36:39]
    s_add_u32 s52, s39, 1
    s_waitcnt vmcnt(6)
    v_cmp_ne_u32 vcc, s52, v14
    s_nop 4
    s_cbranch_vccz L_ok_1019
    s_mov_b32 s60, 0
L_lp_1018:
    v_and_b32 v15, 127, v2
    buffer_load_dword v14, v15, s[4:7], s45 offen sc1
    s_add_u32 s60, s60, 1
    s_cmp_gt_u32 s60, 0x40000
    s_cbranch_scc1 L_abort
    s_waitcnt vmcnt(0)
    v_cmp_ne_u32 vcc, s52, v14
    s_nop 1
    s_cbranch_vccnz L_lp_1018
L_ok_1019:
    v_mfma_f32_16x16x32_bf16 v[40:43], a[176:179], a[0:3], v[40:43]
    s_lshl_b32 s53, s16, 14
    s_add_u32 s53, s53, s37
    buffer_load_dwordx4 a[48:51], v144, s[4:7], s53 offen sc1
    v_mfma_f32_16x16x32_bf16 v[44:47], a[180:183], a[0:3], v[44:47]
    v_mfma_f32_16x16x32_bf16 v[48:51], a[184:187], a[0:3], v[48:51]
    v_mfma_f32_16x16x32_bf16 v[52:55], a[188:191], a[0:3], v[52:55]
    buffer_load_dwordx4 a[52:55], v145, s[4:7], s53 offen sc1
    v_mfma_f32_16x16x32_bf16 v[56:59], a[172:175], a[4:7], v[56:59]
    v_mfma_f32_16x16x32_bf16 v[60:63], a[176:179], a[4:7], v[60:63]
    buffer_load_dwordx4 a[56:59], v146, s[4:7], s53 offen sc1
    v_mfma_f32_16x16x32_bf16 v[64:67], a[180:183], a[4:7], v[64:67]
    v_mfma_f32_16x16x32_bf16 v[68:71], a[184:187], a[4:7], v[68:71]
    buffer_load_dwordx4 a[60:63], v147, s[4:7], s53 offen sc1
    v_mfma_f32_16x16x32_bf16 v[72:75], a[188:191], a[4:7], v[72:75]
    v_mfma_f32_16x16x32_bf16 v[76:79], a[172:175], a[8:11], v[76:79]
    v_mfma_f32_16x16x32_bf16 v[80:83], a[176:179], a[8:11], v[80:83]
    s_add_u32 s53, s53, 4096
    buffer_load_dwordx4 a[64:67], v144, s[4:7], s53 offen sc1
    v_mfma_f32_16x16x32_bf16 v[84:87], a[180:183], a[8:11], v[84:87]
    v_mfma_f32_16x16x32_bf16 v[88:91], a[184:187], a[8:11], v[88:91]
    s_add_u32 s71, s28, 67584
    buffer_load_dwordx4 v[148:151], v1, s[4:7], s71 offen offset:0
    v_mfma_f32_16x16x32_bf16 v[92:95], a[188:191], a[8:11], v[92:95]
    v_mfma_f32_16x16x32_bf16 v[96:99], a[172:175], a[12:15], v[96:99]
    s_add_u32 s83, s97, s25
    s_add_u32 s82, s97, 71680
    s_add_u32 s83, s83, 51200
    s_mov_b32 m0, s82
    s_nop 0
    buffer_load_dwordx4 v1, s[4:7], s83 offen offset:0 lds
    v_mfma_f32_16x16x32_bf16 v[100:103], a[176:179], a[12:15], v[100:103]
    v_mfma_f32_16x16x32_bf16 v[104:107], a[180:183], a[12:15], v[104:107]
    v_mfma_f32_16x16x32_bf16 v[108:111], a[184:187], a[12:15], v[108:111]
    buffer_load_dwordx4 v1, s[4:7], s83 offen offset:1024 lds
    v_mfma_f32_16x16x32_bf16 v[112:115], a[188:191], a[12:15], v[112:115]
    v_mfma_f32_16x16x32_bf16 v[36:39], a[192:195], a[16:19], v[36:39]
    buffer_load_dwordx4 a[68:71], v145, s[4:7], s53 offen sc1
    v_mfma_f32_16x16x32_bf16 v[40:43], a[196:199], a[16:19], v[40:43]
    v_mfma_f32_16x16x32_bf16 v[44:47], a[200:203], a[16:19], v[44:47]
    buffer_load_dwordx4 a[72:75], v146, s[4:7], s53 offen sc1
    v_mfma_f32_16x16x32_bf16 v[48:51], a[204:207], a[16:19], v[48:51]
    v_mfma_f32_16x16x32_bf16 v[52:55], a[208:211], a[16:19], v[52:55]
    v_mfma_f32_16x16x32_bf16 v[56:59], a[192:195], a[20:23], v[56:59]
    buffer_load_dwordx4 a[76:79], v147, s[4:7], s53 offen sc1
    v_mfma_f32_16x16x32_bf16 v[60:63], a[196:199], a[20:23], v[60:63]
    v_mfma_f32_16x16x32_bf16 v[64:67], a[200:203], a[20:23], v[64:67]
    s_add_u32 s53, s53, 4096
    buffer_load_dwordx4 a[0:3], v144, s[4:7], s53 offen sc1
    v_mfma_f32_16x16x32_bf16 v[68:71], a[204:207], a[20:23], v[68:71]
    v_mfma_f32_16x16x32_bf16 v[72:75], a[208:211], a[20:23], v[72:75]
    buffer_load_dwordx4 a[4:7], v145, s[4:7], s53 offen sc1
    v_mfma_f32_16x16x32_bf16 v[76:79], a[192:195], a[24:27], v[76:79]
    v_mfma_f32_16x16x32_bf16 v[80:83], a[196:199], a[24:27], v[80:83]
    buffer_load_dwordx4 v[152:155], v1, s[4:7], s71 offen offset:1024
    v_mfma_f32_16x16x32_bf16 v[84:87], a[200:203], a[24:27], v[84:87]
    v_mfma_f32_16x16x32_bf16 v[88:91], a[204:207], a[24:27], v[88:91]
    buffer_load_dwordx4 v[156:159], v1, s[4:7], s71 offen offset:2048
    v_mfma_f32_16x16x32_bf16 v[92:95], a[208:211], a[24:27], v[92:95]
    v_mfma_f32_16x16x32_bf16 v[96:99], a[192:195], a[28:31], v[96:99]
    v_mfma_f32_16x16x32_bf16 v[100:103], a[196:199], a[28:31], v[100:103]
    buffer_load_dwordx4 v1, s[4:7], s83 offen offset:2048 lds
    v_mfma_f32_16x16x32_bf16 v[104:107], a[200:203], a[28:31], v[104:107]
    v_mfma_f32_16x16x32_bf16 v[108:111], a[204:207], a[28:31], v[108:111]
    buffer_load_dwordx4 v1, s[4:7], s83 offen offset:3072 lds
    v_mfma_f32_16x16x32_bf16 v[112:115], a[208:211], a[28:31], v[112:115]
    s_waitcnt vmcnt(22)
    v_mfma_f32_16x16x32_bf16 v[36:39], a[212:215], a[32:35], v[36:39]
    s_barrier
    v_mfma_f32_16x16x32_bf16 v[40:43], a[216:219], a[32:35], v[40:43]
    buffer_load_dwordx4 a[8:11], v146, s[4:7], s53 offen sc1
    v_mfma_f32_16x16x32_bf16 v[44:47], a[220:223], a[32:35], v[44:47]
    v_mfma_f32_16x16x32_bf16 v[48:51], a[224:227], a[32:35], v[48:51]
    v_mfma_f32_16x16x32_bf16 v[52:55], a[228:231], a[32:35], v[52:55]
    buffer_load_dwordx4 a[12:15], v147, s[4:7], s53 offen sc1
    s_waitcnt vmcnt(23)
    v_mfma_f32_16x16x32_bf16 v[56:59], a[212:215], a[36:39], v[56:59]
    v_mfma_f32_16x16x32_bf16 v[60:63], a[216:219], a[36:39], v[60:63]
    s_add_u32 s53, s53, 4096
    buffer_load_dwordx4 a[16:19], v144, s[4:7], s53 offen sc1
    v_mfma_f32_16x16x32_bf16 v[64:67], a[220:223], a[36:39], v[64:67]
    v_mfma_f32_16x16x32_bf16 v[68:71], a[224:227], a[36:39], v[68:71]
    buffer_load_dwordx4 a[20:23], v145, s[4:7], s53 offen sc1
    v_mfma_f32_16x16x32_bf16 v[72:75], a[228:231], a[36:39], v[72:75]
    s_waitcnt vmcnt(24)
    v_mfma_f32_16x16x32_bf16 v[76:79], a[212:215], a[40:43], v[76:79]
    v_mfma_f32_16x16x32_bf16 v[80:83], a[216:219], a[40:43], v[80:83]
    buffer_load_dwordx4 a[24:27], v146, s[4:7], s53 offen sc1
    v_mfma_f32_16x16x32_bf16 v[84:87], a[220:223], a[40:43], v[84:87]
    v_mfma_f32_16x16x32_bf16 v[88:91], a[224:227], a[40:43], v[88:91]
    buffer_load_dwordx4 v[160:163], v1, s[4:7], s71 offen offset:3072
    v_mfma_f32_16x16x32_bf16 v[92:95], a[228:231], a[40:43], v[92:95]
    s_waitcnt vmcnt(25)
    v_mfma_f32_16x16x32_bf16 v[96:99], a[212:215], a[44:47], v[96:99]
    s_add_u32 s83, s97, s25
    s_add_u32 s82, s97, 88064
    s_add_u32 s83, s83, 67584
    s_mov_b32 m0, s82
    s_nop 0
    buffer_load_dwordx4 v1, s[4:7], s83 offen offset:0 lds
    v_mfma_f32_16x16x32_bf16 v[100:103], a[216:219], a[44:47], v[100:103]
    v_mfma_f32_16x16x32_bf16 v[104:107], a[220:223], a[44:47], v[104:107]
    v_mfma_f32_16x16x32_bf16 v[108:111], a[224:227], a[44:47], v[108:111]
    buffer_load_dwordx4 v1, s[4:7], s83 offen offset:1024 lds
    v_mfma_f32_16x16x32_bf16 v[112:115], a[228:231], a[44:47], v[112:115]
    s_waitcnt vmcnt(24)
    v_mfma_f32_16x16x32_bf16 v[36:39], a[232:235], a[48:51], v[36:39]
    buffer_load_dwordx4 a[28:31], v147, s[4:7], s53 offen sc1
    v_mfma_f32_16x16x32_bf16 v[40:43], a[236:239], a[48:51], v[40:43]
    v_mfma_f32_16x16x32_bf16 v[44:47], a[240:243], a[48:51], v[44:47]
    v_mfma_f32_16x16x32_bf16 v[48:51], a[244:247], a[48:51], v[48:51]
    s_add_u32 s53, s97, s37
    s_add_u32 s53, s53, 65536
    buffer_load_dwordx4 a[32:35], v144, s[4:7], s53 offen sc1
    v_mfma_f32_16x16x32_bf16 v[52:55], a[248:251], a[48:51], v[52:55]
    s_waitcnt vmcnt(25)
    v_mfma_f32_16x16x32_bf16 v[56:59], a[232:235], a[52:55], v[56:59]
    v_mfma_f32_16x16x32_bf16 v[60:63], a[236:239], a[52:55], v[60:63]
    buffer_load_dwordx4 a[36:39], v145, s[4:7], s53 offen sc1
    v_mfma_f32_16x16x32_bf16 v[64:67], a[240:243], a[52:55], v[64:67]
    v_mfma_f32_16x16x32_bf16 v[68:71], a[244:247], a[52:55], v[68:71]
    v_mfma_f32_16x16x32_bf16 v[72:75], a[248:251], a[52:55], v[72:75]
    buffer_load_dwordx4 a[40:43], v146, s[4:7], s53 offen sc1
    s_waitcnt vmcnt(26)
    v_mfma_f32_16x16x32_bf16 v[76:79], a[232:235], a[56:59], v[76:79]
    v_mfma_f32_16x16x32_bf16 v[80:83], a[236:239], a[56:59], v[80:83]
    v_mfma_f32_16x16x32_bf16 v[84:87], a[240:243], a[56:59], v[84:87]
    buffer_load_dwordx4 a[44:47], v147, s[4:7], s53 offen sc1
    v_mfma_f32_16x16x32_bf16 v[88:91], a[244:247], a[56:59], v[88:91]
    v_mfma_f32_16x16x32_bf16 v[92:95], a[248:251], a[56:59], v[92:95]
    s_waitcnt vmcnt(26)
    v_mfma_f32_16x16x32_bf16 v[96:99], a[232:235], a[60:63], v[96:99]
    buffer_load_dwordx4 v1, s[4:7], s83 offen offset:2048 lds
    v_mfma_f32_16x16x32_bf16 v[100:103], a[236:239], a[60:63], v[100:103]
    v_mfma_f32_16x16x32_bf16 v[104:107], a[240:243], a[60:63], v[104:107]
    v_mfma_f32_16x16x32_bf16 v[108:111], a[244:247], a[60:63], v[108:111]
    buffer_load_dwordx4 v1, s[4:7], s83 offen offset:3072 lds
    v_mfma_f32_16x16x32_bf16 v[112:115], a[248:251], a[60:63], v[112:115]
    s_waitcnt vmcnt(27)
    v_mfma_f32_16x16x32_bf16 v[36:39], a[252:255], a[64:67], v[36:39]
    v_mfma_f32_16x16x32_bf16 v[40:43], a[156:159], a[64:67], v[40:43]
    v_mfma_f32_16x16x32_bf16 v[44:47], a[152:155], a[64:67], v[44:47]
    s_lshr_b32 s53, s16, 1
    s_add_u32 s53, s53, 20
    s_lshl_b32 s53, s53, 12
    s_add_u32 s53, s53, s37
    buffer_load_dwordx4 a[48:51], v144, s[4:7], s53 offen sc1
    v_mfma_f32_16x16x32_bf16 v[48:51], a[148:151], a[64:67], v[48:51]
    v_mfma_f32_16x16x32_bf16 v[52:55], a[144:147], a[64:67], v[52:55]
    s_waitcnt vmcnt(24)
    v_mfma_f32_16x16x32_bf16 v[56:59], a[252:255], a[68:71], v[56:59]
    v_mfma_f32_16x16x32_bf16 v[60:63], a[156:159], a[68:71], v[60:63]
    v_mfma_f32_16x16x32_bf16 v[64:67], a[152:155], a[68:71], v[64:67]
    v_mfma_f32_16x16x32_bf16 v[68:71], a[148:151], a[68:71], v[68:71]
    v_mfma_f32_16x16x32_bf16 v[72:75], a[144:147], a[68:71], v[72:75]
    buffer_load_dwordx4 a[56:59], v146, s[4:7], s53 offen sc1
    s_waitcnt vmcnt(24)
    v_mfma_f32_16x16x32_bf16 v[76:79], a[252:255], a[72:75], v[76:79]
    v_mfma_f32_16x16x32_bf16 v[80:83], a[156:159], a[72:75], v[80:83]
    v_mfma_f32_16x16x32_bf16 v[84:87], a[152:155], a[72:75], v[84:87]
    v_mfma_f32_16x16x32_bf16 v[88:91], a[148:151], a[72:75], v[88:91]
    v_mfma_f32_16x16x32_bf16 v[92:95], a[144:147], a[72:75], v[92:95]
    s_waitcnt vmcnt(23)
    v_mfma_f32_16x16x32_bf16 v[96:99], a[252:255], a[76:79], v[96:99]
    v_mfma_f32_16x16x32_bf16 v[100:103], a[156:159], a[76:79], v[100:103]
    s_add_u32 s83, s97, s25
    s_add_u32 s82, s97, 104448
    s_add_u32 s83, s83, 83968
    s_mov_b32 m0, s82
    s_nop 0
    buffer_load_dwordx4 v1, s[4:7], s83 offen offset:0 lds
    v_mfma_f32_16x16x32_bf16 v[104:107], a[152:155], a[76:79], v[104:107]
    v_mfma_f32_16x16x32_bf16 v[108:111], a[148:151], a[76:79], v[108:111]
    v_mfma_f32_16x16x32_bf16 v[112:115], a[144:147], a[76:79], v[112:115]
    s_waitcnt vmcnt(23)
    v_mfma_f32_16x16x32_bf16 v[36:39], a[140:143], a[0:3], v[36:39]
    v_mfma_f32_16x16x32_bf16 v[40:43], a[136:139], a[0:3], v[40:43]
    v_mfma_f32_16x16x32_bf16 v[52:55], a[124:127], a[0:3], v[52:55]
    buffer_load_dwordx4 v1, s[4:7], s83 offen offset:1024 lds
    s_waitcnt vmcnt(16)
    v_mfma_f32_16x16x32_bf16 v[36:39], a[120:123], a[16:19], v[36:39]
    v_mfma_f32_16x16x32_bf16 v[40:43], a[116:119], a[16:19], v[40:43]
    v_mfma_f32_16x16x32_bf16 v[52:55], a[104:107], a[16:19], v[52:55]
    s_waitcnt vmcnt(9)
    v_mfma_f32_16x16x32_bf16 v[36:39], a[100:103], a[32:35], v[36:39]
    v_mfma_f32_16x16x32_bf16 v[40:43], a[96:99], a[32:35], v[40:43]
    v_mfma_f32_16x16x32_bf16 v[52:55], a[84:87], a[32:35], v[52:55]
    buffer_load_dwordx4 v1, s[4:7], s83 offen offset:2048 lds
    s_waitcnt vmcnt(4)
    v_mfma_f32_16x16x32_bf16 v[36:39], a[80:83], a[48:51], v[36:39]
    v_mfma_f32_16x16x32_bf16 v[40:43], v[148:151], a[48:51], v[40:43]
    v_mfma_f32_16x16x32_bf16 v[52:55], v[160:163], a[48:51], v[52:55]
    v_mfma_f32_16x16x32_bf16 v[56:59], a[140:143], a[4:7], v[56:59]
    v_mfma_f32_16x16x32_bf16 v[60:63], a[136:139], a[4:7], v[60:63]
    buffer_load_dwordx4 v1, s[4:7], s83 offen offset:3072 lds
    v_mfma_f32_16x16x32_bf16 v[72:75], a[124:127], a[4:7], v[72:75]
    v_mfma_f32_16x16x32_bf16 v[56:59], a[120:123], a[20:23], v[56:59]
    s_nop 0
    ds_write_b128 v29, v[36:39] offset:0
    v_mfma_f32_16x16x32_bf16 v[60:63], a[116:119], a[20:23], v[60:63]
    v_mfma_f32_16x16x32_bf16 v[72:75], a[104:107], a[20:23], v[72:75]
    ds_write_b128 v29, v[40:43] offset:1024
    v_mfma_f32_16x16x32_bf16 v[56:59], a[100:103], a[36:39], v[56:59]
    s_add_u32 s83, s97, s25
    s_add_u32 s82, s97, 120832
    s_add_u32 s83, s83, 100352
    s_mov_b32 m0, s82
    s_nop 0
    buffer_load_dwordx4 v1, s[4:7], s83 offen offset:0 lds
    v_mfma_f32_16x16x32_bf16 v[60:63], a[96:99], a[36:39], v[60:63]
    ds_write_b128 v29, v[52:55] offset:4096
    v_mfma_f32_16x16x32_bf16 v[72:75], a[84:87], a[36:39], v[72:75]
    v_mfma_f32_16x16x32_bf16 v[76:79], a[140:143], a[8:11], v[76:79]
    v_mfma_f32_16x16x32_bf16 v[80:83], a[136:139], a[8:11], v[80:83]
    v_mfma_f32_16x16x32_bf16 v[92:95], a[124:127], a[8:11], v[92:95]
    buffer_load_dwordx4 v1, s[4:7], s83 offen offset:1024 lds
    v_mfma_f32_16x16x32_bf16 v[76:79], a[120:123], a[24:27], v[76:79]
    ds_write_b128 v30, v[56:59] offset:0
    v_mfma_f32_16x16x32_bf16 v[80:83], a[116:119], a[24:27], v[80:83]
    v_mfma_f32_16x16x32_bf16 v[92:95], a[104:107], a[24:27], v[92:95]
    v_mfma_f32_16x16x32_bf16 v[76:79], a[100:103], a[40:43], v[76:79]
    ds_write_b128 v30, v[60:63] offset:1024
    v_mfma_f32_16x16x32_bf16 v[80:83], a[96:99], a[40:43], v[80:83]
    v_mfma_f32_16x16x32_bf16 v[92:95], a[84:87], a[40:43], v[92:95]
    buffer_load_dwordx4 v1, s[4:7], s83 offen offset:2048 lds
    s_waitcnt vmcnt(7)
    v_mfma_f32_16x16x32_bf16 v[76:79], a[80:83], a[56:59], v[76:79]
    ds_write_b128 v30, v[72:75] offset:4096
    v_mfma_f32_16x16x32_bf16 v[80:83], v[148:151], a[56:59], v[80:83]
    v_mfma_f32_16x16x32_bf16 v[92:95], v[160:163], a[56:59], v[92:95]
    v_mfma_f32_16x16x32_bf16 v[96:99], a[140:143], a[12:15], v[96:99]
    v_mfma_f32_16x16x32_bf16 v[100:103], a[136:139], a[12:15], v[100:103]
    v_mfma_f32_16x16x32_bf16 v[112:115], a[124:127], a[12:15], v[112:115]
    v_mfma_f32_16x16x32_bf16 v[96:99], a[120:123], a[28:31], v[96:99]
    s_nop 0
    ds_write_b128 v31, v[76:79] offset:0
    v_mfma_f32_16x16x32_bf16 v[100:103], a[116:119], a[28:31], v[100:103]
    buffer_load_dwordx4 v1, s[4:7], s83 offen offset:3072 lds
    v_mfma_f32_16x16x32_bf16 v[112:115], a[104:107], a[28:31], v[112:115]
    ds_write_b128 v31, v[80:83] offset:1024
    v_mfma_f32_16x16x32_bf16 v[96:99], a[100:103], a[44:47], v[96:99]
    v_mfma_f32_16x16x32_bf16 v[100:103], a[96:99], a[44:47], v[100:103]
    ds_write_b128 v31, v[92:95] offset:4096
    v_mfma_f32_16x16x32_bf16 v[112:115], a[84:87], a[44:47], v[112:115]
    v_mfma_f32_16x16x32_bf16 v[44:47], a[132:135], a[0:3], v[44:47]
    v_mfma_f32_16x16x32_bf16 v[48:51], a[128:131], a[0:3], v[48:51]
    v_mfma_f32_16x16x32_bf16 v[44:47], a[112:115], a[16:19], v[44:47]
    s_waitcnt lgkmcnt(0)
    s_barrier
    ds_read_b128 v[36:39], v32 offset:0
    v_mfma_f32_16x16x32_bf16 v[48:51], a[108:111], a[16:19], v[48:51]
    ds_read_b128 v[56:59], v32 offset:5120
    ds_read_b128 v[76:79], v32 offset:10240
    v_mfma_f32_16x16x32_bf16 v[44:47], a[92:95], a[32:35], v[44:47]
    ds_read_b128 v[40:43], v32 offset:1024
    ds_read_b128 v[60:63], v32 offset:6144
    v_mfma_f32_16x16x32_bf16 v[48:51], a[88:91], a[32:35], v[48:51]
    ds_read_b128 v[80:83], v32 offset:11264
    ds_read_b128 v[52:55], v32 offset:4096
    v_mfma_f32_16x16x32_bf16 v[44:47], v[152:155], a[48:51], v[44:47]
    ds_read_b128 v[72:75], v32 offset:9216
    ds_read_b128 v[92:95], v32 offset:14336
    v_mfma_f32_16x16x32_bf16 v[48:51], v[156:159], a[48:51], v[48:51]
    v_mov_b32 v140, 0
    v_mov_b32 v141, 0
    v_mfma_f32_16x16x32_bf16 v[64:67], a[132:135], a[4:7], v[64:67]
    v_mov_b32 v142, 0
    v_mov_b32_e64 v143, 0
    v_mfma_f32_16x16x32_bf16 v[68:71], a[128:131], a[4:7], v[68:71]
    v_mov_b32 v139, 0x3f803f80
    s_waitcnt lgkmcnt(8)
    v_add_f32 v96, v96, v36
    v_mfma_f32_16x16x32_bf16 v[64:67], a[112:115], a[20:23], v[64:67]
    v_add_f32 v97, v97, v37
    v_add_f32 v98, v98, v38
    v_mfma_f32_16x16x32_bf16 v[68:71], a[108:111], a[20:23], v[68:71]
    ds_write_b128 v29, v[44:47] offset:2048
    v_add_f32 v99, v99, v39
    s_waitcnt lgkmcnt(7)
    v_add_f32 v56, v56, v76
    v_mfma_f32_16x16x32_bf16 v[64:67], a[92:95], a[36:39], v[64:67]
    v_add_f32 v57, v57, v77
    v_add_f32 v58, v58, v78
    v_mfma_f32_16x16x32_bf16 v[68:71], a[88:91], a[36:39], v[68:71]
    ds_write_b128 v29, v[48:51] offset:3072
    v_add_f32 v59, v59, v79
    v_add_f32 v96, v96, v56
    v_mfma_f32_16x16x32_bf16 v[84:87], a[132:135], a[8:11], v[84:87]
    v_add_f32 v97, v97, v57
    v_add_f32 v98, v98, v58
    v_mfma_f32_16x16x32_bf16 v[88:91], a[128:131], a[8:11], v[88:91]
    v_add_f32 v99, v99, v59
    v_cvt_pk_bf16_f32 v16, v96, v97
    v_mfma_f32_16x16x32_bf16 v[84:87], a[112:115], a[24:27], v[84:87]
    v_cvt_pk_bf16_f32 v17, v98, v99
    s_waitcnt lgkmcnt(7)
    v_add_f32 v100, v100, v40
    v_mfma_f32_16x16x32_bf16 v[88:91], a[108:111], a[24:27], v[88:91]
    ds_write_b128 v30, v[64:67] offset:2048
    v_add_f32 v101, v101, v41
    v_add_f32 v102, v102, v42
    v_mfma_f32_16x16x32_bf16 v[84:87], a[92:95], a[40:43], v[84:87]
    v_add_f32 v103, v103, v43
    s_waitcnt lgkmcnt(6)
    v_add_f32 v60, v60, v80
    v_mfma_f32_16x16x32_bf16 v[88:91], a[88:91], a[40:43], v[88:91]
    ds_write_b128 v30, v[68:71] offset:3072
    v_add_f32 v61, v61, v81
    v_add_f32 v62, v62, v82
    v_mfma_f32_16x16x32_bf16 v[84:87], v[152:155], a[56:59], v[84:87]
    v_add_f32 v63, v63, v83
    v_add_f32 v100, v100, v60
    v_mfma_f32_16x16x32_bf16 v[88:91], v[156:159], a[56:59], v[88:91]
    v_add_f32 v101, v101, v61
    v_add_f32 v102, v102, v62
    v_mfma_f32_16x16x32_bf16 v[104:107], a[132:135], a[12:15], v[104:107]
    v_add_f32 v103, v103, v63
    v_cvt_pk_bf16_f32 v18, v100, v101
    v_mfma_f32_16x16x32_bf16 v[108:111], a[128:131], a[12:15], v[108:111]
    v_cvt_pk_bf16_f32 v19, v102, v103
    buffer_store_dwordx4 v[16:19], v10, s[4:7], 0 offen offset:0 sc1
    v_mfma_f32_16x16x32_bf16 v[104:107], a[112:115], a[28:31], v[104:107]
    s_waitcnt lgkmcnt(6)
    v_add_f32 v112, v112, v52
    v_add_f32 v113, v113, v53
    v_mfma_f32_16x16x32_bf16 v[108:111], a[108:111], a[28:31], v[108:111]
    ds_write_b128 v31, v[84:87] offset:2048
    v_add_f32 v114, v114, v54
    v_add_f32 v115, v115, v55
    v_mfma_f32_16x16x32_bf16 v[104:107], a[92:95], a[44:47], v[104:107]
    s_waitcnt lgkmcnt(5)
    v_add_f32 v72, v72, v92
    v_add_f32 v73, v73, v93
    v_mfma_f32_16x16x32_bf16 v[108:111], a[88:91], a[44:47], v[108:111]
    ds_write_b128 v31, v[88:91] offset:3072
    v_add_f32 v74, v74, v94
    v_add_f32 v75, v75, v95
    v_add_f32 v112, v112, v72
    v_add_f32 v113, v113, v73
    v_add_f32 v114, v114, v74
    v_add_f32 v115, v115, v75
    v_cvt_pk_bf16_f32 v24, v112, v113
    v_cvt_pk_bf16_f32 v25, v114, v115
    buffer_store_dwordx2 v[24:25], v11, s[4:7], 0 offen sc1
    s_add_u32 s83, s97, s25
    s_add_u32 s82, s97, 137216
    s_add_u32 s83, s83, 116736
    s_mov_b32 m0, s82
    s_nop 0
    buffer_load_dwordx4 v1, s[4:7], s83 offen offset:0 lds
    buffer_load_dwordx4 v1, s[4:7], s83 offen offset:1024 lds
    buffer_load_dwordx4 v1, s[4:7], s83 offen offset:2048 lds
    buffer_load_dwordx4 v1, s[4:7], s83 offen offset:3072 lds
    v_dot2_f32_bf16 v140, v16, v139, v140
    v_dot2_f32_bf16 v141, v16, v16, v141
    v_dot2_f32_bf16 v142, v17, v139, v142
    v_dot2_f32_bf16 v143, v17, v17, v143
    v_dot2_f32_bf16 v140, v18, v139, v140
    v_dot2_f32_bf16 v141, v18, v18, v141
    v_dot2_f32_bf16 v142, v19, v139, v142
    v_dot2_f32_bf16 v143, v19, v19, v143
    v_dot2_f32_bf16 v140, v24, v139, v140
    v_dot2_f32_bf16 v141, v24, v24, v141
    v_dot2_f32_bf16 v142, v25, v139, v142
    v_dot2_f32_bf16 v143, v25, v25, v143
    s_add_u32 s3, s39, 2
    v_mov_b32 v15, s3
    s_add_u32 s3, s40, 20480
    s_waitcnt vmcnt(4)
    s_mov_b64 exec, 1
    buffer_store_dword v15, off, s[4:7], s3 sc1
    s_mov_b64 exec, -1
    s_waitcnt lgkmcnt(0)
    s_barrier
    ds_read_b128 v[44:47], v32 offset:2048
    ds_read_b128 v[64:67], v32 offset:7168
    ds_read_b128 v[84:87], v32 offset:12288
    ds_read_b128 v[48:51], v32 offset:3072
    ds_read_b128 v[68:71], v32 offset:8192
    ds_read_b128 v[88:91], v32 offset:13312
    s_waitcnt lgkmcnt(5)
    v_pk_add_f32 v[104:105], v[104:105], v[44:45] op_sel:[0,0] op_sel_hi:[1,1]
    v_pk_add_f32 v[106:107], v[106:107], v[46:47] op_sel:[0,0] op_sel_hi:[1,1]
    s_waitcnt lgkmcnt(3)
    v_pk_add_f32 v[64:65], v[64:65], v[84:85] op_sel:[0,0] op_sel_hi:[1,1]
    v_pk_add_f32 v[66:67], v[66:67], v[86:87] op_sel:[0,0] op_sel_hi:[1,1]
    v_pk_add_f32 v[104:105], v[104:105], v[64:65] op_sel:[0,0] op_sel_hi:[1,1]
    v_pk_add_f32 v[106:107], v[106:107], v[66:67] op_sel:[0,0] op_sel_hi:[1,1]
    v_cvt_pk_bf16_f32 v20, v104, v105
    v_cvt_pk_bf16_f32 v21, v106, v107
    v_dot2_f32_bf16 v140, v20, v139, v140
    v_dot2_f32_bf16 v141, v20, v20, v141
    v_dot2_f32_bf16 v142, v21, v139, v142
    v_dot2_f32_bf16 v143, v21, v21, v143
    s_waitcnt lgkmcnt(2)
    v_pk_add_f32 v[108:109], v[108:109], v[48:49] op_sel:[0,0] op_sel_hi:[1,1]
    v_pk_add_f32 v[110:111], v[110:111], v[50:51] op_sel:[0,0] op_sel_hi:[1,1]
    s_waitcnt lgkmcnt(0)
    v_pk_add_f32 v[68:69], v[68:69], v[88:89] op_sel:[0,0] op_sel_hi:[1,1]
    v_pk_add_f32 v[70:71], v[70:71], v[90:91] op_sel:[0,0] op_sel_hi:[1,1]
    v_pk_add_f32 v[108:109], v[108:109], v[68:69] op_sel:[0,0] op_sel_hi:[1,1]
    v_pk_add_f32 v[110:111], v[110:111], v[70:71] op_sel:[0,0] op_sel_hi:[1,1]
    v_cvt_pk_bf16_f32 v22, v108, v109
    v_cvt_pk_bf16_f32 v23, v110, v111
    buffer_store_dwordx4 v[20:23], v10, s[4:7], 0 offen offset:1024 sc1
    v_dot2_f32_bf16 v140, v22, v139, v140
    v_dot2_f32_bf16 v141, v22, v22, v141
    v_dot2_f32_bf16 v142, v23, v139, v142
    v_dot2_f32_bf16 v143, v23, v23, v143
    s_nop 2
    v_pk_add_f32 v[140:141], v[140:141], v[142:143] op_sel:[0,0] op_sel_hi:[1,1]
    s_nop 1
    v_permlane32_swap_b32 v140, v141
    v_add_f32 v140, v140, v141
    v_mov_b32 v141, v140
    s_nop 1
    v_permlane16_swap_b32 v140, v141
    v_add_f32 v140, v140, v141
    v_and_b32_e64 v15, 63, v2
    v_add_u32 v15, 20480, v15
    buffer_load_dword v14, v15, s[4:7], s41 offen sc1
    buffer_store_dword v140, v9, s[4:7], 0 offen sc1
    s_waitcnt vmcnt(4)
    s_barrier
    ds_read_b128 v[76:79], v3 offset:6144
    ds_read_b128 v[80:83], v3 offset:7168
    ds_read_b128 v[84:87], v3 offset:8192
    ds_read_b128 v[88:91], v3 offset:9216
    ds_read_b128 v[92:95], v3 offset:10240
    s_add_u32 s52, s39, 2
    s_waitcnt vmcnt(1)
    v_cmp_ne_u32 vcc, s52, v14
    s_nop 1
    s_cbranch_vccz L_ok_1022
    s_mov_b32 s60, 0
L_lp_1021:
    v_and_b32_e64 v15, 63, v2
    v_add_u32 v15, 20480, v15
    buffer_load_dword v14, v15, s[4:7], s41 offen sc1
    s_add_u32 s60, s60, 1
    s_cmp_gt_u32 s60, 0x40000
    s_cbranch_scc1 L_abort
    s_waitcnt vmcnt(0)
    v_cmp_ne_u32 vcc, s52, v14
    s_nop 1
    s_cbranch_vccnz L_lp_1021
L_ok_1022:
    buffer_load_dwordx4 a[0:3], v6, s[4:7], 0 offen offset:0 sc1
    buffer_load_dwordx4 a[4:7], v7, s[4:7], 0 offen offset:0 sc1
    buffer_load_dwordx4 a[8:11], v6, s[4:7], 0 offen offset:2048 sc1
    buffer_load_dwordx4 a[12:15], v7, s[4:7], 0 offen offset:2048 sc1
    buffer_load_dwordx4 a[16:19], v6, s[4:7], 0 offen offset:3072 sc1
    buffer_load_dwordx4 a[20:23], v7, s[4:7], 0 offen offset:3072 sc1
    buffer_load_dwordx4 a[24:27], v6, s[4:7], s21 offen offset:1024 sc1
    buffer_load_dwordx4 a[28:31], v7, s[4:7], s21 offen offset:1024 sc1
    s_waitcnt vmcnt(7) lgkmcnt(4)
    v_mfma_f32_16x16x32_bf16 v[36:39], a[0:3], v[76:79], 0
    ds_read_b128 v[96:99], v3 offset:11264
    s_waitcnt vmcnt(6)
    v_mfma_f32_16x16x32_bf16 v[40:43], a[4:7], v[76:79], 0
    s_waitcnt lgkmcnt(4)
    v_mfma_f32_16x16x32_bf16 v[44:47], a[0:3], v[80:83], 0
    ds_read_b128 v[100:103], v3 offset:12288
    buffer_load_dwordx4 a[32:35], v6, s[4:7], s21 offen offset:3072 sc1
    v_mfma_f32_16x16x32_bf16 v[48:51], a[4:7], v[80:83], 0
    s_waitcnt lgkmcnt(4)
    v_mfma_f32_16x16x32_bf16 v[52:55], a[0:3], v[84:87], 0
    ds_read_b128 v[104:107], v3 offset:13312
    v_mfma_f32_16x16x32_bf16 v[56:59], a[4:7], v[84:87], 0
    s_waitcnt lgkmcnt(4)
    v_mfma_f32_16x16x32_bf16 v[60:63], a[0:3], v[88:91], 0
    ds_read_b128 v[108:111], v3 offset:14336
    v_mfma_f32_16x16x32_bf16 v[64:67], a[4:7], v[88:91], 0
    buffer_load_dwordx4 a[36:39], v7, s[4:7], s21 offen offset:3072 sc1
    s_waitcnt lgkmcnt(4)
    v_mfma_f32_16x16x32_bf16 v[68:71], a[0:3], v[92:95], 0
    ds_read_b128 v[112:115], v3 offset:15360
    v_mfma_f32_16x16x32_bf16 v[72:75], a[4:7], v[92:95], 0
    s_waitcnt vmcnt(7) lgkmcnt(4)
    v_mfma_f32_16x16x32_bf16 v[36:39], a[8:11], v[96:99], v[36:39]
    ds_read_b128 v[76:79], v3 offset:16384
    s_waitcnt vmcnt(6)
    v_mfma_f32_16x16x32_bf16 v[40:43], a[12:15], v[96:99], v[40:43]
    s_add_u32 s3, s39, 2
    v_mov_b32 v15, s3
    s_mov_b64 exec, 1
    buffer_store_dword v15, off, s[4:7], s40 sc1
    s_mov_b64 exec, -1
    s_waitcnt lgkmcnt(4)
    v_mfma_f32_16x16x32_bf16 v[44:47], a[8:11], v[100:103], v[44:47]
    ds_read_b128 v[80:83], v3 offset:17408
    v_mfma_f32_16x16x32_bf16 v[48:51], a[12:15], v[100:103], v[48:51]
    s_waitcnt lgkmcnt(4)
    v_mfma_f32_16x16x32_bf16 v[52:55], a[8:11], v[104:107], v[52:55]
    ds_read_b128 v[84:87], v3 offset:18432
    buffer_load_dwordx4 a[40:43], v6, s[4:7], s22 offen offset:0 sc1
    v_mfma_f32_16x16x32_bf16 v[56:59], a[12:15], v[104:107], v[56:59]
    s_waitcnt lgkmcnt(4)
    v_mfma_f32_16x16x32_bf16 v[60:63], a[8:11], v[108:111], v[60:63]
    ds_read_b128 v[88:91], v3 offset:19456
    v_mfma_f32_16x16x32_bf16 v[64:67], a[12:15], v[108:111], v[64:67]
    buffer_load_dwordx4 a[44:47], v7, s[4:7], s22 offen offset:0 sc1
    s_waitcnt lgkmcnt(4)
    v_mfma_f32_16x16x32_bf16 v[68:71], a[8:11], v[112:115], v[68:71]
    ds_read_b128 v[92:95], v3 offset:20480
    v_mfma_f32_16x16x32_bf16 v[72:75], a[12:15], v[112:115], v[72:75]
    s_waitcnt vmcnt(8) lgkmcnt(4)
    v_mfma_f32_16x16x32_bf16 v[36:39], a[16:19], v[76:79], v[36:39]
    ds_read_b128 v[96:99], v3 offset:21504
    s_waitcnt vmcnt(7)
    v_mfma_f32_16x16x32_bf16 v[40:43], a[20:23], v[76:79], v[40:43]
    s_waitcnt lgkmcnt(4)
    v_mfma_f32_16x16x32_bf16 v[44:47], a[16:19], v[80:83], v[44:47]
    ds_read_b128 v[100:103], v3 offset:22528
    buffer_load_dwordx4 a[48:51], v6, s[4:7], s22 offen offset:2048 sc1
    v_mfma_f32_16x16x32_bf16 v[48:51], a[20:23], v[80:83], v[48:51]
    s_waitcnt lgkmcnt(4)
    v_mfma_f32_16x16x32_bf16 v[52:55], a[16:19], v[84:87], v[52:55]
    ds_read_b128 v[104:107], v3 offset:23552
    v_mfma_f32_16x16x32_bf16 v[56:59], a[20:23], v[84:87], v[56:59]
    s_waitcnt lgkmcnt(4)
    v_mfma_f32_16x16x32_bf16 v[60:63], a[16:19], v[88:91], v[60:63]
    ds_read_b128 v[108:111], v3 offset:24576
    v_mfma_f32_16x16x32_bf16 v[64:67], a[20:23], v[88:91], v[64:67]
    buffer_load_dwordx4 a[52:55], v7, s[4:7], s22 offen offset:2048 sc1
    s_waitcnt lgkmcnt(4)
    v_mfma_f32_16x16x32_bf16 v[68:71], a[16:19], v[92:95], v[68:71]
    ds_read_b128 v[112:115], v3 offset:25600
    v_mfma_f32_16x16x32_bf16 v[72:75], a[20:23], v[92:95], v[72:75]
    s_waitcnt vmcnt(8) lgkmcnt(4)
    v_mfma_f32_16x16x32_bf16 v[36:39], a[24:27], v[96:99], v[36:39]
    ds_read_b128 v[76:79], v3 offset:26624
    s_waitcnt vmcnt(7)
    v_mfma_f32_16x16x32_bf16 v[40:43], a[28:31], v[96:99], v[40:43]
    buffer_load_dwordx4 a[56:59], v6, s[4:7], s23 offen offset:0 sc1
    s_waitcnt lgkmcnt(4)
    v_mfma_f32_16x16x32_bf16 v[44:47], a[24:27], v[100:103], v[44:47]
    ds_read_b128 v[80:83], v3 offset:27648
    v_mfma_f32_16x16x32_bf16 v[48:51], a[28:31], v[100:103], v[48:51]
    s_waitcnt lgkmcnt(4)
    v_mfma_f32_16x16x32_bf16 v[52:55], a[24:27], v[104:107], v[52:55]
    ds_read_b128 v[84:87], v3 offset:28672
    buffer_load_dwordx4 a[60:63], v7, s[4:7], s23 offen offset:0 sc1
    v_mfma_f32_16x16x32_bf16 v[56:59], a[28:31], v[104:107], v[56:59]
    s_waitcnt lgkmcnt(4)
    v_mfma_f32_16x16x32_bf16 v[60:63], a[24:27], v[108:111], v[60:63]
    ds_read_b128 v[88:91], v3 offset:29696
    v_mfma_f32_16x16x32_bf16 v[64:67], a[28:31], v[108:111], v[64:67]
    v_and_b32 v15, 63, v2
    buffer_load_dword v14, v15, s[4:7], s41 offen sc1
    s_waitcnt lgkmcnt(4)
    v_mfma_f32_16x16x32_bf16 v[68:71], a[24:27], v[112:115], v[68:71]
    ds_read_b128 v[92:95], v3 offset:30720
    v_mfma_f32_16x16x32_bf16 v[72:75], a[28:31], v[112:115], v[72:75]
    s_waitcnt vmcnt(9) lgkmcnt(4)
    v_mfma_f32_16x16x32_bf16 v[36:39], a[32:35], v[76:79], v[36:39]
    ds_read_b128 v[96:99], v3 offset:31744
    s_waitcnt vmcnt(8)
    v_mfma_f32_16x16x32_bf16 v[40:43], a[36:39], v[76:79], v[40:43]
    buffer_load_dwordx4 a[64:67], v6, s[4:7], s23 offen offset:1024 sc1
    s_waitcnt lgkmcnt(4)
    v_mfma_f32_16x16x32_bf16 v[44:47], a[32:35], v[80:83], v[44:47]
    ds_read_b128 v[100:103], v3 offset:32768
    v_mfma_f32_16x16x32_bf16 v[48:51], a[36:39], v[80:83], v[48:51]
    s_waitcnt lgkmcnt(4)
    v_mfma_f32_16x16x32_bf16 v[52:55], a[32:35], v[84:87], v[52:55]
    ds_read_b128 v[104:107], v3 offset:33792
    buffer_load_dwordx4 a[68:71], v7, s[4:7], s23 offen offset:1024 sc1
    v_mfma_f32_16x16x32_bf16 v[56:59], a[36:39], v[84:87], v[56:59]
    s_waitcnt lgkmcnt(4)
    v_mfma_f32_16x16x32_bf16 v[60:63], a[32:35], v[88:91], v[60:63]
    ds_read_b128 v[108:111], v3 offset:34816
    v_mfma_f32_16x16x32_bf16 v[64:67], a[36:39], v[88:91], v[64:67]
    s_add_u32 s85, s95, s25
    s_add_u32 s84, s95, 51200
    s_add_u32 s85, s85, 133120
    s_mov_b32 m0, s84
    s_nop 0
    buffer_load_dwordx4 v1, s[4:7], s85 offen offset:0 lds
    s_waitcnt lgkmcnt(4)
    v_mfma_f32_16x16x32_bf16 v[68:71], a[32:35], v[92:95], v[68:71]
    ds_read_b128 v[112:115], v3 offset:35840
    v_mfma_f32_16x16x32_bf16 v[72:75], a[36:39], v[92:95], v[72:75]
    s_waitcnt vmcnt(9) lgkmcnt(4)
    v_mfma_f32_16x16x32_bf16 v[36:39], a[40:43], v[96:99], v[36:39]
    ds_read_b128 v[76:79], v3 offset:36864
    s_waitcnt vmcnt(8)
    v_mfma_f32_16x16x32_bf16 v[40:43], a[44:47], v[96:99], v[40:43]
    s_waitcnt lgkmcnt(4)
    v_mfma_f32_16x16x32_bf16 v[44:47], a[40:43], v[100:103], v[44:47]
    ds_read_b128 v[80:83], v3 offset:37888
    buffer_load_dwordx4 a[72:75], v6, s[4:7], s23 offen offset:3072 sc1
    v_mfma_f32_16x16x32_bf16 v[48:51], a[44:47], v[100:103], v[48:51]
    s_waitcnt lgkmcnt(4)
    v_mfma_f32_16x16x32_bf16 v[52:55], a[40:43], v[104:107], v[52:55]
    ds_read_b128 v[84:87], v3 offset:38912
    v_mfma_f32_16x16x32_bf16 v[56:59], a[44:47], v[104:107], v[56:59]
    s_waitcnt lgkmcnt(4)
    v_mfma_f32_16x16x32_bf16 v[60:63], a[40:43], v[108:111], v[60:63]
    ds_read_b128 v[88:91], v3 offset:39936
    v_mfma_f32_16x16x32_bf16 v[64:67], a[44:47], v[108:111], v[64:67]
    buffer_load_dwordx4 a[76:79], v7, s[4:7], s23 offen offset:3072 sc1
    s_waitcnt lgkmcnt(4)
    v_mfma_f32_16x16x32_bf16 v[68:71], a[40:43], v[112:115], v[68:71]
    ds_read_b128 v[92:95], v3 offset:40960
    v_mfma_f32_16x16x32_bf16 v[72:75], a[44:47], v[112:115], v[72:75]
    s_waitcnt vmcnt(9) lgkmcnt(4)
    v_mfma_f32_16x16x32_bf16 v[36:39], a[48:51], v[76:79], v[36:39]
    ds_read_b128 v[96:99], v3 offset:41984
    s_waitcnt vmcnt(8)
    v_mfma_f32_16x16x32_bf16 v[40:43], a[52:55], v[76:79], v[40:43]
    buffer_load_dwordx4 a[80:83], v6, s[4:7], s24 offen offset:1024 sc1
    s_waitcnt lgkmcnt(4)
    v_mfma_f32_16x16x32_bf16 v[44:47], a[48:51], v[80:83], v[44:47]
    ds_read_b128 v[100:103], v3 offset:43008
    v_mfma_f32_16x16x32_bf16 v[48:51], a[52:55], v[80:83], v[48:51]
    s_waitcnt lgkmcnt(4)
    v_mfma_f32_16x16x32_bf16 v[52:55], a[48:51], v[84:87], v[52:55]
    ds_read_b128 v[104:107], v3 offset:44032
    buffer_load_dwordx4 a[84:87], v7, s[4:7], s24 offen offset:1024 sc1
    v_mfma_f32_16x16x32_bf16 v[56:59], a[52:55], v[84:87], v[56:59]
    s_waitcnt lgkmcnt(4)
    v_mfma_f32_16x16x32_bf16 v[60:63], a[48:51], v[88:91], v[60:63]
    ds_read_b128 v[108:111], v3 offset:45056
    v_mfma_f32_16x16x32_bf16 v[64:67], a[52:55], v[88:91], v[64:67]
    buffer_load_dwordx4 v1, s[4:7], s85 offen offset:1024 lds
    s_waitcnt lgkmcnt(4)
    v_mfma_f32_16x16x32_bf16 v[68:71], a[48:51], v[92:95], v[68:71]
    ds_read_b128 v[112:115], v3 offset:46080
    v_mfma_f32_16x16x32_bf16 v[72:75], a[52:55], v[92:95], v[72:75]
    s_waitcnt vmcnt(10) lgkmcnt(4)
    v_mfma_f32_16x16x32_bf16 v[36:39], a[56:59], v[96:99], v[36:39]
    s_add_u32 s52, s39, 2
    s_waitcnt vmcnt(8)
    v_cmp_ne_u32 vcc, s52, v14
    s_nop 4
    s_cbranch_vccz L_ok_1025
    s_mov_b32 s60, 0
L_lp_1024:
    v_and_b32 v15, 63, v2
    buffer_load_dword v14, v15, s[4:7], s41 offen sc1
    s_add_u32 s60, s60, 1
    s_cmp_gt_u32 s60, 0x40000
    s_cbranch_scc1 L_abort
    s_waitcnt vmcnt(0)
    v_cmp_ne_u32 vcc, s52, v14
    s_nop 1
    s_cbranch_vccnz L_lp_1024
L_ok_1025:
    v_mfma_f32_16x16x32_bf16 v[40:43], a[60:63], v[96:99], v[40:43]
    ds_read_b128 v[76:79], v3 offset:47104
    s_waitcnt lgkmcnt(4)
    v_mfma_f32_16x16x32_bf16 v[44:47], a[56:59], v[100:103], v[44:47]
    ds_read_b128 v[80:83], v3 offset:48128
    buffer_load_dwordx4 a[88:91], v6, s[4:7], s24 offen offset:2048 sc1
    v_mfma_f32_16x16x32_bf16 v[48:51], a[60:63], v[100:103], v[48:51]
    ds_read_b128 v[84:87], v3 offset:49152
    s_waitcnt lgkmcnt(5)
    v_mfma_f32_16x16x32_bf16 v[52:55], a[56:59], v[104:107], v[52:55]
    ds_read_b128 v[88:91], v3 offset:50176
    v_mfma_f32_16x16x32_bf16 v[56:59], a[60:63], v[104:107], v[56:59]
    ds_read_b128 v[92:95], v3 offset:51200
    s_waitcnt lgkmcnt(6)
    v_mfma_f32_16x16x32_bf16 v[60:63], a[56:59], v[108:111], v[60:63]
    v_mfma_f32_16x16x32_bf16 v[64:67], a[60:63], v[108:111], v[64:67]
    buffer_load_dwordx4 a[92:95], v7, s[4:7], s24 offen offset:2048 sc1
    s_waitcnt lgkmcnt(5)
    v_mfma_f32_16x16x32_bf16 v[68:71], a[56:59], v[112:115], v[68:71]
    v_mfma_f32_16x16x32_bf16 v[72:75], a[60:63], v[112:115], v[72:75]
    s_waitcnt vmcnt(9) lgkmcnt(4)
    v_mfma_f32_16x16x32_bf16 v[36:39], a[64:67], v[76:79], v[36:39]
    ds_read_b128 v[96:99], v3 offset:52224
    buffer_load_dwordx4 a[96:99], v6, s[4:7], 0 offen offset:1024 sc1
    s_waitcnt vmcnt(9)
    v_mfma_f32_16x16x32_bf16 v[40:43], a[68:71], v[76:79], v[40:43]
    s_waitcnt lgkmcnt(4)
    v_mfma_f32_16x16x32_bf16 v[44:47], a[64:67], v[80:83], v[44:47]
    ds_read_b128 v[100:103], v3 offset:53248
    buffer_load_dwordx4 a[100:103], v7, s[4:7], 0 offen offset:1024 sc1
    v_mfma_f32_16x16x32_bf16 v[48:51], a[68:71], v[80:83], v[48:51]
    s_waitcnt lgkmcnt(4)
    v_mfma_f32_16x16x32_bf16 v[52:55], a[64:67], v[84:87], v[52:55]
    ds_read_b128 v[104:107], v3 offset:54272
    s_add_u32 s85, s94, s25
    s_add_u32 s84, s94, 57344
    s_add_u32 s85, s85, 139264
    s_mov_b32 m0, s84
    s_nop 0
    buffer_load_dwordx4 v1, s[4:7], s85 offen offset:0 lds
    v_mfma_f32_16x16x32_bf16 v[56:59], a[68:71], v[84:87], v[56:59]
    s_waitcnt lgkmcnt(4)
    v_mfma_f32_16x16x32_bf16 v[60:63], a[64:67], v[88:91], v[60:63]
    ds_read_b128 v[108:111], v3 offset:55296
    buffer_load_dwordx4 v[144:147], v8, s[4:7], 0 offen offset:0 sc1
    v_mfma_f32_16x16x32_bf16 v[64:67], a[68:71], v[88:91], v[64:67]
    s_waitcnt lgkmcnt(4)
    v_mfma_f32_16x16x32_bf16 v[68:71], a[64:67], v[92:95], v[68:71]
    ds_read_b128 v[112:115], v3 offset:56320
    buffer_load_dwordx4 v[148:151], v8, s[4:7], 0 offen offset:1024 sc1
    v_mfma_f32_16x16x32_bf16 v[72:75], a[68:71], v[92:95], v[72:75]
    s_waitcnt vmcnt(11) lgkmcnt(4)
    v_mfma_f32_16x16x32_bf16 v[36:39], a[72:75], v[96:99], v[36:39]
    ds_read_b128 v[76:79], v3 offset:57344
    s_waitcnt vmcnt(10)
    v_mfma_f32_16x16x32_bf16 v[40:43], a[76:79], v[96:99], v[40:43]
    s_waitcnt lgkmcnt(4)
    v_mfma_f32_16x16x32_bf16 v[44:47], a[72:75], v[100:103], v[44:47]
    ds_read_b128 v[80:83], v3 offset:58368
    buffer_load_dwordx4 a[104:107], v6, s[4:7], s21 offen offset:0 sc1
    v_mfma_f32_16x16x32_bf16 v[48:51], a[76:79], v[100:103], v[48:51]
    s_waitcnt lgkmcnt(4)
    v_mfma_f32_16x16x32_bf16 v[52:55], a[72:75], v[104:107], v[52:55]
    ds_read_b128 v[84:87], v3 offset:59392
    v_mfma_f32_16x16x32_bf16 v[56:59], a[76:79], v[104:107], v[56:59]
    s_waitcnt lgkmcnt(4)
    v_mfma_f32_16x16x32_bf16 v[60:63], a[72:75], v[108:111], v[60:63]
    ds_read_b128 v[88:91], v3 offset:60416
    v_mfma_f32_16x16x32_bf16 v[64:67], a[76:79], v[108:111], v[64:67]
    buffer_load_dwordx4 a[108:111], v7, s[4:7], s21 offen offset:0 sc1
    s_waitcnt lgkmcnt(4)
    v_mfma_f32_16x16x32_bf16 v[68:71], a[72:75], v[112:115], v[68:71]
    ds_read_b128 v[92:95], v3 offset:61440
    v_mfma_f32_16x16x32_bf16 v[72:75], a[76:79], v[112:115], v[72:75]
    s_waitcnt vmcnt(11) lgkmcnt(4)
    v_mfma_f32_16x16x32_bf16 v[36:39], a[80:83], v[76:79], v[36:39]
    ds_read_b128 v[96:99], v3 offset:62464
    s_waitcnt vmcnt(10)
    v_mfma_f32_16x16x32_bf16 v[40:43], a[84:87], v[76:79], v[40:43]
    buffer_load_dwordx4 a[112:115], v6, s[4:7], s21 offen offset:2048 sc1
    s_waitcnt lgkmcnt(4)
    v_mfma_f32_16x16x32_bf16 v[44:47], a[80:83], v[80:83], v[44:47]
    ds_read_b128 v[100:103], v3 offset:63488
    v_mfma_f32_16x16x32_bf16 v[48:51], a[84:87], v[80:83], v[48:51]
    s_waitcnt lgkmcnt(4)
    v_mfma_f32_16x16x32_bf16 v[52:55], a[80:83], v[84:87], v[52:55]
    ds_read_b128 v[104:107], v3 offset:64512
    buffer_load_dwordx4 a[116:119], v7, s[4:7], s21 offen offset:2048 sc1
    v_mfma_f32_16x16x32_bf16 v[56:59], a[84:87], v[84:87], v[56:59]
    s_waitcnt lgkmcnt(4)
    v_mfma_f32_16x16x32_bf16 v[60:63], a[80:83], v[88:91], v[60:63]
    ds_read_b128 v[108:111], v4 offset:0
    v_mfma_f32_16x16x32_bf16 v[64:67], a[84:87], v[88:91], v[64:67]
    s_add_u32 s87, s97, s25
    s_add_u32 s86, s97, 0
    s_mov_b32 m0, s86
    s_nop 0
    buffer_load_dwordx4 v1, s[4:7], s87 offen offset:0 lds
    s_waitcnt lgkmcnt(4)
    v_mfma_f32_16x16x32_bf16 v[68:71], a[80:83], v[92:95], v[68:71]
    ds_read_b128 v[112:115], v4 offset:1024
    v_mfma_f32_16x16x32_bf16 v[72:75], a[84:87], v[92:95], v[72:75]
    s_waitcnt vmcnt(11) lgkmcnt(4)
    v_mfma_f32_16x16x32_bf16 v[36:39], a[88:91], v[96:99], v[36:39]
    ds_read_b128 v[76:79], v4 offset:2048
    s_waitcnt vmcnt(6)
    v_add_f32 v144, v144, v145
    v_mfma_f32_16x16x32_bf16 v[40:43], a[92:95], v[96:99], v[40:43]
    buffer_load_dwordx4 a[120:123], v6, s[4:7], s22 offen offset:1024 sc1
    s_waitcnt vmcnt(6)
    v_add_f32 v148, v148, v149
    s_waitcnt lgkmcnt(4)
    v_mfma_f32_16x16x32_bf16 v[44:47], a[88:91], v[100:103], v[44:47]
    ds_read_b128 v[80:83], v4 offset:3072
    v_add_f32 v146, v146, v147
    v_mfma_f32_16x16x32_bf16 v[48:51], a[92:95], v[100:103], v[48:51]
    v_add_f32 v150, v150, v151
    s_waitcnt lgkmcnt(4)
    v_mfma_f32_16x16x32_bf16 v[52:55], a[88:91], v[104:107], v[52:55]
    ds_read_b128 v[84:87], v4 offset:4096
    buffer_load_dwordx4 a[124:127], v7, s[4:7], s22 offen offset:1024 sc1
    v_add_f32 v144, v144, v146
    v_mfma_f32_16x16x32_bf16 v[56:59], a[92:95], v[104:107], v[56:59]
    v_add_f32 v148, v148, v150
    s_waitcnt lgkmcnt(4)
    v_mfma_f32_16x16x32_bf16 v[60:63], a[88:91], v[108:111], v[60:63]
    ds_read_b128 v[88:91], v4 offset:5120
    v_mov_b32 v145, v144
    v_mfma_f32_16x16x32_bf16 v[64:67], a[92:95], v[108:111], v[64:67]
    buffer_load_dwordx4 v1, s[4:7], s87 offen offset:1024 lds
    v_mov_b32 v149, v148
    s_waitcnt lgkmcnt(4)
    v_mfma_f32_16x16x32_bf16 v[68:71], a[88:91], v[112:115], v[68:71]
    ds_read_b128 v[92:95], v4 offset:6144
    v_permlane16_swap_b32 v144, v145
    v_mfma_f32_16x16x32_bf16 v[72:75], a[92:95], v[112:115], v[72:75]
    v_permlane16_swap_b32 v148, v149
    s_waitcnt lgkmcnt(4)
    v_mfma_f32_16x16x32_bf16 v[36:39], a[96:99], v[76:79], v[36:39]
    ds_read_b128 v[96:99], v4 offset:7168
    v_add_f32 v144, v144, v145
    v_mfma_f32_16x16x32_bf16 v[40:43], a[100:103], v[76:79], v[40:43]
    buffer_load_dwordx4 a[128:131], v6, s[4:7], s22 offen offset:3072 sc1
    v_add_f32 v148, v148, v149
    s_waitcnt lgkmcnt(4)
    v_mfma_f32_16x16x32_bf16 v[44:47], a[96:99], v[80:83], v[44:47]
    ds_read_b128 v[100:103], v4 offset:8192
    v_mov_b32 v145, v144
    v_mfma_f32_16x16x32_bf16 v[48:51], a[100:103], v[80:83], v[48:51]
    v_mov_b32 v149, v148
    s_waitcnt lgkmcnt(4)
    v_mfma_f32_16x16x32_bf16 v[52:55], a[96:99], v[84:87], v[52:55]
    ds_read_b128 v[104:107], v4 offset:9216
    buffer_load_dwordx4 a[132:135], v7, s[4:7], s22 offen offset:3072 sc1
    v_permlane32_swap_b32 v144, v145
    v_mfma_f32_16x16x32_bf16 v[56:59], a[100:103], v[84:87], v[56:59]
    v_permlane32_swap_b32 v148, v149
    s_waitcnt lgkmcnt(4)
    v_mfma_f32_16x16x32_bf16 v[60:63], a[96:99], v[88:91], v[60:63]
    ds_read_b128 v[108:111], v4 offset:10240
    v_mul_f32 v144, 986500301, v144
    v_mfma_f32_16x16x32_bf16 v[64:67], a[100:103], v[88:91], v[64:67]
    buffer_load_dwordx4 v1, s[4:7], s87 offen offset:2048 lds
    v_mul_f32 v148, 986500301, v148
    s_waitcnt lgkmcnt(4)
    v_mfma_f32_16x16x32_bf16 v[68:71], a[96:99], v[92:95], v[68:71]
    ds_read_b128 v[112:115], v4 offset:11264
    v_mul_f32 v145, 986500301, v145
    v_mfma_f32_16x16x32_bf16 v[72:75], a[100:103], v[92:95], v[72:75]
    v_mul_f32 v149, 986500301, v149
    s_waitcnt vmcnt(10) lgkmcnt(4)
    v_mfma_f32_16x16x32_bf16 v[36:39], a[104:107], v[96:99], v[36:39]
    ds_read_b128 v[76:79], v4 offset:12288
    v_fma_f32 v145, -v144, v144, v145
    s_waitcnt vmcnt(9)
    v_mfma_f32_16x16x32_bf16 v[40:43], a[108:111], v[96:99], v[40:43]
    buffer_load_dwordx4 a[136:139], v6, s[4:7], s23 offen offset:2048 sc1
    v_fma_f32 v149, -v148, v148, v149
    s_waitcnt lgkmcnt(4)
    v_mfma_f32_16x16x32_bf16 v[44:47], a[104:107], v[100:103], v[44:47]
    ds_read_b128 v[80:83], v4 offset:13312
    v_max_f32 v145, 0, v145
    v_mfma_f32_16x16x32_bf16 v[48:51], a[108:111], v[100:103], v[48:51]
    v_max_f32 v149, 0, v149
    s_waitcnt lgkmcnt(4)
    v_mfma_f32_16x16x32_bf16 v[52:55], a[104:107], v[104:107], v[52:55]
    ds_read_b128 v[84:87], v4 offset:14336
    buffer_load_dwordx4 a[140:143], v7, s[4:7], s23 offen offset:2048 sc1
    v_add_f32 v145, 925353388, v145
    v_mfma_f32_16x16x32_bf16 v[56:59], a[108:111], v[104:107], v[56:59]
    v_add_f32 v149, 925353388, v149
    s_waitcnt lgkmcnt(4)
    v_mfma_f32_16x16x32_bf16 v[60:63], a[104:107], v[108:111], v[60:63]
    ds_read_b128 v[88:91], v4 offset:15360
    v_rsq_f32 v132, v145
    v_mfma_f32_16x16x32_bf16 v[64:67], a[108:111], v[108:111], v[64:67]
    buffer_load_dwordx4 v1, s[4:7], s87 offen offset:3072 lds
    v_rsq_f32 v133, v149
    s_waitcnt lgkmcnt(4)
    v_mfma_f32_16x16x32_bf16 v[68:71], a[104:107], v[112:115], v[68:71]
    ds_read_b128 v[92:95], v4 offset:16384
    v_mul_f32_e64 v134, -v144, v132
    v_mfma_f32_16x16x32_bf16 v[72:75], a[108:111], v[112:115], v[72:75]
    v_mul_f32_e64 v135, -v148, v133
    s_waitcnt vmcnt(11) lgkmcnt(4)
    v_mfma_f32_16x16x32_bf16 v[36:39], a[112:115], v[76:79], v[36:39]
    ds_read_b128 v[96:99], v4 offset:17408
    s_lshl_b32 s3, s16, 8
    s_waitcnt vmcnt(10)
    v_mfma_f32_16x16x32_bf16 v[40:43], a[116:119], v[76:79], v[40:43]
    buffer_load_dwordx4 a[144:147], v6, s[4:7], s24 offen offset:0 sc1
    v_add_u32 v154, s3, v13
    s_waitcnt lgkmcnt(4)
    v_mfma_f32_16x16x32_bf16 v[44:47], a[112:115], v[80:83], v[44:47]
    ds_read_b128 v[100:103], v4 offset:18432
    v_add_u32 v155, s3, v12
    v_mfma_f32_16x16x32_bf16 v[48:51], a[116:119], v[80:83], v[48:51]
    s_waitcnt lgkmcnt(4)
    v_mfma_f32_16x16x32_bf16 v[52:55], a[112:115], v[84:87], v[52:55]
    ds_read_b128 v[104:107], v4 offset:19456
    buffer_load_dwordx4 a[148:151], v7, s[4:7], s24 offen offset:0 sc1
    ds_write_b32 v154, v132 offset:2048
    v_mfma_f32_16x16x32_bf16 v[56:59], a[116:119], v[84:87], v[56:59]
    ds_write_b32 v154, v134 offset:2176
    s_waitcnt lgkmcnt(6)
    v_mfma_f32_16x16x32_bf16 v[60:63], a[112:115], v[88:91], v[60:63]
    ds_read_b128 v[108:111], v4 offset:20480
    v_mfma_f32_16x16x32_bf16 v[64:67], a[116:119], v[88:91], v[64:67]
    s_add_u32 s87, s97, s25
    s_add_u32 s86, s97, 16384
    s_add_u32 s87, s87, 16384
    s_mov_b32 m0, s86
    s_nop 0
    buffer_load_dwordx4 v1, s[4:7], s87 offen offset:0 lds
    ds_write_b32 v154, v133 offset:2112
    s_waitcnt lgkmcnt(7)
    v_mfma_f32_16x16x32_bf16 v[68:71], a[112:115], v[92:95], v[68:71]
    ds_read_b128 v[112:115], v4 offset:21504
    ds_write_b32 v154, v135 offset:2240
    v_mfma_f32_16x16x32_bf16 v[72:75], a[116:119], v[92:95], v[72:75]
    s_waitcnt vmcnt(11) lgkmcnt(8)
    v_mfma_f32_16x16x32_bf16 v[36:39], a[120:123], v[96:99], v[36:39]
    s_barrier
    s_waitcnt vmcnt(10)
    v_mfma_f32_16x16x32_bf16 v[40:43], a[124:127], v[96:99], v[40:43]
    ds_read_b128 v[76:79], v1 offset:51200
    ds_read_b128 v[116:119], v155 offset:2048
    s_waitcnt lgkmcnt(9)
    v_mfma_f32_16x16x32_bf16 v[44:47], a[120:123], v[100:103], v[44:47]
    ds_read_b128 v[80:83], v1 offset:52224
    buffer_load_dwordx4 a[152:155], v6, s[4:7], s24 offen offset:3072 sc1
    v_mfma_f32_16x16x32_bf16 v[48:51], a[124:127], v[100:103], v[48:51]
    ds_read_b128 v[84:87], v1 offset:53248
    s_waitcnt lgkmcnt(10)
    v_mfma_f32_16x16x32_bf16 v[52:55], a[120:123], v[104:107], v[52:55]
    ds_read_b128 v[88:91], v1 offset:54272
    v_mfma_f32_16x16x32_bf16 v[56:59], a[124:127], v[104:107], v[56:59]
    ds_read_b128 v[92:95], v1 offset:55296
    buffer_load_dwordx4 a[156:159], v7, s[4:7], s24 offen offset:3072 sc1
    ds_read_b128 v[120:123], v155 offset:2112
    s_waitcnt lgkmcnt(10)
    v_mfma_f32_16x16x32_bf16 v[60:63], a[120:123], v[108:111], v[60:63]
    v_mfma_f32_16x16x32_bf16 v[64:67], a[124:127], v[108:111], v[64:67]
    s_waitcnt lgkmcnt(8)
    v_mfma_f32_16x16x32_bf16 v[68:71], a[120:123], v[112:115], v[68:71]
    buffer_load_dwordx4 v1, s[4:7], s87 offen offset:1024 lds
    v_mfma_f32_16x16x32_bf16 v[72:75], a[124:127], v[112:115], v[72:75]
    s_waitcnt vmcnt(11) lgkmcnt(6)
    v_mfma_f32_16x16x32_bf16 v[36:39], a[128:131], v[76:79], v[36:39]
    ds_read_b128 v[96:99], v1 offset:56320
    ds_read_b128 v[124:127], v155 offset:2176
    s_waitcnt vmcnt(10)
    v_mfma_f32_16x16x32_bf16 v[40:43], a[132:135], v[76:79], v[40:43]
    ds_read_b128 v[128:131], v155 offset:2240
    s_waitcnt lgkmcnt(7)
    v_mfma_f32_16x16x32_bf16 v[44:47], a[128:131], v[80:83], v[44:47]
    ds_read_b128 v[100:103], v1 offset:57344
    v_mov_b32 v156, 897988541
    v_mfma_f32_16x16x32_bf16 v[48:51], a[132:135], v[80:83], v[48:51]
    s_waitcnt lgkmcnt(7)
    v_mfma_f32_16x16x32_bf16 v[52:55], a[128:131], v[84:87], v[52:55]
    ds_read_b128 v[104:107], v1 offset:58368
    buffer_load_dwordx4 v1, s[4:7], s87 offen offset:2048 lds
    v_mov_b32 v157, 1069066811
    v_mfma_f32_16x16x32_bf16 v[56:59], a[132:135], v[84:87], v[56:59]
    v_mov_b32 v160, 3049365963
    s_waitcnt lgkmcnt(7)
    v_mfma_f32_16x16x32_bf16 v[60:63], a[128:131], v[88:91], v[60:63]
    ds_read_b128 v[108:111], v1 offset:59392
    v_mfma_f32_16x16x32_bf16 v[64:67], a[132:135], v[88:91], v[64:67]
    v_mov_b32 v158, 0xc47a0000
    s_waitcnt lgkmcnt(7)
    v_mfma_f32_16x16x32_bf16 v[68:71], a[128:131], v[92:95], v[68:71]
    ds_read_b128 v[112:115], v1 offset:60416
    v_mov_b32 v159, 0xff800000
    v_mfma_f32_16x16x32_bf16 v[72:75], a[132:135], v[92:95], v[72:75]
    s_waitcnt vmcnt(9) lgkmcnt(6)
    v_mfma_f32_16x16x32_bf16 v[36:39], a[136:139], v[96:99], v[36:39]
    ds_read_b128 v[76:79], v1 offset:61440
    ds_read_b32 v136, v13 offset:0
    s_waitcnt vmcnt(8)
    v_mfma_f32_16x16x32_bf16 v[40:43], a[140:143], v[96:99], v[40:43]
    s_waitcnt lgkmcnt(5)
    v_mfma_f32_16x16x32_bf16 v[44:47], a[136:139], v[100:103], v[44:47]
    ds_read_b128 v[80:83], v1 offset:62464
    v_mfma_f32_16x16x32_bf16 v[48:51], a[140:143], v[100:103], v[48:51]
    ds_read_b32 v137, v13 offset:64
    s_waitcnt lgkmcnt(6)
    v_mfma_f32_16x16x32_bf16 v[52:55], a[136:139], v[104:107], v[52:55]
    ds_read_b128 v[84:87], v1 offset:63488
    buffer_load_dwordx4 v1, s[4:7], s87 offen offset:3072 lds
    v_mfma_f32_16x16x32_bf16 v[56:59], a[140:143], v[104:107], v[56:59]
    s_waitcnt lgkmcnt(6)
    v_mfma_f32_16x16x32_bf16 v[60:63], a[136:139], v[108:111], v[60:63]
    ds_read_b128 v[88:91], v1 offset:64512
    ds_read_b32 v138, v13 offset:128
    v_mfma_f32_16x16x32_bf16 v[64:67], a[140:143], v[108:111], v[64:67]
    s_waitcnt lgkmcnt(7)
    v_mfma_f32_16x16x32_bf16 v[68:71], a[136:139], v[112:115], v[68:71]
    ds_read_b128 v[92:95], v3 offset:0
    v_mfma_f32_16x16x32_bf16 v[72:75], a[140:143], v[112:115], v[72:75]
    s_waitcnt vmcnt(7) lgkmcnt(7)
    v_mfma_f32_16x16x32_bf16 v[36:39], a[144:147], v[76:79], v[36:39]
    ds_read_b128 v[96:99], v3 offset:1024
    ds_read_b32 v139, v13 offset:192
    s_waitcnt vmcnt(6)
    v_mfma_f32_16x16x32_bf16 v[40:43], a[148:151], v[76:79], v[40:43]
    ds_read_b32 v140, v13 offset:256
    s_waitcnt lgkmcnt(8)
    v_mfma_f32_16x16x32_bf16 v[44:47], a[144:147], v[80:83], v[44:47]
    ds_read_b128 v[100:103], v3 offset:2048
    v_mfma_f32_16x16x32_bf16 v[48:51], a[148:151], v[80:83], v[48:51]
    v_cndmask_b32 v159, v159, v156, s[50:51]
    s_waitcnt lgkmcnt(7)
    v_mfma_f32_16x16x32_bf16 v[52:55], a[144:147], v[84:87], v[52:55]
    ds_read_b128 v[104:107], v3 offset:3072
    s_add_u32 s87, s97, s25
    s_add_u32 s86, s97, 32768
    s_add_u32 s87, s87, 32768
    s_mov_b32 m0, s86
    s_nop 0
    buffer_load_dwordx4 v1, s[4:7], s87 offen offset:0 lds
    v_mfma_f32_16x16x32_bf16 v[56:59], a[148:151], v[84:87], v[56:59]
    v_cndmask_b32 v156, 0, v156, s[50:51]
    s_waitcnt lgkmcnt(7)
    v_mfma_f32_16x16x32_bf16 v[60:63], a[144:147], v[88:91], v[60:63]
    ds_read_b128 v[108:111], v3 offset:4096
    v_cndmask_b32 v157, 0, v157, s[50:51]
    v_mfma_f32_16x16x32_bf16 v[64:67], a[148:151], v[88:91], v[64:67]
    s_waitcnt lgkmcnt(6)
    v_mfma_f32_16x16x32_bf16 v[68:71], a[144:147], v[92:95], v[68:71]
    ds_read_b128 v[112:115], v3 offset:5120
    v_cndmask_b32 v158, v158, v160, s[50:51]
    v_mfma_f32_16x16x32_bf16 v[72:75], a[148:151], v[92:95], v[72:75]
    s_waitcnt vmcnt(5) lgkmcnt(6)
    v_mfma_f32_16x16x32_bf16 v[36:39], a[152:155], v[96:99], v[36:39]
    v_mov_b32 v161, 3049365963
    s_waitcnt vmcnt(4)
    v_mfma_f32_16x16x32_bf16 v[40:43], a[156:159], v[96:99], v[40:43]
    s_waitcnt lgkmcnt(3)
    v_mfma_f32_16x16x32_bf16 v[44:47], a[152:155], v[100:103], v[44:47]
    v_mfma_f32_16x16x32_bf16 v[48:51], a[156:159], v[100:103], v[48:51]
    s_waitcnt lgkmcnt(2)
    v_mfma_f32_16x16x32_bf16 v[52:55], a[152:155], v[104:107], v[52:55]
    v_mfma_f32_16x16x32_bf16 v[56:59], a[156:159], v[104:107], v[56:59]
    v_mov_b32 v160, 0x3f803f80
    s_waitcnt lgkmcnt(1)
    v_mfma_f32_16x16x32_bf16 v[60:63], a[152:155], v[108:111], v[60:63]
    v_mfma_f32_16x16x32_bf16 v[64:67], a[156:159], v[108:111], v[64:67]
    s_waitcnt lgkmcnt(0)
    v_mfma_f32_16x16x32_bf16 v[68:71], a[152:155], v[112:115], v[68:71]
    v_mfma_f32_16x16x32_bf16 v[72:75], a[156:159], v[112:115], v[72:75]
    v_pk_fma_f32 v[144:145], v[124:125], v[136:137], s[76:77] op_sel:[0,0,0] op_sel_hi:[1,0,1]
    v_pk_fma_f32 v[148:149], v[128:129], v[136:137], s[76:77] op_sel:[0,0,0] op_sel_hi:[1,0,1]
    buffer_load_dwordx4 v1, s[4:7], s87 offen offset:1024 lds
    v_pk_fma_f32 v[146:147], v[126:127], v[136:137], s[76:77] op_sel:[0,0,0] op_sel_hi:[1,0,1]
    v_pk_fma_f32 v[150:151], v[130:131], v[136:137], s[76:77] op_sel:[0,0,0] op_sel_hi:[1,0,1]
    v_pk_fma_f32 v[36:37], v[36:37], v[116:117], v[144:145] op_sel:[0,0,0] op_sel_hi:[1,1,1]
    v_pk_fma_f32 v[40:41], v[40:41], v[120:121], v[148:149] op_sel:[0,0,0] op_sel_hi:[1,1,1]
    v_pk_fma_f32 v[38:39], v[38:39], v[118:119], v[146:147] op_sel:[0,0,0] op_sel_hi:[1,1,1]
    v_pk_fma_f32 v[42:43], v[42:43], v[122:123], v[150:151] op_sel:[0,0,0] op_sel_hi:[1,1,1]
    v_pk_fma_f32 v[144:145], v[36:37], s[78:79], v[160:161] op_sel:[0,0,1] op_sel_hi:[1,1,1]
    v_pk_fma_f32 v[148:149], v[40:41], s[78:79], v[160:161] op_sel:[0,0,1] op_sel_hi:[1,1,1]
    v_pk_fma_f32 v[146:147], v[38:39], s[78:79], v[160:161] op_sel:[0,0,1] op_sel_hi:[1,1,1]
    v_pk_fma_f32 v[150:151], v[42:43], s[78:79], v[160:161] op_sel:[0,0,1] op_sel_hi:[1,1,1]
    v_exp_f32_e64 v144, v144 clamp
    v_exp_f32_e64 v148, v148 clamp
    v_exp_f32_e64 v145, v145 clamp
    v_exp_f32_e64 v149, v149 clamp
    v_exp_f32_e64 v146, v146 clamp
    v_exp_f32_e64 v150, v150 clamp
    v_exp_f32_e64 v147, v147 clamp
    v_exp_f32_e64 v151, v151 clamp
    v_max_f32 v36, s76, v36
    v_max_f32 v40, s76, v40
    v_max_f32 v37, s76, v37
    v_max_f32 v41, s76, v41
    v_max_f32 v38, s76, v38
    v_max_f32 v42, s76, v42
    v_max_f32 v39, s76, v39
    v_max_f32_e64 v43, s76, v43
    v_pk_add_f32 v[36:37], v[36:37], v[144:145] op_sel:[0,0] op_sel_hi:[1,1]
    v_pk_add_f32 v[40:41], v[40:41], v[148:149] op_sel:[0,0] op_sel_hi:[1,1]
    v_pk_add_f32 v[38:39], v[38:39], v[146:147] op_sel:[0,0] op_sel_hi:[1,1]
    buffer_load_dwordx4 v1, s[4:7], s87 offen offset:2048 lds
    v_pk_add_f32 v[42:43], v[42:43], v[150:151] op_sel:[0,0] op_sel_hi:[1,1]
    v_cvt_pk_bf16_f32 v76, v36, v37
    v_cvt_pk_bf16_f32 v78, v40, v41
    v_cvt_pk_bf16_f32 v77, v38, v39
    v_cvt_pk_bf16_f32 v79, v42, v43
    v_pk_fma_f32 v[144:145], v[124:125], v[136:137], s[76:77] op_sel:[0,1,0] op_sel_hi:[1,1,1]
    v_pk_fma_f32 v[148:149], v[128:129], v[136:137], s[76:77] op_sel:[0,1,0] op_sel_hi:[1,1,1]
    v_pk_fma_f32 v[146:147], v[126:127], v[136:137], s[76:77] op_sel:[0,1,0] op_sel_hi:[1,1,1]
    v_pk_fma_f32 v[150:151], v[130:131], v[136:137], s[76:77] op_sel:[0,1,0] op_sel_hi:[1,1,1]
    v_pk_fma_f32 v[44:45], v[44:45], v[116:117], v[144:145] op_sel:[0,0,0] op_sel_hi:[1,1,1]
    v_pk_fma_f32 v[48:49], v[48:49], v[120:121], v[148:149] op_sel:[0,0,0] op_sel_hi:[1,1,1]
    v_pk_fma_f32 v[46:47], v[46:47], v[118:119], v[146:147] op_sel:[0,0,0] op_sel_hi:[1,1,1]
    v_pk_fma_f32 v[50:51], v[50:51], v[122:123], v[150:151] op_sel:[0,0,0] op_sel_hi:[1,1,1]
    v_pk_fma_f32 v[144:145], v[44:45], s[78:79], v[160:161] op_sel:[0,0,1] op_sel_hi:[1,1,1]
    v_pk_fma_f32 v[148:149], v[48:49], s[78:79], v[160:161] op_sel:[0,0,1] op_sel_hi:[1,1,1]
    v_pk_fma_f32 v[146:147], v[46:47], s[78:79], v[160:161] op_sel:[0,0,1] op_sel_hi:[1,1,1]
    v_pk_fma_f32 v[150:151], v[50:51], s[78:79], v[160:161] op_sel:[0,0,1] op_sel_hi:[1,1,1]
    v_exp_f32_e64 v144, v144 clamp
    v_exp_f32_e64 v148, v148 clamp
    v_exp_f32_e64 v145, v145 clamp
    v_exp_f32_e64 v149, v149 clamp
    v_exp_f32_e64 v146, v146 clamp
    v_exp_f32_e64 v150, v150 clamp
    v_exp_f32_e64 v147, v147 clamp
    v_exp_f32_e64 v151, v151 clamp
    v_max_f32 v44, s76, v44
    v_max_f32 v48, s76, v48
    v_max_f32 v45, s76, v45
    v_max_f32 v49, s76, v49
    buffer_load_dwordx4 v1, s[4:7], s87 offen offset:3072 lds
    v_max_f32 v46, s76, v46
    v_max_f32 v50, s76, v50
    v_max_f32 v47, s76, v47
    v_max_f32 v51, s76, v51
    v_pk_add_f32 v[44:45], v[44:45], v[144:145] op_sel:[0,0] op_sel_hi:[1,1]
    v_pk_add_f32 v[48:49], v[48:49], v[148:149] op_sel:[0,0] op_sel_hi:[1,1]
    v_pk_add_f32 v[46:47], v[46:47], v[146:147] op_sel:[0,0] op_sel_hi:[1,1]
    v_pk_add_f32 v[50:51], v[50:51], v[150:151] op_sel:[0,0] op_sel_hi:[1,1]
    v_cvt_pk_bf16_f32 v80, v44, v45
    v_cvt_pk_bf16_f32 v82, v48, v49
    v_cvt_pk_bf16_f32 v81, v46, v47
    v_cvt_pk_bf16_f32 v83, v50, v51
    v_pk_fma_f32 v[144:145], v[124:125], v[140:141], v[156:157] op_sel:[0,0,0] op_sel_hi:[1,0,0]
    v_pk_fma_f32 v[148:149], v[128:129], v[140:141], v[156:157] op_sel:[0,0,0] op_sel_hi:[1,0,0]
    v_pk_fma_f32 v[146:147], v[126:127], v[140:141], v[156:157] op_sel:[0,0,0] op_sel_hi:[1,0,0]
    v_pk_fma_f32 v[150:151], v[130:131], v[140:141], v[156:157] op_sel:[0,0,0] op_sel_hi:[1,0,0]
    v_pk_fma_f32 v[68:69], v[68:69], v[116:117], v[144:145] op_sel:[0,0,0] op_sel_hi:[1,1,1]
    v_pk_fma_f32 v[72:73], v[72:73], v[120:121], v[148:149] op_sel:[0,0,0] op_sel_hi:[1,1,1]
    v_pk_fma_f32 v[70:71], v[70:71], v[118:119], v[146:147] op_sel:[0,0,0] op_sel_hi:[1,1,1]
    v_pk_fma_f32 v[74:75], v[74:75], v[122:123], v[150:151] op_sel:[0,0,0] op_sel_hi:[1,1,1]
    v_pk_fma_f32 v[144:145], v[68:69], v[156:157], v[158:159] op_sel:[0,1,0] op_sel_hi:[1,1,0]
    v_pk_fma_f32 v[148:149], v[72:73], v[156:157], v[158:159] op_sel:[0,1,0] op_sel_hi:[1,1,0]
    v_pk_fma_f32 v[146:147], v[70:71], v[156:157], v[158:159] op_sel:[0,1,0] op_sel_hi:[1,1,0]
    v_pk_fma_f32 v[150:151], v[74:75], v[156:157], v[158:159] op_sel:[0,1,0] op_sel_hi:[1,1,0]
    v_exp_f32_e64 v144, v144 clamp
    v_exp_f32_e64 v148, v148 clamp
    v_exp_f32_e64 v145, v145 clamp
    v_exp_f32_e64 v149, v149 clamp
    v_exp_f32_e64 v146, v146 clamp
    s_add_u32 s87, s94, s25
    s_add_u32 s86, s94, 47104
    s_add_u32 s87, s87, 47104
    s_mov_b32 m0, s86
    s_nop 0
    buffer_load_dwordx4 v1, s[4:7], s87 offen offset:0 lds
    v_exp_f32_e64 v150, v150 clamp
    v_exp_f32_e64 v147, v147 clamp
    v_exp_f32_e64 v151, v151 clamp
    v_max_f32 v68, v159, v68
    v_max_f32 v72, v159, v72
    v_max_f32 v69, v159, v69
    v_max_f32 v73, v159, v73
    v_max_f32 v70, v159, v70
    v_max_f32 v74, v159, v74
    v_max_f32 v71, v159, v71
    v_max_f32_e64 v75, v159, v75
    v_pk_add_f32 v[68:69], v[68:69], v[144:145] op_sel:[0,0] op_sel_hi:[1,1]
    v_pk_add_f32 v[72:73], v[72:73], v[148:149] op_sel:[0,0] op_sel_hi:[1,1]
    v_pk_add_f32 v[70:71], v[70:71], v[146:147] op_sel:[0,0] op_sel_hi:[1,1]
    v_pk_add_f32 v[74:75], v[74:75], v[150:151] op_sel:[0,0] op_sel_hi:[1,1]
    v_cvt_pk_bf16_f32 v92, v68, v69
    v_cvt_pk_bf16_f32 v94, v72, v73
    v_cvt_pk_bf16_f32 v93, v70, v71
    v_cvt_pk_bf16_f32 v95, v74, v75
    v_cndmask_b32 v96, v92, v160, s[50:51]
    v_cndmask_b32 v97, v93, v160, s[50:51]
    v_cndmask_b32 v98, v94, v160, s[50:51]
    v_cndmask_b32 v99, v95, v160, s[50:51]
    s_nop 1
    v_mfma_f32_16x16x32_bf16 v[100:103], v[76:79], v[96:99], 0
    v_mfma_f32_16x16x32_bf16 v[104:107], v[80:83], v[96:99], 0
    v_mfma_f32_16x16x32_bf16 v[108:111], v[92:95], v[96:99], 0
    v_pk_mul_f32 v[144:145], v[124:125], v[138:139] op_sel:[0,0] op_sel_hi:[1,0]
    v_pk_mul_f32 v[148:149], v[128:129], v[138:139] op_sel:[0,0] op_sel_hi:[1,0]
    v_pk_mul_f32 v[146:147], v[126:127], v[138:139] op_sel:[0,0] op_sel_hi:[1,0]
    s_lshl_b32 s3, s18, 1
    s_and_b32 s101, s16, 1
    s_add_u32 s3, s3, s101
    s_mul_i32 s3, s3, 2816
    s_lshr_b32 s101, s16, 1
    s_lshl1_add_u32 s101, s17, s101
    s_mul_i32 s101, s101, 221184
    s_add_u32 s3, s3, s101
    s_add_u32 s3, s3, 13762560
    v_min_u32 v35, 84, v2
    v_lshlrev_b32 v35, 5, v35
    s_mov_b32 s101, 156672
    s_mov_b32 m0, s101
    s_nop 0
    buffer_load_dword v35, s[4:7], s3 offen lds
    v_pk_mul_f32 v[150:151], v[130:131], v[138:139] op_sel:[0,0] op_sel_hi:[1,0]
    v_pk_fma_f32 v[52:53], v[52:53], v[116:117], v[144:145] op_sel:[0,0,0] op_sel_hi:[1,1,1]
    v_pk_fma_f32 v[56:57], v[56:57], v[120:121], v[148:149] op_sel:[0,0,0] op_sel_hi:[1,1,1]
    v_pk_fma_f32 v[54:55], v[54:55], v[118:119], v[146:147] op_sel:[0,0,0] op_sel_hi:[1,1,1]
    v_pk_fma_f32 v[58:59], v[58:59], v[122:123], v[150:151] op_sel:[0,0,0] op_sel_hi:[1,1,1]
    v_cvt_pk_bf16_f32 v84, v52, v53
    v_cvt_pk_bf16_f32 v86, v56, v57
    v_cvt_pk_bf16_f32 v85, v54, v55
    v_cvt_pk_bf16_f32 v87, v58, v59
    s_nop 1
    v_mfma_f32_16x16x32_bf16 v[36:39], v[76:79], v[84:87], 0
    v_mfma_f32_16x16x32_bf16 v[40:43], v[92:95], v[84:87], 0
    v_pk_mul_f32 v[144:145], v[124:125], v[138:139] op_sel:[0,1] op_sel_hi:[1,1]
    v_pk_mul_f32 v[148:149], v[128:129], v[138:139] op_sel:[0,1] op_sel_hi:[1,1]
    v_pk_mul_f32 v[146:147], v[126:127], v[138:139] op_sel:[0,1] op_sel_hi:[1,1]
    v_pk_mul_f32 v[150:151], v[130:131], v[138:139] op_sel:[0,1] op_sel_hi:[1,1]
    v_pk_fma_f32 v[60:61], v[60:61], v[116:117], v[144:145] op_sel:[0,0,0] op_sel_hi:[1,1,1]
    v_pk_fma_f32 v[64:65], v[64:65], v[120:121], v[148:149] op_sel:[0,0,0] op_sel_hi:[1,1,1]
    v_pk_fma_f32 v[62:63], v[62:63], v[118:119], v[146:147] op_sel:[0,0,0] op_sel_hi:[1,1,1]
    v_pk_fma_f32 v[66:67], v[66:67], v[122:123], v[150:151] op_sel:[0,0,0] op_sel_hi:[1,1,1]
    v_cvt_pk_bf16_f32 v88, v60, v61
    v_cvt_pk_bf16_f32 v90, v64, v65
    v_cvt_pk_bf16_f32 v89, v62, v63
    v_cvt_pk_bf16_f32 v91, v66, v67
    s_nop 1
    v_mfma_f32_16x16x32_bf16 v[44:47], v[80:83], v[88:91], 0
    v_mfma_f32_16x16x32_bf16 v[48:51], v[92:95], v[88:91], 0
    v_cndmask_b32 v161, v100, v104, s[48:49]
    v_cndmask_b32 v162, v101, v105, s[48:49]
    v_cndmask_b32 v164, v102, v106, s[48:49]
    v_cndmask_b32 v165, v103, v107, s[48:49]
    v_cndmask_b32 v166, v108, v109, s[48:49]
    v_mov_b32 v167, 0x3e800000
    ds_write_b128 v33, v[164:167] offset:4096
    v_mov_b32 v151, 0x3e800000
    v_mov_b32 v155, 0x3e800000
    v_mov_b32 v159, 0x3e800000
    v_mov_b32 v163, 0x3e800000
    v_mov_b32 v148, v36
    v_mov_b32 v149, v37
    v_mov_b32 v150, v38
    ds_write_b128 v33, v[148:151]
    v_mov_b32 v152, v39
    v_mov_b32 v153, v40
    v_mov_b32 v154, v44
    ds_write_b128 v33, v[152:155] offset:1024
    v_mov_b32 v156, v45
    v_mov_b32 v157, v46
    v_mov_b32 v158, v47
    ds_write_b128 v33, v[156:159] offset:2048
    v_mov_b32 v160, v49
    ds_write_b128 v33, v[160:163] offset:3072
    s_waitcnt lgkmcnt(0)
    s_waitcnt vmcnt(1)
    s_barrier
    ds_read_b32 v100, v34 offset:0
    ds_read_b32 v101, v34 offset:5120
    ds_read_b32 v102, v34 offset:10240
    ds_read_b32 v103, v34 offset:15360
    ds_read_b32 v104, v34 offset:256
    ds_read_b32 v105, v34 offset:5376
    ds_read_b32 v106, v34 offset:10496
    ds_read_b32 v107, v34 offset:15616
    ds_read_b32 v108, v34 offset:512
    ds_read_b32 v109, v34 offset:5632
    ds_read_b32 v110, v34 offset:10752
    ds_read_b32 v111, v34 offset:15872
    ds_read_b32 v112, v34 offset:768
    ds_read_b32 v113, v34 offset:5888
    ds_read_b32 v114, v34 offset:11008
    ds_read_b32 v115, v34 offset:16128
    ds_read_b32 v116, v34 offset:1024
    ds_read_b32 v117, v34 offset:6144
    ds_read_b32 v118, v34 offset:11264
    ds_read_b32 v119, v34 offset:16384
    v_pk_add_f32 v[100:101], v[100:101], v[102:103] op_sel:[0,0] op_sel_hi:[1,1]
    v_add_f32 v100, v100, v101
    buffer_atomic_add_f32 v100, v2, s[4:7], s47 offen offset:0
    s_waitcnt lgkmcnt(12)
    v_pk_add_f32 v[104:105], v[104:105], v[106:107] op_sel:[0,0] op_sel_hi:[1,1]
    v_add_f32 v104, v104, v105
    buffer_atomic_add_f32 v104, v2, s[4:7], s47 offen offset:256
    s_waitcnt lgkmcnt(8)
    v_pk_add_f32 v[108:109], v[108:109], v[110:111] op_sel:[0,0] op_sel_hi:[1,1]
    v_add_f32 v108, v108, v109
    buffer_atomic_add_f32 v108, v2, s[4:7], s47 offen offset:512
    s_waitcnt lgkmcnt(4)
    v_pk_add_f32 v[112:113], v[112:113], v[114:115] op_sel:[0,0] op_sel_hi:[1,1]
    v_add_f32 v112, v112, v113
    buffer_atomic_add_f32 v112, v2, s[4:7], s47 offen offset:768
    s_waitcnt lgkmcnt(0)
    v_pk_add_f32 v[116:117], v[116:117], v[118:119] op_sel:[0,0] op_sel_hi:[1,1]
    v_add_f32 v116, v116, v117
    buffer_atomic_add_f32 v116, v2, s[4:7], s47 offen offset:1024
    ds_read_b128 v[76:79], v1 offset:0
    ds_read_b128 v[80:83], v1 offset:1024
    ds_read_b128 v[84:87], v5 offset:2048
    s_waitcnt lgkmcnt(2)
    v_mfma_f32_16x16x32_bf16 v[36:39], v[76:79], a[152:155], 0
    ds_read_b128 v[88:91], v1 offset:2560
    v_mfma_f32_16x16x32_bf16 v[40:43], v[76:79], a[156:159], 0
    s_waitcnt lgkmcnt(2)
    v_mfma_f32_16x16x32_bf16 v[44:47], v[80:83], a[152:155], 0
    ds_read_b128 v[92:95], v1 offset:3584
    v_mfma_f32_16x16x32_bf16 v[48:51], v[80:83], a[156:159], 0
    s_waitcnt lgkmcnt(2)
    v_mfma_f32_16x16x32_bf16 v[52:55], v[84:87], a[152:155], 0
    ds_read_b128 v[96:99], v5 offset:4608
    v_mfma_f32_16x16x32_bf16 v[56:59], v[84:87], a[156:159], 0
    s_waitcnt lgkmcnt(2)
    v_mfma_f32_16x16x32_bf16 v[36:39], v[88:91], a[144:147], v[36:39]
    ds_read_b128 v[76:79], v1 offset:5120
    v_mfma_f32_16x16x32_bf16 v[40:43], v[88:91], a[148:151], v[40:43]
    s_add_u32 s68, s27, 0
    buffer_load_dwordx4 a[156:159], v1, s[4:7], s68 offen offset:0
    s_waitcnt lgkmcnt(2)
    v_mfma_f32_16x16x32_bf16 v[44:47], v[92:95], a[144:147], v[44:47]
    ds_read_b128 v[80:83], v1 offset:6144
    v_mfma_f32_16x16x32_bf16 v[48:51], v[92:95], a[148:151], v[48:51]
    s_waitcnt lgkmcnt(2)
    v_mfma_f32_16x16x32_bf16 v[52:55], v[96:99], a[144:147], v[52:55]
    ds_read_b128 v[84:87], v5 offset:7168
    buffer_load_dwordx4 a[152:155], v1, s[4:7], s68 offen offset:1024
    v_mfma_f32_16x16x32_bf16 v[56:59], v[96:99], a[148:151], v[56:59]
    s_waitcnt lgkmcnt(2)
    v_mfma_f32_16x16x32_bf16 v[36:39], v[76:79], a[136:139], v[36:39]
    ds_read_b128 v[88:91], v1 offset:7680
    v_mfma_f32_16x16x32_bf16 v[40:43], v[76:79], a[140:143], v[40:43]
    buffer_load_dwordx4 a[148:151], v1, s[4:7], s68 offen offset:2048
    s_waitcnt lgkmcnt(2)
    v_mfma_f32_16x16x32_bf16 v[44:47], v[80:83], a[136:139], v[44:47]
    ds_read_b128 v[92:95], v1 offset:8704
    v_mfma_f32_16x16x32_bf16 v[48:51], v[80:83], a[140:143], v[48:51]
    s_waitcnt lgkmcnt(2)
    v_mfma_f32_16x16x32_bf16 v[52:55], v[84:87], a[136:139], v[52:55]
    ds_read_b128 v[96:99], v5 offset:9728
    buffer_load_dwordx4 a[144:147], v1, s[4:7], s68 offen offset:3072
    v_mfma_f32_16x16x32_bf16 v[56:59], v[84:87], a[140:143], v[56:59]
    s_waitcnt lgkmcnt(2)
    v_mfma_f32_16x16x32_bf16 v[36:39], v[88:91], a[128:131], v[36:39]
    ds_read_b128 v[76:79], v1 offset:10240
    v_mfma_f32_16x16x32_bf16 v[40:43], v[88:91], a[132:135], v[40:43]
    s_waitcnt lgkmcnt(2)
    v_mfma_f32_16x16x32_bf16 v[44:47], v[92:95], a[128:131], v[44:47]
    ds_read_b128 v[80:83], v1 offset:11264
    s_add_u32 s68, s27, 4096
    buffer_load_dwordx4 a[140:143], v1, s[4:7], s68 offen offset:0
    v_mfma_f32_16x16x32_bf16 v[48:51], v[92:95], a[132:135], v[48:51]
    s_waitcnt lgkmcnt(2)
    v_mfma_f32_16x16x32_bf16 v[52:55], v[96:99], a[128:131], v[52:55]
    ds_read_b128 v[84:87], v5 offset:12288
    v_mfma_f32_16x16x32_bf16 v[56:59], v[96:99], a[132:135], v[56:59]
    s_waitcnt lgkmcnt(2)
    v_mfma_f32_16x16x32_bf16 v[36:39], v[76:79], a[120:123], v[36:39]
    s_barrier
    v_mfma_f32_16x16x32_bf16 v[40:43], v[76:79], a[124:127], v[40:43]
    ds_read_b128 v[88:91], v1 offset:12800
    buffer_load_dwordx4 a[136:139], v1, s[4:7], s68 offen offset:1024
    s_waitcnt lgkmcnt(2)
    v_mfma_f32_16x16x32_bf16 v[44:47], v[80:83], a[120:123], v[44:47]
    ds_read_b128 v[92:95], v1 offset:13824
    v_mfma_f32_16x16x32_bf16 v[48:51], v[80:83], a[124:127], v[48:51]
    ds_read_b128 v[96:99], v5 offset:14848
    s_waitcnt lgkmcnt(3)
    v_mfma_f32_16x16x32_bf16 v[52:55], v[84:87], a[120:123], v[52:55]
    buffer_load_dwordx4 a[132:135], v1, s[4:7], s68 offen offset:2048
    v_mfma_f32_16x16x32_bf16 v[56:59], v[84:87], a[124:127], v[56:59]
    s_waitcnt lgkmcnt(2)
    v_mfma_f32_16x16x32_bf16 v[36:39], v[88:91], a[112:115], v[36:39]
    ds_read_b128 v[76:79], v1 offset:15360
    v_mfma_f32_16x16x32_bf16 v[40:43], v[88:91], a[116:119], v[40:43]
    buffer_load_dwordx4 a[128:131], v1, s[4:7], s68 offen offset:3072
    s_waitcnt lgkmcnt(2)
    v_mfma_f32_16x16x32_bf16 v[44:47], v[92:95], a[112:115], v[44:47]
    ds_read_b128 v[80:83], v1 offset:16384
    v_mfma_f32_16x16x32_bf16 v[48:51], v[92:95], a[116:119], v[48:51]
    s_waitcnt lgkmcnt(2)
    v_mfma_f32_16x16x32_bf16 v[52:55], v[96:99], a[112:115], v[52:55]
    ds_read_b128 v[84:87], v5 offset:17408
    s_add_u32 s68, s27, 8192
    buffer_load_dwordx4 a[124:127], v1, s[4:7], s68 offen offset:0
    v_mfma_f32_16x16x32_bf16 v[56:59], v[96:99], a[116:119], v[56:59]
    s_waitcnt lgkmcnt(2)
    v_mfma_f32_16x16x32_bf16 v[36:39], v[76:79], a[104:107], v[36:39]
    ds_read_b128 v[88:91], v1 offset:17920
    v_mfma_f32_16x16x32_bf16 v[40:43], v[76:79], a[108:111], v[40:43]
    s_waitcnt lgkmcnt(2)
    v_mfma_f32_16x16x32_bf16 v[44:47], v[80:83], a[104:107], v[44:47]
    ds_read_b128 v[92:95], v1 offset:18944
    buffer_load_dwordx4 a[120:123], v1, s[4:7], s68 offen offset:1024
    v_mfma_f32_16x16x32_bf16 v[48:51], v[80:83], a[108:111], v[48:51]
    s_waitcnt lgkmcnt(2)
    v_mfma_f32_16x16x32_bf16 v[52:55], v[84:87], a[104:107], v[52:55]
    ds_read_b128 v[96:99], v5 offset:19968
    v_mfma_f32_16x16x32_bf16 v[56:59], v[84:87], a[108:111], v[56:59]
    s_waitcnt lgkmcnt(2)
    v_mfma_f32_16x16x32_bf16 v[36:39], v[88:91], a[96:99], v[36:39]
    ds_read_b128 v[76:79], v1 offset:20480
    v_mfma_f32_16x16x32_bf16 v[40:43], v[88:91], a[100:103], v[40:43]
    buffer_load_dwordx4 a[116:119], v1, s[4:7], s68 offen offset:2048
    s_waitcnt lgkmcnt(2)
    v_mfma_f32_16x16x32_bf16 v[44:47], v[92:95], a[96:99], v[44:47]
    ds_read_b128 v[80:83], v1 offset:21504
    v_mfma_f32_16x16x32_bf16 v[48:51], v[92:95], a[100:103], v[48:51]
    s_waitcnt lgkmcnt(2)
    v_mfma_f32_16x16x32_bf16 v[52:55], v[96:99], a[96:99], v[52:55]
    ds_read_b128 v[84:87], v5 offset:22528
    buffer_load_dwordx4 a[112:115], v1, s[4:7], s68 offen offset:3072
    v_mfma_f32_16x16x32_bf16 v[56:59], v[96:99], a[100:103], v[56:59]
    s_waitcnt lgkmcnt(2)
    v_mfma_f32_16x16x32_bf16 v[36:39], v[76:79], a[88:91], v[36:39]
    ds_read_b128 v[88:91], v1 offset:23040
    v_mfma_f32_16x16x32_bf16 v[40:43], v[76:79], a[92:95], v[40:43]
    s_add_u32 s68, s27, 12288
    buffer_load_dwordx4 a[108:111], v1, s[4:7], s68 offen offset:0
    s_waitcnt lgkmcnt(2)
    v_mfma_f32_16x16x32_bf16 v[44:47], v[80:83], a[88:91], v[44:47]
    ds_read_b128 v[92:95], v1 offset:24064
    v_mfma_f32_16x16x32_bf16 v[48:51], v[80:83], a[92:95], v[48:51]
    s_waitcnt lgkmcnt(2)
    v_mfma_f32_16x16x32_bf16 v[52:55], v[84:87], a[88:91], v[52:55]
    ds_read_b128 v[96:99], v5 offset:25088
    buffer_load_dwordx4 a[104:107], v1, s[4:7], s68 offen offset:1024
    v_mfma_f32_16x16x32_bf16 v[56:59], v[84:87], a[92:95], v[56:59]
    s_waitcnt lgkmcnt(2)
    v_mfma_f32_16x16x32_bf16 v[36:39], v[88:91], a[80:83], v[36:39]
    ds_read_b128 v[76:79], v1 offset:25600
    v_mfma_f32_16x16x32_bf16 v[40:43], v[88:91], a[84:87], v[40:43]
    s_waitcnt lgkmcnt(2)
    v_mfma_f32_16x16x32_bf16 v[44:47], v[92:95], a[80:83], v[44:47]
    ds_read_b128 v[80:83], v1 offset:26624
    buffer_load_dwordx4 a[100:103], v1, s[4:7], s68 offen offset:2048
    v_mfma_f32_16x16x32_bf16 v[48:51], v[92:95], a[84:87], v[48:51]
    s_waitcnt lgkmcnt(2)
    v_mfma_f32_16x16x32_bf16 v[52:55], v[96:99], a[80:83], v[52:55]
    ds_read_b128 v[84:87], v5 offset:27648
    v_mfma_f32_16x16x32_bf16 v[56:59], v[96:99], a[84:87], v[56:59]
    s_waitcnt lgkmcnt(2)
    v_mfma_f32_16x16x32_bf16 v[36:39], v[76:79], a[72:75], v[36:39]
    ds_read_b128 v[88:91], v1 offset:28160
    v_mfma_f32_16x16x32_bf16 v[40:43], v[76:79], a[76:79], v[40:43]
    buffer_load_dwordx4 a[96:99], v1, s[4:7], s68 offen offset:3072
    s_waitcnt lgkmcnt(2)
    v_mfma_f32_16x16x32_bf16 v[44:47], v[80:83], a[72:75], v[44:47]
    ds_read_b128 v[92:95], v1 offset:29184
    v_mfma_f32_16x16x32_bf16 v[48:51], v[80:83], a[76:79], v[48:51]
    s_waitcnt lgkmcnt(2)
    v_mfma_f32_16x16x32_bf16 v[52:55], v[84:87], a[72:75], v[52:55]
    ds_read_b128 v[96:99], v5 offset:30208
    s_add_u32 s68, s27, 16384
    buffer_load_dwordx4 a[92:95], v1, s[4:7], s68 offen offset:0
    v_mfma_f32_16x16x32_bf16 v[56:59], v[84:87], a[76:79], v[56:59]
    s_waitcnt lgkmcnt(2)
    v_mfma_f32_16x16x32_bf16 v[36:39], v[88:91], a[64:67], v[36:39]
    ds_read_b128 v[76:79], v1 offset:30720
    v_mfma_f32_16x16x32_bf16 v[40:43], v[88:91], a[68:71], v[40:43]
    buffer_load_dwordx4 a[88:91], v1, s[4:7], s68 offen offset:1024
    s_waitcnt lgkmcnt(2)
    v_mfma_f32_16x16x32_bf16 v[44:47], v[92:95], a[64:67], v[44:47]
    ds_read_b128 v[80:83], v1 offset:31744
    v_mfma_f32_16x16x32_bf16 v[48:51], v[92:95], a[68:71], v[48:51]
    s_waitcnt lgkmcnt(2)
    v_mfma_f32_16x16x32_bf16 v[52:55], v[96:99], a[64:67], v[52:55]
    ds_read_b128 v[84:87], v5 offset:32768
    buffer_load_dwordx4 a[84:87], v1, s[4:7], s68 offen offset:2048
    v_mfma_f32_16x16x32_bf16 v[56:59], v[96:99], a[68:71], v[56:59]
    s_waitcnt lgkmcnt(2)
    v_mfma_f32_16x16x32_bf16 v[36:39], v[76:79], a[56:59], v[36:39]
    ds_read_b128 v[88:91], v1 offset:33280
    v_mfma_f32_16x16x32_bf16 v[40:43], v[76:79], a[60:63], v[40:43]
    buffer_load_dwordx4 a[80:83], v1, s[4:7], s68 offen offset:3072
    s_waitcnt lgkmcnt(2)
    v_mfma_f32_16x16x32_bf16 v[44:47], v[80:83], a[56:59], v[44:47]
    ds_read_b128 v[92:95], v1 offset:34304
    v_mfma_f32_16x16x32_bf16 v[48:51], v[80:83], a[60:63], v[48:51]
    s_waitcnt lgkmcnt(2)
    v_mfma_f32_16x16x32_bf16 v[52:55], v[84:87], a[56:59], v[52:55]
    ds_read_b128 v[96:99], v5 offset:35328
    s_add_u32 s89, s97, s26
    s_add_u32 s88, s97, 92160
    s_add_u32 s89, s89, 20480
    s_mov_b32 m0, s88
    s_nop 0
    buffer_load_dwordx4 v1, s[4:7], s89 offen offset:0 lds
    v_mfma_f32_16x16x32_bf16 v[56:59], v[84:87], a[60:63], v[56:59]
    s_waitcnt lgkmcnt(2)
    v_mfma_f32_16x16x32_bf16 v[36:39], v[88:91], a[48:51], v[36:39]
    ds_read_b128 v[76:79], v1 offset:35840
    s_add_u32 s68, s27, 20480
    buffer_load_dwordx4 v[116:119], v1, s[4:7], s68 offen offset:0
    v_mfma_f32_16x16x32_bf16 v[40:43], v[88:91], a[52:55], v[40:43]
    s_waitcnt lgkmcnt(2)
    v_mfma_f32_16x16x32_bf16 v[44:47], v[92:95], a[48:51], v[44:47]
    ds_read_b128 v[80:83], v1 offset:36864
    buffer_load_dwordx4 v[120:123], v1, s[4:7], s68 offen offset:1024
    v_mfma_f32_16x16x32_bf16 v[48:51], v[92:95], a[52:55], v[48:51]
    s_waitcnt lgkmcnt(2)
    v_mfma_f32_16x16x32_bf16 v[52:55], v[96:99], a[48:51], v[52:55]
    ds_read_b128 v[84:87], v5 offset:37888
    buffer_load_dwordx4 v1, s[4:7], s89 offen offset:1024 lds
    v_mfma_f32_16x16x32_bf16 v[56:59], v[96:99], a[52:55], v[56:59]
    s_waitcnt lgkmcnt(2)
    v_mfma_f32_16x16x32_bf16 v[36:39], v[76:79], a[40:43], v[36:39]
    ds_read_b128 v[88:91], v1 offset:38400
    v_mfma_f32_16x16x32_bf16 v[40:43], v[76:79], a[44:47], v[40:43]
    buffer_load_dwordx4 v[124:127], v1, s[4:7], s68 offen offset:2048
    s_waitcnt lgkmcnt(2)
    v_mfma_f32_16x16x32_bf16 v[44:47], v[80:83], a[40:43], v[44:47]
    ds_read_b128 v[92:95], v1 offset:39424
    v_mfma_f32_16x16x32_bf16 v[48:51], v[80:83], a[44:47], v[48:51]
    s_waitcnt lgkmcnt(2)
    v_mfma_f32_16x16x32_bf16 v[52:55], v[84:87], a[40:43], v[52:55]
    ds_read_b128 v[96:99], v5 offset:40448
    buffer_load_dwordx4 v[128:131], v1, s[4:7], s68 offen offset:3072
    v_mfma_f32_16x16x32_bf16 v[56:59], v[84:87], a[44:47], v[56:59]
    s_waitcnt lgkmcnt(2)
    v_mfma_f32_16x16x32_bf16 v[36:39], v[88:91], a[32:35], v[36:39]
    ds_read_b128 v[76:79], v1 offset:40960
    v_mfma_f32_16x16x32_bf16 v[40:43], v[88:91], a[36:39], v[40:43]
    s_add_u32 s68, s27, 24576
    buffer_load_dwordx4 v[164:167], v1, s[4:7], s68 offen offset:0
    s_waitcnt lgkmcnt(2)
    v_mfma_f32_16x16x32_bf16 v[44:47], v[92:95], a[32:35], v[44:47]
    ds_read_b128 v[80:83], v1 offset:41984
    v_mfma_f32_16x16x32_bf16 v[48:51], v[92:95], a[36:39], v[48:51]
    s_waitcnt lgkmcnt(2)
    v_mfma_f32_16x16x32_bf16 v[52:55], v[96:99], a[32:35], v[52:55]
    ds_read_b128 v[84:87], v5 offset:43008
    buffer_load_dwordx4 v1, s[4:7], s89 offen offset:2048 lds
    v_mfma_f32_16x16x32_bf16 v[56:59], v[96:99], a[36:39], v[56:59]
    s_waitcnt lgkmcnt(2)
    v_mfma_f32_16x16x32_bf16 v[36:39], v[76:79], a[24:27], v[36:39]
    ds_read_b128 v[88:91], v1 offset:43520
    v_mfma_f32_16x16x32_bf16 v[40:43], v[76:79], a[28:31], v[40:43]
    s_waitcnt lgkmcnt(2)
    v_mfma_f32_16x16x32_bf16 v[44:47], v[80:83], a[24:27], v[44:47]
    ds_read_b128 v[92:95], v1 offset:44544
    buffer_load_dwordx4 v1, s[4:7], s89 offen offset:3072 lds
    v_mfma_f32_16x16x32_bf16 v[48:51], v[80:83], a[28:31], v[48:51]
    s_waitcnt lgkmcnt(2)
    v_mfma_f32_16x16x32_bf16 v[52:55], v[84:87], a[24:27], v[52:55]
    ds_read_b128 v[96:99], v5 offset:45568
    v_mfma_f32_16x16x32_bf16 v[56:59], v[84:87], a[28:31], v[56:59]
    s_waitcnt lgkmcnt(2)
    v_mfma_f32_16x16x32_bf16 v[36:39], v[88:91], a[16:19], v[36:39]
    ds_read_b128 v[76:79], v1 offset:46080
    v_mfma_f32_16x16x32_bf16 v[40:43], v[88:91], a[20:23], v[40:43]
    s_waitcnt lgkmcnt(2)
    v_mfma_f32_16x16x32_bf16 v[44:47], v[92:95], a[16:19], v[44:47]
    ds_read_b128 v[80:83], v1 offset:47104
    v_mfma_f32_16x16x32_bf16 v[48:51], v[92:95], a[20:23], v[48:51]
    s_waitcnt lgkmcnt(2)
    v_mfma_f32_16x16x32_bf16 v[52:55], v[96:99], a[16:19], v[52:55]
    ds_read_b128 v[84:87], v5 offset:48128
    v_mfma_f32_16x16x32_bf16 v[56:59], v[96:99], a[20:23], v[56:59]
    s_waitcnt lgkmcnt(2)
    v_mfma_f32_16x16x32_bf16 v[36:39], v[76:79], a[8:11], v[36:39]
    ds_read_b128 v[88:91], v1 offset:48640
    v_mfma_f32_16x16x32_bf16 v[40:43], v[76:79], a[12:15], v[40:43]
    s_waitcnt lgkmcnt(2)
    v_mfma_f32_16x16x32_bf16 v[44:47], v[80:83], a[8:11], v[44:47]
    ds_read_b128 v[92:95], v1 offset:49664
    s_add_u32 s89, s97, s26
    s_add_u32 s88, s97, 108544
    s_add_u32 s89, s89, 36864
    s_mov_b32 m0, s88
    s_nop 0
    buffer_load_dwordx4 v1, s[4:7], s89 offen offset:0 lds
    v_mfma_f32_16x16x32_bf16 v[48:51], v[80:83], a[12:15], v[48:51]
    s_waitcnt lgkmcnt(2)
    v_mfma_f32_16x16x32_bf16 v[52:55], v[84:87], a[8:11], v[52:55]
    ds_read_b128 v[96:99], v5 offset:50688
    v_mfma_f32_16x16x32_bf16 v[56:59], v[84:87], a[12:15], v[56:59]
    s_waitcnt lgkmcnt(2)
    v_mfma_f32_16x16x32_bf16 v[36:39], v[88:91], a[0:3], v[36:39]
    ds_read_b128 v[76:79], v12 offset:320
    ds_read_b128 v[80:83], v12 offset:384
    v_mfma_f32_16x16x32_bf16 v[40:43], v[88:91], a[4:7], v[40:43]
    ds_read_b128 v[84:87], v12 offset:448
    s_waitcnt lgkmcnt(4)
    v_mfma_f32_16x16x32_bf16 v[44:47], v[92:95], a[0:3], v[44:47]
    v_mov_b32 v103, 0
    v_mov_b32 v107, 0
    v_mfma_f32_16x16x32_bf16 v[48:51], v[92:95], a[4:7], v[48:51]
    v_mov_b32 v111, 0
    s_waitcnt lgkmcnt(3)
    v_mfma_f32_16x16x32_bf16 v[52:55], v[96:99], a[0:3], v[52:55]
    v_mov_b32 v115, 0
    v_mov_b32 v65, 0
    v_mfma_f32_16x16x32_bf16 v[56:59], v[96:99], a[4:7], v[56:59]
    v_mov_b32 v71, 0
    s_barrier
    buffer_load_dwordx4 v[144:147], v1, s[4:7], s46 offen offset:0 sc1
    buffer_load_dwordx4 v[148:151], v1, s[4:7], s46 offen offset:1024 sc1
    buffer_load_dwordx4 v[152:155], v1, s[4:7], s46 offen offset:2048 sc1
    buffer_load_dwordx4 v[156:159], v1, s[4:7], s46 offen offset:3072 sc1
    buffer_load_dwordx4 v[160:163], v26, s[4:7], s46 offen offset:0 sc1
    buffer_load_dwordx4 v1, s[4:7], s89 offen offset:1024 lds
    buffer_load_dwordx4 v1, s[4:7], s89 offen offset:2048 lds
    buffer_load_dwordx4 v1, s[4:7], s89 offen offset:3072 lds
    s_add_u32 s89, s97, s26
    s_add_u32 s88, s97, 124928
    s_add_u32 s89, s89, 53248
    s_mov_b32 m0, s88
    s_nop 0
    buffer_load_dwordx4 v1, s[4:7], s89 offen offset:0 lds
    v_mov_b32 v143, 3049365963
    s_waitcnt lgkmcnt(2)
    v_pk_fma_f32 v[136:137], v[76:77], v[134:135], s[76:77] op_sel:[0,0,0] op_sel_hi:[1,0,1]
    v_pk_fma_f32 v[72:73], v[76:77], v[134:135], s[76:77] op_sel:[0,1,0] op_sel_hi:[1,1,1]
    v_pk_fma_f32 v[138:139], v[78:79], v[134:135], s[76:77] op_sel:[0,0,0] op_sel_hi:[1,0,1]
    v_pk_fma_f32 v[74:75], v[78:79], v[134:135], s[76:77] op_sel:[0,1,0] op_sel_hi:[1,1,1]
    v_pk_fma_f32 v[36:37], v[36:37], v[132:133], v[136:137] op_sel:[0,0,0] op_sel_hi:[1,0,1]
    v_pk_fma_f32 v[40:41], v[40:41], v[132:133], v[72:73] op_sel:[0,1,0] op_sel_hi:[1,1,1]
    v_pk_fma_f32 v[38:39], v[38:39], v[132:133], v[138:139] op_sel:[0,0,0] op_sel_hi:[1,0,1]
    v_pk_fma_f32 v[42:43], v[42:43], v[132:133], v[74:75] op_sel:[0,1,0] op_sel_hi:[1,1,1]
    v_pk_fma_f32 v[136:137], v[36:37], s[78:79], v[142:143] op_sel:[0,0,1] op_sel_hi:[1,1,1]
    v_pk_fma_f32 v[72:73], v[40:41], s[78:79], v[142:143] op_sel:[0,0,1] op_sel_hi:[1,1,1]
    v_pk_fma_f32 v[138:139], v[38:39], s[78:79], v[142:143] op_sel:[0,0,1] op_sel_hi:[1,1,1]
    v_pk_fma_f32 v[74:75], v[42:43], s[78:79], v[142:143] op_sel:[0,0,1] op_sel_hi:[1,1,1]
    v_exp_f32_e64 v136, v136 clamp
    v_exp_f32_e64 v72, v72 clamp
    v_exp_f32_e64 v137, v137 clamp
    v_exp_f32_e64 v73, v73 clamp
    v_exp_f32_e64 v138, v138 clamp
    v_exp_f32_e64 v74, v74 clamp
    v_exp_f32_e64 v139, v139 clamp
    v_exp_f32_e64 v75, v75 clamp
    v_max_f32 v36, s76, v36
    v_max_f32 v40, s76, v40
    v_max_f32 v37, s76, v37
    v_max_f32 v41, s76, v41
    v_max_f32 v38, s76, v38
    v_max_f32 v42, s76, v42
    v_max_f32 v39, s76, v39
    v_max_f32_e64 v43, s76, v43
    v_pk_add_f32 v[36:37], v[36:37], v[136:137] op_sel:[0,0] op_sel_hi:[1,1]
    v_pk_add_f32 v[40:41], v[40:41], v[72:73] op_sel:[0,0] op_sel_hi:[1,1]
    v_pk_add_f32 v[38:39], v[38:39], v[138:139] op_sel:[0,0] op_sel_hi:[1,1]
    v_pk_add_f32 v[42:43], v[42:43], v[74:75] op_sel:[0,0] op_sel_hi:[1,1]
    v_cvt_pk_bf16_f32 v60, v36, v37
    v_cvt_pk_bf16_f32 v66, v40, v41
    v_cvt_pk_bf16_f32 v61, v38, v39
    v_cvt_pk_bf16_f32 v67, v42, v43
    s_waitcnt lgkmcnt(1)
    v_pk_fma_f32 v[136:137], v[80:81], v[134:135], s[76:77] op_sel:[0,0,0] op_sel_hi:[1,0,1]
    v_pk_fma_f32 v[72:73], v[80:81], v[134:135], s[76:77] op_sel:[0,1,0] op_sel_hi:[1,1,1]
    v_pk_fma_f32 v[138:139], v[82:83], v[134:135], s[76:77] op_sel:[0,0,0] op_sel_hi:[1,0,1]
    v_pk_fma_f32 v[74:75], v[82:83], v[134:135], s[76:77] op_sel:[0,1,0] op_sel_hi:[1,1,1]
    v_pk_fma_f32 v[44:45], v[44:45], v[132:133], v[136:137] op_sel:[0,0,0] op_sel_hi:[1,0,1]
    v_pk_fma_f32 v[48:49], v[48:49], v[132:133], v[72:73] op_sel:[0,1,0] op_sel_hi:[1,1,1]
    v_pk_fma_f32 v[46:47], v[46:47], v[132:133], v[138:139] op_sel:[0,0,0] op_sel_hi:[1,0,1]
    v_pk_fma_f32 v[50:51], v[50:51], v[132:133], v[74:75] op_sel:[0,1,0] op_sel_hi:[1,1,1]
    v_pk_fma_f32 v[136:137], v[44:45], s[78:79], v[142:143] op_sel:[0,0,1] op_sel_hi:[1,1,1]
    v_pk_fma_f32 v[72:73], v[48:49], s[78:79], v[142:143] op_sel:[0,0,1] op_sel_hi:[1,1,1]
    v_pk_fma_f32 v[138:139], v[46:47], s[78:79], v[142:143] op_sel:[0,0,1] op_sel_hi:[1,1,1]
    v_pk_fma_f32 v[74:75], v[50:51], s[78:79], v[142:143] op_sel:[0,0,1] op_sel_hi:[1,1,1]
    v_exp_f32_e64 v136, v136 clamp
    v_exp_f32_e64 v72, v72 clamp
    v_exp_f32_e64 v137, v137 clamp
    v_exp_f32_e64 v73, v73 clamp
    v_exp_f32_e64 v138, v138 clamp
    v_exp_f32_e64 v74, v74 clamp
    v_exp_f32_e64 v139, v139 clamp
    v_exp_f32_e64 v75, v75 clamp
    v_max_f32 v44, s76, v44
    v_max_f32 v48, s76, v48
    v_max_f32 v45, s76, v45
    v_max_f32 v49, s76, v49
    v_max_f32 v46, s76, v46
    v_max_f32 v50, s76, v50
    v_max_f32 v47, s76, v47
    v_max_f32_e64 v51, s76, v51
    v_pk_add_f32 v[44:45], v[44:45], v[136:137] op_sel:[0,0] op_sel_hi:[1,1]
    v_pk_add_f32 v[48:49], v[48:49], v[72:73] op_sel:[0,0] op_sel_hi:[1,1]
    v_pk_add_f32 v[46:47], v[46:47], v[138:139] op_sel:[0,0] op_sel_hi:[1,1]
    v_pk_add_f32 v[50:51], v[50:51], v[74:75] op_sel:[0,0] op_sel_hi:[1,1]
    v_cvt_pk_bf16_f32 v63, v44, v45
    v_cvt_pk_bf16_f32 v69, v48, v49
    v_cvt_pk_bf16_f32 v64, v46, v47
    v_cvt_pk_bf16_f32 v70, v50, v51
    s_waitcnt lgkmcnt(0)
    v_pk_fma_f32 v[136:137], v[84:85], v[134:135], s[76:77] op_sel:[0,0,0] op_sel_hi:[1,0,1]
    v_pk_fma_f32 v[72:73], v[84:85], v[134:135], s[76:77] op_sel:[0,1,0] op_sel_hi:[1,1,1]
    v_pk_fma_f32 v[52:53], v[52:53], v[132:133], v[136:137] op_sel:[0,0,0] op_sel_hi:[1,0,1]
    v_pk_fma_f32 v[56:57], v[56:57], v[132:133], v[72:73] op_sel:[0,1,0] op_sel_hi:[1,1,1]
    v_pk_fma_f32 v[136:137], v[52:53], s[78:79], v[142:143] op_sel:[0,0,1] op_sel_hi:[1,1,1]
    v_pk_fma_f32 v[72:73], v[56:57], s[78:79], v[142:143] op_sel:[0,0,1] op_sel_hi:[1,1,1]
    v_exp_f32_e64 v136, v136 clamp
    v_exp_f32_e64 v72, v72 clamp
    v_exp_f32_e64 v137, v137 clamp
    v_exp_f32_e64 v73, v73 clamp
    v_max_f32 v52, s76, v52
    v_max_f32 v56, s76, v56
    v_max_f32 v53, s76, v53
    v_max_f32_e64 v57, s76, v57
    v_pk_add_f32 v[52:53], v[52:53], v[136:137] op_sel:[0,0] op_sel_hi:[1,1]
    v_pk_add_f32 v[56:57], v[56:57], v[72:73] op_sel:[0,0] op_sel_hi:[1,1]
    v_cvt_pk_bf16_f32 v62, v52, v53
    v_cvt_pk_bf16_f32 v68, v56, v57
    s_mov_b32 s52, 0x41800000
    s_waitcnt vmcnt(7)
    v_min_f32 v136, v147, v151
    s_waitcnt vmcnt(5)
    v_min3_f32 v136, v136, v155, v159
    s_waitcnt vmcnt(4)
    v_min_f32 v136, v136, v163
    v_cmp_gt_f32 vcc, s52, v136
    s_nop 1
    s_cbranch_vccz L_ok_1028
    s_mov_b32 s60, 0
L_lp_1027:
    s_sleep 4
    buffer_load_dwordx4 v[144:147], v1, s[4:7], s46 offen offset:0 sc1
    buffer_load_dwordx4 v[148:151], v1, s[4:7], s46 offen offset:1024 sc1
    buffer_load_dwordx4 v[152:155], v1, s[4:7], s46 offen offset:2048 sc1
    buffer_load_dwordx4 v[156:159], v1, s[4:7], s46 offen offset:3072 sc1
    buffer_load_dwordx4 v[160:163], v26, s[4:7], s46 offen offset:0 sc1
    s_add_u32 s60, s60, 1
    s_cmp_gt_u32 s60, 0x40000
    s_cbranch_scc1 L_abort
    s_waitcnt vmcnt(0)
    v_min_f32 v136, v147, v151
    v_min3_f32 v136, v136, v155, v159
    v_min_f32 v136, v136, v163
    v_cmp_gt_f32 vcc, s52, v136
    s_nop 1
    s_cbranch_vccnz L_lp_1027
L_ok_1028:
    v_cvt_pk_bf16_f32 v72, v157, v158
    v_cvt_pk_bf16_f32 v73, v160, v161
    v_cvt_pk_bf16_f32 v74, v162, 0
    v_cvt_pk_bf16_f32 v75, 0, v162
    v_cndmask_b32 v108, v72, 0, s[48:49]
    v_cndmask_b32 v109, v73, 0, s[48:49]
    v_cndmask_b32 v110, v74, 0, s[48:49]
    v_cndmask_b32 v112, 0, v75, s[48:49]
    v_cndmask_b32 v113, 0, v72, s[48:49]
    v_cndmask_b32 v114, 0, v73, s[48:49]
    v_cvt_pk_bf16_f32 v100, v144, v145
    v_mfma_f32_16x16x32_bf16 v[84:87], v[108:111], v[60:63], 0
    v_cvt_pk_bf16_f32 v101, v146, v148
    v_cvt_pk_bf16_f32 v102, v149, 0
    v_mfma_f32_16x16x32_bf16 v[96:99], v[108:111], v[66:69], 0
    v_cvt_pk_bf16_f32 v104, 0, v156
    v_cvt_pk_bf16_f32 v105, v150, v152
    v_mfma_f32_16x16x32_bf16 v[84:87], v[112:115], v[62:65], v[84:87]
    v_cvt_pk_bf16_f32 v106, v153, v154
    v_mfma_f32_16x16x32_bf16 v[96:99], v[112:115], v[68:71], v[96:99]
    v_mfma_f32_16x16x32_bf16 v[76:79], v[100:103], v[60:63], 0
    v_mfma_f32_16x16x32_bf16 v[80:83], v[104:107], v[62:65], 0
    v_mfma_f32_16x16x32_bf16 v[88:91], v[100:103], v[66:69], 0
    v_mfma_f32_16x16x32_bf16 v[92:95], v[104:107], v[68:71], 0
    s_nop 1
    v_pk_add_f32 v[84:85], v[84:85], s[76:77] op_sel:[0,0] op_sel_hi:[1,1]
    v_rcp_f32 v84, v84
    v_rcp_f32_e64 v85, v85
    v_pk_add_f32 v[96:97], v[96:97], s[76:77] op_sel:[0,0] op_sel_hi:[1,1]
    v_rcp_f32 v96, v96
    v_rcp_f32 v97, v97
    v_pk_mul_f32 v[86:87], v[86:87], v[84:85] op_sel:[0,0] op_sel_hi:[1,1]
    v_pk_mul_f32 v[76:77], v[76:77], v[84:85] op_sel:[0,0] op_sel_hi:[1,0]
    v_pk_mul_f32 v[78:79], v[78:79], v[84:85] op_sel:[0,0] op_sel_hi:[1,0]
    v_pk_mul_f32 v[80:81], v[80:81], v[84:85] op_sel:[0,1] op_sel_hi:[1,1]
    v_pk_mul_f32 v[82:83], v[82:83], v[84:85] op_sel:[0,1] op_sel_hi:[1,1]
    v_cvt_pk_bf16_f32 v40, v86, v87
    v_cvt_pk_bf16_f32 v36, v76, v77
    v_cvt_pk_bf16_f32 v37, v78, v79
    v_cvt_pk_bf16_f32 v38, v80, v81
    v_cvt_pk_bf16_f32 v39, v82, v83
    buffer_store_dwordx4 v[36:39], v1, s[4:7], s29 offen sc1
    buffer_store_dword v40, v27, s[4:7], s29 offen sc1
    v_pk_mul_f32 v[98:99], v[98:99], v[96:97] op_sel:[0,0] op_sel_hi:[1,1]
    v_pk_mul_f32 v[88:89], v[88:89], v[96:97] op_sel:[0,0] op_sel_hi:[1,0]
    v_pk_mul_f32 v[90:91], v[90:91], v[96:97] op_sel:[0,0] op_sel_hi:[1,0]
    v_pk_mul_f32 v[92:93], v[92:93], v[96:97] op_sel:[0,1] op_sel_hi:[1,1]
    v_pk_mul_f32 v[94:95], v[94:95], v[96:97] op_sel:[0,1] op_sel_hi:[1,1]
    v_cvt_pk_bf16_f32 v46, v98, v99
    v_cvt_pk_bf16_f32 v42, v88, v89
    v_cvt_pk_bf16_f32 v43, v90, v91
    v_cvt_pk_bf16_f32 v44, v92, v93
    v_cvt_pk_bf16_f32 v45, v94, v95
    buffer_store_dwordx4 v[42:45], v1, s[4:7], s30 offen sc1
    buffer_store_dword v46, v27, s[4:7], s30 offen sc1
    s_add_u32 s46, s46, 81920
    s_add_u32 s47, s47, 81920
    s_add_u32 s52, s39, 2
    v_mov_b32 v15, s52
    s_waitcnt vmcnt(0)
    s_mov_b64 exec, 1
    buffer_store_dword v15, off, s[4:7], s42 sc1
    s_mov_b64 exec, -1
    v_lshlrev_b32 v96, 16, v16
    v_and_b32 v97, 0xffff0000, v16
    v_lshlrev_b32_e64 v98, 16, v17
    v_and_b32 v99, 0xffff0000, v17
    v_lshlrev_b32_e64 v100, 16, v18
    v_and_b32 v101, 0xffff0000, v18
    v_lshlrev_b32_e64 v102, 16, v19
    v_and_b32 v103, 0xffff0000, v19
    v_lshlrev_b32_e64 v104, 16, v20
    v_and_b32 v105, 0xffff0000, v20
    v_lshlrev_b32_e64 v106, 16, v21
    v_and_b32 v107, 0xffff0000, v21
    v_lshlrev_b32_e64 v108, 16, v22
    v_and_b32 v109, 0xffff0000, v22
    v_lshlrev_b32_e64 v110, 16, v23
    v_and_b32 v111, 0xffff0000, v23
    v_lshlrev_b32_e64 v112, 16, v24
    v_and_b32 v113, 0xffff0000, v24
    v_lshlrev_b32_e64 v114, 16, v25
    v_and_b32 v115, 0xffff0000, v25
    v_and_b32 v15, 31, v2
    s_mov_b32 s60, 0
    s_add_u32 s52, s39, 2
L_poll_1029:
    buffer_load_dword v14, v15, s[4:7], s43 offen sc1
    s_add_u32 s60, s60, 1
    s_cmp_gt_u32 s60, 0x40000
    s_cbranch_scc1 L_abort
    s_waitcnt vmcnt(0)
    v_cmp_ne_u32 vcc, s52, v14
    s_nop 1
    s_cbranch_vccnz L_poll_1029
    buffer_load_dwordx4 a[0:3], v1, s[4:7], s31 offen offset:0 sc1
    buffer_load_dwordx4 a[4:7], v1, s[4:7], s31 offen offset:1024 sc1
    buffer_load_dwordx4 a[8:11], v1, s[4:7], s31 offen offset:2048 sc1
    buffer_load_dwordx4 a[12:15], v1, s[4:7], s31 offen offset:3072 sc1
    buffer_load_dwordx4 a[16:19], v26, s[4:7], s31 offen offset:0 sc1
    buffer_load_dwordx4 a[20:23], v1, s[4:7], s32 offen offset:0 sc1
    s_waitcnt vmcnt(5)
    v_mfma_f32_16x16x32_bf16 v[36:39], a[156:159], a[0:3], 0
    buffer_load_dwordx4 a[24:27], v1, s[4:7], s32 offen offset:1024 sc1
    v_mfma_f32_16x16x32_bf16 v[40:43], a[152:155], a[0:3], 0
    v_mfma_f32_16x16x32_bf16 v[52:55], a[140:143], a[0:3], 0
    buffer_load_dwordx4 a[28:31], v1, s[4:7], s32 offen offset:2048 sc1
    s_waitcnt vmcnt(6)
    v_mfma_f32_16x16x32_bf16 v[36:39], a[136:139], a[4:7], v[36:39]
    v_mfma_f32_16x16x32_bf16 v[40:43], a[132:135], a[4:7], v[40:43]
    buffer_load_dwordx4 a[32:35], v1, s[4:7], s32 offen offset:3072 sc1
    v_mfma_f32_16x16x32_bf16 v[52:55], a[120:123], a[4:7], v[52:55]
    s_waitcnt vmcnt(6)
    v_mfma_f32_16x16x32_bf16 v[36:39], a[116:119], a[8:11], v[36:39]
    v_mfma_f32_16x16x32_bf16 v[40:43], a[112:115], a[8:11], v[40:43]
    buffer_load_dwordx4 a[36:39], v26, s[4:7], s32 offen offset:0 sc1
    v_mfma_f32_16x16x32_bf16 v[52:55], a[100:103], a[8:11], v[52:55]
    s_waitcnt vmcnt(6)
    v_mfma_f32_16x16x32_bf16 v[36:39], a[96:99], a[12:15], v[36:39]
    buffer_load_dwordx4 a[40:43], v1, s[4:7], s33 offen offset:0 sc1
    v_mfma_f32_16x16x32_bf16 v[40:43], a[92:95], a[12:15], v[40:43]
    v_mfma_f32_16x16x32_bf16 v[52:55], a[80:83], a[12:15], v[52:55]
    buffer_load_dwordx4 a[44:47], v1, s[4:7], s33 offen offset:1024 sc1
    s_waitcnt vmcnt(7)
    v_mfma_f32_16x16x32_bf16 v[36:39], v[116:119], a[16:19], v[36:39]
    v_mfma_f32_16x16x32_bf16 v[40:43], v[120:123], a[16:19], v[40:43]
    buffer_load_dwordx4 a[48:51], v1, s[4:7], s33 offen offset:2048 sc1
    v_mfma_f32_16x16x32_bf16 v[52:55], v[164:167], a[16:19], v[52:55]
    s_waitcnt vmcnt(7)
    v_mfma_f32_16x16x32_bf16 v[56:59], a[156:159], a[20:23], 0
    buffer_load_dwordx4 a[52:55], v1, s[4:7], s33 offen offset:3072 sc1
    v_mfma_f32_16x16x32_bf16 v[60:63], a[152:155], a[20:23], 0
    v_mfma_f32_16x16x32_bf16 v[72:75], a[140:143], a[20:23], 0
    buffer_load_dwordx4 a[56:59], v26, s[4:7], s33 offen offset:0 sc1
    s_waitcnt vmcnt(8)
    v_mfma_f32_16x16x32_bf16 v[56:59], a[136:139], a[24:27], v[56:59]
    ds_write_b128 v29, v[36:39] offset:0
    v_mfma_f32_16x16x32_bf16 v[60:63], a[132:135], a[24:27], v[60:63]
    buffer_load_dwordx4 a[60:63], v1, s[4:7], s34 offen offset:0 sc1
    v_mfma_f32_16x16x32_bf16 v[72:75], a[120:123], a[24:27], v[72:75]
    s_waitcnt vmcnt(8)
    v_mfma_f32_16x16x32_bf16 v[56:59], a[116:119], a[28:31], v[56:59]
    v_mfma_f32_16x16x32_bf16 v[60:63], a[112:115], a[28:31], v[60:63]
    buffer_load_dwordx4 a[64:67], v1, s[4:7], s34 offen offset:1024 sc1
    ds_write_b128 v29, v[40:43] offset:1024
    v_mfma_f32_16x16x32_bf16 v[72:75], a[100:103], a[28:31], v[72:75]
    s_waitcnt vmcnt(8)
    v_mfma_f32_16x16x32_bf16 v[56:59], a[96:99], a[32:35], v[56:59]
    buffer_load_dwordx4 a[68:71], v1, s[4:7], s34 offen offset:2048 sc1
    v_mfma_f32_16x16x32_bf16 v[60:63], a[92:95], a[32:35], v[60:63]
    v_mfma_f32_16x16x32_bf16 v[72:75], a[80:83], a[32:35], v[72:75]
    buffer_load_dwordx4 a[72:75], v1, s[4:7], s34 offen offset:3072 sc1
    ds_write_b128 v29, v[52:55] offset:4096
    s_waitcnt vmcnt(9)
    v_mfma_f32_16x16x32_bf16 v[56:59], v[116:119], a[36:39], v[56:59]
    v_mfma_f32_16x16x32_bf16 v[60:63], v[120:123], a[36:39], v[60:63]
    buffer_load_dwordx4 a[76:79], v26, s[4:7], s34 offen offset:0 sc1
    v_mfma_f32_16x16x32_bf16 v[72:75], v[164:167], a[36:39], v[72:75]
    s_waitcnt vmcnt(9)
    v_mfma_f32_16x16x32_bf16 v[76:79], a[156:159], a[40:43], 0
    v_mfma_f32_16x16x32_bf16 v[80:83], a[152:155], a[40:43], 0
    v_mfma_f32_16x16x32_bf16 v[92:95], a[140:143], a[40:43], 0
    s_waitcnt vmcnt(8)
    v_mfma_f32_16x16x32_bf16 v[76:79], a[136:139], a[44:47], v[76:79]
    ds_write_b128 v30, v[56:59] offset:0
    v_mfma_f32_16x16x32_bf16 v[80:83], a[132:135], a[44:47], v[80:83]
    v_mfma_f32_16x16x32_bf16 v[92:95], a[120:123], a[44:47], v[92:95]
    s_waitcnt vmcnt(7)
    v_mfma_f32_16x16x32_bf16 v[76:79], a[116:119], a[48:51], v[76:79]
    v_mfma_f32_16x16x32_bf16 v[80:83], a[112:115], a[48:51], v[80:83]
    ds_write_b128 v30, v[60:63] offset:1024
    v_mfma_f32_16x16x32_bf16 v[92:95], a[100:103], a[48:51], v[92:95]
    s_waitcnt vmcnt(6)
    v_mfma_f32_16x16x32_bf16 v[76:79], a[96:99], a[52:55], v[76:79]
    v_mfma_f32_16x16x32_bf16 v[80:83], a[92:95], a[52:55], v[80:83]
    v_mfma_f32_16x16x32_bf16 v[92:95], a[80:83], a[52:55], v[92:95]
    ds_write_b128 v30, v[72:75] offset:4096
    s_waitcnt vmcnt(5)
    v_mfma_f32_16x16x32_bf16 v[76:79], v[116:119], a[56:59], v[76:79]
    v_mfma_f32_16x16x32_bf16 v[80:83], v[120:123], a[56:59], v[80:83]
    v_mfma_f32_16x16x32_bf16 v[92:95], v[164:167], a[56:59], v[92:95]
    s_waitcnt vmcnt(4)
    v_mfma_f32_16x16x32_bf16 v[96:99], a[156:159], a[60:63], v[96:99]
    v_mfma_f32_16x16x32_bf16 v[100:103], a[152:155], a[60:63], v[100:103]
    v_mfma_f32_16x16x32_bf16 v[112:115], a[140:143], a[60:63], v[112:115]
    s_waitcnt vmcnt(3)
    v_mfma_f32_16x16x32_bf16 v[96:99], a[136:139], a[64:67], v[96:99]
    ds_write_b128 v31, v[76:79] offset:0
    v_mfma_f32_16x16x32_bf16 v[100:103], a[132:135], a[64:67], v[100:103]
    v_mfma_f32_16x16x32_bf16 v[112:115], a[120:123], a[64:67], v[112:115]
    s_waitcnt vmcnt(2)
    v_mfma_f32_16x16x32_bf16 v[96:99], a[116:119], a[68:71], v[96:99]
    v_mfma_f32_16x16x32_bf16 v[100:103], a[112:115], a[68:71], v[100:103]
    ds_write_b128 v31, v[80:83] offset:1024
    v_mfma_f32_16x16x32_bf16 v[112:115], a[100:103], a[68:71], v[112:115]
    s_waitcnt vmcnt(1)
    v_mfma_f32_16x16x32_bf16 v[96:99], a[96:99], a[72:75], v[96:99]
    v_mfma_f32_16x16x32_bf16 v[100:103], a[92:95], a[72:75], v[100:103]
    v_mfma_f32_16x16x32_bf16 v[112:115], a[80:83], a[72:75], v[112:115]
    ds_write_b128 v31, v[92:95] offset:4096
    s_waitcnt vmcnt(0)
    v_mfma_f32_16x16x32_bf16 v[96:99], v[116:119], a[76:79], v[96:99]
    v_mfma_f32_16x16x32_bf16 v[100:103], v[120:123], a[76:79], v[100:103]
    v_mfma_f32_16x16x32_bf16 v[112:115], v[164:167], a[76:79], v[112:115]
    v_mfma_f32_16x16x32_bf16 v[44:47], a[148:151], a[0:3], 0
    v_mfma_f32_16x16x32_bf16 v[48:51], a[144:147], a[0:3], 0
    s_mov_b32 m0, s88
    s_nop 0
    buffer_load_dwordx4 v1, s[4:7], s89 offen offset:1024 lds
    v_mfma_f32_16x16x32_bf16 v[44:47], a[128:131], a[4:7], v[44:47]
    s_waitcnt lgkmcnt(0)
    s_barrier
    ds_read_b128 v[36:39], v32 offset:0
    v_mfma_f32_16x16x32_bf16 v[48:51], a[124:127], a[4:7], v[48:51]
    ds_read_b128 v[56:59], v32 offset:5120
    ds_read_b128 v[76:79], v32 offset:10240
    v_mfma_f32_16x16x32_bf16 v[44:47], a[108:111], a[8:11], v[44:47]
    buffer_load_dwordx4 v1, s[4:7], s89 offen offset:2048 lds
    ds_read_b128 v[40:43], v32 offset:1024
    ds_read_b128 v[60:63], v32 offset:6144
    v_mfma_f32_16x16x32_bf16 v[48:51], a[104:107], a[8:11], v[48:51]
    ds_read_b128 v[80:83], v32 offset:11264
    ds_read_b128 v[52:55], v32 offset:4096
    v_mfma_f32_16x16x32_bf16 v[44:47], a[88:91], a[12:15], v[44:47]
    ds_read_b128 v[72:75], v32 offset:9216
    ds_read_b128 v[92:95], v32 offset:14336
    v_mfma_f32_16x16x32_bf16 v[48:51], a[84:87], a[12:15], v[48:51]
    buffer_load_dwordx4 v1, s[4:7], s89 offen offset:3072 lds
    v_mov_b32 v140, 0
    v_mov_b32 v141, 0
    v_mfma_f32_16x16x32_bf16 v[44:47], v[124:127], a[16:19], v[44:47]
    v_mov_b32 v142, 0
    v_mov_b32_e64 v143, 0
    v_mfma_f32_16x16x32_bf16 v[48:51], v[128:131], a[16:19], v[48:51]
    v_mov_b32 v139, 0x3f803f80
    s_waitcnt lgkmcnt(8)
    v_add_f32 v96, v96, v36
    v_mfma_f32_16x16x32_bf16 v[64:67], a[148:151], a[20:23], 0
    v_add_f32 v97, v97, v37
    v_add_f32 v98, v98, v38
    v_mfma_f32_16x16x32_bf16 v[68:71], a[144:147], a[20:23], 0
    s_add_u32 s89, s96, s26
    s_add_u32 s88, s96, 141312
    s_add_u32 s89, s89, 69632
    s_mov_b32 m0, s88
    s_nop 0
    buffer_load_dwordx4 v1, s[4:7], s89 offen offset:0 lds
    v_add_f32 v99, v99, v39
    s_waitcnt lgkmcnt(6)
    v_add_f32 v56, v56, v76
    v_mfma_f32_16x16x32_bf16 v[64:67], a[128:131], a[24:27], v[64:67]
    v_add_f32 v57, v57, v77
    v_add_f32 v58, v58, v78
    v_mfma_f32_16x16x32_bf16 v[68:71], a[124:127], a[24:27], v[68:71]
    ds_write_b128 v29, v[44:47] offset:2048
    v_add_f32 v59, v59, v79
    v_add_f32 v96, v96, v56
    v_mfma_f32_16x16x32_bf16 v[64:67], a[108:111], a[28:31], v[64:67]
    buffer_load_dwordx4 v1, s[4:7], s89 offen offset:1024 lds
    v_add_f32 v97, v97, v57
    v_add_f32 v98, v98, v58
    v_mfma_f32_16x16x32_bf16 v[68:71], a[104:107], a[28:31], v[68:71]
    ds_write_b128 v29, v[48:51] offset:3072
    v_add_f32_e64 v99, v99, v59
    v_cvt_pk_bf16_f32 v16, v96, v97
    v_mfma_f32_16x16x32_bf16 v[64:67], a[88:91], a[32:35], v[64:67]
    v_cvt_pk_bf16_f32 v17, v98, v99
    s_waitcnt lgkmcnt(7)
    v_add_f32 v100, v100, v40
    v_mfma_f32_16x16x32_bf16 v[68:71], a[84:87], a[32:35], v[68:71]
    buffer_load_dwordx4 v1, s[4:7], s89 offen offset:2048 lds
    v_add_f32 v101, v101, v41
    v_add_f32 v102, v102, v42
    v_mfma_f32_16x16x32_bf16 v[64:67], v[124:127], a[36:39], v[64:67]
    v_add_f32 v103, v103, v43
    s_waitcnt lgkmcnt(5)
    v_add_f32 v60, v60, v80
    v_mfma_f32_16x16x32_bf16 v[68:71], v[128:131], a[36:39], v[68:71]
    v_add_f32 v61, v61, v81
    v_add_f32 v62, v62, v82
    v_mfma_f32_16x16x32_bf16 v[84:87], a[148:151], a[40:43], 0
    v_add_f32 v63, v63, v83
    v_add_f32 v100, v100, v60
    v_mfma_f32_16x16x32_bf16 v[88:91], a[144:147], a[40:43], 0
    s_add_u32 s13, s97, s26
    s_add_u32 s12, s97, 71680
    s_mov_b32 m0, s12
    s_nop 0
    buffer_load_dwordx4 v1, s[4:7], s13 offen offset:0 lds
    v_add_f32 v101, v101, v61
    v_add_f32 v102, v102, v62
    v_mfma_f32_16x16x32_bf16 v[84:87], a[128:131], a[44:47], v[84:87]
    v_add_f32_e64 v103, v103, v63
    v_cvt_pk_bf16_f32 v18, v100, v101
    v_mfma_f32_16x16x32_bf16 v[88:91], a[124:127], a[44:47], v[88:91]
    ds_write_b128 v30, v[64:67] offset:2048
    v_cvt_pk_bf16_f32 v19, v102, v103
    buffer_store_dwordx4 v[16:19], v10, s[4:7], 0 offen offset:0 sc1
    v_mfma_f32_16x16x32_bf16 v[84:87], a[108:111], a[48:51], v[84:87]
    buffer_load_dwordx4 v1, s[4:7], s13 offen offset:1024 lds
    s_waitcnt lgkmcnt(5)
    v_add_f32 v112, v112, v52
    v_add_f32 v113, v113, v53
    v_mfma_f32_16x16x32_bf16 v[88:91], a[104:107], a[48:51], v[88:91]
    ds_write_b128 v30, v[68:71] offset:3072
    v_add_f32 v114, v114, v54
    v_add_f32 v115, v115, v55
    v_mfma_f32_16x16x32_bf16 v[84:87], a[88:91], a[52:55], v[84:87]
    s_waitcnt lgkmcnt(4)
    v_add_f32 v72, v72, v92
    v_add_f32 v73, v73, v93
    v_mfma_f32_16x16x32_bf16 v[88:91], a[84:87], a[52:55], v[88:91]
    buffer_load_dwordx4 v1, s[4:7], s13 offen offset:2048 lds
    v_add_f32 v74, v74, v94
    v_add_f32 v75, v75, v95
    v_mfma_f32_16x16x32_bf16 v[84:87], v[124:127], a[56:59], v[84:87]
    v_add_f32 v112, v112, v72
    v_add_f32 v113, v113, v73
    v_mfma_f32_16x16x32_bf16 v[88:91], v[128:131], a[56:59], v[88:91]
    v_add_f32 v114, v114, v74
    v_add_f32 v115, v115, v75
    v_mfma_f32_16x16x32_bf16 v[104:107], a[148:151], a[60:63], v[104:107]
    v_cvt_pk_bf16_f32 v24, v112, v113
    v_cvt_pk_bf16_f32 v25, v114, v115
    v_mfma_f32_16x16x32_bf16 v[108:111], a[144:147], a[60:63], v[108:111]
    buffer_store_dwordx2 v[24:25], v11, s[4:7], 0 offen sc1
    v_mfma_f32_16x16x32_bf16 v[104:107], a[128:131], a[64:67], v[104:107]
    v_mfma_f32_16x16x32_bf16 v[108:111], a[124:127], a[64:67], v[108:111]
    ds_write_b128 v31, v[84:87] offset:2048
    v_mfma_f32_16x16x32_bf16 v[104:107], a[108:111], a[68:71], v[104:107]
    v_mfma_f32_16x16x32_bf16 v[108:111], a[104:107], a[68:71], v[108:111]
    ds_write_b128 v31, v[88:91] offset:3072
    v_mfma_f32_16x16x32_bf16 v[104:107], a[88:91], a[72:75], v[104:107]
    v_mfma_f32_16x16x32_bf16 v[108:111], a[84:87], a[72:75], v[108:111]
    v_mfma_f32_16x16x32_bf16 v[104:107], v[124:127], a[76:79], v[104:107]
    v_mfma_f32_16x16x32_bf16 v[108:111], v[128:131], a[76:79], v[108:111]
    buffer_load_dwordx4 v1, s[4:7], s13 offen offset:3072 lds
    s_add_u32 s13, s94, s26
    s_add_u32 s12, s94, 88064
    s_add_u32 s13, s13, 16384
    s_mov_b32 m0, s12
    s_nop 0
    buffer_load_dwordx4 v1, s[4:7], s13 offen offset:0 lds
    v_dot2_f32_bf16 v140, v16, v139, v140
    v_dot2_f32_bf16 v141, v16, v16, v141
    v_dot2_f32_bf16 v142, v17, v139, v142
    v_dot2_f32_bf16 v143, v17, v17, v143
    v_dot2_f32_bf16 v140, v18, v139, v140
    v_dot2_f32_bf16 v141, v18, v18, v141
    v_dot2_f32_bf16 v142, v19, v139, v142
    v_dot2_f32_bf16 v143, v19, v19, v143
    v_dot2_f32_bf16 v140, v24, v139, v140
    v_dot2_f32_bf16 v141, v24, v24, v141
    v_dot2_f32_bf16 v142, v25, v139, v142
    v_dot2_f32_bf16 v143, v25, v25, v143
    s_add_u32 s3, s39, 3
    v_mov_b32 v15, s3
    s_add_u32 s3, s40, 20480
    s_waitcnt vmcnt(2)
    s_mov_b64 exec, 1
    buffer_store_dword v15, off, s[4:7], s3 sc1
    s_mov_b64 exec, -1
    s_waitcnt lgkmcnt(0)
    s_barrier
    ds_read_b128 v[44:47], v32 offset:2048
    ds_read_b128 v[64:67], v32 offset:7168
    ds_read_b128 v[84:87], v32 offset:12288
    ds_read_b128 v[48:51], v32 offset:3072
    ds_read_b128 v[68:71], v32 offset:8192
    ds_read_b128 v[88:91], v32 offset:13312
    s_waitcnt lgkmcnt(5)
    v_pk_add_f32 v[104:105], v[104:105], v[44:45] op_sel:[0,0] op_sel_hi:[1,1]
    v_pk_add_f32 v[106:107], v[106:107], v[46:47] op_sel:[0,0] op_sel_hi:[1,1]
    s_waitcnt lgkmcnt(3)
    v_pk_add_f32 v[64:65], v[64:65], v[84:85] op_sel:[0,0] op_sel_hi:[1,1]
    v_pk_add_f32 v[66:67], v[66:67], v[86:87] op_sel:[0,0] op_sel_hi:[1,1]
    v_pk_add_f32 v[104:105], v[104:105], v[64:65] op_sel:[0,0] op_sel_hi:[1,1]
    v_pk_add_f32 v[106:107], v[106:107], v[66:67] op_sel:[0,0] op_sel_hi:[1,1]
    v_cvt_pk_bf16_f32 v20, v104, v105
    v_cvt_pk_bf16_f32 v21, v106, v107
    v_dot2_f32_bf16 v140, v20, v139, v140
    v_dot2_f32_bf16 v141, v20, v20, v141
    v_dot2_f32_bf16 v142, v21, v139, v142
    v_dot2_f32_bf16 v143, v21, v21, v143
    s_waitcnt lgkmcnt(2)
    v_pk_add_f32 v[108:109], v[108:109], v[48:49] op_sel:[0,0] op_sel_hi:[1,1]
    v_pk_add_f32 v[110:111], v[110:111], v[50:51] op_sel:[0,0] op_sel_hi:[1,1]
    s_waitcnt lgkmcnt(0)
    v_pk_add_f32 v[68:69], v[68:69], v[88:89] op_sel:[0,0] op_sel_hi:[1,1]
    v_pk_add_f32 v[70:71], v[70:71], v[90:91] op_sel:[0,0] op_sel_hi:[1,1]
    v_pk_add_f32 v[108:109], v[108:109], v[68:69] op_sel:[0,0] op_sel_hi:[1,1]
    v_pk_add_f32 v[110:111], v[110:111], v[70:71] op_sel:[0,0] op_sel_hi:[1,1]
    v_cvt_pk_bf16_f32 v22, v108, v109
    v_cvt_pk_bf16_f32 v23, v110, v111
    buffer_store_dwordx4 v[20:23], v10, s[4:7], 0 offen offset:1024 sc1
    v_dot2_f32_bf16 v140, v22, v139, v140
    v_dot2_f32_bf16 v141, v22, v22, v141
    v_dot2_f32_bf16 v142, v23, v139, v142
    v_dot2_f32_bf16 v143, v23, v23, v143
    s_nop 2
    v_pk_add_f32 v[140:141], v[140:141], v[142:143] op_sel:[0,0] op_sel_hi:[1,1]
    s_nop 1
    v_permlane32_swap_b32 v140, v141
    v_add_f32 v140, v140, v141
    v_mov_b32 v141, v140
    s_nop 1
    v_permlane16_swap_b32 v140, v141
    v_add_f32 v140, v140, v141
    v_and_b32_e64 v15, 63, v2
    v_add_u32 v15, 20480, v15
    buffer_load_dword v14, v15, s[4:7], s41 offen sc1
    buffer_store_dword v140, v9, s[4:7], 0 offen sc1
    s_waitcnt vmcnt(4)
    s_barrier
    ds_read_b128 v[92:95], v3 offset:6144
    ds_read_b128 v[96:99], v3 offset:7168
    ds_read_b128 v[100:103], v3 offset:8192
    ds_read_b128 v[104:107], v3 offset:9216
    s_add_u32 s52, s39, 3
    s_waitcnt vmcnt(1)
    v_cmp_ne_u32 vcc, s52, v14
    s_nop 1
    s_cbranch_vccz L_ok_1032
    s_mov_b32 s60, 0
L_lp_1031:
    v_and_b32_e64 v15, 63, v2
    v_add_u32 v15, 20480, v15
    buffer_load_dword v14, v15, s[4:7], s41 offen sc1
    s_add_u32 s60, s60, 1
    s_cmp_gt_u32 s60, 0x40000
    s_cbranch_scc1 L_abort
    s_waitcnt vmcnt(0)
    v_cmp_ne_u32 vcc, s52, v14
    s_nop 1
    s_cbranch_vccnz L_lp_1031
L_ok_1032:
    buffer_load_dwordx4 a[0:3], v6, s[4:7], 0 offen offset:0 sc1
    buffer_load_dwordx4 a[4:7], v7, s[4:7], 0 offen offset:0 sc1
    buffer_load_dwordx4 a[8:11], v6, s[4:7], 0 offen offset:2048 sc1
    buffer_load_dwordx4 a[12:15], v7, s[4:7], 0 offen offset:2048 sc1
    buffer_load_dwordx4 a[16:19], v6, s[4:7], 0 offen offset:3072 sc1
    buffer_load_dwordx4 a[20:23], v7, s[4:7], 0 offen offset:3072 sc1
    buffer_load_dwordx4 a[24:27], v6, s[4:7], s21 offen offset:1024 sc1
    buffer_load_dwordx4 a[28:31], v7, s[4:7], s21 offen offset:1024 sc1
    s_waitcnt vmcnt(7) lgkmcnt(3)
    v_mfma_f32_16x16x32_bf16 v[36:39], v[92:95], a[0:3], 0
    ds_read_b128 v[108:111], v3 offset:10240
    s_add_u32 s3, s39, 3
    v_mov_b32 v15, s3
    s_mov_b64 exec, 1
    buffer_store_dword v15, off, s[4:7], s40 sc1
    s_mov_b64 exec, -1
    s_waitcnt vmcnt(7)
    v_mfma_f32_16x16x32_bf16 v[40:43], v[92:95], a[4:7], 0
    s_waitcnt lgkmcnt(3)
    v_mfma_f32_16x16x32_bf16 v[44:47], v[96:99], a[0:3], 0
    ds_read_b128 v[112:115], v3 offset:11264
    v_mfma_f32_16x16x32_bf16 v[48:51], v[96:99], a[4:7], 0
    buffer_load_dwordx4 a[32:35], v6, s[4:7], s21 offen offset:3072 sc1
    s_waitcnt lgkmcnt(3)
    v_mfma_f32_16x16x32_bf16 v[52:55], v[100:103], a[0:3], 0
    ds_read_b128 v[116:119], v3 offset:12288
    v_mfma_f32_16x16x32_bf16 v[56:59], v[100:103], a[4:7], 0
    s_waitcnt lgkmcnt(3)
    v_mfma_f32_16x16x32_bf16 v[60:63], v[104:107], a[0:3], 0
    ds_read_b128 v[120:123], v3 offset:13312
    buffer_load_dwordx4 a[36:39], v7, s[4:7], s21 offen offset:3072 sc1
    v_mfma_f32_16x16x32_bf16 v[64:67], v[104:107], a[4:7], 0
    s_waitcnt vmcnt(8) lgkmcnt(3)
    v_mfma_f32_16x16x32_bf16 v[36:39], v[108:111], a[8:11], v[36:39]
    ds_read_b128 v[92:95], v3 offset:14336
    s_waitcnt vmcnt(7)
    v_mfma_f32_16x16x32_bf16 v[40:43], v[108:111], a[12:15], v[40:43]
    buffer_load_dwordx4 a[40:43], v6, s[4:7], s22 offen offset:0 sc1
    s_waitcnt lgkmcnt(3)
    v_mfma_f32_16x16x32_bf16 v[44:47], v[112:115], a[8:11], v[44:47]
    ds_read_b128 v[96:99], v3 offset:15360
    v_mfma_f32_16x16x32_bf16 v[48:51], v[112:115], a[12:15], v[48:51]
    s_waitcnt lgkmcnt(3)
    v_mfma_f32_16x16x32_bf16 v[52:55], v[116:119], a[8:11], v[52:55]
    ds_read_b128 v[100:103], v3 offset:16384
    v_mfma_f32_16x16x32_bf16 v[56:59], v[116:119], a[12:15], v[56:59]
    buffer_load_dwordx4 a[44:47], v7, s[4:7], s22 offen offset:0 sc1
    s_waitcnt lgkmcnt(3)
    v_mfma_f32_16x16x32_bf16 v[60:63], v[120:123], a[8:11], v[60:63]
    ds_read_b128 v[104:107], v3 offset:17408
    v_mfma_f32_16x16x32_bf16 v[64:67], v[120:123], a[12:15], v[64:67]
    s_waitcnt vmcnt(8) lgkmcnt(3)
    v_mfma_f32_16x16x32_bf16 v[36:39], v[92:95], a[16:19], v[36:39]
    ds_read_b128 v[108:111], v3 offset:18432
    s_waitcnt vmcnt(7)
    v_mfma_f32_16x16x32_bf16 v[40:43], v[92:95], a[20:23], v[40:43]
    buffer_load_dwordx4 a[48:51], v6, s[4:7], s22 offen offset:2048 sc1
    s_waitcnt lgkmcnt(3)
    v_mfma_f32_16x16x32_bf16 v[44:47], v[96:99], a[16:19], v[44:47]
    ds_read_b128 v[112:115], v3 offset:19456
    v_mfma_f32_16x16x32_bf16 v[48:51], v[96:99], a[20:23], v[48:51]
    s_waitcnt lgkmcnt(3)
    v_mfma_f32_16x16x32_bf16 v[52:55], v[100:103], a[16:19], v[52:55]
    ds_read_b128 v[116:119], v3 offset:20480
    v_mfma_f32_16x16x32_bf16 v[56:59], v[100:103], a[20:23], v[56:59]
    buffer_load_dwordx4 a[52:55], v7, s[4:7], s22 offen offset:2048 sc1
    s_waitcnt lgkmcnt(3)
    v_mfma_f32_16x16x32_bf16 v[60:63], v[104:107], a[16:19], v[60:63]
    ds_read_b128 v[120:123], v3 offset:21504
    v_mfma_f32_16x16x32_bf16 v[64:67], v[104:107], a[20:23], v[64:67]
    s_waitcnt vmcnt(8) lgkmcnt(3)
    v_mfma_f32_16x16x32_bf16 v[36:39], v[108:111], a[24:27], v[36:39]
    ds_read_b128 v[92:95], v3 offset:22528
    buffer_load_dwordx4 a[56:59], v6, s[4:7], s23 offen offset:0 sc1
    s_waitcnt vmcnt(8)
    v_mfma_f32_16x16x32_bf16 v[40:43], v[108:111], a[28:31], v[40:43]
    s_waitcnt lgkmcnt(3)
    v_mfma_f32_16x16x32_bf16 v[44:47], v[112:115], a[24:27], v[44:47]
    ds_read_b128 v[96:99], v3 offset:23552
    v_mfma_f32_16x16x32_bf16 v[48:51], v[112:115], a[28:31], v[48:51]
    buffer_load_dwordx4 a[60:63], v7, s[4:7], s23 offen offset:0 sc1
    s_waitcnt lgkmcnt(3)
    v_mfma_f32_16x16x32_bf16 v[52:55], v[116:119], a[24:27], v[52:55]
    ds_read_b128 v[100:103], v3 offset:24576
    v_mfma_f32_16x16x32_bf16 v[56:59], v[116:119], a[28:31], v[56:59]
    s_waitcnt lgkmcnt(3)
    v_mfma_f32_16x16x32_bf16 v[60:63], v[120:123], a[24:27], v[60:63]
    ds_read_b128 v[104:107], v3 offset:25600
    v_and_b32 v15, 63, v2
    buffer_load_dword v14, v15, s[4:7], s41 offen sc1
    v_mfma_f32_16x16x32_bf16 v[64:67], v[120:123], a[28:31], v[64:67]
    s_waitcnt vmcnt(8) lgkmcnt(3)
    v_mfma_f32_16x16x32_bf16 v[36:39], v[92:95], a[32:35], v[36:39]
    ds_read_b128 v[108:111], v3 offset:26624
    s_waitcnt vmcnt(7)
    v_mfma_f32_16x16x32_bf16 v[40:43], v[92:95], a[36:39], v[40:43]
    buffer_load_dwordx4 a[64:67], v6, s[4:7], s23 offen offset:1024 sc1
    s_waitcnt lgkmcnt(3)
    v_mfma_f32_16x16x32_bf16 v[44:47], v[96:99], a[32:35], v[44:47]
    ds_read_b128 v[112:115], v3 offset:27648
    v_mfma_f32_16x16x32_bf16 v[48:51], v[96:99], a[36:39], v[48:51]
    s_waitcnt lgkmcnt(3)
    v_mfma_f32_16x16x32_bf16 v[52:55], v[100:103], a[32:35], v[52:55]
    ds_read_b128 v[116:119], v3 offset:28672
    v_mfma_f32_16x16x32_bf16 v[56:59], v[100:103], a[36:39], v[56:59]
    buffer_load_dwordx4 a[68:71], v7, s[4:7], s23 offen offset:1024 sc1
    s_waitcnt lgkmcnt(3)
    v_mfma_f32_16x16x32_bf16 v[60:63], v[104:107], a[32:35], v[60:63]
    ds_read_b128 v[120:123], v3 offset:29696
    v_mfma_f32_16x16x32_bf16 v[64:67], v[104:107], a[36:39], v[64:67]
    s_waitcnt vmcnt(8) lgkmcnt(3)
    v_mfma_f32_16x16x32_bf16 v[36:39], v[108:111], a[40:43], v[36:39]
    ds_read_b128 v[92:95], v3 offset:30720
    s_waitcnt vmcnt(7)
    v_mfma_f32_16x16x32_bf16 v[40:43], v[108:111], a[44:47], v[40:43]
    buffer_load_dwordx4 a[72:75], v6, s[4:7], s23 offen offset:3072 sc1
    s_waitcnt lgkmcnt(3)
    v_mfma_f32_16x16x32_bf16 v[44:47], v[112:115], a[40:43], v[44:47]
    ds_read_b128 v[96:99], v3 offset:31744
    v_mfma_f32_16x16x32_bf16 v[48:51], v[112:115], a[44:47], v[48:51]
    s_waitcnt lgkmcnt(3)
    v_mfma_f32_16x16x32_bf16 v[52:55], v[116:119], a[40:43], v[52:55]
    ds_read_b128 v[100:103], v3 offset:32768
    v_mfma_f32_16x16x32_bf16 v[56:59], v[116:119], a[44:47], v[56:59]
    buffer_load_dwordx4 a[76:79], v7, s[4:7], s23 offen offset:3072 sc1
    s_waitcnt lgkmcnt(3)
    v_mfma_f32_16x16x32_bf16 v[60:63], v[120:123], a[40:43], v[60:63]
    ds_read_b128 v[104:107], v3 offset:33792
    v_mfma_f32_16x16x32_bf16 v[64:67], v[120:123], a[44:47], v[64:67]
    s_waitcnt vmcnt(8) lgkmcnt(3)
    v_mfma_f32_16x16x32_bf16 v[36:39], v[92:95], a[48:51], v[36:39]
    ds_read_b128 v[108:111], v3 offset:34816
    s_waitcnt vmcnt(7)
    v_mfma_f32_16x16x32_bf16 v[40:43], v[92:95], a[52:55], v[40:43]
    buffer_load_dwordx4 a[80:83], v6, s[4:7], s24 offen offset:1024 sc1
    s_waitcnt lgkmcnt(3)
    v_mfma_f32_16x16x32_bf16 v[44:47], v[96:99], a[48:51], v[44:47]
    ds_read_b128 v[112:115], v3 offset:35840
    v_mfma_f32_16x16x32_bf16 v[48:51], v[96:99], a[52:55], v[48:51]
    s_waitcnt lgkmcnt(3)
    v_mfma_f32_16x16x32_bf16 v[52:55], v[100:103], a[48:51], v[52:55]
    ds_read_b128 v[116:119], v3 offset:36864
    v_mfma_f32_16x16x32_bf16 v[56:59], v[100:103], a[52:55], v[56:59]
    buffer_load_dwordx4 a[84:87], v7, s[4:7], s24 offen offset:1024 sc1
    s_waitcnt lgkmcnt(3)
    v_mfma_f32_16x16x32_bf16 v[60:63], v[104:107], a[48:51], v[60:63]
    ds_read_b128 v[120:123], v3 offset:37888
    v_mfma_f32_16x16x32_bf16 v[64:67], v[104:107], a[52:55], v[64:67]
    s_waitcnt vmcnt(8) lgkmcnt(3)
    v_mfma_f32_16x16x32_bf16 v[36:39], v[108:111], a[56:59], v[36:39]
    s_add_u32 s52, s39, 3
    s_waitcnt vmcnt(6)
    v_cmp_ne_u32 vcc, s52, v14
    s_nop 4
    s_cbranch_vccz L_ok_1035
    s_mov_b32 s60, 0
L_lp_1034:
    v_and_b32 v15, 63, v2
    buffer_load_dword v14, v15, s[4:7], s41 offen sc1
    s_add_u32 s60, s60, 1
    s_cmp_gt_u32 s60, 0x40000
    s_cbranch_scc1 L_abort
    s_waitcnt vmcnt(0)
    v_cmp_ne_u32 vcc, s52, v14
    s_nop 1
    s_cbranch_vccnz L_lp_1034
L_ok_1035:
    v_mfma_f32_16x16x32_bf16 v[40:43], v[108:111], a[60:63], v[40:43]
    ds_read_b128 v[92:95], v3 offset:38912
    s_waitcnt lgkmcnt(3)
    v_mfma_f32_16x16x32_bf16 v[44:47], v[112:115], a[56:59], v[44:47]
    ds_read_b128 v[96:99], v3 offset:39936
    buffer_load_dwordx4 a[88:91], v6, s[4:7], s24 offen offset:2048 sc1
    v_mfma_f32_16x16x32_bf16 v[48:51], v[112:115], a[60:63], v[48:51]
    ds_read_b128 v[100:103], v3 offset:40960
    s_waitcnt lgkmcnt(4)
    v_mfma_f32_16x16x32_bf16 v[52:55], v[116:119], a[56:59], v[52:55]
    ds_read_b128 v[104:107], v3 offset:41984
    v_mfma_f32_16x16x32_bf16 v[56:59], v[116:119], a[60:63], v[56:59]
    buffer_load_dwordx4 a[92:95], v7, s[4:7], s24 offen offset:2048 sc1
    s_waitcnt lgkmcnt(4)
    v_mfma_f32_16x16x32_bf16 v[60:63], v[120:123], a[56:59], v[60:63]
    v_mfma_f32_16x16x32_bf16 v[64:67], v[120:123], a[60:63], v[64:67]
    s_waitcnt vmcnt(7) lgkmcnt(3)
    v_mfma_f32_16x16x32_bf16 v[36:39], v[92:95], a[64:67], v[36:39]
    ds_read_b128 v[108:111], v3 offset:43008
    buffer_load_dwordx4 a[96:99], v6, s[4:7], 0 offen offset:1024 sc1
    s_waitcnt vmcnt(7)
    v_mfma_f32_16x16x32_bf16 v[40:43], v[92:95], a[68:71], v[40:43]
    s_waitcnt lgkmcnt(3)
    v_mfma_f32_16x16x32_bf16 v[44:47], v[96:99], a[64:67], v[44:47]
    ds_read_b128 v[112:115], v3 offset:44032
    buffer_load_dwordx4 a[100:103], v7, s[4:7], 0 offen offset:1024 sc1
    v_mfma_f32_16x16x32_bf16 v[48:51], v[96:99], a[68:71], v[48:51]
    s_waitcnt lgkmcnt(3)
    v_mfma_f32_16x16x32_bf16 v[52:55], v[100:103], a[64:67], v[52:55]
    ds_read_b128 v[116:119], v3 offset:45056
    buffer_load_dwordx4 v[128:131], v8, s[4:7], 0 offen offset:0 sc1
    v_mfma_f32_16x16x32_bf16 v[56:59], v[100:103], a[68:71], v[56:59]
    s_waitcnt lgkmcnt(3)
    v_mfma_f32_16x16x32_bf16 v[60:63], v[104:107], a[64:67], v[60:63]
    ds_read_b128 v[120:123], v3 offset:46080
    buffer_load_dwordx4 v[132:135], v8, s[4:7], 0 offen offset:1024 sc1
    v_mfma_f32_16x16x32_bf16 v[64:67], v[104:107], a[68:71], v[64:67]
    s_waitcnt vmcnt(9) lgkmcnt(3)
    v_mfma_f32_16x16x32_bf16 v[36:39], v[108:111], a[72:75], v[36:39]
    ds_read_b128 v[92:95], v3 offset:47104
    s_waitcnt vmcnt(8)
    v_mfma_f32_16x16x32_bf16 v[40:43], v[108:111], a[76:79], v[40:43]
    buffer_load_dwordx4 a[104:107], v6, s[4:7], s21 offen offset:0 sc1
    s_waitcnt lgkmcnt(3)
    v_mfma_f32_16x16x32_bf16 v[44:47], v[112:115], a[72:75], v[44:47]
    ds_read_b128 v[96:99], v3 offset:48128
    v_mfma_f32_16x16x32_bf16 v[48:51], v[112:115], a[76:79], v[48:51]
    s_waitcnt lgkmcnt(3)
    v_mfma_f32_16x16x32_bf16 v[52:55], v[116:119], a[72:75], v[52:55]
    ds_read_b128 v[100:103], v3 offset:49152
    v_mfma_f32_16x16x32_bf16 v[56:59], v[116:119], a[76:79], v[56:59]
    buffer_load_dwordx4 a[108:111], v7, s[4:7], s21 offen offset:0 sc1
    s_waitcnt lgkmcnt(3)
    v_mfma_f32_16x16x32_bf16 v[60:63], v[120:123], a[72:75], v[60:63]
    ds_read_b128 v[104:107], v3 offset:50176
    v_mfma_f32_16x16x32_bf16 v[64:67], v[120:123], a[76:79], v[64:67]
    s_waitcnt vmcnt(9) lgkmcnt(3)
    v_mfma_f32_16x16x32_bf16 v[36:39], v[92:95], a[80:83], v[36:39]
    ds_read_b128 v[108:111], v3 offset:51200
    buffer_load_dwordx4 a[112:115], v6, s[4:7], s21 offen offset:2048 sc1
    s_waitcnt vmcnt(9)
    v_mfma_f32_16x16x32_bf16 v[40:43], v[92:95], a[84:87], v[40:43]
    s_waitcnt lgkmcnt(3)
    v_mfma_f32_16x16x32_bf16 v[44:47], v[96:99], a[80:83], v[44:47]
    ds_read_b128 v[112:115], v3 offset:52224
    buffer_load_dwordx4 a[116:119], v7, s[4:7], s21 offen offset:2048 sc1
    v_mfma_f32_16x16x32_bf16 v[48:51], v[96:99], a[84:87], v[48:51]
    s_waitcnt lgkmcnt(3)
    v_mfma_f32_16x16x32_bf16 v[52:55], v[100:103], a[80:83], v[52:55]
    ds_read_b128 v[116:119], v3 offset:53248
    s_add_u32 s15, s97, s26
    s_add_u32 s14, s97, 0
    s_add_u32 s15, s15, 81920
    s_mov_b32 m0, s14
    s_nop 0
    buffer_load_dwordx4 v1, s[4:7], s15 offen offset:0 lds
    v_mfma_f32_16x16x32_bf16 v[56:59], v[100:103], a[84:87], v[56:59]
    s_waitcnt lgkmcnt(3)
    v_mfma_f32_16x16x32_bf16 v[60:63], v[104:107], a[80:83], v[60:63]
    ds_read_b128 v[120:123], v3 offset:54272
    buffer_load_dwordx4 v1, s[4:7], s15 offen offset:1024 lds
    v_mfma_f32_16x16x32_bf16 v[64:67], v[104:107], a[84:87], v[64:67]
    s_waitcnt vmcnt(11) lgkmcnt(3)
    v_mfma_f32_16x16x32_bf16 v[36:39], v[108:111], a[88:91], v[36:39]
    ds_read_b128 v[92:95], v3 offset:55296
    buffer_load_dwordx4 a[120:123], v6, s[4:7], s22 offen offset:1024 sc1
    s_waitcnt vmcnt(11)
    v_mfma_f32_16x16x32_bf16 v[40:43], v[108:111], a[92:95], v[40:43]
    s_waitcnt lgkmcnt(3)
    v_mfma_f32_16x16x32_bf16 v[44:47], v[112:115], a[88:91], v[44:47]
    ds_read_b128 v[96:99], v3 offset:56320
    v_mfma_f32_16x16x32_bf16 v[48:51], v[112:115], a[92:95], v[48:51]
    buffer_load_dwordx4 a[124:127], v7, s[4:7], s22 offen offset:1024 sc1
    s_waitcnt lgkmcnt(3)
    v_mfma_f32_16x16x32_bf16 v[52:55], v[116:119], a[88:91], v[52:55]
    ds_read_b128 v[100:103], v3 offset:57344
    v_mfma_f32_16x16x32_bf16 v[56:59], v[116:119], a[92:95], v[56:59]
    s_waitcnt lgkmcnt(3)
    v_mfma_f32_16x16x32_bf16 v[60:63], v[120:123], a[88:91], v[60:63]
    ds_read_b128 v[104:107], v3 offset:58368
    buffer_load_dwordx4 v1, s[4:7], s15 offen offset:2048 lds
    v_mfma_f32_16x16x32_bf16 v[64:67], v[120:123], a[92:95], v[64:67]
    s_waitcnt vmcnt(12) lgkmcnt(3)
    v_mfma_f32_16x16x32_bf16 v[36:39], v[92:95], a[96:99], v[36:39]
    ds_read_b128 v[108:111], v3 offset:59392
    buffer_load_dwordx4 a[128:131], v6, s[4:7], s22 offen offset:3072 sc1
    s_waitcnt vmcnt(11)
    v_add_f32 v128, v128, v129
    s_waitcnt vmcnt(10)
    v_add_f32 v132, v132, v133
    v_mfma_f32_16x16x32_bf16 v[40:43], v[92:95], a[100:103], v[40:43]
    v_add_f32 v130, v130, v131
    s_waitcnt lgkmcnt(3)
    v_mfma_f32_16x16x32_bf16 v[44:47], v[96:99], a[96:99], v[44:47]
    ds_read_b128 v[112:115], v3 offset:60416
    v_add_f32 v134, v134, v135
    v_mfma_f32_16x16x32_bf16 v[48:51], v[96:99], a[100:103], v[48:51]
    buffer_load_dwordx4 a[132:135], v7, s[4:7], s22 offen offset:3072 sc1
    v_add_f32 v128, v128, v130
    s_waitcnt lgkmcnt(3)
    v_mfma_f32_16x16x32_bf16 v[52:55], v[100:103], a[96:99], v[52:55]
    ds_read_b128 v[116:119], v3 offset:61440
    v_add_f32 v132, v132, v134
    v_mov_b32 v129, v128
    v_mfma_f32_16x16x32_bf16 v[56:59], v[100:103], a[100:103], v[56:59]
    v_mov_b32 v133, v132
    s_waitcnt lgkmcnt(3)
    v_mfma_f32_16x16x32_bf16 v[60:63], v[104:107], a[96:99], v[60:63]
    ds_read_b128 v[120:123], v3 offset:62464
    buffer_load_dwordx4 v1, s[4:7], s15 offen offset:3072 lds
    v_permlane16_swap_b32 v128, v129
    v_mfma_f32_16x16x32_bf16 v[64:67], v[104:107], a[100:103], v[64:67]
    v_permlane16_swap_b32 v132, v133
    s_waitcnt vmcnt(11) lgkmcnt(3)
    v_mfma_f32_16x16x32_bf16 v[36:39], v[108:111], a[104:107], v[36:39]
    ds_read_b128 v[92:95], v3 offset:63488
    buffer_load_dwordx4 a[136:139], v6, s[4:7], s23 offen offset:2048 sc1
    v_add_f32 v128, v128, v129
    v_add_f32 v132, v132, v133
    s_waitcnt vmcnt(11)
    v_mfma_f32_16x16x32_bf16 v[40:43], v[108:111], a[108:111], v[40:43]
    v_mov_b32 v129, v128
    s_waitcnt lgkmcnt(3)
    v_mfma_f32_16x16x32_bf16 v[44:47], v[112:115], a[104:107], v[44:47]
    ds_read_b128 v[96:99], v3 offset:64512
    buffer_load_dwordx4 a[140:143], v7, s[4:7], s23 offen offset:2048 sc1
    v_mov_b32 v133, v132
    v_mfma_f32_16x16x32_bf16 v[48:51], v[112:115], a[108:111], v[48:51]
    v_permlane32_swap_b32 v128, v129
    s_waitcnt lgkmcnt(3)
    v_mfma_f32_16x16x32_bf16 v[52:55], v[116:119], a[104:107], v[52:55]
    ds_read_b128 v[100:103], v4 offset:0
    s_add_u32 s15, s97, s26
    s_add_u32 s14, s97, 16384
    s_add_u32 s15, s15, 98304
    s_mov_b32 m0, s14
    s_nop 0
    buffer_load_dwordx4 v1, s[4:7], s15 offen offset:0 lds
    v_permlane32_swap_b32 v132, v133
    v_mul_f32 v128, 986500301, v128
    v_mfma_f32_16x16x32_bf16 v[56:59], v[116:119], a[108:111], v[56:59]
    v_mul_f32 v132, 986500301, v132
    s_waitcnt lgkmcnt(3)
    v_mfma_f32_16x16x32_bf16 v[60:63], v[120:123], a[104:107], v[60:63]
    ds_read_b128 v[104:107], v4 offset:1024
    buffer_load_dwordx4 v1, s[4:7], s15 offen offset:1024 lds
    v_mul_f32 v129, 986500301, v129
    v_mfma_f32_16x16x32_bf16 v[64:67], v[120:123], a[108:111], v[64:67]
    v_mul_f32 v133, 986500301, v133
    s_waitcnt vmcnt(13) lgkmcnt(3)
    v_mfma_f32_16x16x32_bf16 v[36:39], v[92:95], a[112:115], v[36:39]
    ds_read_b128 v[108:111], v4 offset:2048
    buffer_load_dwordx4 a[144:147], v6, s[4:7], s24 offen offset:0 sc1
    v_fma_f32 v129, -v128, v128, v129
    v_fma_f32 v133, -v132, v132, v133
    s_waitcnt vmcnt(13)
    v_mfma_f32_16x16x32_bf16 v[40:43], v[92:95], a[116:119], v[40:43]
    v_max_f32 v129, 0, v129
    s_waitcnt lgkmcnt(3)
    v_mfma_f32_16x16x32_bf16 v[44:47], v[96:99], a[112:115], v[44:47]
    ds_read_b128 v[112:115], v4 offset:3072
    v_max_f32 v133, 0, v133
    v_mfma_f32_16x16x32_bf16 v[48:51], v[96:99], a[116:119], v[48:51]
    buffer_load_dwordx4 a[148:151], v7, s[4:7], s24 offen offset:0 sc1
    v_add_f32 v129, 925353388, v129
    s_waitcnt lgkmcnt(3)
    v_mfma_f32_16x16x32_bf16 v[52:55], v[100:103], a[112:115], v[52:55]
    ds_read_b128 v[116:119], v4 offset:4096
    v_add_f32 v133, 925353388, v133
    v_rsq_f32 v124, v129
    v_mfma_f32_16x16x32_bf16 v[56:59], v[100:103], a[116:119], v[56:59]
    v_rsq_f32 v125, v133
    s_waitcnt lgkmcnt(3)
    v_mfma_f32_16x16x32_bf16 v[60:63], v[104:107], a[112:115], v[60:63]
    ds_read_b128 v[120:123], v4 offset:5120
    buffer_load_dwordx4 v1, s[4:7], s15 offen offset:2048 lds
    v_mul_f32_e64 v126, -v128, v124
    v_mfma_f32_16x16x32_bf16 v[64:67], v[104:107], a[116:119], v[64:67]
    v_mul_f32_e64 v127, -v132, v125
    s_waitcnt vmcnt(12) lgkmcnt(3)
    v_mfma_f32_16x16x32_bf16 v[36:39], v[108:111], a[120:123], v[36:39]
    ds_read_b128 v[92:95], v4 offset:6144
    buffer_load_dwordx4 a[152:155], v6, s[4:7], s24 offen offset:3072 sc1
    ds_read_b128 v[160:163], v12 offset:512
    s_waitcnt vmcnt(12)
    v_mfma_f32_16x16x32_bf16 v[40:43], v[108:111], a[124:127], v[40:43]
    s_waitcnt lgkmcnt(4)
    v_mfma_f32_16x16x32_bf16 v[44:47], v[112:115], a[120:123], v[44:47]
    ds_read_b128 v[96:99], v4 offset:7168
    v_mfma_f32_16x16x32_bf16 v[48:51], v[112:115], a[124:127], v[48:51]
    buffer_load_dwordx4 a[156:159], v7, s[4:7], s24 offen offset:3072 sc1
    s_waitcnt lgkmcnt(4)
    v_mfma_f32_16x16x32_bf16 v[52:55], v[116:119], a[120:123], v[52:55]
    ds_read_b128 v[100:103], v4 offset:8192
    ds_read_b128 v[164:167], v12 offset:1024
    v_mfma_f32_16x16x32_bf16 v[56:59], v[116:119], a[124:127], v[56:59]
    s_waitcnt lgkmcnt(5)
    v_mfma_f32_16x16x32_bf16 v[60:63], v[120:123], a[120:123], v[60:63]
    ds_read_b128 v[104:107], v4 offset:9216
    buffer_load_dwordx4 v1, s[4:7], s15 offen offset:3072 lds
    v_mfma_f32_16x16x32_bf16 v[64:67], v[120:123], a[124:127], v[64:67]
    s_waitcnt vmcnt(12) lgkmcnt(5)
    v_mfma_f32_16x16x32_bf16 v[36:39], v[92:95], a[128:131], v[36:39]
    ds_read_b128 v[108:111], v4 offset:10240
    s_waitcnt lgkmcnt(2)
    v_fma_f32 v128, v160, v126, v164
    v_fma_f32 v129, v161, v126, v165
    s_waitcnt vmcnt(11)
    v_mfma_f32_16x16x32_bf16 v[40:43], v[92:95], a[132:135], v[40:43]
    v_fma_f32 v130, v162, v126, v166
    s_add_u32 s15, s97, s26
    s_add_u32 s14, s97, 32768
    s_add_u32 s15, s15, 114688
    s_mov_b32 m0, s14
    s_nop 0
    buffer_load_dwordx4 v1, s[4:7], s15 offen offset:0 lds
    v_mfma_f32_16x16x32_bf16 v[44:47], v[96:99], a[128:131], v[44:47]
    ds_read_b128 v[112:115], v4 offset:11264
    v_fma_f32 v131, v163, v126, v167
    v_mfma_f32_16x16x32_bf16 v[48:51], v[96:99], a[132:135], v[48:51]
    v_fma_f32 v132, v160, v127, v164
    v_mfma_f32_16x16x32_bf16 v[52:55], v[100:103], a[128:131], v[52:55]
    ds_read_b128 v[116:119], v4 offset:12288
    v_fma_f32 v133, v161, v127, v165
    v_fma_f32 v134, v162, v127, v166
    v_mfma_f32_16x16x32_bf16 v[56:59], v[100:103], a[132:135], v[56:59]
    v_fma_f32 v135, v163, v127, v167
    buffer_load_dwordx4 v1, s[4:7], s15 offen offset:1024 lds
    s_waitcnt lgkmcnt(3)
    v_mfma_f32_16x16x32_bf16 v[60:63], v[104:107], a[128:131], v[60:63]
    ds_read_b128 v[120:123], v4 offset:13312
    ds_read_b128 v[160:163], v12 offset:576
    v_mfma_f32_16x16x32_bf16 v[64:67], v[104:107], a[132:135], v[64:67]
    ds_read_b128 v[164:167], v12 offset:1088
    s_waitcnt vmcnt(11) lgkmcnt(5)
    v_mfma_f32_16x16x32_bf16 v[36:39], v[108:111], a[136:139], v[36:39]
    ds_read_b128 v[92:95], v4 offset:14336
    s_waitcnt lgkmcnt(1)
    v_fma_f32 v136, v160, v126, v164
    v_fma_f32 v137, v161, v126, v165
    s_waitcnt vmcnt(10)
    v_mfma_f32_16x16x32_bf16 v[40:43], v[108:111], a[140:143], v[40:43]
    v_fma_f32 v138, v162, v126, v166
    v_mfma_f32_16x16x32_bf16 v[44:47], v[112:115], a[136:139], v[44:47]
    ds_read_b128 v[96:99], v4 offset:15360
    v_fma_f32 v139, v163, v126, v167
    v_mfma_f32_16x16x32_bf16 v[48:51], v[112:115], a[140:143], v[48:51]
    v_fma_f32 v140, v160, v127, v164
    buffer_load_dwordx4 v1, s[4:7], s15 offen offset:2048 lds
    v_mfma_f32_16x16x32_bf16 v[52:55], v[116:119], a[136:139], v[52:55]
    ds_read_b128 v[100:103], v4 offset:16384
    v_fma_f32 v141, v161, v127, v165
    v_fma_f32 v142, v162, v127, v166
    v_mfma_f32_16x16x32_bf16 v[56:59], v[116:119], a[140:143], v[56:59]
    v_fma_f32 v143, v163, v127, v167
    v_mfma_f32_16x16x32_bf16 v[60:63], v[120:123], a[136:139], v[60:63]
    ds_read_b128 v[104:107], v4 offset:17408
    ds_read_b128 v[160:163], v12 offset:640
    v_mfma_f32_16x16x32_bf16 v[64:67], v[120:123], a[140:143], v[64:67]
    ds_read_b128 v[164:167], v12 offset:1152
    s_waitcnt vmcnt(8) lgkmcnt(5)
    v_mfma_f32_16x16x32_bf16 v[36:39], v[92:95], a[144:147], v[36:39]
    ds_read_b128 v[108:111], v4 offset:18432
    s_waitcnt lgkmcnt(1)
    v_fma_f32 v144, v160, v126, v164
    v_fma_f32 v145, v161, v126, v165
    s_waitcnt vmcnt(7)
    v_mfma_f32_16x16x32_bf16 v[40:43], v[92:95], a[148:151], v[40:43]
    v_fma_f32 v146, v162, v126, v166
    v_mfma_f32_16x16x32_bf16 v[44:47], v[96:99], a[144:147], v[44:47]
    ds_read_b128 v[112:115], v4 offset:19456
    v_fma_f32 v147, v163, v126, v167
    v_mfma_f32_16x16x32_bf16 v[48:51], v[96:99], a[148:151], v[48:51]
    v_fma_f32 v148, v160, v127, v164
    buffer_load_dwordx4 v1, s[4:7], s15 offen offset:3072 lds
    v_mfma_f32_16x16x32_bf16 v[52:55], v[100:103], a[144:147], v[52:55]
    ds_read_b128 v[116:119], v4 offset:20480
    v_fma_f32 v149, v161, v127, v165
    v_fma_f32 v150, v162, v127, v166
    v_mfma_f32_16x16x32_bf16 v[56:59], v[100:103], a[148:151], v[56:59]
    v_fma_f32 v151, v163, v127, v167
    v_mfma_f32_16x16x32_bf16 v[60:63], v[104:107], a[144:147], v[60:63]
    ds_read_b128 v[120:123], v4 offset:21504
    ds_read_b128 v[160:163], v12 offset:704
    v_mfma_f32_16x16x32_bf16 v[64:67], v[104:107], a[148:151], v[64:67]
    ds_read_b128 v[164:167], v12 offset:1216
    s_waitcnt vmcnt(6) lgkmcnt(5)
    v_mfma_f32_16x16x32_bf16 v[36:39], v[108:111], a[152:155], v[36:39]
    s_waitcnt lgkmcnt(0)
    v_fma_f32 v152, v160, v126, v164
    s_waitcnt vmcnt(5)
    v_mfma_f32_16x16x32_bf16 v[40:43], v[108:111], a[156:159], v[40:43]
    v_fma_f32 v153, v161, v126, v165
    v_mfma_f32_16x16x32_bf16 v[44:47], v[112:115], a[152:155], v[44:47]
    v_fma_f32 v154, v162, v126, v166
    v_mfma_f32_16x16x32_bf16 v[48:51], v[112:115], a[156:159], v[48:51]
    v_fma_f32 v155, v163, v126, v167
    s_add_u32 s15, s96, s26
    s_add_u32 s14, s96, 49152
    s_add_u32 s15, s15, 131072
    s_mov_b32 m0, s14
    s_nop 0
    buffer_load_dwordx4 v1, s[4:7], s15 offen offset:0 lds
    v_mfma_f32_16x16x32_bf16 v[52:55], v[116:119], a[152:155], v[52:55]
    v_fma_f32 v156, v160, v127, v164
    v_mfma_f32_16x16x32_bf16 v[56:59], v[116:119], a[156:159], v[56:59]
    v_fma_f32 v157, v161, v127, v165
    v_mfma_f32_16x16x32_bf16 v[60:63], v[120:123], a[152:155], v[60:63]
    v_fma_f32 v158, v162, v127, v166
    v_mfma_f32_16x16x32_bf16 v[64:67], v[120:123], a[156:159], v[64:67]
    v_fma_f32 v159, v163, v127, v167
    s_waitcnt vmcnt(5)
    s_barrier
    ds_read_b128 v[92:95], v1 offset:0
    ds_read_b128 v[96:99], v1 offset:1024
    ds_read_b128 v[100:103], v1 offset:2048
    ds_read_b128 v[104:107], v1 offset:3072
    ds_read_b128 v[108:111], v1 offset:4096
    ds_read_b128 v[112:115], v1 offset:5120
    s_waitcnt lgkmcnt(3)
    v_mfma_f32_16x16x32_bf16 v[68:71], v[92:95], a[152:155], 0
    ds_read_b128 v[116:119], v1 offset:6144
    s_add_u32 s53, s35, 4096
    v_fma_f32 v36, v36, v124, v128
    v_mfma_f32_16x16x32_bf16 v[72:75], v[92:95], a[156:159], 0
    v_fma_f32 v37, v37, v124, v129
    v_fma_f32 v38, v38, v124, v130
    v_mfma_f32_16x16x32_bf16 v[76:79], v[96:99], a[152:155], 0
    ds_read_b128 v[120:123], v1 offset:7168
    v_fma_f32 v39, v39, v124, v131
    buffer_load_dwordx4 v1, s[4:7], s15 offen offset:1024 lds
    v_mfma_f32_16x16x32_bf16 v[80:83], v[96:99], a[156:159], 0
    v_max_f32 v36, 0, v36
    v_max_f32 v37, 0, v37
    v_mfma_f32_16x16x32_bf16 v[84:87], v[100:103], a[152:155], 0
    ds_read_b128 v[164:167], v1 offset:8192
    v_max_f32 v38, 0, v38
    v_max_f32 v39, 0, v39
    v_mfma_f32_16x16x32_bf16 v[88:91], v[100:103], a[156:159], 0
    v_mul_f32 v36, v36, v36
    s_waitcnt lgkmcnt(3)
    v_mfma_f32_16x16x32_bf16 v[68:71], v[104:107], a[144:147], v[68:71]
    ds_read_b128 v[92:95], v1 offset:9216
    v_mul_f32 v37, v37, v37
    v_mul_f32 v38, v38, v38
    v_mfma_f32_16x16x32_bf16 v[72:75], v[104:107], a[148:151], v[72:75]
    v_mul_f32 v39, v39, v39
    v_cvt_pk_bf16_f32 v36, v36, v37
    v_mfma_f32_16x16x32_bf16 v[76:79], v[108:111], a[144:147], v[76:79]
    ds_read_b128 v[96:99], v1 offset:10240
    v_cvt_pk_bf16_f32 v37, v38, v39
    buffer_load_dwordx4 v1, s[4:7], s15 offen offset:2048 lds
    v_mfma_f32_16x16x32_bf16 v[80:83], v[108:111], a[148:151], v[80:83]
    v_fma_f32 v44, v44, v124, v136
    v_fma_f32 v45, v45, v124, v137
    v_mfma_f32_16x16x32_bf16 v[84:87], v[112:115], a[144:147], v[84:87]
    ds_read_b128 v[100:103], v1 offset:11264
    v_fma_f32 v46, v46, v124, v138
    v_fma_f32 v47, v47, v124, v139
    v_mfma_f32_16x16x32_bf16 v[88:91], v[112:115], a[148:151], v[88:91]
    v_max_f32 v44, 0, v44
    s_waitcnt lgkmcnt(3)
    v_mfma_f32_16x16x32_bf16 v[68:71], v[116:119], a[136:139], v[68:71]
    ds_read_b128 v[104:107], v1 offset:12288
    v_max_f32 v45, 0, v45
    v_max_f32 v46, 0, v46
    v_mfma_f32_16x16x32_bf16 v[72:75], v[116:119], a[140:143], v[72:75]
    v_max_f32 v47, 0, v47
    v_mfma_f32_16x16x32_bf16 v[76:79], v[120:123], a[136:139], v[76:79]
    ds_read_b128 v[108:111], v1 offset:13312
    v_mul_f32 v44, v44, v44
    v_mul_f32 v45, v45, v45
    v_mfma_f32_16x16x32_bf16 v[80:83], v[120:123], a[140:143], v[80:83]
    v_mul_f32 v46, v46, v46
    v_mfma_f32_16x16x32_bf16 v[84:87], v[164:167], a[136:139], v[84:87]
    ds_read_b128 v[112:115], v1 offset:14336
    v_mul_f32_e64 v47, v47, v47
    v_cvt_pk_bf16_f32 v38, v44, v45
    v_mfma_f32_16x16x32_bf16 v[88:91], v[164:167], a[140:143], v[88:91]
    v_cvt_pk_bf16_f32 v39, v46, v47
    buffer_store_dwordx4 v[36:39], v1, s[4:7], s35 offen offset:0 sc1
    s_waitcnt lgkmcnt(3)
    v_mfma_f32_16x16x32_bf16 v[68:71], v[92:95], a[128:131], v[68:71]
    ds_read_b128 v[116:119], v1 offset:15360
    v_fma_f32 v40, v40, v125, v132
    v_fma_f32 v41, v41, v125, v133
    v_mfma_f32_16x16x32_bf16 v[72:75], v[92:95], a[132:135], v[72:75]
    v_fma_f32 v42, v42, v125, v134
    s_add_u32 s71, s28, 47104
    buffer_load_dwordx4 a[156:159], v1, s[4:7], s71 offen offset:0
    v_mfma_f32_16x16x32_bf16 v[76:79], v[96:99], a[128:131], v[76:79]
    ds_read_b128 v[120:123], v1 offset:16384
    v_fma_f32 v43, v43, v125, v135
    v_max_f32 v40, 0, v40
    v_mfma_f32_16x16x32_bf16 v[80:83], v[96:99], a[132:135], v[80:83]
    v_max_f32 v41, 0, v41
    v_mfma_f32_16x16x32_bf16 v[84:87], v[100:103], a[128:131], v[84:87]
    ds_read_b128 v[164:167], v1 offset:17408
    v_max_f32 v42, 0, v42
    v_max_f32 v43, 0, v43
    buffer_load_dwordx4 a[152:155], v1, s[4:7], s71 offen offset:1024
    v_mfma_f32_16x16x32_bf16 v[88:91], v[100:103], a[132:135], v[88:91]
    v_mul_f32 v40, v40, v40
    s_waitcnt lgkmcnt(3)
    v_mfma_f32_16x16x32_bf16 v[68:71], v[104:107], a[120:123], v[68:71]
    ds_read_b128 v[92:95], v1 offset:18432
    v_mul_f32 v41, v41, v41
    v_mul_f32 v42, v42, v42
    v_mfma_f32_16x16x32_bf16 v[72:75], v[104:107], a[124:127], v[72:75]
    v_mul_f32 v43, v43, v43
    v_cvt_pk_bf16_f32 v40, v40, v41
    v_mfma_f32_16x16x32_bf16 v[76:79], v[108:111], a[120:123], v[76:79]
    ds_read_b128 v[96:99], v1 offset:19456
    v_cvt_pk_bf16_f32 v41, v42, v43
    buffer_load_dwordx4 a[148:151], v1, s[4:7], s71 offen offset:2048
    v_mfma_f32_16x16x32_bf16 v[80:83], v[108:111], a[124:127], v[80:83]
    v_fma_f32 v48, v48, v125, v140
    v_fma_f32 v49, v49, v125, v141
    v_mfma_f32_16x16x32_bf16 v[84:87], v[112:115], a[120:123], v[84:87]
    ds_read_b128 v[100:103], v1 offset:20480
    v_fma_f32 v50, v50, v125, v142
    v_fma_f32 v51, v51, v125, v143
    v_mfma_f32_16x16x32_bf16 v[88:91], v[112:115], a[124:127], v[88:91]
    v_max_f32 v48, 0, v48
    s_waitcnt lgkmcnt(3)
    v_mfma_f32_16x16x32_bf16 v[68:71], v[116:119], a[112:115], v[68:71]
    ds_read_b128 v[104:107], v1 offset:21504
    v_max_f32 v49, 0, v49
    v_max_f32 v50, 0, v50
    v_mfma_f32_16x16x32_bf16 v[72:75], v[116:119], a[116:119], v[72:75]
    v_max_f32 v51, 0, v51
    v_mfma_f32_16x16x32_bf16 v[76:79], v[120:123], a[112:115], v[76:79]
    ds_read_b128 v[108:111], v1 offset:22528
    v_mul_f32 v48, v48, v48
    v_mul_f32 v49, v49, v49
    v_mfma_f32_16x16x32_bf16 v[80:83], v[120:123], a[116:119], v[80:83]
    v_mul_f32 v50, v50, v50
    v_mfma_f32_16x16x32_bf16 v[84:87], v[164:167], a[112:115], v[84:87]
    ds_read_b128 v[112:115], v1 offset:23552
    v_mul_f32_e64 v51, v51, v51
    v_cvt_pk_bf16_f32 v42, v48, v49
    v_mfma_f32_16x16x32_bf16 v[88:91], v[164:167], a[116:119], v[88:91]
    v_cvt_pk_bf16_f32 v43, v50, v51
    buffer_store_dwordx4 v[40:43], v1, s[4:7], s35 offen offset:1024 sc1
    buffer_load_dwordx4 a[144:147], v1, s[4:7], s71 offen offset:3072
    s_waitcnt lgkmcnt(3)
    v_mfma_f32_16x16x32_bf16 v[68:71], v[92:95], a[104:107], v[68:71]
    ds_read_b128 v[116:119], v1 offset:24576
    v_fma_f32 v52, v52, v124, v144
    v_fma_f32 v53, v53, v124, v145
    v_mfma_f32_16x16x32_bf16 v[72:75], v[92:95], a[108:111], v[72:75]
    v_fma_f32 v54, v54, v124, v146
    v_fma_f32 v55, v55, v124, v147
    v_mfma_f32_16x16x32_bf16 v[76:79], v[96:99], a[104:107], v[76:79]
    ds_read_b128 v[120:123], v1 offset:25600
    v_max_f32 v52, 0, v52
    s_add_u32 s71, s28, 51200
    buffer_load_dwordx4 a[140:143], v1, s[4:7], s71 offen offset:0
    v_mfma_f32_16x16x32_bf16 v[80:83], v[96:99], a[108:111], v[80:83]
    v_max_f32 v53, 0, v53
    v_max_f32 v54, 0, v54
    v_mfma_f32_16x16x32_bf16 v[84:87], v[100:103], a[104:107], v[84:87]
    ds_read_b128 v[164:167], v1 offset:26624
    v_max_f32 v55, 0, v55
    v_mul_f32 v52, v52, v52
    v_mfma_f32_16x16x32_bf16 v[88:91], v[100:103], a[108:111], v[88:91]
    v_mul_f32 v53, v53, v53
    s_waitcnt lgkmcnt(3)
    v_mfma_f32_16x16x32_bf16 v[68:71], v[104:107], a[96:99], v[68:71]
    ds_read_b128 v[92:95], v1 offset:27648
    v_mul_f32 v54, v54, v54
    v_mul_f32 v55, v55, v55
    v_mfma_f32_16x16x32_bf16 v[72:75], v[104:107], a[100:103], v[72:75]
    v_cvt_pk_bf16_f32 v52, v52, v53
    buffer_load_dwordx4 a[136:139], v1, s[4:7], s71 offen offset:1024
    v_mfma_f32_16x16x32_bf16 v[76:79], v[108:111], a[96:99], v[76:79]
    ds_read_b128 v[96:99], v1 offset:28672
    v_cvt_pk_bf16_f32 v53, v54, v55
    v_fma_f32 v60, v60, v124, v152
    v_mfma_f32_16x16x32_bf16 v[80:83], v[108:111], a[100:103], v[80:83]
    v_fma_f32 v61, v61, v124, v153
    v_mfma_f32_16x16x32_bf16 v[84:87], v[112:115], a[96:99], v[84:87]
    ds_read_b128 v[100:103], v1 offset:29696
    v_fma_f32 v62, v62, v124, v154
    v_fma_f32 v63, v63, v124, v155
    buffer_load_dwordx4 a[132:135], v1, s[4:7], s71 offen offset:2048
    v_mfma_f32_16x16x32_bf16 v[88:91], v[112:115], a[100:103], v[88:91]
    v_max_f32 v60, 0, v60
    s_waitcnt lgkmcnt(3)
    v_mfma_f32_16x16x32_bf16 v[68:71], v[116:119], a[88:91], v[68:71]
    s_waitcnt vmcnt(9)
    s_barrier
    v_mfma_f32_16x16x32_bf16 v[72:75], v[116:119], a[92:95], v[72:75]
    ds_read_b128 v[104:107], v1 offset:30720
    v_max_f32 v61, 0, v61
    v_max_f32 v62, 0, v62
    v_mfma_f32_16x16x32_bf16 v[76:79], v[120:123], a[88:91], v[76:79]
    ds_read_b128 v[108:111], v1 offset:31744
    v_max_f32 v63, 0, v63
    v_mul_f32 v60, v60, v60
    v_mfma_f32_16x16x32_bf16 v[80:83], v[120:123], a[92:95], v[80:83]
    ds_read_b128 v[112:115], v1 offset:32768
    v_mul_f32 v61, v61, v61
    v_mul_f32 v62, v62, v62
    v_mfma_f32_16x16x32_bf16 v[84:87], v[164:167], a[88:91], v[84:87]
    v_mul_f32_e64 v63, v63, v63
    v_cvt_pk_bf16_f32 v54, v60, v61
    v_mfma_f32_16x16x32_bf16 v[88:91], v[164:167], a[92:95], v[88:91]
    v_cvt_pk_bf16_f32 v55, v62, v63
    buffer_store_dwordx4 v[52:55], v1, s[4:7], s53 offen offset:0 sc1
    buffer_load_dwordx4 a[128:131], v1, s[4:7], s71 offen offset:3072
    s_waitcnt lgkmcnt(3)
    v_mfma_f32_16x16x32_bf16 v[68:71], v[92:95], a[80:83], v[68:71]
    ds_read_b128 v[116:119], v1 offset:33792
    v_fma_f32 v56, v56, v125, v148
    v_fma_f32 v57, v57, v125, v149
    v_mfma_f32_16x16x32_bf16 v[72:75], v[92:95], a[84:87], v[72:75]
    v_fma_f32 v58, v58, v125, v150
    v_fma_f32 v59, v59, v125, v151
    v_mfma_f32_16x16x32_bf16 v[76:79], v[96:99], a[80:83], v[76:79]
    ds_read_b128 v[120:123], v1 offset:34816
    v_max_f32 v56, 0, v56
    s_add_u32 s71, s28, 55296
    buffer_load_dwordx4 a[124:127], v1, s[4:7], s71 offen offset:0
    v_mfma_f32_16x16x32_bf16 v[80:83], v[96:99], a[84:87], v[80:83]
    v_max_f32 v57, 0, v57
    v_max_f32 v58, 0, v58
    v_mfma_f32_16x16x32_bf16 v[84:87], v[100:103], a[80:83], v[84:87]
    ds_read_b128 v[164:167], v1 offset:35840
    v_max_f32 v59, 0, v59
    v_mul_f32 v56, v56, v56
    v_mfma_f32_16x16x32_bf16 v[88:91], v[100:103], a[84:87], v[88:91]
    v_mul_f32 v57, v57, v57
    s_waitcnt lgkmcnt(3)
    v_mfma_f32_16x16x32_bf16 v[68:71], v[104:107], a[72:75], v[68:71]
    ds_read_b128 v[92:95], v1 offset:36864
    v_mul_f32 v58, v58, v58
    v_mul_f32 v59, v59, v59
    v_mfma_f32_16x16x32_bf16 v[72:75], v[104:107], a[76:79], v[72:75]
    v_cvt_pk_bf16_f32 v56, v56, v57
    v_cvt_pk_bf16_f32 v57, v58, v59
    v_mfma_f32_16x16x32_bf16 v[76:79], v[108:111], a[72:75], v[76:79]
    ds_read_b128 v[96:99], v1 offset:37888
    v_fma_f32 v64, v64, v125, v156
    buffer_load_dwordx4 a[120:123], v1, s[4:7], s71 offen offset:1024
    v_mfma_f32_16x16x32_bf16 v[80:83], v[108:111], a[76:79], v[80:83]
    v_fma_f32 v65, v65, v125, v157
    v_fma_f32 v66, v66, v125, v158
    v_mfma_f32_16x16x32_bf16 v[84:87], v[112:115], a[72:75], v[84:87]
    ds_read_b128 v[100:103], v1 offset:38912
    v_fma_f32 v67, v67, v125, v159
    v_max_f32 v64, 0, v64
    v_mfma_f32_16x16x32_bf16 v[88:91], v[112:115], a[76:79], v[88:91]
    v_max_f32 v65, 0, v65
    s_waitcnt lgkmcnt(3)
    v_mfma_f32_16x16x32_bf16 v[68:71], v[116:119], a[64:67], v[68:71]
    ds_read_b128 v[104:107], v1 offset:39936
    v_max_f32 v66, 0, v66
    v_max_f32 v67, 0, v67
    v_mfma_f32_16x16x32_bf16 v[72:75], v[116:119], a[68:71], v[72:75]
    v_mul_f32 v64, v64, v64
    v_mfma_f32_16x16x32_bf16 v[76:79], v[120:123], a[64:67], v[76:79]
    ds_read_b128 v[108:111], v1 offset:40960
    v_mul_f32 v65, v65, v65
    v_mfma_f32_16x16x32_bf16 v[80:83], v[120:123], a[68:71], v[80:83]
    v_mul_f32 v66, v66, v66
    v_mul_f32_e64 v67, v67, v67
    v_mfma_f32_16x16x32_bf16 v[84:87], v[164:167], a[64:67], v[84:87]
    ds_read_b128 v[112:115], v1 offset:41984
    v_cvt_pk_bf16_f32 v58, v64, v65
    v_mfma_f32_16x16x32_bf16 v[88:91], v[164:167], a[68:71], v[88:91]
    v_cvt_pk_bf16_f32 v59, v66, v67
    buffer_store_dwordx4 v[56:59], v1, s[4:7], s53 offen offset:1024 sc1
    buffer_load_dwordx4 a[116:119], v1, s[4:7], s71 offen offset:2048
    buffer_load_dwordx4 a[112:115], v1, s[4:7], s71 offen offset:3072
    s_waitcnt lgkmcnt(3)
    v_mfma_f32_16x16x32_bf16 v[68:71], v[92:95], a[56:59], v[68:71]
    ds_read_b128 v[116:119], v1 offset:43008
    v_mfma_f32_16x16x32_bf16 v[72:75], v[92:95], a[60:63], v[72:75]
    v_mfma_f32_16x16x32_bf16 v[76:79], v[96:99], a[56:59], v[76:79]
    ds_read_b128 v[120:123], v1 offset:44032
    s_add_u32 s71, s28, 59392
    buffer_load_dwordx4 a[108:111], v1, s[4:7], s71 offen offset:0
    v_mfma_f32_16x16x32_bf16 v[80:83], v[96:99], a[60:63], v[80:83]
    v_mfma_f32_16x16x32_bf16 v[84:87], v[100:103], a[56:59], v[84:87]
    ds_read_b128 v[164:167], v1 offset:45056
    v_mfma_f32_16x16x32_bf16 v[88:91], v[100:103], a[60:63], v[88:91]
    s_waitcnt lgkmcnt(3)
    v_mfma_f32_16x16x32_bf16 v[68:71], v[104:107], a[48:51], v[68:71]
    ds_read_b128 v[92:95], v1 offset:46080
    v_mfma_f32_16x16x32_bf16 v[72:75], v[104:107], a[52:55], v[72:75]
    v_mfma_f32_16x16x32_bf16 v[76:79], v[108:111], a[48:51], v[76:79]
    ds_read_b128 v[96:99], v1 offset:47104
    buffer_load_dwordx4 a[104:107], v1, s[4:7], s71 offen offset:1024
    v_mfma_f32_16x16x32_bf16 v[80:83], v[108:111], a[52:55], v[80:83]
    v_mfma_f32_16x16x32_bf16 v[84:87], v[112:115], a[48:51], v[84:87]
    ds_read_b128 v[100:103], v1 offset:48128
    v_mfma_f32_16x16x32_bf16 v[88:91], v[112:115], a[52:55], v[88:91]
    s_waitcnt lgkmcnt(3)
    v_mfma_f32_16x16x32_bf16 v[68:71], v[116:119], a[40:43], v[68:71]
    ds_read_b128 v[104:107], v1 offset:49152
    v_mfma_f32_16x16x32_bf16 v[72:75], v[116:119], a[44:47], v[72:75]
    v_mfma_f32_16x16x32_bf16 v[76:79], v[120:123], a[40:43], v[76:79]
    ds_read_b128 v[108:111], v1 offset:50176
    buffer_load_dwordx4 a[100:103], v1, s[4:7], s71 offen offset:2048
    v_mfma_f32_16x16x32_bf16 v[80:83], v[120:123], a[44:47], v[80:83]
    v_mfma_f32_16x16x32_bf16 v[84:87], v[164:167], a[40:43], v[84:87]
    ds_read_b128 v[112:115], v1 offset:51200
    v_mfma_f32_16x16x32_bf16 v[88:91], v[164:167], a[44:47], v[88:91]
    s_waitcnt lgkmcnt(3)
    v_mfma_f32_16x16x32_bf16 v[68:71], v[92:95], a[32:35], v[68:71]
    ds_read_b128 v[116:119], v1 offset:52224
    v_mfma_f32_16x16x32_bf16 v[72:75], v[92:95], a[36:39], v[72:75]
    buffer_load_dwordx4 a[96:99], v1, s[4:7], s71 offen offset:3072
    v_mfma_f32_16x16x32_bf16 v[76:79], v[96:99], a[32:35], v[76:79]
    ds_read_b128 v[120:123], v1 offset:53248
    v_mfma_f32_16x16x32_bf16 v[80:83], v[96:99], a[36:39], v[80:83]
    v_mfma_f32_16x16x32_bf16 v[84:87], v[100:103], a[32:35], v[84:87]
    ds_read_b128 v[164:167], v1 offset:54272
    s_add_u32 s71, s28, 63488
    buffer_load_dwordx4 a[92:95], v1, s[4:7], s71 offen offset:0
    v_mfma_f32_16x16x32_bf16 v[88:91], v[100:103], a[36:39], v[88:91]
    s_waitcnt lgkmcnt(3)
    v_mfma_f32_16x16x32_bf16 v[68:71], v[104:107], a[24:27], v[68:71]
    ds_read_b128 v[92:95], v1 offset:55296
    v_mfma_f32_16x16x32_bf16 v[72:75], v[104:107], a[28:31], v[72:75]
    v_mfma_f32_16x16x32_bf16 v[76:79], v[108:111], a[24:27], v[76:79]
    ds_read_b128 v[96:99], v1 offset:56320
    buffer_load_dwordx4 a[88:91], v1, s[4:7], s71 offen offset:1024
    v_mfma_f32_16x16x32_bf16 v[80:83], v[108:111], a[28:31], v[80:83]
    v_mfma_f32_16x16x32_bf16 v[84:87], v[112:115], a[24:27], v[84:87]
    ds_read_b128 v[100:103], v1 offset:57344
    v_mfma_f32_16x16x32_bf16 v[88:91], v[112:115], a[28:31], v[88:91]
    s_waitcnt lgkmcnt(3)
    v_mfma_f32_16x16x32_bf16 v[68:71], v[116:119], a[16:19], v[68:71]
    ds_read_b128 v[104:107], v1 offset:58368
    ds_read_b128 v[144:147], v12 offset:768
    v_mfma_f32_16x16x32_bf16 v[72:75], v[116:119], a[20:23], v[72:75]
    v_mfma_f32_16x16x32_bf16 v[76:79], v[120:123], a[16:19], v[76:79]
    ds_read_b128 v[108:111], v1 offset:59392
    buffer_load_dwordx4 a[84:87], v1, s[4:7], s71 offen offset:2048
    v_mfma_f32_16x16x32_bf16 v[80:83], v[120:123], a[20:23], v[80:83]
    ds_read_b128 v[148:151], v12 offset:1280
    v_mfma_f32_16x16x32_bf16 v[84:87], v[164:167], a[16:19], v[84:87]
    ds_read_b128 v[112:115], v1 offset:60416
    v_mfma_f32_16x16x32_bf16 v[88:91], v[164:167], a[20:23], v[88:91]
    s_waitcnt lgkmcnt(5)
    v_mfma_f32_16x16x32_bf16 v[68:71], v[92:95], a[8:11], v[68:71]
    ds_read_b128 v[152:155], v12 offset:832
    v_mfma_f32_16x16x32_bf16 v[72:75], v[92:95], a[12:15], v[72:75]
    s_add_u32 s3, s39, 2
    v_mov_b32 v15, s3
    s_add_u32 s3, s44, 4096
    s_waitcnt vmcnt(9)
    s_mov_b64 exec, 1
    buffer_store_dword v15, off, s[4:7], s3 sc1
    s_mov_b64 exec, -1
    v_mfma_f32_16x16x32_bf16 v[76:79], v[96:99], a[8:11], v[76:79]
    v_mfma_f32_16x16x32_bf16 v[80:83], v[96:99], a[12:15], v[80:83]
    ds_read_b128 v[156:159], v12 offset:1344
    v_mfma_f32_16x16x32_bf16 v[84:87], v[100:103], a[8:11], v[84:87]
    buffer_load_dwordx4 a[80:83], v1, s[4:7], s71 offen offset:3072
    v_mfma_f32_16x16x32_bf16 v[88:91], v[100:103], a[12:15], v[88:91]
    s_waitcnt lgkmcnt(2)
    v_mfma_f32_16x16x32_bf16 v[68:71], v[104:107], a[0:3], v[68:71]
    ds_read_b128 v[136:139], v12 offset:896
    v_mfma_f32_16x16x32_bf16 v[72:75], v[104:107], a[4:7], v[72:75]
    v_mfma_f32_16x16x32_bf16 v[76:79], v[108:111], a[0:3], v[76:79]
    v_mfma_f32_16x16x32_bf16 v[80:83], v[108:111], a[4:7], v[80:83]
    ds_read_b128 v[140:143], v12 offset:1408
    v_mfma_f32_16x16x32_bf16 v[84:87], v[112:115], a[0:3], v[84:87]
    v_mfma_f32_16x16x32_bf16 v[88:91], v[112:115], a[4:7], v[88:91]
    v_pk_fma_f32 v[128:129], v[144:145], v[126:127], v[148:149] op_sel:[0,0,0] op_sel_hi:[1,0,1]
    v_pk_fma_f32 v[130:131], v[146:147], v[126:127], v[150:151] op_sel:[0,0,0] op_sel_hi:[1,0,1]
    v_pk_fma_f32 v[68:69], v[68:69], v[124:125], v[128:129] op_sel:[0,0,0] op_sel_hi:[1,0,1]
    v_pk_fma_f32 v[70:71], v[70:71], v[124:125], v[130:131] op_sel:[0,0,0] op_sel_hi:[1,0,1]
    v_max_f32 v68, 0, v68
    v_max_f32 v69, 0, v69
    v_max_f32 v70, 0, v70
    v_max_f32_e64 v71, 0, v71
    v_pk_mul_f32 v[68:69], v[68:69], v[68:69] op_sel:[0,0] op_sel_hi:[1,1]
    v_pk_mul_f32 v[70:71], v[70:71], v[70:71] op_sel:[0,0] op_sel_hi:[1,1]
    v_cvt_pk_bf16_f32 v68, v68, v69
    v_cvt_pk_bf16_f32 v69, v70, v71
    s_waitcnt lgkmcnt(2)
    v_pk_fma_f32 v[128:129], v[152:153], v[126:127], v[156:157] op_sel:[0,0,0] op_sel_hi:[1,0,1]
    v_pk_fma_f32 v[130:131], v[154:155], v[126:127], v[158:159] op_sel:[0,0,0] op_sel_hi:[1,0,1]
    v_pk_fma_f32 v[76:77], v[76:77], v[124:125], v[128:129] op_sel:[0,0,0] op_sel_hi:[1,0,1]
    v_pk_fma_f32 v[78:79], v[78:79], v[124:125], v[130:131] op_sel:[0,0,0] op_sel_hi:[1,0,1]
    v_max_f32 v76, 0, v76
    v_max_f32 v77, 0, v77
    v_max_f32 v78, 0, v78
    v_max_f32_e64 v79, 0, v79
    v_pk_mul_f32 v[76:77], v[76:77], v[76:77] op_sel:[0,0] op_sel_hi:[1,1]
    v_pk_mul_f32 v[78:79], v[78:79], v[78:79] op_sel:[0,0] op_sel_hi:[1,1]
    v_cvt_pk_bf16_f32 v70, v76, v77
    v_cvt_pk_bf16_f32 v71, v78, v79
    buffer_store_dwordx4 v[68:71], v1, s[4:7], s38 offen offset:0 sc1
    v_pk_fma_f32 v[132:133], v[144:145], v[126:127], v[148:149] op_sel:[0,1,0] op_sel_hi:[1,1,1]
    v_pk_fma_f32 v[134:135], v[146:147], v[126:127], v[150:151] op_sel:[0,1,0] op_sel_hi:[1,1,1]
    v_pk_fma_f32 v[72:73], v[72:73], v[124:125], v[132:133] op_sel:[0,1,0] op_sel_hi:[1,1,1]
    v_pk_fma_f32 v[74:75], v[74:75], v[124:125], v[134:135] op_sel:[0,1,0] op_sel_hi:[1,1,1]
    v_max_f32 v72, 0, v72
    v_max_f32 v73, 0, v73
    v_max_f32 v74, 0, v74
    v_max_f32 v75, 0, v75
    v_pk_mul_f32 v[72:73], v[72:73], v[72:73] op_sel:[0,0] op_sel_hi:[1,1]
    v_pk_mul_f32 v[74:75], v[74:75], v[74:75] op_sel:[0,0] op_sel_hi:[1,1]
    v_cvt_pk_bf16_f32 v72, v72, v73
    v_cvt_pk_bf16_f32 v73, v74, v75
    v_pk_fma_f32 v[132:133], v[152:153], v[126:127], v[156:157] op_sel:[0,1,0] op_sel_hi:[1,1,1]
    v_pk_fma_f32 v[134:135], v[154:155], v[126:127], v[158:159] op_sel:[0,1,0] op_sel_hi:[1,1,1]
    v_pk_fma_f32 v[80:81], v[80:81], v[124:125], v[132:133] op_sel:[0,1,0] op_sel_hi:[1,1,1]
    v_pk_fma_f32 v[82:83], v[82:83], v[124:125], v[134:135] op_sel:[0,1,0] op_sel_hi:[1,1,1]
    v_max_f32 v80, 0, v80
    v_max_f32 v81, 0, v81
    v_max_f32 v82, 0, v82
    v_max_f32 v83, 0, v83
    v_pk_mul_f32 v[80:81], v[80:81], v[80:81] op_sel:[0,0] op_sel_hi:[1,1]
    v_pk_mul_f32 v[82:83], v[82:83], v[82:83] op_sel:[0,0] op_sel_hi:[1,1]
    v_cvt_pk_bf16_f32 v74, v80, v81
    v_cvt_pk_bf16_f32 v75, v82, v83
    buffer_store_dwordx4 v[72:75], v1, s[4:7], s38 offen offset:1024 sc1
    s_waitcnt lgkmcnt(0)
    v_pk_fma_f32 v[128:129], v[136:137], v[126:127], v[140:141] op_sel:[0,0,0] op_sel_hi:[1,0,1]
    v_pk_fma_f32 v[130:131], v[138:139], v[126:127], v[142:143] op_sel:[0,0,0] op_sel_hi:[1,0,1]
    v_pk_fma_f32 v[84:85], v[84:85], v[124:125], v[128:129] op_sel:[0,0,0] op_sel_hi:[1,0,1]
    v_pk_fma_f32 v[86:87], v[86:87], v[124:125], v[130:131] op_sel:[0,0,0] op_sel_hi:[1,0,1]
    v_max_f32 v84, 0, v84
    v_max_f32 v85, 0, v85
    v_max_f32 v86, 0, v86
    v_max_f32_e64 v87, 0, v87
    v_pk_mul_f32 v[84:85], v[84:85], v[84:85] op_sel:[0,0] op_sel_hi:[1,1]
    v_pk_mul_f32 v[86:87], v[86:87], v[86:87] op_sel:[0,0] op_sel_hi:[1,1]
    v_cvt_pk_bf16_f32 v84, v84, v85
    v_cvt_pk_bf16_f32 v85, v86, v87
    buffer_store_dwordx2 v[84:85], v28, s[4:7], s36 offen offset:0 sc1
    v_pk_fma_f32 v[132:133], v[136:137], v[126:127], v[140:141] op_sel:[0,1,0] op_sel_hi:[1,1,1]
    v_pk_fma_f32 v[134:135], v[138:139], v[126:127], v[142:143] op_sel:[0,1,0] op_sel_hi:[1,1,1]
    v_pk_fma_f32 v[88:89], v[88:89], v[124:125], v[132:133] op_sel:[0,1,0] op_sel_hi:[1,1,1]
    v_pk_fma_f32 v[90:91], v[90:91], v[124:125], v[134:135] op_sel:[0,1,0] op_sel_hi:[1,1,1]
    v_max_f32 v88, 0, v88
    v_max_f32 v89, 0, v89
    v_max_f32 v90, 0, v90
    v_max_f32 v91, 0, v91
    v_pk_mul_f32 v[88:89], v[88:89], v[88:89] op_sel:[0,0] op_sel_hi:[1,1]
    v_pk_mul_f32 v[90:91], v[90:91], v[90:91] op_sel:[0,0] op_sel_hi:[1,1]
    v_cvt_pk_bf16_f32 v88, v88, v89
    v_cvt_pk_bf16_f32 v89, v90, v91
    buffer_store_dwordx2 v[88:89], v28, s[4:7], s36 offen offset:1024 sc1
    v_and_b32 v15, 127, v2
    v_add_u32 v15, 4096, v15
    buffer_load_dword v14, v15, s[4:7], s45 offen sc1
    s_add_u32 s71, s28, 67584
    buffer_load_dwordx4 v[148:151], v1, s[4:7], s71 offen offset:0
    buffer_load_dwordx4 v[152:155], v1, s[4:7], s71 offen offset:1024
    buffer_load_dwordx4 v[156:159], v1, s[4:7], s71 offen offset:2048
    buffer_load_dwordx4 v[160:163], v1, s[4:7], s71 offen offset:3072
    s_add_u32 s3, s16, 1
    s_and_b32 s3, s3, 3
    s_lshl_b32 s3, s3, 10
    v_add_u32 v144, s3, v1
    s_add_u32 s3, s16, 2
    s_and_b32 s3, s3, 3
    s_lshl_b32 s3, s3, 10
    v_add_u32 v145, s3, v1
    s_add_u32 s3, s16, 3
    s_and_b32 s3, s3, 3
    s_lshl_b32 s3, s3, 10
    v_add_u32 v146, s3, v1
    s_add_u32 s3, s16, 4
    s_and_b32 s3, s3, 3
    s_lshl_b32 s3, s3, 10
    v_add_u32 v147, s3, v1
    ds_read_b128 v[120:123], v12 offset:1536
    ds_read_b128 v[124:127], v12 offset:1600
    ds_read_b128 v[128:131], v12 offset:1664
    ds_read_b128 v[132:135], v12 offset:1728
    ds_read_b128 v[136:139], v12 offset:1792
    v_lshlrev_b32_e64 v96, 16, v16
    v_and_b32 v97, 0xffff0000, v16
    v_lshlrev_b32_e64 v98, 16, v17
    v_and_b32 v99, 0xffff0000, v17
    v_lshlrev_b32_e64 v100, 16, v18
    v_and_b32 v101, 0xffff0000, v18
    v_lshlrev_b32_e64 v102, 16, v19
    v_and_b32 v103, 0xffff0000, v19
    v_lshlrev_b32_e64 v104, 16, v20
    v_and_b32 v105, 0xffff0000, v20
    v_lshlrev_b32_e64 v106, 16, v21
    v_and_b32 v107, 0xffff0000, v21
    v_lshlrev_b32_e64 v108, 16, v22
    v_and_b32 v109, 0xffff0000, v22
    v_lshlrev_b32_e64 v110, 16, v23
    v_and_b32 v111, 0xffff0000, v23
    v_lshlrev_b32_e64 v112, 16, v24
    v_and_b32 v113, 0xffff0000, v24
    v_lshlrev_b32_e64 v114, 16, v25
    v_and_b32 v115, 0xffff0000, v25
    s_waitcnt lgkmcnt(4)
    v_pk_add_f32 v[96:97], v[96:97], v[120:121] op_sel:[0,0] op_sel_hi:[1,1]
    v_pk_add_f32 v[98:99], v[98:99], v[122:123] op_sel:[0,0] op_sel_hi:[1,1]
    s_waitcnt lgkmcnt(3)
    v_pk_add_f32 v[100:101], v[100:101], v[124:125] op_sel:[0,0] op_sel_hi:[1,1]
    v_pk_add_f32 v[102:103], v[102:103], v[126:127] op_sel:[0,0] op_sel_hi:[1,1]
    s_waitcnt lgkmcnt(2)
    v_pk_add_f32 v[104:105], v[104:105], v[128:129] op_sel:[0,0] op_sel_hi:[1,1]
    v_pk_add_f32 v[106:107], v[106:107], v[130:131] op_sel:[0,0] op_sel_hi:[1,1]
    s_waitcnt lgkmcnt(1)
    v_pk_add_f32 v[108:109], v[108:109], v[132:133] op_sel:[0,0] op_sel_hi:[1,1]
    v_pk_add_f32 v[110:111], v[110:111], v[134:135] op_sel:[0,0] op_sel_hi:[1,1]
    s_waitcnt lgkmcnt(0)
    v_pk_add_f32 v[112:113], v[112:113], v[136:137] op_sel:[0,0] op_sel_hi:[1,1]
    v_pk_add_f32 v[114:115], v[114:115], v[138:139] op_sel:[0,0] op_sel_hi:[1,1]
    s_add_u32 s52, s39, 2
    s_waitcnt vmcnt(4)
    v_cmp_ne_u32 vcc, s52, v14
    s_nop 1
    s_cbranch_vccz L_ok_1038
    s_mov_b32 s60, 0
L_lp_1037:
    v_and_b32 v15, 127, v2
    v_add_u32 v15, 4096, v15
    buffer_load_dword v14, v15, s[4:7], s45 offen sc1
    s_add_u32 s60, s60, 1
    s_cmp_gt_u32 s60, 0x40000
    s_cbranch_scc1 L_abort
    s_waitcnt vmcnt(0)
    v_cmp_ne_u32 vcc, s52, v14
    s_nop 1
    s_cbranch_vccnz L_lp_1037
L_ok_1038:
    s_lshl_b32 s53, s16, 15
    s_add_u32 s53, s53, s37
    s_add_u32 s53, s53, 90112
    buffer_load_dwordx4 a[0:3], v144, s[4:7], s53 offen sc1
    buffer_load_dwordx4 a[4:7], v145, s[4:7], s53 offen sc1
    buffer_load_dwordx4 a[8:11], v146, s[4:7], s53 offen sc1
    buffer_load_dwordx4 a[12:15], v147, s[4:7], s53 offen sc1
    s_add_u32 s53, s53, 4096
    buffer_load_dwordx4 a[16:19], v144, s[4:7], s53 offen sc1
    buffer_load_dwordx4 a[20:23], v145, s[4:7], s53 offen sc1
    buffer_load_dwordx4 a[24:27], v146, s[4:7], s53 offen sc1
    buffer_load_dwordx4 a[28:31], v147, s[4:7], s53 offen sc1
    s_waitcnt vmcnt(7)
    v_mfma_f32_16x16x32_bf16 v[36:39], v[168:171], a[0:3], 0
    v_mfma_f32_16x16x32_bf16 v[40:43], v[172:175], a[0:3], 0
    s_add_u32 s53, s53, 4096
    buffer_load_dwordx4 a[32:35], v144, s[4:7], s53 offen sc1
    v_mfma_f32_16x16x32_bf16 v[44:47], v[176:179], a[0:3], 0
    v_mfma_f32_16x16x32_bf16 v[48:51], v[180:183], a[0:3], 0
    v_mfma_f32_16x16x32_bf16 v[52:55], v[184:187], a[0:3], 0
    s_waitcnt vmcnt(7)
    v_mfma_f32_16x16x32_bf16 v[56:59], v[168:171], a[4:7], 0
    buffer_load_dwordx4 a[36:39], v145, s[4:7], s53 offen sc1
    v_mfma_f32_16x16x32_bf16 v[60:63], v[172:175], a[4:7], 0
    v_mfma_f32_16x16x32_bf16 v[64:67], v[176:179], a[4:7], 0
    v_mfma_f32_16x16x32_bf16 v[68:71], v[180:183], a[4:7], 0
    v_mfma_f32_16x16x32_bf16 v[72:75], v[184:187], a[4:7], 0
    buffer_load_dwordx4 a[40:43], v146, s[4:7], s53 offen sc1
    s_waitcnt vmcnt(8)
    v_mfma_f32_16x16x32_bf16 v[76:79], v[168:171], a[8:11], 0
    v_mfma_f32_16x16x32_bf16 v[80:83], v[172:175], a[8:11], 0
    v_mfma_f32_16x16x32_bf16 v[84:87], v[176:179], a[8:11], 0
    v_mfma_f32_16x16x32_bf16 v[88:91], v[180:183], a[8:11], 0
    buffer_load_dwordx4 a[44:47], v147, s[4:7], s53 offen sc1
    v_mfma_f32_16x16x32_bf16 v[92:95], v[184:187], a[8:11], 0
    s_waitcnt vmcnt(8)
    v_mfma_f32_16x16x32_bf16 v[96:99], v[168:171], a[12:15], v[96:99]
    v_mfma_f32_16x16x32_bf16 v[100:103], v[172:175], a[12:15], v[100:103]
    v_mfma_f32_16x16x32_bf16 v[104:107], v[176:179], a[12:15], v[104:107]
    s_add_u32 s53, s53, 4096
    buffer_load_dwordx4 a[48:51], v144, s[4:7], s53 offen sc1
    v_mfma_f32_16x16x32_bf16 v[108:111], v[180:183], a[12:15], v[108:111]
    v_mfma_f32_16x16x32_bf16 v[112:115], v[184:187], a[12:15], v[112:115]
    s_waitcnt vmcnt(8)
    v_mfma_f32_16x16x32_bf16 v[36:39], v[188:191], a[16:19], v[36:39]
    v_mfma_f32_16x16x32_bf16 v[40:43], v[192:195], a[16:19], v[40:43]
    s_add_u32 s3, s39, 2
    v_mov_b32 v15, s3
    s_mov_b64 exec, 1
    buffer_store_dword v15, off, s[4:7], s44 sc1
    s_mov_b64 exec, -1
    v_mfma_f32_16x16x32_bf16 v[44:47], v[196:199], a[16:19], v[44:47]
    v_mfma_f32_16x16x32_bf16 v[48:51], v[200:203], a[16:19], v[48:51]
    v_mfma_f32_16x16x32_bf16 v[52:55], v[204:207], a[16:19], v[52:55]
    buffer_load_dwordx4 a[52:55], v145, s[4:7], s53 offen sc1
    s_waitcnt vmcnt(9)
    v_mfma_f32_16x16x32_bf16 v[56:59], v[188:191], a[20:23], v[56:59]
    v_mfma_f32_16x16x32_bf16 v[60:63], v[192:195], a[20:23], v[60:63]
    v_mfma_f32_16x16x32_bf16 v[64:67], v[196:199], a[20:23], v[64:67]
    buffer_load_dwordx4 a[56:59], v146, s[4:7], s53 offen sc1
    v_mfma_f32_16x16x32_bf16 v[68:71], v[200:203], a[20:23], v[68:71]
    v_mfma_f32_16x16x32_bf16 v[72:75], v[204:207], a[20:23], v[72:75]
    s_waitcnt vmcnt(9)
    v_mfma_f32_16x16x32_bf16 v[76:79], v[188:191], a[24:27], v[76:79]
    v_mfma_f32_16x16x32_bf16 v[80:83], v[192:195], a[24:27], v[80:83]
    buffer_load_dwordx4 a[60:63], v147, s[4:7], s53 offen sc1
    v_mfma_f32_16x16x32_bf16 v[84:87], v[196:199], a[24:27], v[84:87]
    v_mfma_f32_16x16x32_bf16 v[88:91], v[200:203], a[24:27], v[88:91]
    v_mfma_f32_16x16x32_bf16 v[92:95], v[204:207], a[24:27], v[92:95]
    s_add_u32 s53, s53, 4096
    buffer_load_dwordx4 a[64:67], v144, s[4:7], s53 offen sc1
    s_waitcnt vmcnt(10)
    v_mfma_f32_16x16x32_bf16 v[96:99], v[188:191], a[28:31], v[96:99]
    v_mfma_f32_16x16x32_bf16 v[100:103], v[192:195], a[28:31], v[100:103]
    v_mfma_f32_16x16x32_bf16 v[104:107], v[196:199], a[28:31], v[104:107]
    buffer_load_dwordx4 a[68:71], v145, s[4:7], s53 offen sc1
    v_mfma_f32_16x16x32_bf16 v[108:111], v[200:203], a[28:31], v[108:111]
    v_mfma_f32_16x16x32_bf16 v[112:115], v[204:207], a[28:31], v[112:115]
    s_waitcnt vmcnt(10)
    v_mfma_f32_16x16x32_bf16 v[36:39], v[208:211], a[32:35], v[36:39]
    v_mfma_f32_16x16x32_bf16 v[40:43], v[212:215], a[32:35], v[40:43]
    buffer_load_dwordx4 a[72:75], v146, s[4:7], s53 offen sc1
    v_mfma_f32_16x16x32_bf16 v[44:47], v[216:219], a[32:35], v[44:47]
    v_mfma_f32_16x16x32_bf16 v[48:51], v[220:223], a[32:35], v[48:51]
    v_mfma_f32_16x16x32_bf16 v[52:55], v[224:227], a[32:35], v[52:55]
    s_waitcnt vmcnt(10)
    v_mfma_f32_16x16x32_bf16 v[56:59], v[208:211], a[36:39], v[56:59]
    buffer_load_dwordx4 a[76:79], v147, s[4:7], s53 offen sc1
    v_mfma_f32_16x16x32_bf16 v[60:63], v[212:215], a[36:39], v[60:63]
    v_mfma_f32_16x16x32_bf16 v[64:67], v[216:219], a[36:39], v[64:67]
    v_mfma_f32_16x16x32_bf16 v[68:71], v[220:223], a[36:39], v[68:71]
    v_mfma_f32_16x16x32_bf16 v[72:75], v[224:227], a[36:39], v[72:75]
    s_add_u32 s53, s53, 4096
    buffer_load_dwordx4 a[0:3], v144, s[4:7], s53 offen sc1
    s_waitcnt vmcnt(11)
    v_mfma_f32_16x16x32_bf16 v[76:79], v[208:211], a[40:43], v[76:79]
    v_mfma_f32_16x16x32_bf16 v[80:83], v[212:215], a[40:43], v[80:83]
    v_mfma_f32_16x16x32_bf16 v[84:87], v[216:219], a[40:43], v[84:87]
    v_mfma_f32_16x16x32_bf16 v[88:91], v[220:223], a[40:43], v[88:91]
    buffer_load_dwordx4 a[4:7], v145, s[4:7], s53 offen sc1
    v_mfma_f32_16x16x32_bf16 v[92:95], v[224:227], a[40:43], v[92:95]
    s_waitcnt vmcnt(11)
    v_mfma_f32_16x16x32_bf16 v[96:99], v[208:211], a[44:47], v[96:99]
    v_mfma_f32_16x16x32_bf16 v[100:103], v[212:215], a[44:47], v[100:103]
    v_mfma_f32_16x16x32_bf16 v[104:107], v[216:219], a[44:47], v[104:107]
    buffer_load_dwordx4 a[8:11], v146, s[4:7], s53 offen sc1
    v_mfma_f32_16x16x32_bf16 v[108:111], v[220:223], a[44:47], v[108:111]
    v_mfma_f32_16x16x32_bf16 v[112:115], v[224:227], a[44:47], v[112:115]
    s_waitcnt vmcnt(11)
    v_mfma_f32_16x16x32_bf16 v[36:39], v[228:231], a[48:51], v[36:39]
    v_mfma_f32_16x16x32_bf16 v[40:43], v[232:235], a[48:51], v[40:43]
    buffer_load_dwordx4 a[12:15], v147, s[4:7], s53 offen sc1
    v_mfma_f32_16x16x32_bf16 v[44:47], v[236:239], a[48:51], v[44:47]
    v_mfma_f32_16x16x32_bf16 v[48:51], v[240:243], a[48:51], v[48:51]
    v_mfma_f32_16x16x32_bf16 v[52:55], v[244:247], a[48:51], v[52:55]
    s_add_u32 s53, s53, 4096
    buffer_load_dwordx4 a[16:19], v144, s[4:7], s53 offen sc1
    s_waitcnt vmcnt(11)
    v_mfma_f32_16x16x32_bf16 v[56:59], v[228:231], a[52:55], v[56:59]
    v_mfma_f32_16x16x32_bf16 v[60:63], v[232:235], a[52:55], v[60:63]
    v_mfma_f32_16x16x32_bf16 v[64:67], v[236:239], a[52:55], v[64:67]
    buffer_load_dwordx4 a[20:23], v145, s[4:7], s53 offen sc1
    v_mfma_f32_16x16x32_bf16 v[68:71], v[240:243], a[52:55], v[68:71]
    v_mfma_f32_16x16x32_bf16 v[72:75], v[244:247], a[52:55], v[72:75]
    s_waitcnt vmcnt(11)
    v_mfma_f32_16x16x32_bf16 v[76:79], v[228:231], a[56:59], v[76:79]
    v_mfma_f32_16x16x32_bf16 v[80:83], v[232:235], a[56:59], v[80:83]
    buffer_load_dwordx4 a[24:27], v146, s[4:7], s53 offen sc1
    v_mfma_f32_16x16x32_bf16 v[84:87], v[236:239], a[56:59], v[84:87]
    v_mfma_f32_16x16x32_bf16 v[88:91], v[240:243], a[56:59], v[88:91]
    v_mfma_f32_16x16x32_bf16 v[92:95], v[244:247], a[56:59], v[92:95]
    buffer_load_dwordx4 a[28:31], v147, s[4:7], s53 offen sc1
    s_waitcnt vmcnt(12)
    v_mfma_f32_16x16x32_bf16 v[96:99], v[228:231], a[60:63], v[96:99]
    v_mfma_f32_16x16x32_bf16 v[100:103], v[232:235], a[60:63], v[100:103]
    v_mfma_f32_16x16x32_bf16 v[104:107], v[236:239], a[60:63], v[104:107]
    v_and_b32 v15, 127, v2
    buffer_load_dword v14, v15, s[4:7], s45 offen sc1
    v_mfma_f32_16x16x32_bf16 v[108:111], v[240:243], a[60:63], v[108:111]
    v_mfma_f32_16x16x32_bf16 v[112:115], v[244:247], a[60:63], v[112:115]
    s_waitcnt vmcnt(12)
    v_mfma_f32_16x16x32_bf16 v[36:39], v[248:251], a[64:67], v[36:39]
    v_mfma_f32_16x16x32_bf16 v[40:43], v[252:255], a[64:67], v[40:43]
    v_mfma_f32_16x16x32_bf16 v[44:47], a[160:163], a[64:67], v[44:47]
    s_add_u32 s53, s53, 4096
    buffer_load_dwordx4 a[32:35], v144, s[4:7], s53 offen sc1
    v_mfma_f32_16x16x32_bf16 v[48:51], a[164:167], a[64:67], v[48:51]
    v_mfma_f32_16x16x32_bf16 v[52:55], a[168:171], a[64:67], v[52:55]
    s_waitcnt vmcnt(12)
    v_mfma_f32_16x16x32_bf16 v[56:59], v[248:251], a[68:71], v[56:59]
    v_mfma_f32_16x16x32_bf16 v[60:63], v[252:255], a[68:71], v[60:63]
    v_mfma_f32_16x16x32_bf16 v[64:67], a[160:163], a[68:71], v[64:67]
    buffer_load_dwordx4 a[36:39], v145, s[4:7], s53 offen sc1
    v_mfma_f32_16x16x32_bf16 v[68:71], a[164:167], a[68:71], v[68:71]
    v_mfma_f32_16x16x32_bf16 v[72:75], a[168:171], a[68:71], v[72:75]
    s_waitcnt vmcnt(12)
    v_mfma_f32_16x16x32_bf16 v[76:79], v[248:251], a[72:75], v[76:79]
    v_mfma_f32_16x16x32_bf16 v[80:83], v[252:255], a[72:75], v[80:83]
    v_mfma_f32_16x16x32_bf16 v[84:87], a[160:163], a[72:75], v[84:87]
    buffer_load_dwordx4 a[40:43], v146, s[4:7], s53 offen sc1
    v_mfma_f32_16x16x32_bf16 v[88:91], a[164:167], a[72:75], v[88:91]
    v_mfma_f32_16x16x32_bf16 v[92:95], a[168:171], a[72:75], v[92:95]
    s_waitcnt vmcnt(12)
    v_mfma_f32_16x16x32_bf16 v[96:99], v[248:251], a[76:79], v[96:99]
    v_mfma_f32_16x16x32_bf16 v[100:103], v[252:255], a[76:79], v[100:103]
    v_mfma_f32_16x16x32_bf16 v[104:107], a[160:163], a[76:79], v[104:107]
    buffer_load_dwordx4 a[44:47], v147, s[4:7], s53 offen sc1
    v_mfma_f32_16x16x32_bf16 v[108:111], a[164:167], a[76:79], v[108:111]
    v_mfma_f32_16x16x32_bf16 v[112:115], a[168:171], a[76:79], v[112:115]
    s_waitcnt vmcnt(12)
    v_mfma_f32_16x16x32_bf16 v[36:39], a[172:175], a[0:3], v[36:39]
    s_add_u32 s52, s39, 2
    s_waitcnt vmcnt(4)
    v_cmp_ne_u32 vcc, s52, v14
    s_nop 4
    s_cbranch_vccz L_ok_1041
    s_mov_b32 s60, 0
L_lp_1040:
    v_and_b32 v15, 127, v2
    buffer_load_dword v14, v15, s[4:7], s45 offen sc1
    s_add_u32 s60, s60, 1
    s_cmp_gt_u32 s60, 0x40000
    s_cbranch_scc1 L_abort
    s_waitcnt vmcnt(0)
    v_cmp_ne_u32 vcc, s52, v14
    s_nop 1
    s_cbranch_vccnz L_lp_1040
L_ok_1041:
    v_mfma_f32_16x16x32_bf16 v[40:43], a[176:179], a[0:3], v[40:43]
    v_mfma_f32_16x16x32_bf16 v[44:47], a[180:183], a[0:3], v[44:47]
    s_lshl_b32 s53, s16, 14
    s_add_u32 s53, s53, s37
    buffer_load_dwordx4 a[48:51], v144, s[4:7], s53 offen sc1
    v_mfma_f32_16x16x32_bf16 v[48:51], a[184:187], a[0:3], v[48:51]
    v_mfma_f32_16x16x32_bf16 v[52:55], a[188:191], a[0:3], v[52:55]
    v_mfma_f32_16x16x32_bf16 v[56:59], a[172:175], a[4:7], v[56:59]
    v_mfma_f32_16x16x32_bf16 v[60:63], a[176:179], a[4:7], v[60:63]
    buffer_load_dwordx4 a[52:55], v145, s[4:7], s53 offen sc1
    v_mfma_f32_16x16x32_bf16 v[64:67], a[180:183], a[4:7], v[64:67]
    v_mfma_f32_16x16x32_bf16 v[68:71], a[184:187], a[4:7], v[68:71]
    v_mfma_f32_16x16x32_bf16 v[72:75], a[188:191], a[4:7], v[72:75]
    v_mfma_f32_16x16x32_bf16 v[76:79], a[172:175], a[8:11], v[76:79]
    buffer_load_dwordx4 a[56:59], v146, s[4:7], s53 offen sc1
    v_mfma_f32_16x16x32_bf16 v[80:83], a[176:179], a[8:11], v[80:83]
    v_mfma_f32_16x16x32_bf16 v[84:87], a[180:183], a[8:11], v[84:87]
    v_mfma_f32_16x16x32_bf16 v[88:91], a[184:187], a[8:11], v[88:91]
    buffer_load_dwordx4 a[60:63], v147, s[4:7], s53 offen sc1
    v_mfma_f32_16x16x32_bf16 v[92:95], a[188:191], a[8:11], v[92:95]
    v_mfma_f32_16x16x32_bf16 v[96:99], a[172:175], a[12:15], v[96:99]
    v_mfma_f32_16x16x32_bf16 v[100:103], a[176:179], a[12:15], v[100:103]
    v_mfma_f32_16x16x32_bf16 v[104:107], a[180:183], a[12:15], v[104:107]
    s_add_u32 s53, s53, 4096
    buffer_load_dwordx4 a[64:67], v144, s[4:7], s53 offen sc1
    v_mfma_f32_16x16x32_bf16 v[108:111], a[184:187], a[12:15], v[108:111]
    v_mfma_f32_16x16x32_bf16 v[112:115], a[188:191], a[12:15], v[112:115]
    v_mfma_f32_16x16x32_bf16 v[36:39], a[192:195], a[16:19], v[36:39]
    v_mfma_f32_16x16x32_bf16 v[40:43], a[196:199], a[16:19], v[40:43]
    buffer_load_dwordx4 a[68:71], v145, s[4:7], s53 offen sc1
    v_mfma_f32_16x16x32_bf16 v[44:47], a[200:203], a[16:19], v[44:47]
    v_mfma_f32_16x16x32_bf16 v[48:51], a[204:207], a[16:19], v[48:51]
    v_mfma_f32_16x16x32_bf16 v[52:55], a[208:211], a[16:19], v[52:55]
    v_mfma_f32_16x16x32_bf16 v[56:59], a[192:195], a[20:23], v[56:59]
    buffer_load_dwordx4 a[72:75], v146, s[4:7], s53 offen sc1
    v_mfma_f32_16x16x32_bf16 v[60:63], a[196:199], a[20:23], v[60:63]
    v_mfma_f32_16x16x32_bf16 v[64:67], a[200:203], a[20:23], v[64:67]
    v_mfma_f32_16x16x32_bf16 v[68:71], a[204:207], a[20:23], v[68:71]
    v_mfma_f32_16x16x32_bf16 v[72:75], a[208:211], a[20:23], v[72:75]
    buffer_load_dwordx4 a[76:79], v147, s[4:7], s53 offen sc1
    v_mfma_f32_16x16x32_bf16 v[76:79], a[192:195], a[24:27], v[76:79]
    v_mfma_f32_16x16x32_bf16 v[80:83], a[196:199], a[24:27], v[80:83]
    v_mfma_f32_16x16x32_bf16 v[84:87], a[200:203], a[24:27], v[84:87]
    v_mfma_f32_16x16x32_bf16 v[88:91], a[204:207], a[24:27], v[88:91]
    s_add_u32 s53, s53, 4096
    buffer_load_dwordx4 a[0:3], v144, s[4:7], s53 offen sc1
    v_mfma_f32_16x16x32_bf16 v[92:95], a[208:211], a[24:27], v[92:95]
    v_mfma_f32_16x16x32_bf16 v[96:99], a[192:195], a[28:31], v[96:99]
    v_mfma_f32_16x16x32_bf16 v[100:103], a[196:199], a[28:31], v[100:103]
    v_mfma_f32_16x16x32_bf16 v[104:107], a[200:203], a[28:31], v[104:107]
    buffer_load_dwordx4 a[4:7], v145, s[4:7], s53 offen sc1
    v_mfma_f32_16x16x32_bf16 v[108:111], a[204:207], a[28:31], v[108:111]
    v_mfma_f32_16x16x32_bf16 v[112:115], a[208:211], a[28:31], v[112:115]
    s_waitcnt vmcnt(13)
    v_mfma_f32_16x16x32_bf16 v[36:39], a[212:215], a[32:35], v[36:39]
    s_barrier
    v_mfma_f32_16x16x32_bf16 v[40:43], a[216:219], a[32:35], v[40:43]
    v_mfma_f32_16x16x32_bf16 v[44:47], a[220:223], a[32:35], v[44:47]
    buffer_load_dwordx4 a[8:11], v146, s[4:7], s53 offen sc1
    v_mfma_f32_16x16x32_bf16 v[48:51], a[224:227], a[32:35], v[48:51]
    v_mfma_f32_16x16x32_bf16 v[52:55], a[228:231], a[32:35], v[52:55]
    s_waitcnt vmcnt(13)
    v_mfma_f32_16x16x32_bf16 v[56:59], a[212:215], a[36:39], v[56:59]
    v_mfma_f32_16x16x32_bf16 v[60:63], a[216:219], a[36:39], v[60:63]
    buffer_load_dwordx4 a[12:15], v147, s[4:7], s53 offen sc1
    v_mfma_f32_16x16x32_bf16 v[64:67], a[220:223], a[36:39], v[64:67]
    v_mfma_f32_16x16x32_bf16 v[68:71], a[224:227], a[36:39], v[68:71]
    v_mfma_f32_16x16x32_bf16 v[72:75], a[228:231], a[36:39], v[72:75]
    s_waitcnt vmcnt(13)
    v_mfma_f32_16x16x32_bf16 v[76:79], a[212:215], a[40:43], v[76:79]
    s_add_u32 s53, s53, 4096
    buffer_load_dwordx4 a[16:19], v144, s[4:7], s53 offen sc1
    v_mfma_f32_16x16x32_bf16 v[80:83], a[216:219], a[40:43], v[80:83]
    v_mfma_f32_16x16x32_bf16 v[84:87], a[220:223], a[40:43], v[84:87]
    v_mfma_f32_16x16x32_bf16 v[88:91], a[224:227], a[40:43], v[88:91]
    buffer_load_dwordx4 a[20:23], v145, s[4:7], s53 offen sc1
    v_mfma_f32_16x16x32_bf16 v[92:95], a[228:231], a[40:43], v[92:95]
    s_waitcnt vmcnt(14)
    v_mfma_f32_16x16x32_bf16 v[96:99], a[212:215], a[44:47], v[96:99]
    v_mfma_f32_16x16x32_bf16 v[100:103], a[216:219], a[44:47], v[100:103]
    v_mfma_f32_16x16x32_bf16 v[104:107], a[220:223], a[44:47], v[104:107]
    buffer_load_dwordx4 a[24:27], v146, s[4:7], s53 offen sc1
    v_mfma_f32_16x16x32_bf16 v[108:111], a[224:227], a[44:47], v[108:111]
    v_mfma_f32_16x16x32_bf16 v[112:115], a[228:231], a[44:47], v[112:115]
    s_waitcnt vmcnt(14)
    v_mfma_f32_16x16x32_bf16 v[36:39], a[232:235], a[48:51], v[36:39]
    v_mfma_f32_16x16x32_bf16 v[40:43], a[236:239], a[48:51], v[40:43]
    buffer_load_dwordx4 a[28:31], v147, s[4:7], s53 offen sc1
    v_mfma_f32_16x16x32_bf16 v[44:47], a[240:243], a[48:51], v[44:47]
    v_mfma_f32_16x16x32_bf16 v[48:51], a[244:247], a[48:51], v[48:51]
    v_mfma_f32_16x16x32_bf16 v[52:55], a[248:251], a[48:51], v[52:55]
    s_waitcnt vmcnt(14)
    v_mfma_f32_16x16x32_bf16 v[56:59], a[232:235], a[52:55], v[56:59]
    s_add_u32 s53, s97, s37
    s_add_u32 s53, s53, 65536
    buffer_load_dwordx4 a[32:35], v144, s[4:7], s53 offen sc1
    v_mfma_f32_16x16x32_bf16 v[60:63], a[236:239], a[52:55], v[60:63]
    v_mfma_f32_16x16x32_bf16 v[64:67], a[240:243], a[52:55], v[64:67]
    v_mfma_f32_16x16x32_bf16 v[68:71], a[244:247], a[52:55], v[68:71]
    v_mfma_f32_16x16x32_bf16 v[72:75], a[248:251], a[52:55], v[72:75]
    buffer_load_dwordx4 a[36:39], v145, s[4:7], s53 offen sc1
    s_waitcnt vmcnt(15)
    v_mfma_f32_16x16x32_bf16 v[76:79], a[232:235], a[56:59], v[76:79]
    v_mfma_f32_16x16x32_bf16 v[80:83], a[236:239], a[56:59], v[80:83]
    v_mfma_f32_16x16x32_bf16 v[84:87], a[240:243], a[56:59], v[84:87]
    v_mfma_f32_16x16x32_bf16 v[88:91], a[244:247], a[56:59], v[88:91]
    buffer_load_dwordx4 a[40:43], v146, s[4:7], s53 offen sc1
    v_mfma_f32_16x16x32_bf16 v[92:95], a[248:251], a[56:59], v[92:95]
    s_waitcnt vmcnt(15)
    v_mfma_f32_16x16x32_bf16 v[96:99], a[232:235], a[60:63], v[96:99]
    v_mfma_f32_16x16x32_bf16 v[100:103], a[236:239], a[60:63], v[100:103]
    v_mfma_f32_16x16x32_bf16 v[104:107], a[240:243], a[60:63], v[104:107]
    buffer_load_dwordx4 a[44:47], v147, s[4:7], s53 offen sc1
    v_mfma_f32_16x16x32_bf16 v[108:111], a[244:247], a[60:63], v[108:111]
    v_mfma_f32_16x16x32_bf16 v[112:115], a[248:251], a[60:63], v[112:115]
    s_waitcnt vmcnt(15)
    v_mfma_f32_16x16x32_bf16 v[36:39], a[252:255], a[64:67], v[36:39]
    v_mfma_f32_16x16x32_bf16 v[40:43], a[156:159], a[64:67], v[40:43]
    v_mfma_f32_16x16x32_bf16 v[44:47], a[152:155], a[64:67], v[44:47]
    v_mfma_f32_16x16x32_bf16 v[48:51], a[148:151], a[64:67], v[48:51]
    v_mfma_f32_16x16x32_bf16 v[52:55], a[144:147], a[64:67], v[52:55]
    s_lshr_b32 s53, s16, 1
    s_add_u32 s53, s53, 20
    s_lshl_b32 s53, s53, 12
    s_add_u32 s53, s53, s37
    buffer_load_dwordx4 a[48:51], v144, s[4:7], s53 offen sc1
    s_waitcnt vmcnt(15)
    v_mfma_f32_16x16x32_bf16 v[56:59], a[252:255], a[68:71], v[56:59]
    v_mfma_f32_16x16x32_bf16 v[60:63], a[156:159], a[68:71], v[60:63]
    v_mfma_f32_16x16x32_bf16 v[64:67], a[152:155], a[68:71], v[64:67]
    v_mfma_f32_16x16x32_bf16 v[68:71], a[148:151], a[68:71], v[68:71]
    v_mfma_f32_16x16x32_bf16 v[72:75], a[144:147], a[68:71], v[72:75]
    s_waitcnt vmcnt(14)
    v_mfma_f32_16x16x32_bf16 v[76:79], a[252:255], a[72:75], v[76:79]
    v_mfma_f32_16x16x32_bf16 v[80:83], a[156:159], a[72:75], v[80:83]
    v_mfma_f32_16x16x32_bf16 v[84:87], a[152:155], a[72:75], v[84:87]
    v_mfma_f32_16x16x32_bf16 v[88:91], a[148:151], a[72:75], v[88:91]
    v_mfma_f32_16x16x32_bf16 v[92:95], a[144:147], a[72:75], v[92:95]
    buffer_load_dwordx4 a[56:59], v146, s[4:7], s53 offen sc1
    s_waitcnt vmcnt(14)
    v_mfma_f32_16x16x32_bf16 v[96:99], a[252:255], a[76:79], v[96:99]
    v_mfma_f32_16x16x32_bf16 v[100:103], a[156:159], a[76:79], v[100:103]
    v_mfma_f32_16x16x32_bf16 v[104:107], a[152:155], a[76:79], v[104:107]
    v_mfma_f32_16x16x32_bf16 v[108:111], a[148:151], a[76:79], v[108:111]
    v_mfma_f32_16x16x32_bf16 v[112:115], a[144:147], a[76:79], v[112:115]
    s_waitcnt vmcnt(13)
    v_mfma_f32_16x16x32_bf16 v[36:39], a[140:143], a[0:3], v[36:39]
    v_mfma_f32_16x16x32_bf16 v[40:43], a[136:139], a[0:3], v[40:43]
    v_mfma_f32_16x16x32_bf16 v[52:55], a[124:127], a[0:3], v[52:55]
    s_waitcnt vmcnt(9)
    v_mfma_f32_16x16x32_bf16 v[36:39], a[120:123], a[16:19], v[36:39]
    v_mfma_f32_16x16x32_bf16 v[40:43], a[116:119], a[16:19], v[40:43]
    v_mfma_f32_16x16x32_bf16 v[52:55], a[104:107], a[16:19], v[52:55]
    s_waitcnt vmcnt(5)
    v_mfma_f32_16x16x32_bf16 v[36:39], a[100:103], a[32:35], v[36:39]
    v_mfma_f32_16x16x32_bf16 v[40:43], a[96:99], a[32:35], v[40:43]
    v_mfma_f32_16x16x32_bf16 v[52:55], a[84:87], a[32:35], v[52:55]
    s_waitcnt vmcnt(1)
    v_mfma_f32_16x16x32_bf16 v[36:39], a[80:83], a[48:51], v[36:39]
    v_mfma_f32_16x16x32_bf16 v[40:43], v[148:151], a[48:51], v[40:43]
    v_mfma_f32_16x16x32_bf16 v[52:55], v[160:163], a[48:51], v[52:55]
    v_mfma_f32_16x16x32_bf16 v[56:59], a[140:143], a[4:7], v[56:59]
    v_mfma_f32_16x16x32_bf16 v[60:63], a[136:139], a[4:7], v[60:63]
    v_mfma_f32_16x16x32_bf16 v[72:75], a[124:127], a[4:7], v[72:75]
    v_mfma_f32_16x16x32_bf16 v[56:59], a[120:123], a[20:23], v[56:59]
    s_nop 1
    ds_write_b128 v29, v[36:39] offset:0
    v_mfma_f32_16x16x32_bf16 v[60:63], a[116:119], a[20:23], v[60:63]
    v_mfma_f32_16x16x32_bf16 v[72:75], a[104:107], a[20:23], v[72:75]
    ds_write_b128 v29, v[40:43] offset:1024
    v_mfma_f32_16x16x32_bf16 v[56:59], a[100:103], a[36:39], v[56:59]
    v_mfma_f32_16x16x32_bf16 v[60:63], a[96:99], a[36:39], v[60:63]
    ds_write_b128 v29, v[52:55] offset:4096
    v_mfma_f32_16x16x32_bf16 v[72:75], a[84:87], a[36:39], v[72:75]
    v_mfma_f32_16x16x32_bf16 v[76:79], a[140:143], a[8:11], v[76:79]
    v_mfma_f32_16x16x32_bf16 v[80:83], a[136:139], a[8:11], v[80:83]
    v_mfma_f32_16x16x32_bf16 v[92:95], a[124:127], a[8:11], v[92:95]
    v_mfma_f32_16x16x32_bf16 v[76:79], a[120:123], a[24:27], v[76:79]
    s_nop 0
    ds_write_b128 v30, v[56:59] offset:0
    v_mfma_f32_16x16x32_bf16 v[80:83], a[116:119], a[24:27], v[80:83]
    v_mfma_f32_16x16x32_bf16 v[92:95], a[104:107], a[24:27], v[92:95]
    v_mfma_f32_16x16x32_bf16 v[76:79], a[100:103], a[40:43], v[76:79]
    ds_write_b128 v30, v[60:63] offset:1024
    v_mfma_f32_16x16x32_bf16 v[80:83], a[96:99], a[40:43], v[80:83]
    v_mfma_f32_16x16x32_bf16 v[92:95], a[84:87], a[40:43], v[92:95]
    s_waitcnt vmcnt(0)
    v_mfma_f32_16x16x32_bf16 v[76:79], a[80:83], a[56:59], v[76:79]
    ds_write_b128 v30, v[72:75] offset:4096
    v_mfma_f32_16x16x32_bf16 v[80:83], v[148:151], a[56:59], v[80:83]
    v_mfma_f32_16x16x32_bf16 v[92:95], v[160:163], a[56:59], v[92:95]
    v_mfma_f32_16x16x32_bf16 v[96:99], a[140:143], a[12:15], v[96:99]
    v_mfma_f32_16x16x32_bf16 v[100:103], a[136:139], a[12:15], v[100:103]
    v_mfma_f32_16x16x32_bf16 v[112:115], a[124:127], a[12:15], v[112:115]
    v_mfma_f32_16x16x32_bf16 v[96:99], a[120:123], a[28:31], v[96:99]
    s_nop 0
    ds_write_b128 v31, v[76:79] offset:0
    v_mfma_f32_16x16x32_bf16 v[100:103], a[116:119], a[28:31], v[100:103]
    v_mfma_f32_16x16x32_bf16 v[112:115], a[104:107], a[28:31], v[112:115]
    ds_write_b128 v31, v[80:83] offset:1024
    v_mfma_f32_16x16x32_bf16 v[96:99], a[100:103], a[44:47], v[96:99]
    v_mfma_f32_16x16x32_bf16 v[100:103], a[96:99], a[44:47], v[100:103]
    ds_write_b128 v31, v[92:95] offset:4096
    v_mfma_f32_16x16x32_bf16 v[112:115], a[84:87], a[44:47], v[112:115]
    v_mfma_f32_16x16x32_bf16 v[44:47], a[132:135], a[0:3], v[44:47]
    v_mfma_f32_16x16x32_bf16 v[48:51], a[128:131], a[0:3], v[48:51]
    v_mfma_f32_16x16x32_bf16 v[44:47], a[112:115], a[16:19], v[44:47]
    s_waitcnt lgkmcnt(0)
    s_barrier
    ds_read_b128 v[36:39], v32 offset:0
    v_mfma_f32_16x16x32_bf16 v[48:51], a[108:111], a[16:19], v[48:51]
    ds_read_b128 v[56:59], v32 offset:5120
    ds_read_b128 v[76:79], v32 offset:10240
    v_mfma_f32_16x16x32_bf16 v[44:47], a[92:95], a[32:35], v[44:47]
    ds_read_b128 v[40:43], v32 offset:1024
    ds_read_b128 v[60:63], v32 offset:6144
    v_mfma_f32_16x16x32_bf16 v[48:51], a[88:91], a[32:35], v[48:51]
    ds_read_b128 v[80:83], v32 offset:11264
    ds_read_b128 v[52:55], v32 offset:4096
    v_mfma_f32_16x16x32_bf16 v[44:47], v[152:155], a[48:51], v[44:47]
    ds_read_b128 v[72:75], v32 offset:9216
    ds_read_b128 v[92:95], v32 offset:14336
    v_mfma_f32_16x16x32_bf16 v[48:51], v[156:159], a[48:51], v[48:51]
    v_lshrrev_b32 v148, 6, v2
    v_lshlrev_b32 v148, 4, v148
    v_mfma_f32_16x16x32_bf16 v[64:67], a[132:135], a[4:7], v[64:67]
    v_and_b32_e64 v149, 60, v2
    v_mul_u32_u24 v149, 320, v149
    v_mfma_f32_16x16x32_bf16 v[68:71], a[128:131], a[4:7], v[68:71]
    v_add_u32 v148, v148, v149
    s_and_b32 s3, s20, 1
    s_mul_i32 s3, s3, 4294967112
    s_add_u32 s3, s3, 128
    s_add_u32 s54, s3, s61
    v_mfma_f32_16x16x32_bf16 v[64:67], a[112:115], a[20:23], v[64:67]
    s_waitcnt lgkmcnt(8)
    v_add_f32 v96, v96, v36
    v_add_f32 v97, v97, v37
    v_mfma_f32_16x16x32_bf16 v[68:71], a[108:111], a[20:23], v[68:71]
    ds_write_b128 v29, v[44:47] offset:2048
    v_add_f32 v98, v98, v38
    v_add_f32 v99, v99, v39
    v_mfma_f32_16x16x32_bf16 v[64:67], a[92:95], a[36:39], v[64:67]
    s_waitcnt lgkmcnt(7)
    v_add_f32 v56, v56, v76
    v_add_f32 v57, v57, v77
    v_mfma_f32_16x16x32_bf16 v[68:71], a[88:91], a[36:39], v[68:71]
    ds_write_b128 v29, v[48:51] offset:3072
    v_add_f32 v58, v58, v78
    v_add_f32 v59, v59, v79
    v_mfma_f32_16x16x32_bf16 v[84:87], a[132:135], a[8:11], v[84:87]
    v_add_f32 v96, v96, v56
    v_add_f32 v97, v97, v57
    v_mfma_f32_16x16x32_bf16 v[88:91], a[128:131], a[8:11], v[88:91]
    v_add_f32 v98, v98, v58
    v_add_f32_e64 v99, v99, v59
    v_mfma_f32_16x16x32_bf16 v[84:87], a[112:115], a[24:27], v[84:87]
    v_cvt_pk_bf16_f32 v16, v96, v97
    v_cvt_pk_bf16_f32 v17, v98, v99
    v_mfma_f32_16x16x32_bf16 v[88:91], a[108:111], a[24:27], v[88:91]
    ds_write_b128 v30, v[64:67] offset:2048
    s_waitcnt lgkmcnt(8)
    v_add_f32 v100, v100, v40
    v_add_f32 v101, v101, v41
    v_mfma_f32_16x16x32_bf16 v[84:87], a[92:95], a[40:43], v[84:87]
    v_add_f32 v102, v102, v42
    v_add_f32 v103, v103, v43
    v_mfma_f32_16x16x32_bf16 v[88:91], a[88:91], a[40:43], v[88:91]
    ds_write_b128 v30, v[68:71] offset:3072
    s_waitcnt lgkmcnt(7)
    v_add_f32 v60, v60, v80
    v_add_f32 v61, v61, v81
    v_mfma_f32_16x16x32_bf16 v[84:87], v[152:155], a[56:59], v[84:87]
    v_add_f32 v62, v62, v82
    v_add_f32 v63, v63, v83
    v_mfma_f32_16x16x32_bf16 v[88:91], v[156:159], a[56:59], v[88:91]
    v_add_f32 v100, v100, v60
    v_add_f32 v101, v101, v61
    v_mfma_f32_16x16x32_bf16 v[104:107], a[132:135], a[12:15], v[104:107]
    v_add_f32 v102, v102, v62
    v_add_f32 v103, v103, v63
    v_mfma_f32_16x16x32_bf16 v[108:111], a[128:131], a[12:15], v[108:111]
    v_cvt_pk_bf16_f32 v18, v100, v101
    v_cvt_pk_bf16_f32 v19, v102, v103
    v_mfma_f32_16x16x32_bf16 v[104:107], a[112:115], a[28:31], v[104:107]
    buffer_store_dwordx4 v[16:19], v148, s[8:11], s61 offen offset:0
    s_waitcnt lgkmcnt(6)
    v_add_f32 v112, v112, v52
    v_mfma_f32_16x16x32_bf16 v[108:111], a[108:111], a[28:31], v[108:111]
    ds_write_b128 v31, v[84:87] offset:2048
    v_add_f32 v113, v113, v53
    v_add_f32 v114, v114, v54
    v_mfma_f32_16x16x32_bf16 v[104:107], a[92:95], a[44:47], v[104:107]
    v_add_f32 v115, v115, v55
    s_waitcnt lgkmcnt(5)
    v_add_f32 v72, v72, v92
    v_mfma_f32_16x16x32_bf16 v[108:111], a[88:91], a[44:47], v[108:111]
    ds_write_b128 v31, v[88:91] offset:3072
    v_add_f32 v73, v73, v93
    v_add_f32 v74, v74, v94
    v_add_f32 v75, v75, v95
    v_add_f32 v112, v112, v72
    v_add_f32 v113, v113, v73
    v_add_f32 v114, v114, v74
    v_add_f32 v115, v115, v75
    v_cvt_pk_bf16_f32 v24, v112, v113
    v_cvt_pk_bf16_f32 v25, v114, v115
    buffer_store_dwordx2 v[24:25], v148, s[8:11], s54 offen
    s_waitcnt lgkmcnt(0)
    s_barrier
    ds_read_b128 v[44:47], v32 offset:2048
    ds_read_b128 v[64:67], v32 offset:7168
    ds_read_b128 v[84:87], v32 offset:12288
    ds_read_b128 v[48:51], v32 offset:3072
    ds_read_b128 v[68:71], v32 offset:8192
    ds_read_b128 v[88:91], v32 offset:13312
    s_waitcnt lgkmcnt(5)
    v_pk_add_f32 v[104:105], v[104:105], v[44:45] op_sel:[0,0] op_sel_hi:[1,1]
    v_pk_add_f32 v[106:107], v[106:107], v[46:47] op_sel:[0,0] op_sel_hi:[1,1]
    s_waitcnt lgkmcnt(3)
    v_pk_add_f32 v[64:65], v[64:65], v[84:85] op_sel:[0,0] op_sel_hi:[1,1]
    v_pk_add_f32 v[66:67], v[66:67], v[86:87] op_sel:[0,0] op_sel_hi:[1,1]
    v_pk_add_f32 v[104:105], v[104:105], v[64:65] op_sel:[0,0] op_sel_hi:[1,1]
    v_pk_add_f32 v[106:107], v[106:107], v[66:67] op_sel:[0,0] op_sel_hi:[1,1]
    v_cvt_pk_bf16_f32 v20, v104, v105
    v_cvt_pk_bf16_f32 v21, v106, v107
    s_waitcnt lgkmcnt(2)
    v_pk_add_f32 v[108:109], v[108:109], v[48:49] op_sel:[0,0] op_sel_hi:[1,1]
    v_pk_add_f32 v[110:111], v[110:111], v[50:51] op_sel:[0,0] op_sel_hi:[1,1]
    s_waitcnt lgkmcnt(0)
    v_pk_add_f32 v[68:69], v[68:69], v[88:89] op_sel:[0,0] op_sel_hi:[1,1]
    v_pk_add_f32 v[70:71], v[70:71], v[90:91] op_sel:[0,0] op_sel_hi:[1,1]
    v_pk_add_f32 v[108:109], v[108:109], v[68:69] op_sel:[0,0] op_sel_hi:[1,1]
    v_pk_add_f32 v[110:111], v[110:111], v[70:71] op_sel:[0,0] op_sel_hi:[1,1]
    v_cvt_pk_bf16_f32 v22, v108, v109
    v_cvt_pk_bf16_f32 v23, v110, v111
    buffer_store_dwordx4 v[20:23], v148, s[8:11], s61 offen offset:64
    s_endpgm
.section .rodata,"a"
.p2align 6
.amdhsa_kernel interleave_layers__linear_attn_block__dense_activation_squared_relu__prompt_kernel
  .amdhsa_next_free_vgpr 512
  .amdhsa_next_free_sgpr 102
  .amdhsa_accum_offset 256
  .amdhsa_group_segment_fixed_size 0
  .amdhsa_kernarg_size 88
  .amdhsa_user_sgpr_count 2
  .amdhsa_user_sgpr_kernarg_segment_ptr 1
  .amdhsa_system_sgpr_workgroup_id_x 1
  .amdhsa_float_denorm_mode_32 3
.end_amdhsa_kernel
```
